```python
import torch

def _softmax(x, axis=-1):
    return torch.softmax(x, dim=axis)

def _gelu(x):
    return torch.nn.functional.gelu(x, approximate='tanh')

def _silu(x):
    return torch.nn.functional.silu(x)

def _sigmoid(x):
    return torch.sigmoid(x)

def _layernorm(x, axis=-1, eps=1e-05):
    m = x.mean(dim=axis, keepdim=True)
    v = x.var(dim=axis, keepdim=True, unbiased=False)
    return (x - m) / torch.sqrt(v + eps)

def _scatter_add(tgt, idx, src, axis=0):
    return tgt.clone().index_add_(axis, idx, src)

def _segment_sum(src, seg, n):
    out = torch.zeros((n,) + src.shape[1:], dtype=src.dtype)
    return out.index_add_(0, seg, src)

def _pad(x, pw):
    flat = tuple((v for pair in reversed(pw) for v in pair))
    return torch.nn.functional.pad(x, flat)
kernel_name = 'adaLN_cond__mha_block_cached__mixer_channel_mlp__prompt'

def setup_inputs():

    _w = lambda a: (lambda t: t.to(torch.bfloat16) if t.is_floating_point() else t)(torch.as_tensor(a))

    def _A_setup():
        B, Sq, D = (1, 2048, 1024)
        H, Sk, Dh = (32, 2048, 128)
        return {'x': _w((lambda *s: torch.randn(*s, dtype=torch.bfloat16) * 0.05)(B, Sq, D)), 'k_cache': _w((lambda *s: torch.randn(*s, dtype=torch.bfloat16) * 3.2)(B, H, Sk, Dh)), 'v_cache': _w((lambda *s: torch.randn(*s, dtype=torch.bfloat16) * 0.4)(B, H, Sk, Dh)), 'wq': _w((lambda *s: torch.randn(*s, dtype=torch.bfloat16) * 3.2)(D, H * Dh) * D ** (-0.5)), 'wo': _w((lambda *s: torch.randn(*s, dtype=torch.bfloat16) * 0.4)(H * Dh, D) * (H * Dh) ** (-0.5))}
    _A_in = _A_setup()

    def _B_setup():
        B, S, D, F = (1, 2048, 1024, 3584)
        return {'x': _w((lambda *s: torch.randn(*s, dtype=torch.bfloat16) * 0.05)(B, S, D)), 'w1': _w((lambda *s: torch.randn(*s, dtype=torch.bfloat16) * 3.2)(D, F) * D ** (-0.5)), 'b1': _w((lambda *s: torch.randn(*s, dtype=torch.bfloat16) * 1.6)(F)), 'w2': _w((lambda *s: torch.randn(*s, dtype=torch.bfloat16) * 0.1)(F, D) * F ** (-0.5)), 'b2': _w((lambda *s: torch.randn(*s, dtype=torch.bfloat16) * 0.2)(D))}
    _B_in = _B_setup()
    return {'A_x': _A_in['x'], 'A_k_cache': _A_in['k_cache'], 'A_v_cache': _A_in['v_cache'], 'A_wq': _A_in['wq'], 'A_wo': _A_in['wo'], 'B_x': _B_in['x'], 'B_w1': _B_in['w1'], 'B_b1': _B_in['b1'], 'B_w2': _B_in['w2'], 'B_b2': _B_in['b2'], 'c': _w((lambda *s: torch.randn(*s, dtype=torch.bfloat16) * 0.1)(1, 1024) * 8.0), 'w_mod': _w((lambda *s: torch.randn(*s, dtype=torch.bfloat16) * 0.1)(1024, 6 * 1024) * 1024 ** (-0.5) * 8.0)}

def reference(A_x, A_k_cache, A_v_cache, A_wq, A_wo, B_x, B_w1, B_b1, B_w2, B_b2, c, w_mod):

    def _A_ref(x, k_cache, v_cache, wq, wo):
        B, Sq, D = x.shape
        H, Dh = (32, 128)
        q = (lambda x, *d: x.permute(*d))((x @ wq).reshape(B, Sq, H, Dh), 0, 2, 1, 3)
        scores = torch.einsum('bhqd,bhkd->bhqk', q, k_cache) * Dh ** (-0.5)
        p = _softmax(scores, axis=-1)
        o = torch.einsum('bhqk,bhkd->bhqd', p, v_cache)
        return (lambda x, *d: x.permute(*d))(o, 0, 2, 1, 3).reshape(B, Sq, H * Dh) @ wo

    def _B_ref(x, w1, b1, w2, b2):
        y = _layernorm(x, axis=-1)
        h = _gelu(torch.einsum('bsd,df->bsf', y, w1) + b1)
        return torch.einsum('bsf,fd->bsd', h, w2) + b2
    x = A_x
    mod = (_silu(c) @ w_mod).reshape(c.shape[0], 6, 1, -1)
    sa, ca, ga, sb, cb, gb = (mod[:, 0].clone(), mod[:, 1].clone(), mod[:, 2].clone(), mod[:, 3].clone(), mod[:, 4].clone(), mod[:, 5].clone())
    h = _layernorm(x, axis=-1) * (1 + ca) + sa
    x = x + ga * _A_ref(h, A_k_cache, A_v_cache, A_wq, A_wo)
    h = _layernorm(x, axis=-1) * (1 + cb) + sb
    x = x + gb * _B_ref(h, B_w1, B_b1, B_w2, B_b2)
    return x
```

```asm
; @launch grid=(256,1,1) block=(256,1,1) lds=163840
.amdgcn_target "amdgcn-amd-amdhsa--gfx950"
.macro mm a:vararg
v_mfma_f32_16x16x32_bf16 \a
.endm
.macro tr a:vararg
ds_read_b64_tr_b16 \a
.endm
.macro bl a:vararg
buffer_load_dwordx4 \a
.endm
.macro ar a:vararg
v_accvgpr_read_b32 \a
.endm
.macro aw a:vararg
v_accvgpr_write_b32 \a
.endm
.macro cv a:vararg
v_cvt_pk_bf16_f32 \a
.endm
.text
attn_slow_0:
s_nop 15
s_add_u32 s62,s62,1
v_max3_f32 v204,v0,v1,v2
v_max3_f32 v204,v3,v16,v204
v_max3_f32 v204,v17,v18,v204
v_max3_f32 v204,v19,v32,v204
v_max3_f32 v204,v33,v34,v204
v_max3_f32 v204,v35,v48,v204
v_max3_f32 v204,v49,v50,v204
v_max_f32 v204,v51,v204
v_max3_f32 v205,v4,v5,v6
v_max3_f32 v205,v7,v20,v205
v_max3_f32 v205,v21,v22,v205
v_max3_f32 v205,v23,v36,v205
v_max3_f32 v205,v37,v38,v205
v_max3_f32 v205,v39,v52,v205
v_max3_f32 v205,v53,v54,v205
v_max_f32 v205,v55,v205
v_max3_f32 v206,v8,v9,v10
v_max3_f32 v206,v11,v24,v206
v_max3_f32 v206,v25,v26,v206
v_max3_f32 v206,v27,v40,v206
v_max3_f32 v206,v41,v42,v206
v_max3_f32 v206,v43,v56,v206
v_max3_f32 v206,v57,v58,v206
v_max_f32 v206,v59,v206
v_max3_f32 v207,v12,v13,v14
v_max3_f32 v207,v15,v28,v207
v_max3_f32 v207,v29,v30,v207
v_max3_f32 v207,v31,v44,v207
v_max3_f32 v207,v45,v46,v207
v_max3_f32 v207,v47,v60,v207
v_max3_f32 v207,v61,v62,v207
v_max_f32 v207,v63,v207
v_mov_b32 v208,v204
v_mov_b32 v209,v205
v_mov_b32 v210,v206
v_mov_b32 v211,v207
v_permlane16_swap_b32 v208,v204
v_permlane16_swap_b32 v209,v205
v_permlane16_swap_b32 v210,v206
v_permlane16_swap_b32 v211,v207
v_max_f32 v204,v204,v208
v_max_f32 v205,v205,v209
v_max_f32 v206,v206,v210
v_max_f32 v207,v207,v211
v_mov_b32 v208,v204
v_mov_b32 v209,v205
v_mov_b32 v210,v206
v_mov_b32 v211,v207
v_permlane32_swap_b32 v208,v204
v_permlane32_swap_b32 v209,v205
v_permlane32_swap_b32 v210,v206
v_permlane32_swap_b32 v211,v207
v_max_f32 v204,v204,v208
v_max_f32 v205,v205,v209
v_max_f32 v206,v206,v210
v_max_f32 v207,v207,v211
v_add_f32 v204,0x42b40000,v204
v_max_f32 v204,0,v204
v_add_f32 v205,0x42b40000,v205
v_max_f32 v205,0,v205
v_add_f32 v206,0x42b40000,v206
v_max_f32 v206,0,v206
v_add_f32 v207,0x42b40000,v207
v_max_f32 v207,0,v207
v_exp_f32 v212,-v204
v_exp_f32 v213,-v205
v_exp_f32 v214,-v206
v_exp_f32 v215,-v207
v_sub_f32 v160,v160,v204
v_sub_f32 v161,v161,v204
v_sub_f32 v162,v162,v204
v_sub_f32 v163,v163,v204
v_sub_f32 v0,v0,v204
v_sub_f32 v1,v1,v204
v_sub_f32 v2,v2,v204
v_sub_f32 v3,v3,v204
v_sub_f32 v16,v16,v204
v_sub_f32 v17,v17,v204
v_sub_f32 v18,v18,v204
v_sub_f32 v19,v19,v204
v_sub_f32 v32,v32,v204
v_sub_f32 v33,v33,v204
v_sub_f32 v34,v34,v204
v_sub_f32 v35,v35,v204
v_sub_f32 v48,v48,v204
v_sub_f32 v49,v49,v204
v_sub_f32 v50,v50,v204
v_sub_f32 v51,v51,v204
v_sub_f32 v64,v64,v204
v_sub_f32 v65,v65,v204
v_sub_f32 v66,v66,v204
v_sub_f32 v67,v67,v204
v_sub_f32 v80,v80,v204
v_sub_f32 v81,v81,v204
v_sub_f32 v82,v82,v204
v_sub_f32 v83,v83,v204
v_sub_f32 v96,v96,v204
v_sub_f32 v97,v97,v204
v_sub_f32 v98,v98,v204
v_sub_f32 v99,v99,v204
v_sub_f32 v112,v112,v204
v_sub_f32 v113,v113,v204
v_sub_f32 v114,v114,v204
v_sub_f32 v115,v115,v204
v_sub_f32 v164,v164,v205
v_sub_f32 v165,v165,v205
v_sub_f32 v166,v166,v205
v_sub_f32 v167,v167,v205
v_sub_f32 v4,v4,v205
v_sub_f32 v5,v5,v205
v_sub_f32 v6,v6,v205
v_sub_f32 v7,v7,v205
v_sub_f32 v20,v20,v205
v_sub_f32 v21,v21,v205
v_sub_f32 v22,v22,v205
v_sub_f32 v23,v23,v205
v_sub_f32 v36,v36,v205
v_sub_f32 v37,v37,v205
v_sub_f32 v38,v38,v205
v_sub_f32 v39,v39,v205
v_sub_f32 v52,v52,v205
v_sub_f32 v53,v53,v205
v_sub_f32 v54,v54,v205
v_sub_f32 v55,v55,v205
v_sub_f32 v68,v68,v205
v_sub_f32 v69,v69,v205
v_sub_f32 v70,v70,v205
v_sub_f32 v71,v71,v205
v_sub_f32 v84,v84,v205
v_sub_f32 v85,v85,v205
v_sub_f32 v86,v86,v205
v_sub_f32 v87,v87,v205
v_sub_f32 v100,v100,v205
v_sub_f32 v101,v101,v205
v_sub_f32 v102,v102,v205
v_sub_f32 v103,v103,v205
v_sub_f32 v116,v116,v205
v_sub_f32 v117,v117,v205
v_sub_f32 v118,v118,v205
v_sub_f32 v119,v119,v205
v_sub_f32 v168,v168,v206
v_sub_f32 v169,v169,v206
v_sub_f32 v170,v170,v206
v_sub_f32 v171,v171,v206
v_sub_f32 v8,v8,v206
v_sub_f32 v9,v9,v206
v_sub_f32 v10,v10,v206
v_sub_f32 v11,v11,v206
v_sub_f32 v24,v24,v206
v_sub_f32 v25,v25,v206
v_sub_f32 v26,v26,v206
v_sub_f32 v27,v27,v206
v_sub_f32 v40,v40,v206
v_sub_f32 v41,v41,v206
v_sub_f32 v42,v42,v206
v_sub_f32 v43,v43,v206
v_sub_f32 v56,v56,v206
v_sub_f32 v57,v57,v206
v_sub_f32 v58,v58,v206
v_sub_f32 v59,v59,v206
v_sub_f32 v72,v72,v206
v_sub_f32 v73,v73,v206
v_sub_f32 v74,v74,v206
v_sub_f32 v75,v75,v206
v_sub_f32 v88,v88,v206
v_sub_f32 v89,v89,v206
v_sub_f32 v90,v90,v206
v_sub_f32 v91,v91,v206
v_sub_f32 v104,v104,v206
v_sub_f32 v105,v105,v206
v_sub_f32 v106,v106,v206
v_sub_f32 v107,v107,v206
v_sub_f32 v120,v120,v206
v_sub_f32 v121,v121,v206
v_sub_f32 v122,v122,v206
v_sub_f32 v123,v123,v206
v_sub_f32 v172,v172,v207
v_sub_f32 v173,v173,v207
v_sub_f32 v174,v174,v207
v_sub_f32 v175,v175,v207
v_sub_f32 v12,v12,v207
v_sub_f32 v13,v13,v207
v_sub_f32 v14,v14,v207
v_sub_f32 v15,v15,v207
v_sub_f32 v28,v28,v207
v_sub_f32 v29,v29,v207
v_sub_f32 v30,v30,v207
v_sub_f32 v31,v31,v207
v_sub_f32 v44,v44,v207
v_sub_f32 v45,v45,v207
v_sub_f32 v46,v46,v207
v_sub_f32 v47,v47,v207
v_sub_f32 v60,v60,v207
v_sub_f32 v61,v61,v207
v_sub_f32 v62,v62,v207
v_sub_f32 v63,v63,v207
v_sub_f32 v76,v76,v207
v_sub_f32 v77,v77,v207
v_sub_f32 v78,v78,v207
v_sub_f32 v79,v79,v207
v_sub_f32 v92,v92,v207
v_sub_f32 v93,v93,v207
v_sub_f32 v94,v94,v207
v_sub_f32 v95,v95,v207
v_sub_f32 v108,v108,v207
v_sub_f32 v109,v109,v207
v_sub_f32 v110,v110,v207
v_sub_f32 v111,v111,v207
v_sub_f32 v124,v124,v207
v_sub_f32 v125,v125,v207
v_sub_f32 v126,v126,v207
v_sub_f32 v127,v127,v207
ar v208,a0
ar v209,a1
ar v210,a2
ar v211,a3
v_mul_f32 v208,v208,v212
v_mul_f32 v209,v209,v212
v_mul_f32 v210,v210,v212
v_mul_f32 v211,v211,v212
aw a0,v208
aw a1,v209
aw a2,v210
aw a3,v211
ar v208,a4
ar v209,a5
ar v210,a6
ar v211,a7
v_mul_f32 v208,v208,v213
v_mul_f32 v209,v209,v213
v_mul_f32 v210,v210,v213
v_mul_f32 v211,v211,v213
aw a4,v208
aw a5,v209
aw a6,v210
aw a7,v211
ar v208,a8
ar v209,a9
ar v210,a10
ar v211,a11
v_mul_f32 v208,v208,v214
v_mul_f32 v209,v209,v214
v_mul_f32 v210,v210,v214
v_mul_f32 v211,v211,v214
aw a8,v208
aw a9,v209
aw a10,v210
aw a11,v211
ar v208,a12
ar v209,a13
ar v210,a14
ar v211,a15
v_mul_f32 v208,v208,v215
v_mul_f32 v209,v209,v215
v_mul_f32 v210,v210,v215
v_mul_f32 v211,v211,v215
aw a12,v208
aw a13,v209
aw a14,v210
aw a15,v211
ar v208,a16
ar v209,a17
ar v210,a18
ar v211,a19
v_mul_f32 v208,v208,v212
v_mul_f32 v209,v209,v212
v_mul_f32 v210,v210,v212
v_mul_f32 v211,v211,v212
aw a16,v208
aw a17,v209
aw a18,v210
aw a19,v211
ar v208,a20
ar v209,a21
ar v210,a22
ar v211,a23
v_mul_f32 v208,v208,v213
v_mul_f32 v209,v209,v213
v_mul_f32 v210,v210,v213
v_mul_f32 v211,v211,v213
aw a20,v208
aw a21,v209
aw a22,v210
aw a23,v211
ar v208,a24
ar v209,a25
ar v210,a26
ar v211,a27
v_mul_f32 v208,v208,v214
v_mul_f32 v209,v209,v214
v_mul_f32 v210,v210,v214
v_mul_f32 v211,v211,v214
aw a24,v208
aw a25,v209
aw a26,v210
aw a27,v211
ar v208,a28
ar v209,a29
ar v210,a30
ar v211,a31
v_mul_f32 v208,v208,v215
v_mul_f32 v209,v209,v215
v_mul_f32 v210,v210,v215
v_mul_f32 v211,v211,v215
aw a28,v208
aw a29,v209
aw a30,v210
aw a31,v211
ar v208,a32
ar v209,a33
ar v210,a34
ar v211,a35
v_mul_f32 v208,v208,v212
v_mul_f32 v209,v209,v212
v_mul_f32 v210,v210,v212
v_mul_f32 v211,v211,v212
aw a32,v208
aw a33,v209
aw a34,v210
aw a35,v211
ar v208,a36
ar v209,a37
ar v210,a38
ar v211,a39
v_mul_f32 v208,v208,v213
v_mul_f32 v209,v209,v213
v_mul_f32 v210,v210,v213
v_mul_f32 v211,v211,v213
aw a36,v208
aw a37,v209
aw a38,v210
aw a39,v211
ar v208,a40
ar v209,a41
ar v210,a42
ar v211,a43
v_mul_f32 v208,v208,v214
v_mul_f32 v209,v209,v214
v_mul_f32 v210,v210,v214
v_mul_f32 v211,v211,v214
aw a40,v208
aw a41,v209
aw a42,v210
aw a43,v211
ar v208,a44
ar v209,a45
ar v210,a46
ar v211,a47
v_mul_f32 v208,v208,v215
v_mul_f32 v209,v209,v215
v_mul_f32 v210,v210,v215
v_mul_f32 v211,v211,v215
aw a44,v208
aw a45,v209
aw a46,v210
aw a47,v211
ar v208,a48
ar v209,a49
ar v210,a50
ar v211,a51
v_mul_f32 v208,v208,v212
v_mul_f32 v209,v209,v212
v_mul_f32 v210,v210,v212
v_mul_f32 v211,v211,v212
aw a48,v208
aw a49,v209
aw a50,v210
aw a51,v211
ar v208,a52
ar v209,a53
ar v210,a54
ar v211,a55
v_mul_f32 v208,v208,v213
v_mul_f32 v209,v209,v213
v_mul_f32 v210,v210,v213
v_mul_f32 v211,v211,v213
aw a52,v208
aw a53,v209
aw a54,v210
aw a55,v211
ar v208,a56
ar v209,a57
ar v210,a58
ar v211,a59
v_mul_f32 v208,v208,v214
v_mul_f32 v209,v209,v214
v_mul_f32 v210,v210,v214
v_mul_f32 v211,v211,v214
aw a56,v208
aw a57,v209
aw a58,v210
aw a59,v211
ar v208,a60
ar v209,a61
ar v210,a62
ar v211,a63
v_mul_f32 v208,v208,v215
v_mul_f32 v209,v209,v215
v_mul_f32 v210,v210,v215
v_mul_f32 v211,v211,v215
aw a60,v208
aw a61,v209
aw a62,v210
aw a63,v211
ar v208,a64
ar v209,a65
ar v210,a66
ar v211,a67
v_mul_f32 v208,v208,v212
v_mul_f32 v209,v209,v212
v_mul_f32 v210,v210,v212
v_mul_f32 v211,v211,v212
aw a64,v208
aw a65,v209
aw a66,v210
aw a67,v211
ar v208,a68
ar v209,a69
ar v210,a70
ar v211,a71
v_mul_f32 v208,v208,v213
v_mul_f32 v209,v209,v213
v_mul_f32 v210,v210,v213
v_mul_f32 v211,v211,v213
aw a68,v208
aw a69,v209
aw a70,v210
aw a71,v211
ar v208,a72
ar v209,a73
ar v210,a74
ar v211,a75
v_mul_f32 v208,v208,v214
v_mul_f32 v209,v209,v214
v_mul_f32 v210,v210,v214
v_mul_f32 v211,v211,v214
aw a72,v208
aw a73,v209
aw a74,v210
aw a75,v211
ar v208,a76
ar v209,a77
ar v210,a78
ar v211,a79
v_mul_f32 v208,v208,v215
v_mul_f32 v209,v209,v215
v_mul_f32 v210,v210,v215
v_mul_f32 v211,v211,v215
aw a76,v208
aw a77,v209
aw a78,v210
aw a79,v211
ar v208,a80
ar v209,a81
ar v210,a82
ar v211,a83
v_mul_f32 v208,v208,v212
v_mul_f32 v209,v209,v212
v_mul_f32 v210,v210,v212
v_mul_f32 v211,v211,v212
aw a80,v208
aw a81,v209
aw a82,v210
aw a83,v211
ar v208,a84
ar v209,a85
ar v210,a86
ar v211,a87
v_mul_f32 v208,v208,v213
v_mul_f32 v209,v209,v213
v_mul_f32 v210,v210,v213
v_mul_f32 v211,v211,v213
aw a84,v208
aw a85,v209
aw a86,v210
aw a87,v211
ar v208,a88
ar v209,a89
ar v210,a90
ar v211,a91
v_mul_f32 v208,v208,v214
v_mul_f32 v209,v209,v214
v_mul_f32 v210,v210,v214
v_mul_f32 v211,v211,v214
aw a88,v208
aw a89,v209
aw a90,v210
aw a91,v211
ar v208,a92
ar v209,a93
ar v210,a94
ar v211,a95
v_mul_f32 v208,v208,v215
v_mul_f32 v209,v209,v215
v_mul_f32 v210,v210,v215
v_mul_f32 v211,v211,v215
aw a92,v208
aw a93,v209
aw a94,v210
aw a95,v211
ar v208,a96
ar v209,a97
ar v210,a98
ar v211,a99
v_mul_f32 v208,v208,v212
v_mul_f32 v209,v209,v212
v_mul_f32 v210,v210,v212
v_mul_f32 v211,v211,v212
aw a96,v208
aw a97,v209
aw a98,v210
aw a99,v211
ar v208,a100
ar v209,a101
ar v210,a102
ar v211,a103
v_mul_f32 v208,v208,v213
v_mul_f32 v209,v209,v213
v_mul_f32 v210,v210,v213
v_mul_f32 v211,v211,v213
aw a100,v208
aw a101,v209
aw a102,v210
aw a103,v211
ar v208,a104
ar v209,a105
ar v210,a106
ar v211,a107
v_mul_f32 v208,v208,v214
v_mul_f32 v209,v209,v214
v_mul_f32 v210,v210,v214
v_mul_f32 v211,v211,v214
aw a104,v208
aw a105,v209
aw a106,v210
aw a107,v211
ar v208,a108
ar v209,a109
ar v210,a110
ar v211,a111
v_mul_f32 v208,v208,v215
v_mul_f32 v209,v209,v215
v_mul_f32 v210,v210,v215
v_mul_f32 v211,v211,v215
aw a108,v208
aw a109,v209
aw a110,v210
aw a111,v211
ar v208,a112
ar v209,a113
ar v210,a114
ar v211,a115
v_mul_f32 v208,v208,v212
v_mul_f32 v209,v209,v212
v_mul_f32 v210,v210,v212
v_mul_f32 v211,v211,v212
aw a112,v208
aw a113,v209
aw a114,v210
aw a115,v211
ar v208,a116
ar v209,a117
ar v210,a118
ar v211,a119
v_mul_f32 v208,v208,v213
v_mul_f32 v209,v209,v213
v_mul_f32 v210,v210,v213
v_mul_f32 v211,v211,v213
aw a116,v208
aw a117,v209
aw a118,v210
aw a119,v211
ar v208,a120
ar v209,a121
ar v210,a122
ar v211,a123
v_mul_f32 v208,v208,v214
v_mul_f32 v209,v209,v214
v_mul_f32 v210,v210,v214
v_mul_f32 v211,v211,v214
aw a120,v208
aw a121,v209
aw a122,v210
aw a123,v211
ar v208,a124
ar v209,a125
ar v210,a126
ar v211,a127
v_mul_f32 v208,v208,v215
v_mul_f32 v209,v209,v215
v_mul_f32 v210,v210,v215
v_mul_f32 v211,v211,v215
aw a124,v208
aw a125,v209
aw a126,v210
aw a127,v211
ar v208,a224
ar v209,a225
ar v210,a226
ar v211,a227
v_mul_f32 v208,v208,v212
v_mul_f32 v209,v209,v212
v_mul_f32 v210,v210,v212
v_mul_f32 v211,v211,v212
aw a224,v208
aw a225,v209
aw a226,v210
aw a227,v211
ar v208,a228
ar v209,a229
ar v210,a230
ar v211,a231
v_mul_f32 v208,v208,v213
v_mul_f32 v209,v209,v213
v_mul_f32 v210,v210,v213
v_mul_f32 v211,v211,v213
aw a228,v208
aw a229,v209
aw a230,v210
aw a231,v211
ar v208,a232
ar v209,a233
ar v210,a234
ar v211,a235
v_mul_f32 v208,v208,v214
v_mul_f32 v209,v209,v214
v_mul_f32 v210,v210,v214
v_mul_f32 v211,v211,v214
aw a232,v208
aw a233,v209
aw a234,v210
aw a235,v211
ar v208,a236
ar v209,a237
ar v210,a238
ar v211,a239
v_mul_f32 v208,v208,v215
v_mul_f32 v209,v209,v215
v_mul_f32 v210,v210,v215
v_mul_f32 v211,v211,v215
aw a236,v208
aw a237,v209
aw a238,v210
aw a239,v211
v_exp_f32 v176,v0
v_exp_f32 v177,v1
s_nop 0
cv v128,v176,v177
v_exp_f32 v178,v2
v_exp_f32 v179,v3
s_nop 0
cv v129,v178,v179
v_exp_f32 v180,v16
v_exp_f32 v181,v17
s_nop 0
cv v130,v180,v181
v_exp_f32 v182,v18
v_exp_f32 v183,v19
s_nop 0
cv v131,v182,v183
v_exp_f32 v176,v4
v_exp_f32 v177,v5
s_nop 0
cv v132,v176,v177
v_exp_f32 v178,v6
v_exp_f32 v179,v7
s_nop 0
cv v133,v178,v179
v_exp_f32 v180,v20
v_exp_f32 v181,v21
s_nop 0
cv v134,v180,v181
v_exp_f32 v182,v22
v_exp_f32 v183,v23
s_nop 0
cv v135,v182,v183
v_exp_f32 v176,v8
v_exp_f32 v177,v9
s_nop 0
cv v136,v176,v177
v_exp_f32 v178,v10
v_exp_f32 v179,v11
s_nop 0
cv v137,v178,v179
v_exp_f32 v180,v24
v_exp_f32 v181,v25
s_nop 0
cv v138,v180,v181
v_exp_f32 v182,v26
v_exp_f32 v183,v27
s_nop 0
cv v139,v182,v183
v_exp_f32 v176,v12
v_exp_f32 v177,v13
s_nop 0
cv v140,v176,v177
v_exp_f32 v178,v14
v_exp_f32 v179,v15
s_nop 0
cv v141,v178,v179
v_exp_f32 v180,v28
v_exp_f32 v181,v29
s_nop 0
cv v142,v180,v181
v_exp_f32 v182,v30
v_exp_f32 v183,v31
s_nop 0
cv v143,v182,v183
v_exp_f32 v176,v32
v_exp_f32 v177,v33
v_exp_f32 v178,v34
cv v144,v176,v177
v_exp_f32 v179,v35
s_nop 0
cv v145,v178,v179
v_exp_f32 v180,v48
v_exp_f32 v181,v49
v_exp_f32 v182,v50
cv v146,v180,v181
v_or3_b32 v185,v144,v145,v146
v_exp_f32 v183,v51
v_exp_f32 v176,v36
cv v147,v182,v183
v_exp_f32 v177,v37
v_exp_f32 v178,v38
cv v148,v176,v177
v_exp_f32 v179,v39
v_exp_f32 v180,v52
v_or3_b32 v185,v147,v148,v185
cv v149,v178,v179
v_exp_f32 v181,v53
v_exp_f32 v182,v54
cv v150,v180,v181
v_or3_b32 v185,v149,v150,v185
v_exp_f32 v183,v55
v_exp_f32 v176,v40
cv v151,v182,v183
s_nop 3
s_setpc_b64 s[60:61]
attn_slow_1:
s_nop 15
s_add_u32 s62,s62,1
v_max3_f32 v204,v32,v33,v34
v_max3_f32 v204,v35,v48,v204
v_max3_f32 v204,v49,v50,v204
v_max_f32 v204,v51,v204
v_max3_f32 v205,v36,v37,v38
v_max3_f32 v205,v39,v52,v205
v_max3_f32 v205,v53,v54,v205
v_max_f32 v205,v55,v205
v_max3_f32 v206,v40,v41,v42
v_max3_f32 v206,v43,v56,v206
v_max3_f32 v206,v57,v58,v206
v_max_f32 v206,v59,v206
v_max3_f32 v207,v44,v45,v46
v_max3_f32 v207,v47,v60,v207
v_max3_f32 v207,v61,v62,v207
v_max_f32 v207,v63,v207
v_mov_b32 v208,v204
v_mov_b32 v209,v205
v_mov_b32 v210,v206
v_mov_b32 v211,v207
v_permlane16_swap_b32 v208,v204
v_permlane16_swap_b32 v209,v205
v_permlane16_swap_b32 v210,v206
v_permlane16_swap_b32 v211,v207
v_max_f32 v204,v204,v208
v_max_f32 v205,v205,v209
v_max_f32 v206,v206,v210
v_max_f32 v207,v207,v211
v_mov_b32 v208,v204
v_mov_b32 v209,v205
v_mov_b32 v210,v206
v_mov_b32 v211,v207
v_permlane32_swap_b32 v208,v204
v_permlane32_swap_b32 v209,v205
v_permlane32_swap_b32 v210,v206
v_permlane32_swap_b32 v211,v207
v_max_f32 v204,v204,v208
v_max_f32 v205,v205,v209
v_max_f32 v206,v206,v210
v_max_f32 v207,v207,v211
v_add_f32 v204,0x42b40000,v204
v_max_f32 v204,0,v204
v_add_f32 v205,0x42b40000,v205
v_max_f32 v205,0,v205
v_add_f32 v206,0x42b40000,v206
v_max_f32 v206,0,v206
v_add_f32 v207,0x42b40000,v207
v_max_f32 v207,0,v207
v_exp_f32 v212,-v204
v_exp_f32 v213,-v205
v_exp_f32 v214,-v206
v_exp_f32 v215,-v207
v_sub_f32 v160,v160,v204
v_sub_f32 v161,v161,v204
v_sub_f32 v162,v162,v204
v_sub_f32 v163,v163,v204
v_sub_f32 v32,v32,v204
v_sub_f32 v33,v33,v204
v_sub_f32 v34,v34,v204
v_sub_f32 v35,v35,v204
v_sub_f32 v48,v48,v204
v_sub_f32 v49,v49,v204
v_sub_f32 v50,v50,v204
v_sub_f32 v51,v51,v204
v_sub_f32 v64,v64,v204
v_sub_f32 v65,v65,v204
v_sub_f32 v66,v66,v204
v_sub_f32 v67,v67,v204
v_sub_f32 v80,v80,v204
v_sub_f32 v81,v81,v204
v_sub_f32 v82,v82,v204
v_sub_f32 v83,v83,v204
v_sub_f32 v96,v96,v204
v_sub_f32 v97,v97,v204
v_sub_f32 v98,v98,v204
v_sub_f32 v99,v99,v204
v_sub_f32 v112,v112,v204
v_sub_f32 v113,v113,v204
v_sub_f32 v114,v114,v204
v_sub_f32 v115,v115,v204
v_sub_f32 v164,v164,v205
v_sub_f32 v165,v165,v205
v_sub_f32 v166,v166,v205
v_sub_f32 v167,v167,v205
v_sub_f32 v36,v36,v205
v_sub_f32 v37,v37,v205
v_sub_f32 v38,v38,v205
v_sub_f32 v39,v39,v205
v_sub_f32 v52,v52,v205
v_sub_f32 v53,v53,v205
v_sub_f32 v54,v54,v205
v_sub_f32 v55,v55,v205
v_sub_f32 v68,v68,v205
v_sub_f32 v69,v69,v205
v_sub_f32 v70,v70,v205
v_sub_f32 v71,v71,v205
v_sub_f32 v84,v84,v205
v_sub_f32 v85,v85,v205
v_sub_f32 v86,v86,v205
v_sub_f32 v87,v87,v205
v_sub_f32 v100,v100,v205
v_sub_f32 v101,v101,v205
v_sub_f32 v102,v102,v205
v_sub_f32 v103,v103,v205
v_sub_f32 v116,v116,v205
v_sub_f32 v117,v117,v205
v_sub_f32 v118,v118,v205
v_sub_f32 v119,v119,v205
v_sub_f32 v168,v168,v206
v_sub_f32 v169,v169,v206
v_sub_f32 v170,v170,v206
v_sub_f32 v171,v171,v206
v_sub_f32 v40,v40,v206
v_sub_f32 v41,v41,v206
v_sub_f32 v42,v42,v206
v_sub_f32 v43,v43,v206
v_sub_f32 v56,v56,v206
v_sub_f32 v57,v57,v206
v_sub_f32 v58,v58,v206
v_sub_f32 v59,v59,v206
v_sub_f32 v72,v72,v206
v_sub_f32 v73,v73,v206
v_sub_f32 v74,v74,v206
v_sub_f32 v75,v75,v206
v_sub_f32 v88,v88,v206
v_sub_f32 v89,v89,v206
v_sub_f32 v90,v90,v206
v_sub_f32 v91,v91,v206
v_sub_f32 v104,v104,v206
v_sub_f32 v105,v105,v206
v_sub_f32 v106,v106,v206
v_sub_f32 v107,v107,v206
v_sub_f32 v120,v120,v206
v_sub_f32 v121,v121,v206
v_sub_f32 v122,v122,v206
v_sub_f32 v123,v123,v206
v_sub_f32 v172,v172,v207
v_sub_f32 v173,v173,v207
v_sub_f32 v174,v174,v207
v_sub_f32 v175,v175,v207
v_sub_f32 v44,v44,v207
v_sub_f32 v45,v45,v207
v_sub_f32 v46,v46,v207
v_sub_f32 v47,v47,v207
v_sub_f32 v60,v60,v207
v_sub_f32 v61,v61,v207
v_sub_f32 v62,v62,v207
v_sub_f32 v63,v63,v207
v_sub_f32 v76,v76,v207
v_sub_f32 v77,v77,v207
v_sub_f32 v78,v78,v207
v_sub_f32 v79,v79,v207
v_sub_f32 v92,v92,v207
v_sub_f32 v93,v93,v207
v_sub_f32 v94,v94,v207
v_sub_f32 v95,v95,v207
v_sub_f32 v108,v108,v207
v_sub_f32 v109,v109,v207
v_sub_f32 v110,v110,v207
v_sub_f32 v111,v111,v207
v_sub_f32 v124,v124,v207
v_sub_f32 v125,v125,v207
v_sub_f32 v126,v126,v207
v_sub_f32 v127,v127,v207
ar v208,a0
ar v209,a1
ar v210,a2
ar v211,a3
v_mul_f32 v208,v208,v212
v_mul_f32 v209,v209,v212
v_mul_f32 v210,v210,v212
v_mul_f32 v211,v211,v212
aw a0,v208
aw a1,v209
aw a2,v210
aw a3,v211
ar v208,a4
ar v209,a5
ar v210,a6
ar v211,a7
v_mul_f32 v208,v208,v213
v_mul_f32 v209,v209,v213
v_mul_f32 v210,v210,v213
v_mul_f32 v211,v211,v213
aw a4,v208
aw a5,v209
aw a6,v210
aw a7,v211
ar v208,a8
ar v209,a9
ar v210,a10
ar v211,a11
v_mul_f32 v208,v208,v214
v_mul_f32 v209,v209,v214
v_mul_f32 v210,v210,v214
v_mul_f32 v211,v211,v214
aw a8,v208
aw a9,v209
aw a10,v210
aw a11,v211
ar v208,a12
ar v209,a13
ar v210,a14
ar v211,a15
v_mul_f32 v208,v208,v215
v_mul_f32 v209,v209,v215
v_mul_f32 v210,v210,v215
v_mul_f32 v211,v211,v215
aw a12,v208
aw a13,v209
aw a14,v210
aw a15,v211
ar v208,a16
ar v209,a17
ar v210,a18
ar v211,a19
v_mul_f32 v208,v208,v212
v_mul_f32 v209,v209,v212
v_mul_f32 v210,v210,v212
v_mul_f32 v211,v211,v212
aw a16,v208
aw a17,v209
aw a18,v210
aw a19,v211
ar v208,a20
ar v209,a21
ar v210,a22
ar v211,a23
v_mul_f32 v208,v208,v213
v_mul_f32 v209,v209,v213
v_mul_f32 v210,v210,v213
v_mul_f32 v211,v211,v213
aw a20,v208
aw a21,v209
aw a22,v210
aw a23,v211
ar v208,a24
ar v209,a25
ar v210,a26
ar v211,a27
v_mul_f32 v208,v208,v214
v_mul_f32 v209,v209,v214
v_mul_f32 v210,v210,v214
v_mul_f32 v211,v211,v214
aw a24,v208
aw a25,v209
aw a26,v210
aw a27,v211
ar v208,a28
ar v209,a29
ar v210,a30
ar v211,a31
v_mul_f32 v208,v208,v215
v_mul_f32 v209,v209,v215
v_mul_f32 v210,v210,v215
v_mul_f32 v211,v211,v215
aw a28,v208
aw a29,v209
aw a30,v210
aw a31,v211
ar v208,a32
ar v209,a33
ar v210,a34
ar v211,a35
v_mul_f32 v208,v208,v212
v_mul_f32 v209,v209,v212
v_mul_f32 v210,v210,v212
v_mul_f32 v211,v211,v212
aw a32,v208
aw a33,v209
aw a34,v210
aw a35,v211
ar v208,a36
ar v209,a37
ar v210,a38
ar v211,a39
v_mul_f32 v208,v208,v213
v_mul_f32 v209,v209,v213
v_mul_f32 v210,v210,v213
v_mul_f32 v211,v211,v213
aw a36,v208
aw a37,v209
aw a38,v210
aw a39,v211
ar v208,a40
ar v209,a41
ar v210,a42
ar v211,a43
v_mul_f32 v208,v208,v214
v_mul_f32 v209,v209,v214
v_mul_f32 v210,v210,v214
v_mul_f32 v211,v211,v214
aw a40,v208
aw a41,v209
aw a42,v210
aw a43,v211
ar v208,a44
ar v209,a45
ar v210,a46
ar v211,a47
v_mul_f32 v208,v208,v215
v_mul_f32 v209,v209,v215
v_mul_f32 v210,v210,v215
v_mul_f32 v211,v211,v215
aw a44,v208
aw a45,v209
aw a46,v210
aw a47,v211
ar v208,a48
ar v209,a49
ar v210,a50
ar v211,a51
v_mul_f32 v208,v208,v212
v_mul_f32 v209,v209,v212
v_mul_f32 v210,v210,v212
v_mul_f32 v211,v211,v212
aw a48,v208
aw a49,v209
aw a50,v210
aw a51,v211
ar v208,a52
ar v209,a53
ar v210,a54
ar v211,a55
v_mul_f32 v208,v208,v213
v_mul_f32 v209,v209,v213
v_mul_f32 v210,v210,v213
v_mul_f32 v211,v211,v213
aw a52,v208
aw a53,v209
aw a54,v210
aw a55,v211
ar v208,a56
ar v209,a57
ar v210,a58
ar v211,a59
v_mul_f32 v208,v208,v214
v_mul_f32 v209,v209,v214
v_mul_f32 v210,v210,v214
v_mul_f32 v211,v211,v214
aw a56,v208
aw a57,v209
aw a58,v210
aw a59,v211
ar v208,a60
ar v209,a61
ar v210,a62
ar v211,a63
v_mul_f32 v208,v208,v215
v_mul_f32 v209,v209,v215
v_mul_f32 v210,v210,v215
v_mul_f32 v211,v211,v215
aw a60,v208
aw a61,v209
aw a62,v210
aw a63,v211
ar v208,a64
ar v209,a65
ar v210,a66
ar v211,a67
v_mul_f32 v208,v208,v212
v_mul_f32 v209,v209,v212
v_mul_f32 v210,v210,v212
v_mul_f32 v211,v211,v212
aw a64,v208
aw a65,v209
aw a66,v210
aw a67,v211
ar v208,a68
ar v209,a69
ar v210,a70
ar v211,a71
v_mul_f32 v208,v208,v213
v_mul_f32 v209,v209,v213
v_mul_f32 v210,v210,v213
v_mul_f32 v211,v211,v213
aw a68,v208
aw a69,v209
aw a70,v210
aw a71,v211
ar v208,a72
ar v209,a73
ar v210,a74
ar v211,a75
v_mul_f32 v208,v208,v214
v_mul_f32 v209,v209,v214
v_mul_f32 v210,v210,v214
v_mul_f32 v211,v211,v214
aw a72,v208
aw a73,v209
aw a74,v210
aw a75,v211
ar v208,a76
ar v209,a77
ar v210,a78
ar v211,a79
v_mul_f32 v208,v208,v215
v_mul_f32 v209,v209,v215
v_mul_f32 v210,v210,v215
v_mul_f32 v211,v211,v215
aw a76,v208
aw a77,v209
aw a78,v210
aw a79,v211
ar v208,a80
ar v209,a81
ar v210,a82
ar v211,a83
v_mul_f32 v208,v208,v212
v_mul_f32 v209,v209,v212
v_mul_f32 v210,v210,v212
v_mul_f32 v211,v211,v212
aw a80,v208
aw a81,v209
aw a82,v210
aw a83,v211
ar v208,a84
ar v209,a85
ar v210,a86
ar v211,a87
v_mul_f32 v208,v208,v213
v_mul_f32 v209,v209,v213
v_mul_f32 v210,v210,v213
v_mul_f32 v211,v211,v213
aw a84,v208
aw a85,v209
aw a86,v210
aw a87,v211
ar v208,a88
ar v209,a89
ar v210,a90
ar v211,a91
v_mul_f32 v208,v208,v214
v_mul_f32 v209,v209,v214
v_mul_f32 v210,v210,v214
v_mul_f32 v211,v211,v214
aw a88,v208
aw a89,v209
aw a90,v210
aw a91,v211
ar v208,a92
ar v209,a93
ar v210,a94
ar v211,a95
v_mul_f32 v208,v208,v215
v_mul_f32 v209,v209,v215
v_mul_f32 v210,v210,v215
v_mul_f32 v211,v211,v215
aw a92,v208
aw a93,v209
aw a94,v210
aw a95,v211
ar v208,a96
ar v209,a97
ar v210,a98
ar v211,a99
v_mul_f32 v208,v208,v212
v_mul_f32 v209,v209,v212
v_mul_f32 v210,v210,v212
v_mul_f32 v211,v211,v212
aw a96,v208
aw a97,v209
aw a98,v210
aw a99,v211
ar v208,a100
ar v209,a101
ar v210,a102
ar v211,a103
v_mul_f32 v208,v208,v213
v_mul_f32 v209,v209,v213
v_mul_f32 v210,v210,v213
v_mul_f32 v211,v211,v213
aw a100,v208
aw a101,v209
aw a102,v210
aw a103,v211
ar v208,a104
ar v209,a105
ar v210,a106
ar v211,a107
v_mul_f32 v208,v208,v214
v_mul_f32 v209,v209,v214
v_mul_f32 v210,v210,v214
v_mul_f32 v211,v211,v214
aw a104,v208
aw a105,v209
aw a106,v210
aw a107,v211
ar v208,a108
ar v209,a109
ar v210,a110
ar v211,a111
v_mul_f32 v208,v208,v215
v_mul_f32 v209,v209,v215
v_mul_f32 v210,v210,v215
v_mul_f32 v211,v211,v215
aw a108,v208
aw a109,v209
aw a110,v210
aw a111,v211
ar v208,a112
ar v209,a113
ar v210,a114
ar v211,a115
v_mul_f32 v208,v208,v212
v_mul_f32 v209,v209,v212
v_mul_f32 v210,v210,v212
v_mul_f32 v211,v211,v212
aw a112,v208
aw a113,v209
aw a114,v210
aw a115,v211
ar v208,a116
ar v209,a117
ar v210,a118
ar v211,a119
v_mul_f32 v208,v208,v213
v_mul_f32 v209,v209,v213
v_mul_f32 v210,v210,v213
v_mul_f32 v211,v211,v213
aw a116,v208
aw a117,v209
aw a118,v210
aw a119,v211
ar v208,a120
ar v209,a121
ar v210,a122
ar v211,a123
v_mul_f32 v208,v208,v214
v_mul_f32 v209,v209,v214
v_mul_f32 v210,v210,v214
v_mul_f32 v211,v211,v214
aw a120,v208
aw a121,v209
aw a122,v210
aw a123,v211
ar v208,a124
ar v209,a125
ar v210,a126
ar v211,a127
v_mul_f32 v208,v208,v215
v_mul_f32 v209,v209,v215
v_mul_f32 v210,v210,v215
v_mul_f32 v211,v211,v215
aw a124,v208
aw a125,v209
aw a126,v210
aw a127,v211
ar v208,a224
ar v209,a225
ar v210,a226
ar v211,a227
v_mul_f32 v208,v208,v212
v_mul_f32 v209,v209,v212
v_mul_f32 v210,v210,v212
v_mul_f32 v211,v211,v212
aw a224,v208
aw a225,v209
aw a226,v210
aw a227,v211
ar v208,a228
ar v209,a229
ar v210,a230
ar v211,a231
v_mul_f32 v208,v208,v213
v_mul_f32 v209,v209,v213
v_mul_f32 v210,v210,v213
v_mul_f32 v211,v211,v213
aw a228,v208
aw a229,v209
aw a230,v210
aw a231,v211
ar v208,a232
ar v209,a233
ar v210,a234
ar v211,a235
v_mul_f32 v208,v208,v214
v_mul_f32 v209,v209,v214
v_mul_f32 v210,v210,v214
v_mul_f32 v211,v211,v214
aw a232,v208
aw a233,v209
aw a234,v210
aw a235,v211
ar v208,a236
ar v209,a237
ar v210,a238
ar v211,a239
v_mul_f32 v208,v208,v215
v_mul_f32 v209,v209,v215
v_mul_f32 v210,v210,v215
v_mul_f32 v211,v211,v215
aw a236,v208
aw a237,v209
aw a238,v210
aw a239,v211
v_exp_f32 v176,v32
v_exp_f32 v177,v33
s_nop 0
cv v144,v176,v177
v_exp_f32 v178,v34
v_exp_f32 v179,v35
s_nop 0
cv v145,v178,v179
v_exp_f32 v180,v48
v_exp_f32 v181,v49
s_nop 0
cv v146,v180,v181
v_exp_f32 v182,v50
v_exp_f32 v183,v51
s_nop 0
cv v147,v182,v183
v_exp_f32 v176,v36
v_exp_f32 v177,v37
s_nop 0
cv v148,v176,v177
v_exp_f32 v178,v38
v_exp_f32 v179,v39
s_nop 0
cv v149,v178,v179
v_exp_f32 v180,v52
v_exp_f32 v181,v53
s_nop 0
cv v150,v180,v181
v_exp_f32 v182,v54
v_exp_f32 v183,v55
s_nop 0
cv v151,v182,v183
v_exp_f32 v176,v40
v_exp_f32 v177,v41
s_nop 0
cv v152,v176,v177
v_exp_f32 v178,v42
v_exp_f32 v179,v43
s_nop 0
cv v153,v178,v179
v_exp_f32 v180,v56
v_exp_f32 v181,v57
s_nop 0
cv v154,v180,v181
v_exp_f32 v182,v58
v_exp_f32 v183,v59
s_nop 0
cv v155,v182,v183
v_exp_f32 v176,v44
v_exp_f32 v177,v45
s_nop 0
cv v156,v176,v177
v_exp_f32 v178,v46
v_exp_f32 v179,v47
s_nop 0
cv v157,v178,v179
v_exp_f32 v180,v60
v_exp_f32 v181,v61
s_nop 0
cv v158,v180,v181
v_exp_f32 v182,v62
v_exp_f32 v183,v63
s_nop 0
cv v159,v182,v183
s_nop 3
s_setpc_b64 s[60:61]
attn_slow_2:
s_nop 15
s_add_u32 s62,s62,1
v_max3_f32 v204,v64,v65,v66
v_max3_f32 v204,v67,v80,v204
v_max3_f32 v204,v81,v82,v204
v_max3_f32 v204,v83,v96,v204
v_max3_f32 v204,v97,v98,v204
v_max3_f32 v204,v99,v112,v204
v_max3_f32 v204,v113,v114,v204
v_max_f32 v204,v115,v204
v_max3_f32 v205,v68,v69,v70
v_max3_f32 v205,v71,v84,v205
v_max3_f32 v205,v85,v86,v205
v_max3_f32 v205,v87,v100,v205
v_max3_f32 v205,v101,v102,v205
v_max3_f32 v205,v103,v116,v205
v_max3_f32 v205,v117,v118,v205
v_max_f32 v205,v119,v205
v_max3_f32 v206,v72,v73,v74
v_max3_f32 v206,v75,v88,v206
v_max3_f32 v206,v89,v90,v206
v_max3_f32 v206,v91,v104,v206
v_max3_f32 v206,v105,v106,v206
v_max3_f32 v206,v107,v120,v206
v_max3_f32 v206,v121,v122,v206
v_max_f32 v206,v123,v206
v_max3_f32 v207,v76,v77,v78
v_max3_f32 v207,v79,v92,v207
v_max3_f32 v207,v93,v94,v207
v_max3_f32 v207,v95,v108,v207
v_max3_f32 v207,v109,v110,v207
v_max3_f32 v207,v111,v124,v207
v_max3_f32 v207,v125,v126,v207
v_max_f32 v207,v127,v207
v_mov_b32 v208,v204
v_mov_b32 v209,v205
v_mov_b32 v210,v206
v_mov_b32 v211,v207
v_permlane16_swap_b32 v208,v204
v_permlane16_swap_b32 v209,v205
v_permlane16_swap_b32 v210,v206
v_permlane16_swap_b32 v211,v207
v_max_f32 v204,v204,v208
v_max_f32 v205,v205,v209
v_max_f32 v206,v206,v210
v_max_f32 v207,v207,v211
v_mov_b32 v208,v204
v_mov_b32 v209,v205
v_mov_b32 v210,v206
v_mov_b32 v211,v207
v_permlane32_swap_b32 v208,v204
v_permlane32_swap_b32 v209,v205
v_permlane32_swap_b32 v210,v206
v_permlane32_swap_b32 v211,v207
v_max_f32 v204,v204,v208
v_max_f32 v205,v205,v209
v_max_f32 v206,v206,v210
v_max_f32 v207,v207,v211
v_add_f32 v204,0x42b40000,v204
v_max_f32 v204,0,v204
v_add_f32 v205,0x42b40000,v205
v_max_f32 v205,0,v205
v_add_f32 v206,0x42b40000,v206
v_max_f32 v206,0,v206
v_add_f32 v207,0x42b40000,v207
v_max_f32 v207,0,v207
v_exp_f32 v212,-v204
v_exp_f32 v213,-v205
v_exp_f32 v214,-v206
v_exp_f32 v215,-v207
v_sub_f32 v160,v160,v204
v_sub_f32 v161,v161,v204
v_sub_f32 v162,v162,v204
v_sub_f32 v163,v163,v204
v_sub_f32 v64,v64,v204
v_sub_f32 v65,v65,v204
v_sub_f32 v66,v66,v204
v_sub_f32 v67,v67,v204
v_sub_f32 v80,v80,v204
v_sub_f32 v81,v81,v204
v_sub_f32 v82,v82,v204
v_sub_f32 v83,v83,v204
v_sub_f32 v96,v96,v204
v_sub_f32 v97,v97,v204
v_sub_f32 v98,v98,v204
v_sub_f32 v99,v99,v204
v_sub_f32 v112,v112,v204
v_sub_f32 v113,v113,v204
v_sub_f32 v114,v114,v204
v_sub_f32 v115,v115,v204
v_sub_f32 v0,v0,v204
v_sub_f32 v1,v1,v204
v_sub_f32 v2,v2,v204
v_sub_f32 v3,v3,v204
v_sub_f32 v16,v16,v204
v_sub_f32 v17,v17,v204
v_sub_f32 v18,v18,v204
v_sub_f32 v19,v19,v204
v_sub_f32 v32,v32,v204
v_sub_f32 v33,v33,v204
v_sub_f32 v34,v34,v204
v_sub_f32 v35,v35,v204
v_sub_f32 v48,v48,v204
v_sub_f32 v49,v49,v204
v_sub_f32 v50,v50,v204
v_sub_f32 v51,v51,v204
v_sub_f32 v164,v164,v205
v_sub_f32 v165,v165,v205
v_sub_f32 v166,v166,v205
v_sub_f32 v167,v167,v205
v_sub_f32 v68,v68,v205
v_sub_f32 v69,v69,v205
v_sub_f32 v70,v70,v205
v_sub_f32 v71,v71,v205
v_sub_f32 v84,v84,v205
v_sub_f32 v85,v85,v205
v_sub_f32 v86,v86,v205
v_sub_f32 v87,v87,v205
v_sub_f32 v100,v100,v205
v_sub_f32 v101,v101,v205
v_sub_f32 v102,v102,v205
v_sub_f32 v103,v103,v205
v_sub_f32 v116,v116,v205
v_sub_f32 v117,v117,v205
v_sub_f32 v118,v118,v205
v_sub_f32 v119,v119,v205
v_sub_f32 v4,v4,v205
v_sub_f32 v5,v5,v205
v_sub_f32 v6,v6,v205
v_sub_f32 v7,v7,v205
v_sub_f32 v20,v20,v205
v_sub_f32 v21,v21,v205
v_sub_f32 v22,v22,v205
v_sub_f32 v23,v23,v205
v_sub_f32 v36,v36,v205
v_sub_f32 v37,v37,v205
v_sub_f32 v38,v38,v205
v_sub_f32 v39,v39,v205
v_sub_f32 v52,v52,v205
v_sub_f32 v53,v53,v205
v_sub_f32 v54,v54,v205
v_sub_f32 v55,v55,v205
v_sub_f32 v168,v168,v206
v_sub_f32 v169,v169,v206
v_sub_f32 v170,v170,v206
v_sub_f32 v171,v171,v206
v_sub_f32 v72,v72,v206
v_sub_f32 v73,v73,v206
v_sub_f32 v74,v74,v206
v_sub_f32 v75,v75,v206
v_sub_f32 v88,v88,v206
v_sub_f32 v89,v89,v206
v_sub_f32 v90,v90,v206
v_sub_f32 v91,v91,v206
v_sub_f32 v104,v104,v206
v_sub_f32 v105,v105,v206
v_sub_f32 v106,v106,v206
v_sub_f32 v107,v107,v206
v_sub_f32 v120,v120,v206
v_sub_f32 v121,v121,v206
v_sub_f32 v122,v122,v206
v_sub_f32 v123,v123,v206
v_sub_f32 v8,v8,v206
v_sub_f32 v9,v9,v206
v_sub_f32 v10,v10,v206
v_sub_f32 v11,v11,v206
v_sub_f32 v24,v24,v206
v_sub_f32 v25,v25,v206
v_sub_f32 v26,v26,v206
v_sub_f32 v27,v27,v206
v_sub_f32 v40,v40,v206
v_sub_f32 v41,v41,v206
v_sub_f32 v42,v42,v206
v_sub_f32 v43,v43,v206
v_sub_f32 v56,v56,v206
v_sub_f32 v57,v57,v206
v_sub_f32 v58,v58,v206
v_sub_f32 v59,v59,v206
v_sub_f32 v172,v172,v207
v_sub_f32 v173,v173,v207
v_sub_f32 v174,v174,v207
v_sub_f32 v175,v175,v207
v_sub_f32 v76,v76,v207
v_sub_f32 v77,v77,v207
v_sub_f32 v78,v78,v207
v_sub_f32 v79,v79,v207
v_sub_f32 v92,v92,v207
v_sub_f32 v93,v93,v207
v_sub_f32 v94,v94,v207
v_sub_f32 v95,v95,v207
v_sub_f32 v108,v108,v207
v_sub_f32 v109,v109,v207
v_sub_f32 v110,v110,v207
v_sub_f32 v111,v111,v207
v_sub_f32 v124,v124,v207
v_sub_f32 v125,v125,v207
v_sub_f32 v126,v126,v207
v_sub_f32 v127,v127,v207
v_sub_f32 v12,v12,v207
v_sub_f32 v13,v13,v207
v_sub_f32 v14,v14,v207
v_sub_f32 v15,v15,v207
v_sub_f32 v28,v28,v207
v_sub_f32 v29,v29,v207
v_sub_f32 v30,v30,v207
v_sub_f32 v31,v31,v207
v_sub_f32 v44,v44,v207
v_sub_f32 v45,v45,v207
v_sub_f32 v46,v46,v207
v_sub_f32 v47,v47,v207
v_sub_f32 v60,v60,v207
v_sub_f32 v61,v61,v207
v_sub_f32 v62,v62,v207
v_sub_f32 v63,v63,v207
ar v208,a0
ar v209,a1
ar v210,a2
ar v211,a3
v_mul_f32 v208,v208,v212
v_mul_f32 v209,v209,v212
v_mul_f32 v210,v210,v212
v_mul_f32 v211,v211,v212
aw a0,v208
aw a1,v209
aw a2,v210
aw a3,v211
ar v208,a4
ar v209,a5
ar v210,a6
ar v211,a7
v_mul_f32 v208,v208,v213
v_mul_f32 v209,v209,v213
v_mul_f32 v210,v210,v213
v_mul_f32 v211,v211,v213
aw a4,v208
aw a5,v209
aw a6,v210
aw a7,v211
ar v208,a8
ar v209,a9
ar v210,a10
ar v211,a11
v_mul_f32 v208,v208,v214
v_mul_f32 v209,v209,v214
v_mul_f32 v210,v210,v214
v_mul_f32 v211,v211,v214
aw a8,v208
aw a9,v209
aw a10,v210
aw a11,v211
ar v208,a12
ar v209,a13
ar v210,a14
ar v211,a15
v_mul_f32 v208,v208,v215
v_mul_f32 v209,v209,v215
v_mul_f32 v210,v210,v215
v_mul_f32 v211,v211,v215
aw a12,v208
aw a13,v209
aw a14,v210
aw a15,v211
ar v208,a16
ar v209,a17
ar v210,a18
ar v211,a19
v_mul_f32 v208,v208,v212
v_mul_f32 v209,v209,v212
v_mul_f32 v210,v210,v212
v_mul_f32 v211,v211,v212
aw a16,v208
aw a17,v209
aw a18,v210
aw a19,v211
ar v208,a20
ar v209,a21
ar v210,a22
ar v211,a23
v_mul_f32 v208,v208,v213
v_mul_f32 v209,v209,v213
v_mul_f32 v210,v210,v213
v_mul_f32 v211,v211,v213
aw a20,v208
aw a21,v209
aw a22,v210
aw a23,v211
ar v208,a24
ar v209,a25
ar v210,a26
ar v211,a27
v_mul_f32 v208,v208,v214
v_mul_f32 v209,v209,v214
v_mul_f32 v210,v210,v214
v_mul_f32 v211,v211,v214
aw a24,v208
aw a25,v209
aw a26,v210
aw a27,v211
ar v208,a28
ar v209,a29
ar v210,a30
ar v211,a31
v_mul_f32 v208,v208,v215
v_mul_f32 v209,v209,v215
v_mul_f32 v210,v210,v215
v_mul_f32 v211,v211,v215
aw a28,v208
aw a29,v209
aw a30,v210
aw a31,v211
ar v208,a32
ar v209,a33
ar v210,a34
ar v211,a35
v_mul_f32 v208,v208,v212
v_mul_f32 v209,v209,v212
v_mul_f32 v210,v210,v212
v_mul_f32 v211,v211,v212
aw a32,v208
aw a33,v209
aw a34,v210
aw a35,v211
ar v208,a36
ar v209,a37
ar v210,a38
ar v211,a39
v_mul_f32 v208,v208,v213
v_mul_f32 v209,v209,v213
v_mul_f32 v210,v210,v213
v_mul_f32 v211,v211,v213
aw a36,v208
aw a37,v209
aw a38,v210
aw a39,v211
ar v208,a40
ar v209,a41
ar v210,a42
ar v211,a43
v_mul_f32 v208,v208,v214
v_mul_f32 v209,v209,v214
v_mul_f32 v210,v210,v214
v_mul_f32 v211,v211,v214
aw a40,v208
aw a41,v209
aw a42,v210
aw a43,v211
ar v208,a44
ar v209,a45
ar v210,a46
ar v211,a47
v_mul_f32 v208,v208,v215
v_mul_f32 v209,v209,v215
v_mul_f32 v210,v210,v215
v_mul_f32 v211,v211,v215
aw a44,v208
aw a45,v209
aw a46,v210
aw a47,v211
ar v208,a48
ar v209,a49
ar v210,a50
ar v211,a51
v_mul_f32 v208,v208,v212
v_mul_f32 v209,v209,v212
v_mul_f32 v210,v210,v212
v_mul_f32 v211,v211,v212
aw a48,v208
aw a49,v209
aw a50,v210
aw a51,v211
ar v208,a52
ar v209,a53
ar v210,a54
ar v211,a55
v_mul_f32 v208,v208,v213
v_mul_f32 v209,v209,v213
v_mul_f32 v210,v210,v213
v_mul_f32 v211,v211,v213
aw a52,v208
aw a53,v209
aw a54,v210
aw a55,v211
ar v208,a56
ar v209,a57
ar v210,a58
ar v211,a59
v_mul_f32 v208,v208,v214
v_mul_f32 v209,v209,v214
v_mul_f32 v210,v210,v214
v_mul_f32 v211,v211,v214
aw a56,v208
aw a57,v209
aw a58,v210
aw a59,v211
ar v208,a60
ar v209,a61
ar v210,a62
ar v211,a63
v_mul_f32 v208,v208,v215
v_mul_f32 v209,v209,v215
v_mul_f32 v210,v210,v215
v_mul_f32 v211,v211,v215
aw a60,v208
aw a61,v209
aw a62,v210
aw a63,v211
ar v208,a64
ar v209,a65
ar v210,a66
ar v211,a67
v_mul_f32 v208,v208,v212
v_mul_f32 v209,v209,v212
v_mul_f32 v210,v210,v212
v_mul_f32 v211,v211,v212
aw a64,v208
aw a65,v209
aw a66,v210
aw a67,v211
ar v208,a68
ar v209,a69
ar v210,a70
ar v211,a71
v_mul_f32 v208,v208,v213
v_mul_f32 v209,v209,v213
v_mul_f32 v210,v210,v213
v_mul_f32 v211,v211,v213
aw a68,v208
aw a69,v209
aw a70,v210
aw a71,v211
ar v208,a72
ar v209,a73
ar v210,a74
ar v211,a75
v_mul_f32 v208,v208,v214
v_mul_f32 v209,v209,v214
v_mul_f32 v210,v210,v214
v_mul_f32 v211,v211,v214
aw a72,v208
aw a73,v209
aw a74,v210
aw a75,v211
ar v208,a76
ar v209,a77
ar v210,a78
ar v211,a79
v_mul_f32 v208,v208,v215
v_mul_f32 v209,v209,v215
v_mul_f32 v210,v210,v215
v_mul_f32 v211,v211,v215
aw a76,v208
aw a77,v209
aw a78,v210
aw a79,v211
ar v208,a80
ar v209,a81
ar v210,a82
ar v211,a83
v_mul_f32 v208,v208,v212
v_mul_f32 v209,v209,v212
v_mul_f32 v210,v210,v212
v_mul_f32 v211,v211,v212
aw a80,v208
aw a81,v209
aw a82,v210
aw a83,v211
ar v208,a84
ar v209,a85
ar v210,a86
ar v211,a87
v_mul_f32 v208,v208,v213
v_mul_f32 v209,v209,v213
v_mul_f32 v210,v210,v213
v_mul_f32 v211,v211,v213
aw a84,v208
aw a85,v209
aw a86,v210
aw a87,v211
ar v208,a88
ar v209,a89
ar v210,a90
ar v211,a91
v_mul_f32 v208,v208,v214
v_mul_f32 v209,v209,v214
v_mul_f32 v210,v210,v214
v_mul_f32 v211,v211,v214
aw a88,v208
aw a89,v209
aw a90,v210
aw a91,v211
ar v208,a92
ar v209,a93
ar v210,a94
ar v211,a95
v_mul_f32 v208,v208,v215
v_mul_f32 v209,v209,v215
v_mul_f32 v210,v210,v215
v_mul_f32 v211,v211,v215
aw a92,v208
aw a93,v209
aw a94,v210
aw a95,v211
ar v208,a96
ar v209,a97
ar v210,a98
ar v211,a99
v_mul_f32 v208,v208,v212
v_mul_f32 v209,v209,v212
v_mul_f32 v210,v210,v212
v_mul_f32 v211,v211,v212
aw a96,v208
aw a97,v209
aw a98,v210
aw a99,v211
ar v208,a100
ar v209,a101
ar v210,a102
ar v211,a103
v_mul_f32 v208,v208,v213
v_mul_f32 v209,v209,v213
v_mul_f32 v210,v210,v213
v_mul_f32 v211,v211,v213
aw a100,v208
aw a101,v209
aw a102,v210
aw a103,v211
ar v208,a104
ar v209,a105
ar v210,a106
ar v211,a107
v_mul_f32 v208,v208,v214
v_mul_f32 v209,v209,v214
v_mul_f32 v210,v210,v214
v_mul_f32 v211,v211,v214
aw a104,v208
aw a105,v209
aw a106,v210
aw a107,v211
ar v208,a108
ar v209,a109
ar v210,a110
ar v211,a111
v_mul_f32 v208,v208,v215
v_mul_f32 v209,v209,v215
v_mul_f32 v210,v210,v215
v_mul_f32 v211,v211,v215
aw a108,v208
aw a109,v209
aw a110,v210
aw a111,v211
ar v208,a112
ar v209,a113
ar v210,a114
ar v211,a115
v_mul_f32 v208,v208,v212
v_mul_f32 v209,v209,v212
v_mul_f32 v210,v210,v212
v_mul_f32 v211,v211,v212
aw a112,v208
aw a113,v209
aw a114,v210
aw a115,v211
ar v208,a116
ar v209,a117
ar v210,a118
ar v211,a119
v_mul_f32 v208,v208,v213
v_mul_f32 v209,v209,v213
v_mul_f32 v210,v210,v213
v_mul_f32 v211,v211,v213
aw a116,v208
aw a117,v209
aw a118,v210
aw a119,v211
ar v208,a120
ar v209,a121
ar v210,a122
ar v211,a123
v_mul_f32 v208,v208,v214
v_mul_f32 v209,v209,v214
v_mul_f32 v210,v210,v214
v_mul_f32 v211,v211,v214
aw a120,v208
aw a121,v209
aw a122,v210
aw a123,v211
ar v208,a124
ar v209,a125
ar v210,a126
ar v211,a127
v_mul_f32 v208,v208,v215
v_mul_f32 v209,v209,v215
v_mul_f32 v210,v210,v215
v_mul_f32 v211,v211,v215
aw a124,v208
aw a125,v209
aw a126,v210
aw a127,v211
ar v208,a224
ar v209,a225
ar v210,a226
ar v211,a227
v_mul_f32 v208,v208,v212
v_mul_f32 v209,v209,v212
v_mul_f32 v210,v210,v212
v_mul_f32 v211,v211,v212
aw a224,v208
aw a225,v209
aw a226,v210
aw a227,v211
ar v208,a228
ar v209,a229
ar v210,a230
ar v211,a231
v_mul_f32 v208,v208,v213
v_mul_f32 v209,v209,v213
v_mul_f32 v210,v210,v213
v_mul_f32 v211,v211,v213
aw a228,v208
aw a229,v209
aw a230,v210
aw a231,v211
ar v208,a232
ar v209,a233
ar v210,a234
ar v211,a235
v_mul_f32 v208,v208,v214
v_mul_f32 v209,v209,v214
v_mul_f32 v210,v210,v214
v_mul_f32 v211,v211,v214
aw a232,v208
aw a233,v209
aw a234,v210
aw a235,v211
ar v208,a236
ar v209,a237
ar v210,a238
ar v211,a239
v_mul_f32 v208,v208,v215
v_mul_f32 v209,v209,v215
v_mul_f32 v210,v210,v215
v_mul_f32 v211,v211,v215
aw a236,v208
aw a237,v209
aw a238,v210
aw a239,v211
v_exp_f32 v176,v64
v_exp_f32 v177,v65
s_nop 0
cv v128,v176,v177
v_exp_f32 v178,v66
v_exp_f32 v179,v67
s_nop 0
cv v129,v178,v179
v_exp_f32 v180,v80
v_exp_f32 v181,v81
s_nop 0
cv v130,v180,v181
v_exp_f32 v182,v82
v_exp_f32 v183,v83
s_nop 0
cv v131,v182,v183
v_exp_f32 v176,v68
v_exp_f32 v177,v69
s_nop 0
cv v132,v176,v177
v_exp_f32 v178,v70
v_exp_f32 v179,v71
s_nop 0
cv v133,v178,v179
v_exp_f32 v180,v84
v_exp_f32 v181,v85
s_nop 0
cv v134,v180,v181
v_exp_f32 v182,v86
v_exp_f32 v183,v87
s_nop 0
cv v135,v182,v183
v_exp_f32 v176,v72
v_exp_f32 v177,v73
s_nop 0
cv v136,v176,v177
v_exp_f32 v178,v74
v_exp_f32 v179,v75
s_nop 0
cv v137,v178,v179
v_exp_f32 v180,v88
v_exp_f32 v181,v89
s_nop 0
cv v138,v180,v181
v_exp_f32 v182,v90
v_exp_f32 v183,v91
s_nop 0
cv v139,v182,v183
v_exp_f32 v176,v76
v_exp_f32 v177,v77
s_nop 0
cv v140,v176,v177
v_exp_f32 v178,v78
v_exp_f32 v179,v79
s_nop 0
cv v141,v178,v179
v_exp_f32 v180,v92
v_exp_f32 v181,v93
s_nop 0
cv v142,v180,v181
v_exp_f32 v182,v94
v_exp_f32 v183,v95
s_nop 0
cv v143,v182,v183
v_exp_f32 v176,v96
v_exp_f32 v177,v97
v_exp_f32 v178,v98
cv v144,v176,v177
v_exp_f32 v179,v99
s_nop 0
cv v145,v178,v179
v_exp_f32 v180,v112
v_exp_f32 v181,v113
v_exp_f32 v182,v114
cv v146,v180,v181
v_or3_b32 v185,v144,v145,v146
v_exp_f32 v183,v115
v_exp_f32 v176,v100
cv v147,v182,v183
v_exp_f32 v177,v101
v_exp_f32 v178,v102
cv v148,v176,v177
v_exp_f32 v179,v103
v_exp_f32 v180,v116
v_or3_b32 v185,v147,v148,v185
cv v149,v178,v179
v_exp_f32 v181,v117
v_exp_f32 v182,v118
cv v150,v180,v181
v_or3_b32 v185,v149,v150,v185
v_exp_f32 v183,v119
v_exp_f32 v176,v104
cv v151,v182,v183
s_nop 3
s_setpc_b64 s[60:61]
attn_slow_3:
s_nop 15
s_add_u32 s62,s62,1
v_max3_f32 v204,v96,v97,v98
v_max3_f32 v204,v99,v112,v204
v_max3_f32 v204,v113,v114,v204
v_max_f32 v204,v115,v204
v_max3_f32 v205,v100,v101,v102
v_max3_f32 v205,v103,v116,v205
v_max3_f32 v205,v117,v118,v205
v_max_f32 v205,v119,v205
v_max3_f32 v206,v104,v105,v106
v_max3_f32 v206,v107,v120,v206
v_max3_f32 v206,v121,v122,v206
v_max_f32 v206,v123,v206
v_max3_f32 v207,v108,v109,v110
v_max3_f32 v207,v111,v124,v207
v_max3_f32 v207,v125,v126,v207
v_max_f32 v207,v127,v207
v_mov_b32 v208,v204
v_mov_b32 v209,v205
v_mov_b32 v210,v206
v_mov_b32 v211,v207
v_permlane16_swap_b32 v208,v204
v_permlane16_swap_b32 v209,v205
v_permlane16_swap_b32 v210,v206
v_permlane16_swap_b32 v211,v207
v_max_f32 v204,v204,v208
v_max_f32 v205,v205,v209
v_max_f32 v206,v206,v210
v_max_f32 v207,v207,v211
v_mov_b32 v208,v204
v_mov_b32 v209,v205
v_mov_b32 v210,v206
v_mov_b32 v211,v207
v_permlane32_swap_b32 v208,v204
v_permlane32_swap_b32 v209,v205
v_permlane32_swap_b32 v210,v206
v_permlane32_swap_b32 v211,v207
v_max_f32 v204,v204,v208
v_max_f32 v205,v205,v209
v_max_f32 v206,v206,v210
v_max_f32 v207,v207,v211
v_add_f32 v204,0x42b40000,v204
v_max_f32 v204,0,v204
v_add_f32 v205,0x42b40000,v205
v_max_f32 v205,0,v205
v_add_f32 v206,0x42b40000,v206
v_max_f32 v206,0,v206
v_add_f32 v207,0x42b40000,v207
v_max_f32 v207,0,v207
v_exp_f32 v212,-v204
v_exp_f32 v213,-v205
v_exp_f32 v214,-v206
v_exp_f32 v215,-v207
v_sub_f32 v160,v160,v204
v_sub_f32 v161,v161,v204
v_sub_f32 v162,v162,v204
v_sub_f32 v163,v163,v204
v_sub_f32 v96,v96,v204
v_sub_f32 v97,v97,v204
v_sub_f32 v98,v98,v204
v_sub_f32 v99,v99,v204
v_sub_f32 v112,v112,v204
v_sub_f32 v113,v113,v204
v_sub_f32 v114,v114,v204
v_sub_f32 v115,v115,v204
v_sub_f32 v0,v0,v204
v_sub_f32 v1,v1,v204
v_sub_f32 v2,v2,v204
v_sub_f32 v3,v3,v204
v_sub_f32 v16,v16,v204
v_sub_f32 v17,v17,v204
v_sub_f32 v18,v18,v204
v_sub_f32 v19,v19,v204
v_sub_f32 v32,v32,v204
v_sub_f32 v33,v33,v204
v_sub_f32 v34,v34,v204
v_sub_f32 v35,v35,v204
v_sub_f32 v48,v48,v204
v_sub_f32 v49,v49,v204
v_sub_f32 v50,v50,v204
v_sub_f32 v51,v51,v204
v_sub_f32 v164,v164,v205
v_sub_f32 v165,v165,v205
v_sub_f32 v166,v166,v205
v_sub_f32 v167,v167,v205
v_sub_f32 v100,v100,v205
v_sub_f32 v101,v101,v205
v_sub_f32 v102,v102,v205
v_sub_f32 v103,v103,v205
v_sub_f32 v116,v116,v205
v_sub_f32 v117,v117,v205
v_sub_f32 v118,v118,v205
v_sub_f32 v119,v119,v205
v_sub_f32 v4,v4,v205
v_sub_f32 v5,v5,v205
v_sub_f32 v6,v6,v205
v_sub_f32 v7,v7,v205
v_sub_f32 v20,v20,v205
v_sub_f32 v21,v21,v205
v_sub_f32 v22,v22,v205
v_sub_f32 v23,v23,v205
v_sub_f32 v36,v36,v205
v_sub_f32 v37,v37,v205
v_sub_f32 v38,v38,v205
v_sub_f32 v39,v39,v205
v_sub_f32 v52,v52,v205
v_sub_f32 v53,v53,v205
v_sub_f32 v54,v54,v205
v_sub_f32 v55,v55,v205
v_sub_f32 v168,v168,v206
v_sub_f32 v169,v169,v206
v_sub_f32 v170,v170,v206
v_sub_f32 v171,v171,v206
v_sub_f32 v104,v104,v206
v_sub_f32 v105,v105,v206
v_sub_f32 v106,v106,v206
v_sub_f32 v107,v107,v206
v_sub_f32 v120,v120,v206
v_sub_f32 v121,v121,v206
v_sub_f32 v122,v122,v206
v_sub_f32 v123,v123,v206
v_sub_f32 v8,v8,v206
v_sub_f32 v9,v9,v206
v_sub_f32 v10,v10,v206
v_sub_f32 v11,v11,v206
v_sub_f32 v24,v24,v206
v_sub_f32 v25,v25,v206
v_sub_f32 v26,v26,v206
v_sub_f32 v27,v27,v206
v_sub_f32 v40,v40,v206
v_sub_f32 v41,v41,v206
v_sub_f32 v42,v42,v206
v_sub_f32 v43,v43,v206
v_sub_f32 v56,v56,v206
v_sub_f32 v57,v57,v206
v_sub_f32 v58,v58,v206
v_sub_f32 v59,v59,v206
v_sub_f32 v172,v172,v207
v_sub_f32 v173,v173,v207
v_sub_f32 v174,v174,v207
v_sub_f32 v175,v175,v207
v_sub_f32 v108,v108,v207
v_sub_f32 v109,v109,v207
v_sub_f32 v110,v110,v207
v_sub_f32 v111,v111,v207
v_sub_f32 v124,v124,v207
v_sub_f32 v125,v125,v207
v_sub_f32 v126,v126,v207
v_sub_f32 v127,v127,v207
v_sub_f32 v12,v12,v207
v_sub_f32 v13,v13,v207
v_sub_f32 v14,v14,v207
v_sub_f32 v15,v15,v207
v_sub_f32 v28,v28,v207
v_sub_f32 v29,v29,v207
v_sub_f32 v30,v30,v207
v_sub_f32 v31,v31,v207
v_sub_f32 v44,v44,v207
v_sub_f32 v45,v45,v207
v_sub_f32 v46,v46,v207
v_sub_f32 v47,v47,v207
v_sub_f32 v60,v60,v207
v_sub_f32 v61,v61,v207
v_sub_f32 v62,v62,v207
v_sub_f32 v63,v63,v207
ar v208,a0
ar v209,a1
ar v210,a2
ar v211,a3
v_mul_f32 v208,v208,v212
v_mul_f32 v209,v209,v212
v_mul_f32 v210,v210,v212
v_mul_f32 v211,v211,v212
aw a0,v208
aw a1,v209
aw a2,v210
aw a3,v211
ar v208,a4
ar v209,a5
ar v210,a6
ar v211,a7
v_mul_f32 v208,v208,v213
v_mul_f32 v209,v209,v213
v_mul_f32 v210,v210,v213
v_mul_f32 v211,v211,v213
aw a4,v208
aw a5,v209
aw a6,v210
aw a7,v211
ar v208,a8
ar v209,a9
ar v210,a10
ar v211,a11
v_mul_f32 v208,v208,v214
v_mul_f32 v209,v209,v214
v_mul_f32 v210,v210,v214
v_mul_f32 v211,v211,v214
aw a8,v208
aw a9,v209
aw a10,v210
aw a11,v211
ar v208,a12
ar v209,a13
ar v210,a14
ar v211,a15
v_mul_f32 v208,v208,v215
v_mul_f32 v209,v209,v215
v_mul_f32 v210,v210,v215
v_mul_f32 v211,v211,v215
aw a12,v208
aw a13,v209
aw a14,v210
aw a15,v211
ar v208,a16
ar v209,a17
ar v210,a18
ar v211,a19
v_mul_f32 v208,v208,v212
v_mul_f32 v209,v209,v212
v_mul_f32 v210,v210,v212
v_mul_f32 v211,v211,v212
aw a16,v208
aw a17,v209
aw a18,v210
aw a19,v211
ar v208,a20
ar v209,a21
ar v210,a22
ar v211,a23
v_mul_f32 v208,v208,v213
v_mul_f32 v209,v209,v213
v_mul_f32 v210,v210,v213
v_mul_f32 v211,v211,v213
aw a20,v208
aw a21,v209
aw a22,v210
aw a23,v211
ar v208,a24
ar v209,a25
ar v210,a26
ar v211,a27
v_mul_f32 v208,v208,v214
v_mul_f32 v209,v209,v214
v_mul_f32 v210,v210,v214
v_mul_f32 v211,v211,v214
aw a24,v208
aw a25,v209
aw a26,v210
aw a27,v211
ar v208,a28
ar v209,a29
ar v210,a30
ar v211,a31
v_mul_f32 v208,v208,v215
v_mul_f32 v209,v209,v215
v_mul_f32 v210,v210,v215
v_mul_f32 v211,v211,v215
aw a28,v208
aw a29,v209
aw a30,v210
aw a31,v211
ar v208,a32
ar v209,a33
ar v210,a34
ar v211,a35
v_mul_f32 v208,v208,v212
v_mul_f32 v209,v209,v212
v_mul_f32 v210,v210,v212
v_mul_f32 v211,v211,v212
aw a32,v208
aw a33,v209
aw a34,v210
aw a35,v211
ar v208,a36
ar v209,a37
ar v210,a38
ar v211,a39
v_mul_f32 v208,v208,v213
v_mul_f32 v209,v209,v213
v_mul_f32 v210,v210,v213
v_mul_f32 v211,v211,v213
aw a36,v208
aw a37,v209
aw a38,v210
aw a39,v211
ar v208,a40
ar v209,a41
ar v210,a42
ar v211,a43
v_mul_f32 v208,v208,v214
v_mul_f32 v209,v209,v214
v_mul_f32 v210,v210,v214
v_mul_f32 v211,v211,v214
aw a40,v208
aw a41,v209
aw a42,v210
aw a43,v211
ar v208,a44
ar v209,a45
ar v210,a46
ar v211,a47
v_mul_f32 v208,v208,v215
v_mul_f32 v209,v209,v215
v_mul_f32 v210,v210,v215
v_mul_f32 v211,v211,v215
aw a44,v208
aw a45,v209
aw a46,v210
aw a47,v211
ar v208,a48
ar v209,a49
ar v210,a50
ar v211,a51
v_mul_f32 v208,v208,v212
v_mul_f32 v209,v209,v212
v_mul_f32 v210,v210,v212
v_mul_f32 v211,v211,v212
aw a48,v208
aw a49,v209
aw a50,v210
aw a51,v211
ar v208,a52
ar v209,a53
ar v210,a54
ar v211,a55
v_mul_f32 v208,v208,v213
v_mul_f32 v209,v209,v213
v_mul_f32 v210,v210,v213
v_mul_f32 v211,v211,v213
aw a52,v208
aw a53,v209
aw a54,v210
aw a55,v211
ar v208,a56
ar v209,a57
ar v210,a58
ar v211,a59
v_mul_f32 v208,v208,v214
v_mul_f32 v209,v209,v214
v_mul_f32 v210,v210,v214
v_mul_f32 v211,v211,v214
aw a56,v208
aw a57,v209
aw a58,v210
aw a59,v211
ar v208,a60
ar v209,a61
ar v210,a62
ar v211,a63
v_mul_f32 v208,v208,v215
v_mul_f32 v209,v209,v215
v_mul_f32 v210,v210,v215
v_mul_f32 v211,v211,v215
aw a60,v208
aw a61,v209
aw a62,v210
aw a63,v211
ar v208,a64
ar v209,a65
ar v210,a66
ar v211,a67
v_mul_f32 v208,v208,v212
v_mul_f32 v209,v209,v212
v_mul_f32 v210,v210,v212
v_mul_f32 v211,v211,v212
aw a64,v208
aw a65,v209
aw a66,v210
aw a67,v211
ar v208,a68
ar v209,a69
ar v210,a70
ar v211,a71
v_mul_f32 v208,v208,v213
v_mul_f32 v209,v209,v213
v_mul_f32 v210,v210,v213
v_mul_f32 v211,v211,v213
aw a68,v208
aw a69,v209
aw a70,v210
aw a71,v211
ar v208,a72
ar v209,a73
ar v210,a74
ar v211,a75
v_mul_f32 v208,v208,v214
v_mul_f32 v209,v209,v214
v_mul_f32 v210,v210,v214
v_mul_f32 v211,v211,v214
aw a72,v208
aw a73,v209
aw a74,v210
aw a75,v211
ar v208,a76
ar v209,a77
ar v210,a78
ar v211,a79
v_mul_f32 v208,v208,v215
v_mul_f32 v209,v209,v215
v_mul_f32 v210,v210,v215
v_mul_f32 v211,v211,v215
aw a76,v208
aw a77,v209
aw a78,v210
aw a79,v211
ar v208,a80
ar v209,a81
ar v210,a82
ar v211,a83
v_mul_f32 v208,v208,v212
v_mul_f32 v209,v209,v212
v_mul_f32 v210,v210,v212
v_mul_f32 v211,v211,v212
aw a80,v208
aw a81,v209
aw a82,v210
aw a83,v211
ar v208,a84
ar v209,a85
ar v210,a86
ar v211,a87
v_mul_f32 v208,v208,v213
v_mul_f32 v209,v209,v213
v_mul_f32 v210,v210,v213
v_mul_f32 v211,v211,v213
aw a84,v208
aw a85,v209
aw a86,v210
aw a87,v211
ar v208,a88
ar v209,a89
ar v210,a90
ar v211,a91
v_mul_f32 v208,v208,v214
v_mul_f32 v209,v209,v214
v_mul_f32 v210,v210,v214
v_mul_f32 v211,v211,v214
aw a88,v208
aw a89,v209
aw a90,v210
aw a91,v211
ar v208,a92
ar v209,a93
ar v210,a94
ar v211,a95
v_mul_f32 v208,v208,v215
v_mul_f32 v209,v209,v215
v_mul_f32 v210,v210,v215
v_mul_f32 v211,v211,v215
aw a92,v208
aw a93,v209
aw a94,v210
aw a95,v211
ar v208,a96
ar v209,a97
ar v210,a98
ar v211,a99
v_mul_f32 v208,v208,v212
v_mul_f32 v209,v209,v212
v_mul_f32 v210,v210,v212
v_mul_f32 v211,v211,v212
aw a96,v208
aw a97,v209
aw a98,v210
aw a99,v211
ar v208,a100
ar v209,a101
ar v210,a102
ar v211,a103
v_mul_f32 v208,v208,v213
v_mul_f32 v209,v209,v213
v_mul_f32 v210,v210,v213
v_mul_f32 v211,v211,v213
aw a100,v208
aw a101,v209
aw a102,v210
aw a103,v211
ar v208,a104
ar v209,a105
ar v210,a106
ar v211,a107
v_mul_f32 v208,v208,v214
v_mul_f32 v209,v209,v214
v_mul_f32 v210,v210,v214
v_mul_f32 v211,v211,v214
aw a104,v208
aw a105,v209
aw a106,v210
aw a107,v211
ar v208,a108
ar v209,a109
ar v210,a110
ar v211,a111
v_mul_f32 v208,v208,v215
v_mul_f32 v209,v209,v215
v_mul_f32 v210,v210,v215
v_mul_f32 v211,v211,v215
aw a108,v208
aw a109,v209
aw a110,v210
aw a111,v211
ar v208,a112
ar v209,a113
ar v210,a114
ar v211,a115
v_mul_f32 v208,v208,v212
v_mul_f32 v209,v209,v212
v_mul_f32 v210,v210,v212
v_mul_f32 v211,v211,v212
aw a112,v208
aw a113,v209
aw a114,v210
aw a115,v211
ar v208,a116
ar v209,a117
ar v210,a118
ar v211,a119
v_mul_f32 v208,v208,v213
v_mul_f32 v209,v209,v213
v_mul_f32 v210,v210,v213
v_mul_f32 v211,v211,v213
aw a116,v208
aw a117,v209
aw a118,v210
aw a119,v211
ar v208,a120
ar v209,a121
ar v210,a122
ar v211,a123
v_mul_f32 v208,v208,v214
v_mul_f32 v209,v209,v214
v_mul_f32 v210,v210,v214
v_mul_f32 v211,v211,v214
aw a120,v208
aw a121,v209
aw a122,v210
aw a123,v211
ar v208,a124
ar v209,a125
ar v210,a126
ar v211,a127
v_mul_f32 v208,v208,v215
v_mul_f32 v209,v209,v215
v_mul_f32 v210,v210,v215
v_mul_f32 v211,v211,v215
aw a124,v208
aw a125,v209
aw a126,v210
aw a127,v211
ar v208,a224
ar v209,a225
ar v210,a226
ar v211,a227
v_mul_f32 v208,v208,v212
v_mul_f32 v209,v209,v212
v_mul_f32 v210,v210,v212
v_mul_f32 v211,v211,v212
aw a224,v208
aw a225,v209
aw a226,v210
aw a227,v211
ar v208,a228
ar v209,a229
ar v210,a230
ar v211,a231
v_mul_f32 v208,v208,v213
v_mul_f32 v209,v209,v213
v_mul_f32 v210,v210,v213
v_mul_f32 v211,v211,v213
aw a228,v208
aw a229,v209
aw a230,v210
aw a231,v211
ar v208,a232
ar v209,a233
ar v210,a234
ar v211,a235
v_mul_f32 v208,v208,v214
v_mul_f32 v209,v209,v214
v_mul_f32 v210,v210,v214
v_mul_f32 v211,v211,v214
aw a232,v208
aw a233,v209
aw a234,v210
aw a235,v211
ar v208,a236
ar v209,a237
ar v210,a238
ar v211,a239
v_mul_f32 v208,v208,v215
v_mul_f32 v209,v209,v215
v_mul_f32 v210,v210,v215
v_mul_f32 v211,v211,v215
aw a236,v208
aw a237,v209
aw a238,v210
aw a239,v211
v_exp_f32 v176,v96
v_exp_f32 v177,v97
s_nop 0
cv v144,v176,v177
v_exp_f32 v178,v98
v_exp_f32 v179,v99
s_nop 0
cv v145,v178,v179
v_exp_f32 v180,v112
v_exp_f32 v181,v113
s_nop 0
cv v146,v180,v181
v_exp_f32 v182,v114
v_exp_f32 v183,v115
s_nop 0
cv v147,v182,v183
v_exp_f32 v176,v100
v_exp_f32 v177,v101
s_nop 0
cv v148,v176,v177
v_exp_f32 v178,v102
v_exp_f32 v179,v103
s_nop 0
cv v149,v178,v179
v_exp_f32 v180,v116
v_exp_f32 v181,v117
s_nop 0
cv v150,v180,v181
v_exp_f32 v182,v118
v_exp_f32 v183,v119
s_nop 0
cv v151,v182,v183
v_exp_f32 v176,v104
v_exp_f32 v177,v105
s_nop 0
cv v152,v176,v177
v_exp_f32 v178,v106
v_exp_f32 v179,v107
s_nop 0
cv v153,v178,v179
v_exp_f32 v180,v120
v_exp_f32 v181,v121
s_nop 0
cv v154,v180,v181
v_exp_f32 v182,v122
v_exp_f32 v183,v123
s_nop 0
cv v155,v182,v183
v_exp_f32 v176,v108
v_exp_f32 v177,v109
s_nop 0
cv v156,v176,v177
v_exp_f32 v178,v110
v_exp_f32 v179,v111
s_nop 0
cv v157,v178,v179
v_exp_f32 v180,v124
v_exp_f32 v181,v125
s_nop 0
cv v158,v180,v181
v_exp_f32 v182,v126
v_exp_f32 v183,v127
s_nop 0
cv v159,v182,v183
s_nop 3
s_setpc_b64 s[60:61]
attn_slow_4:
s_nop 15
s_add_u32 s62,s62,1
v_max3_f32 v204,v0,v1,v2
v_max3_f32 v204,v3,v16,v204
v_max3_f32 v204,v17,v18,v204
v_max3_f32 v204,v19,v32,v204
v_max3_f32 v204,v33,v34,v204
v_max3_f32 v204,v35,v48,v204
v_max3_f32 v204,v49,v50,v204
v_max_f32 v204,v51,v204
v_max3_f32 v205,v4,v5,v6
v_max3_f32 v205,v7,v20,v205
v_max3_f32 v205,v21,v22,v205
v_max3_f32 v205,v23,v36,v205
v_max3_f32 v205,v37,v38,v205
v_max3_f32 v205,v39,v52,v205
v_max3_f32 v205,v53,v54,v205
v_max_f32 v205,v55,v205
v_max3_f32 v206,v8,v9,v10
v_max3_f32 v206,v11,v24,v206
v_max3_f32 v206,v25,v26,v206
v_max3_f32 v206,v27,v40,v206
v_max3_f32 v206,v41,v42,v206
v_max3_f32 v206,v43,v56,v206
v_max3_f32 v206,v57,v58,v206
v_max_f32 v206,v59,v206
v_max3_f32 v207,v12,v13,v14
v_max3_f32 v207,v15,v28,v207
v_max3_f32 v207,v29,v30,v207
v_max3_f32 v207,v31,v44,v207
v_max3_f32 v207,v45,v46,v207
v_max3_f32 v207,v47,v60,v207
v_max3_f32 v207,v61,v62,v207
v_max_f32 v207,v63,v207
v_mov_b32 v208,v204
v_mov_b32 v209,v205
v_mov_b32 v210,v206
v_mov_b32 v211,v207
v_permlane16_swap_b32 v208,v204
v_permlane16_swap_b32 v209,v205
v_permlane16_swap_b32 v210,v206
v_permlane16_swap_b32 v211,v207
v_max_f32 v204,v204,v208
v_max_f32 v205,v205,v209
v_max_f32 v206,v206,v210
v_max_f32 v207,v207,v211
v_mov_b32 v208,v204
v_mov_b32 v209,v205
v_mov_b32 v210,v206
v_mov_b32 v211,v207
v_permlane32_swap_b32 v208,v204
v_permlane32_swap_b32 v209,v205
v_permlane32_swap_b32 v210,v206
v_permlane32_swap_b32 v211,v207
v_max_f32 v204,v204,v208
v_max_f32 v205,v205,v209
v_max_f32 v206,v206,v210
v_max_f32 v207,v207,v211
v_add_f32 v204,0x42b40000,v204
v_max_f32 v204,0,v204
v_add_f32 v205,0x42b40000,v205
v_max_f32 v205,0,v205
v_add_f32 v206,0x42b40000,v206
v_max_f32 v206,0,v206
v_add_f32 v207,0x42b40000,v207
v_max_f32 v207,0,v207
v_exp_f32 v212,-v204
v_exp_f32 v213,-v205
v_exp_f32 v214,-v206
v_exp_f32 v215,-v207
v_sub_f32 v160,v160,v204
v_sub_f32 v161,v161,v204
v_sub_f32 v162,v162,v204
v_sub_f32 v163,v163,v204
v_sub_f32 v0,v0,v204
v_sub_f32 v1,v1,v204
v_sub_f32 v2,v2,v204
v_sub_f32 v3,v3,v204
v_sub_f32 v16,v16,v204
v_sub_f32 v17,v17,v204
v_sub_f32 v18,v18,v204
v_sub_f32 v19,v19,v204
v_sub_f32 v32,v32,v204
v_sub_f32 v33,v33,v204
v_sub_f32 v34,v34,v204
v_sub_f32 v35,v35,v204
v_sub_f32 v48,v48,v204
v_sub_f32 v49,v49,v204
v_sub_f32 v50,v50,v204
v_sub_f32 v51,v51,v204
v_sub_f32 v64,v64,v204
v_sub_f32 v65,v65,v204
v_sub_f32 v66,v66,v204
v_sub_f32 v67,v67,v204
v_sub_f32 v80,v80,v204
v_sub_f32 v81,v81,v204
v_sub_f32 v82,v82,v204
v_sub_f32 v83,v83,v204
v_sub_f32 v96,v96,v204
v_sub_f32 v97,v97,v204
v_sub_f32 v98,v98,v204
v_sub_f32 v99,v99,v204
v_sub_f32 v112,v112,v204
v_sub_f32 v113,v113,v204
v_sub_f32 v114,v114,v204
v_sub_f32 v115,v115,v204
v_sub_f32 v164,v164,v205
v_sub_f32 v165,v165,v205
v_sub_f32 v166,v166,v205
v_sub_f32 v167,v167,v205
v_sub_f32 v4,v4,v205
v_sub_f32 v5,v5,v205
v_sub_f32 v6,v6,v205
v_sub_f32 v7,v7,v205
v_sub_f32 v20,v20,v205
v_sub_f32 v21,v21,v205
v_sub_f32 v22,v22,v205
v_sub_f32 v23,v23,v205
v_sub_f32 v36,v36,v205
v_sub_f32 v37,v37,v205
v_sub_f32 v38,v38,v205
v_sub_f32 v39,v39,v205
v_sub_f32 v52,v52,v205
v_sub_f32 v53,v53,v205
v_sub_f32 v54,v54,v205
v_sub_f32 v55,v55,v205
v_sub_f32 v68,v68,v205
v_sub_f32 v69,v69,v205
v_sub_f32 v70,v70,v205
v_sub_f32 v71,v71,v205
v_sub_f32 v84,v84,v205
v_sub_f32 v85,v85,v205
v_sub_f32 v86,v86,v205
v_sub_f32 v87,v87,v205
v_sub_f32 v100,v100,v205
v_sub_f32 v101,v101,v205
v_sub_f32 v102,v102,v205
v_sub_f32 v103,v103,v205
v_sub_f32 v116,v116,v205
v_sub_f32 v117,v117,v205
v_sub_f32 v118,v118,v205
v_sub_f32 v119,v119,v205
v_sub_f32 v168,v168,v206
v_sub_f32 v169,v169,v206
v_sub_f32 v170,v170,v206
v_sub_f32 v171,v171,v206
v_sub_f32 v8,v8,v206
v_sub_f32 v9,v9,v206
v_sub_f32 v10,v10,v206
v_sub_f32 v11,v11,v206
v_sub_f32 v24,v24,v206
v_sub_f32 v25,v25,v206
v_sub_f32 v26,v26,v206
v_sub_f32 v27,v27,v206
v_sub_f32 v40,v40,v206
v_sub_f32 v41,v41,v206
v_sub_f32 v42,v42,v206
v_sub_f32 v43,v43,v206
v_sub_f32 v56,v56,v206
v_sub_f32 v57,v57,v206
v_sub_f32 v58,v58,v206
v_sub_f32 v59,v59,v206
v_sub_f32 v72,v72,v206
v_sub_f32 v73,v73,v206
v_sub_f32 v74,v74,v206
v_sub_f32 v75,v75,v206
v_sub_f32 v88,v88,v206
v_sub_f32 v89,v89,v206
v_sub_f32 v90,v90,v206
v_sub_f32 v91,v91,v206
v_sub_f32 v104,v104,v206
v_sub_f32 v105,v105,v206
v_sub_f32 v106,v106,v206
v_sub_f32 v107,v107,v206
v_sub_f32 v120,v120,v206
v_sub_f32 v121,v121,v206
v_sub_f32 v122,v122,v206
v_sub_f32 v123,v123,v206
v_sub_f32 v172,v172,v207
v_sub_f32 v173,v173,v207
v_sub_f32 v174,v174,v207
v_sub_f32 v175,v175,v207
v_sub_f32 v12,v12,v207
v_sub_f32 v13,v13,v207
v_sub_f32 v14,v14,v207
v_sub_f32 v15,v15,v207
v_sub_f32 v28,v28,v207
v_sub_f32 v29,v29,v207
v_sub_f32 v30,v30,v207
v_sub_f32 v31,v31,v207
v_sub_f32 v44,v44,v207
v_sub_f32 v45,v45,v207
v_sub_f32 v46,v46,v207
v_sub_f32 v47,v47,v207
v_sub_f32 v60,v60,v207
v_sub_f32 v61,v61,v207
v_sub_f32 v62,v62,v207
v_sub_f32 v63,v63,v207
v_sub_f32 v76,v76,v207
v_sub_f32 v77,v77,v207
v_sub_f32 v78,v78,v207
v_sub_f32 v79,v79,v207
v_sub_f32 v92,v92,v207
v_sub_f32 v93,v93,v207
v_sub_f32 v94,v94,v207
v_sub_f32 v95,v95,v207
v_sub_f32 v108,v108,v207
v_sub_f32 v109,v109,v207
v_sub_f32 v110,v110,v207
v_sub_f32 v111,v111,v207
v_sub_f32 v124,v124,v207
v_sub_f32 v125,v125,v207
v_sub_f32 v126,v126,v207
v_sub_f32 v127,v127,v207
ar v208,a0
ar v209,a1
ar v210,a2
ar v211,a3
v_mul_f32 v208,v208,v212
v_mul_f32 v209,v209,v212
v_mul_f32 v210,v210,v212
v_mul_f32 v211,v211,v212
aw a0,v208
aw a1,v209
aw a2,v210
aw a3,v211
ar v208,a4
ar v209,a5
ar v210,a6
ar v211,a7
v_mul_f32 v208,v208,v213
v_mul_f32 v209,v209,v213
v_mul_f32 v210,v210,v213
v_mul_f32 v211,v211,v213
aw a4,v208
aw a5,v209
aw a6,v210
aw a7,v211
ar v208,a8
ar v209,a9
ar v210,a10
ar v211,a11
v_mul_f32 v208,v208,v214
v_mul_f32 v209,v209,v214
v_mul_f32 v210,v210,v214
v_mul_f32 v211,v211,v214
aw a8,v208
aw a9,v209
aw a10,v210
aw a11,v211
ar v208,a12
ar v209,a13
ar v210,a14
ar v211,a15
v_mul_f32 v208,v208,v215
v_mul_f32 v209,v209,v215
v_mul_f32 v210,v210,v215
v_mul_f32 v211,v211,v215
aw a12,v208
aw a13,v209
aw a14,v210
aw a15,v211
ar v208,a16
ar v209,a17
ar v210,a18
ar v211,a19
v_mul_f32 v208,v208,v212
v_mul_f32 v209,v209,v212
v_mul_f32 v210,v210,v212
v_mul_f32 v211,v211,v212
aw a16,v208
aw a17,v209
aw a18,v210
aw a19,v211
ar v208,a20
ar v209,a21
ar v210,a22
ar v211,a23
v_mul_f32 v208,v208,v213
v_mul_f32 v209,v209,v213
v_mul_f32 v210,v210,v213
v_mul_f32 v211,v211,v213
aw a20,v208
aw a21,v209
aw a22,v210
aw a23,v211
ar v208,a24
ar v209,a25
ar v210,a26
ar v211,a27
v_mul_f32 v208,v208,v214
v_mul_f32 v209,v209,v214
v_mul_f32 v210,v210,v214
v_mul_f32 v211,v211,v214
aw a24,v208
aw a25,v209
aw a26,v210
aw a27,v211
ar v208,a28
ar v209,a29
ar v210,a30
ar v211,a31
v_mul_f32 v208,v208,v215
v_mul_f32 v209,v209,v215
v_mul_f32 v210,v210,v215
v_mul_f32 v211,v211,v215
aw a28,v208
aw a29,v209
aw a30,v210
aw a31,v211
ar v208,a32
ar v209,a33
ar v210,a34
ar v211,a35
v_mul_f32 v208,v208,v212
v_mul_f32 v209,v209,v212
v_mul_f32 v210,v210,v212
v_mul_f32 v211,v211,v212
aw a32,v208
aw a33,v209
aw a34,v210
aw a35,v211
ar v208,a36
ar v209,a37
ar v210,a38
ar v211,a39
v_mul_f32 v208,v208,v213
v_mul_f32 v209,v209,v213
v_mul_f32 v210,v210,v213
v_mul_f32 v211,v211,v213
aw a36,v208
aw a37,v209
aw a38,v210
aw a39,v211
ar v208,a40
ar v209,a41
ar v210,a42
ar v211,a43
v_mul_f32 v208,v208,v214
v_mul_f32 v209,v209,v214
v_mul_f32 v210,v210,v214
v_mul_f32 v211,v211,v214
aw a40,v208
aw a41,v209
aw a42,v210
aw a43,v211
ar v208,a44
ar v209,a45
ar v210,a46
ar v211,a47
v_mul_f32 v208,v208,v215
v_mul_f32 v209,v209,v215
v_mul_f32 v210,v210,v215
v_mul_f32 v211,v211,v215
aw a44,v208
aw a45,v209
aw a46,v210
aw a47,v211
ar v208,a48
ar v209,a49
ar v210,a50
ar v211,a51
v_mul_f32 v208,v208,v212
v_mul_f32 v209,v209,v212
v_mul_f32 v210,v210,v212
v_mul_f32 v211,v211,v212
aw a48,v208
aw a49,v209
aw a50,v210
aw a51,v211
ar v208,a52
ar v209,a53
ar v210,a54
ar v211,a55
v_mul_f32 v208,v208,v213
v_mul_f32 v209,v209,v213
v_mul_f32 v210,v210,v213
v_mul_f32 v211,v211,v213
aw a52,v208
aw a53,v209
aw a54,v210
aw a55,v211
ar v208,a56
ar v209,a57
ar v210,a58
ar v211,a59
v_mul_f32 v208,v208,v214
v_mul_f32 v209,v209,v214
v_mul_f32 v210,v210,v214
v_mul_f32 v211,v211,v214
aw a56,v208
aw a57,v209
aw a58,v210
aw a59,v211
ar v208,a60
ar v209,a61
ar v210,a62
ar v211,a63
v_mul_f32 v208,v208,v215
v_mul_f32 v209,v209,v215
v_mul_f32 v210,v210,v215
v_mul_f32 v211,v211,v215
aw a60,v208
aw a61,v209
aw a62,v210
aw a63,v211
ar v208,a64
ar v209,a65
ar v210,a66
ar v211,a67
v_mul_f32 v208,v208,v212
v_mul_f32 v209,v209,v212
v_mul_f32 v210,v210,v212
v_mul_f32 v211,v211,v212
aw a64,v208
aw a65,v209
aw a66,v210
aw a67,v211
ar v208,a68
ar v209,a69
ar v210,a70
ar v211,a71
v_mul_f32 v208,v208,v213
v_mul_f32 v209,v209,v213
v_mul_f32 v210,v210,v213
v_mul_f32 v211,v211,v213
aw a68,v208
aw a69,v209
aw a70,v210
aw a71,v211
ar v208,a72
ar v209,a73
ar v210,a74
ar v211,a75
v_mul_f32 v208,v208,v214
v_mul_f32 v209,v209,v214
v_mul_f32 v210,v210,v214
v_mul_f32 v211,v211,v214
aw a72,v208
aw a73,v209
aw a74,v210
aw a75,v211
ar v208,a76
ar v209,a77
ar v210,a78
ar v211,a79
v_mul_f32 v208,v208,v215
v_mul_f32 v209,v209,v215
v_mul_f32 v210,v210,v215
v_mul_f32 v211,v211,v215
aw a76,v208
aw a77,v209
aw a78,v210
aw a79,v211
ar v208,a80
ar v209,a81
ar v210,a82
ar v211,a83
v_mul_f32 v208,v208,v212
v_mul_f32 v209,v209,v212
v_mul_f32 v210,v210,v212
v_mul_f32 v211,v211,v212
aw a80,v208
aw a81,v209
aw a82,v210
aw a83,v211
ar v208,a84
ar v209,a85
ar v210,a86
ar v211,a87
v_mul_f32 v208,v208,v213
v_mul_f32 v209,v209,v213
v_mul_f32 v210,v210,v213
v_mul_f32 v211,v211,v213
aw a84,v208
aw a85,v209
aw a86,v210
aw a87,v211
ar v208,a88
ar v209,a89
ar v210,a90
ar v211,a91
v_mul_f32 v208,v208,v214
v_mul_f32 v209,v209,v214
v_mul_f32 v210,v210,v214
v_mul_f32 v211,v211,v214
aw a88,v208
aw a89,v209
aw a90,v210
aw a91,v211
ar v208,a92
ar v209,a93
ar v210,a94
ar v211,a95
v_mul_f32 v208,v208,v215
v_mul_f32 v209,v209,v215
v_mul_f32 v210,v210,v215
v_mul_f32 v211,v211,v215
aw a92,v208
aw a93,v209
aw a94,v210
aw a95,v211
ar v208,a96
ar v209,a97
ar v210,a98
ar v211,a99
v_mul_f32 v208,v208,v212
v_mul_f32 v209,v209,v212
v_mul_f32 v210,v210,v212
v_mul_f32 v211,v211,v212
aw a96,v208
aw a97,v209
aw a98,v210
aw a99,v211
ar v208,a100
ar v209,a101
ar v210,a102
ar v211,a103
v_mul_f32 v208,v208,v213
v_mul_f32 v209,v209,v213
v_mul_f32 v210,v210,v213
v_mul_f32 v211,v211,v213
aw a100,v208
aw a101,v209
aw a102,v210
aw a103,v211
ar v208,a104
ar v209,a105
ar v210,a106
ar v211,a107
v_mul_f32 v208,v208,v214
v_mul_f32 v209,v209,v214
v_mul_f32 v210,v210,v214
v_mul_f32 v211,v211,v214
aw a104,v208
aw a105,v209
aw a106,v210
aw a107,v211
ar v208,a108
ar v209,a109
ar v210,a110
ar v211,a111
v_mul_f32 v208,v208,v215
v_mul_f32 v209,v209,v215
v_mul_f32 v210,v210,v215
v_mul_f32 v211,v211,v215
aw a108,v208
aw a109,v209
aw a110,v210
aw a111,v211
ar v208,a112
ar v209,a113
ar v210,a114
ar v211,a115
v_mul_f32 v208,v208,v212
v_mul_f32 v209,v209,v212
v_mul_f32 v210,v210,v212
v_mul_f32 v211,v211,v212
aw a112,v208
aw a113,v209
aw a114,v210
aw a115,v211
ar v208,a116
ar v209,a117
ar v210,a118
ar v211,a119
v_mul_f32 v208,v208,v213
v_mul_f32 v209,v209,v213
v_mul_f32 v210,v210,v213
v_mul_f32 v211,v211,v213
aw a116,v208
aw a117,v209
aw a118,v210
aw a119,v211
ar v208,a120
ar v209,a121
ar v210,a122
ar v211,a123
v_mul_f32 v208,v208,v214
v_mul_f32 v209,v209,v214
v_mul_f32 v210,v210,v214
v_mul_f32 v211,v211,v214
aw a120,v208
aw a121,v209
aw a122,v210
aw a123,v211
ar v208,a124
ar v209,a125
ar v210,a126
ar v211,a127
v_mul_f32 v208,v208,v215
v_mul_f32 v209,v209,v215
v_mul_f32 v210,v210,v215
v_mul_f32 v211,v211,v215
aw a124,v208
aw a125,v209
aw a126,v210
aw a127,v211
ar v208,a224
ar v209,a225
ar v210,a226
ar v211,a227
v_mul_f32 v208,v208,v212
v_mul_f32 v209,v209,v212
v_mul_f32 v210,v210,v212
v_mul_f32 v211,v211,v212
aw a224,v208
aw a225,v209
aw a226,v210
aw a227,v211
ar v208,a228
ar v209,a229
ar v210,a230
ar v211,a231
v_mul_f32 v208,v208,v213
v_mul_f32 v209,v209,v213
v_mul_f32 v210,v210,v213
v_mul_f32 v211,v211,v213
aw a228,v208
aw a229,v209
aw a230,v210
aw a231,v211
ar v208,a232
ar v209,a233
ar v210,a234
ar v211,a235
v_mul_f32 v208,v208,v214
v_mul_f32 v209,v209,v214
v_mul_f32 v210,v210,v214
v_mul_f32 v211,v211,v214
aw a232,v208
aw a233,v209
aw a234,v210
aw a235,v211
ar v208,a236
ar v209,a237
ar v210,a238
ar v211,a239
v_mul_f32 v208,v208,v215
v_mul_f32 v209,v209,v215
v_mul_f32 v210,v210,v215
v_mul_f32 v211,v211,v215
aw a236,v208
aw a237,v209
aw a238,v210
aw a239,v211
v_exp_f32 v176,v0
v_exp_f32 v177,v1
s_nop 0
cv v128,v176,v177
v_exp_f32 v178,v2
v_exp_f32 v179,v3
s_nop 0
cv v129,v178,v179
v_exp_f32 v180,v16
v_exp_f32 v181,v17
s_nop 0
cv v130,v180,v181
v_exp_f32 v182,v18
v_exp_f32 v183,v19
s_nop 0
cv v131,v182,v183
v_exp_f32 v176,v4
v_exp_f32 v177,v5
s_nop 0
cv v132,v176,v177
v_exp_f32 v178,v6
v_exp_f32 v179,v7
s_nop 0
cv v133,v178,v179
v_exp_f32 v180,v20
v_exp_f32 v181,v21
s_nop 0
cv v134,v180,v181
v_exp_f32 v182,v22
v_exp_f32 v183,v23
s_nop 0
cv v135,v182,v183
v_exp_f32 v176,v8
v_exp_f32 v177,v9
s_nop 0
cv v136,v176,v177
v_exp_f32 v178,v10
v_exp_f32 v179,v11
s_nop 0
cv v137,v178,v179
v_exp_f32 v180,v24
v_exp_f32 v181,v25
s_nop 0
cv v138,v180,v181
v_exp_f32 v182,v26
v_exp_f32 v183,v27
s_nop 0
cv v139,v182,v183
v_exp_f32 v176,v12
v_exp_f32 v177,v13
s_nop 0
cv v140,v176,v177
v_exp_f32 v178,v14
v_exp_f32 v179,v15
s_nop 0
cv v141,v178,v179
v_exp_f32 v180,v28
v_exp_f32 v181,v29
s_nop 0
cv v142,v180,v181
v_exp_f32 v182,v30
v_exp_f32 v183,v31
s_nop 0
cv v143,v182,v183
v_exp_f32 v176,v32
v_exp_f32 v177,v33
v_exp_f32 v178,v34
cv v144,v176,v177
v_exp_f32 v179,v35
s_nop 0
cv v145,v178,v179
v_exp_f32 v180,v48
v_exp_f32 v181,v49
v_exp_f32 v182,v50
cv v146,v180,v181
v_or3_b32 v185,v144,v145,v146
v_exp_f32 v183,v51
v_exp_f32 v176,v36
cv v147,v182,v183
v_exp_f32 v177,v37
v_exp_f32 v178,v38
cv v148,v176,v177
v_exp_f32 v179,v39
v_exp_f32 v180,v52
v_or3_b32 v185,v147,v148,v185
cv v149,v178,v179
v_exp_f32 v181,v53
v_exp_f32 v182,v54
cv v150,v180,v181
v_exp_f32 v183,v55
v_exp_f32 v176,v40
v_or3_b32 v185,v149,v150,v185
cv v151,v182,v183
s_nop 3
s_setpc_b64 s[60:61]
attn_slow_5:
s_nop 15
s_add_u32 s62,s62,1
v_max3_f32 v204,v64,v65,v66
v_max3_f32 v204,v67,v80,v204
v_max3_f32 v204,v81,v82,v204
v_max3_f32 v204,v83,v96,v204
v_max3_f32 v204,v97,v98,v204
v_max3_f32 v204,v99,v112,v204
v_max3_f32 v204,v113,v114,v204
v_max_f32 v204,v115,v204
v_max3_f32 v205,v68,v69,v70
v_max3_f32 v205,v71,v84,v205
v_max3_f32 v205,v85,v86,v205
v_max3_f32 v205,v87,v100,v205
v_max3_f32 v205,v101,v102,v205
v_max3_f32 v205,v103,v116,v205
v_max3_f32 v205,v117,v118,v205
v_max_f32 v205,v119,v205
v_max3_f32 v206,v72,v73,v74
v_max3_f32 v206,v75,v88,v206
v_max3_f32 v206,v89,v90,v206
v_max3_f32 v206,v91,v104,v206
v_max3_f32 v206,v105,v106,v206
v_max3_f32 v206,v107,v120,v206
v_max3_f32 v206,v121,v122,v206
v_max_f32 v206,v123,v206
v_max3_f32 v207,v76,v77,v78
v_max3_f32 v207,v79,v92,v207
v_max3_f32 v207,v93,v94,v207
v_max3_f32 v207,v95,v108,v207
v_max3_f32 v207,v109,v110,v207
v_max3_f32 v207,v111,v124,v207
v_max3_f32 v207,v125,v126,v207
v_max_f32 v207,v127,v207
v_mov_b32 v208,v204
v_mov_b32 v209,v205
v_mov_b32 v210,v206
v_mov_b32 v211,v207
v_permlane16_swap_b32 v208,v204
v_permlane16_swap_b32 v209,v205
v_permlane16_swap_b32 v210,v206
v_permlane16_swap_b32 v211,v207
v_max_f32 v204,v204,v208
v_max_f32 v205,v205,v209
v_max_f32 v206,v206,v210
v_max_f32 v207,v207,v211
v_mov_b32 v208,v204
v_mov_b32 v209,v205
v_mov_b32 v210,v206
v_mov_b32 v211,v207
v_permlane32_swap_b32 v208,v204
v_permlane32_swap_b32 v209,v205
v_permlane32_swap_b32 v210,v206
v_permlane32_swap_b32 v211,v207
v_max_f32 v204,v204,v208
v_max_f32 v205,v205,v209
v_max_f32 v206,v206,v210
v_max_f32 v207,v207,v211
v_add_f32 v204,0x42b40000,v204
v_max_f32 v204,0,v204
v_add_f32 v205,0x42b40000,v205
v_max_f32 v205,0,v205
v_add_f32 v206,0x42b40000,v206
v_max_f32 v206,0,v206
v_add_f32 v207,0x42b40000,v207
v_max_f32 v207,0,v207
v_exp_f32 v212,-v204
v_exp_f32 v213,-v205
v_exp_f32 v214,-v206
v_exp_f32 v215,-v207
v_sub_f32 v160,v160,v204
v_sub_f32 v161,v161,v204
v_sub_f32 v162,v162,v204
v_sub_f32 v163,v163,v204
v_sub_f32 v64,v64,v204
v_sub_f32 v65,v65,v204
v_sub_f32 v66,v66,v204
v_sub_f32 v67,v67,v204
v_sub_f32 v80,v80,v204
v_sub_f32 v81,v81,v204
v_sub_f32 v82,v82,v204
v_sub_f32 v83,v83,v204
v_sub_f32 v96,v96,v204
v_sub_f32 v97,v97,v204
v_sub_f32 v98,v98,v204
v_sub_f32 v99,v99,v204
v_sub_f32 v112,v112,v204
v_sub_f32 v113,v113,v204
v_sub_f32 v114,v114,v204
v_sub_f32 v115,v115,v204
v_sub_f32 v0,v0,v204
v_sub_f32 v1,v1,v204
v_sub_f32 v2,v2,v204
v_sub_f32 v3,v3,v204
v_sub_f32 v16,v16,v204
v_sub_f32 v17,v17,v204
v_sub_f32 v18,v18,v204
v_sub_f32 v19,v19,v204
v_sub_f32 v32,v32,v204
v_sub_f32 v33,v33,v204
v_sub_f32 v34,v34,v204
v_sub_f32 v35,v35,v204
v_sub_f32 v48,v48,v204
v_sub_f32 v49,v49,v204
v_sub_f32 v50,v50,v204
v_sub_f32 v51,v51,v204
v_sub_f32 v164,v164,v205
v_sub_f32 v165,v165,v205
v_sub_f32 v166,v166,v205
v_sub_f32 v167,v167,v205
v_sub_f32 v68,v68,v205
v_sub_f32 v69,v69,v205
v_sub_f32 v70,v70,v205
v_sub_f32 v71,v71,v205
v_sub_f32 v84,v84,v205
v_sub_f32 v85,v85,v205
v_sub_f32 v86,v86,v205
v_sub_f32 v87,v87,v205
v_sub_f32 v100,v100,v205
v_sub_f32 v101,v101,v205
v_sub_f32 v102,v102,v205
v_sub_f32 v103,v103,v205
v_sub_f32 v116,v116,v205
v_sub_f32 v117,v117,v205
v_sub_f32 v118,v118,v205
v_sub_f32 v119,v119,v205
v_sub_f32 v4,v4,v205
v_sub_f32 v5,v5,v205
v_sub_f32 v6,v6,v205
v_sub_f32 v7,v7,v205
v_sub_f32 v20,v20,v205
v_sub_f32 v21,v21,v205
v_sub_f32 v22,v22,v205
v_sub_f32 v23,v23,v205
v_sub_f32 v36,v36,v205
v_sub_f32 v37,v37,v205
v_sub_f32 v38,v38,v205
v_sub_f32 v39,v39,v205
v_sub_f32 v52,v52,v205
v_sub_f32 v53,v53,v205
v_sub_f32 v54,v54,v205
v_sub_f32 v55,v55,v205
v_sub_f32 v168,v168,v206
v_sub_f32 v169,v169,v206
v_sub_f32 v170,v170,v206
v_sub_f32 v171,v171,v206
v_sub_f32 v72,v72,v206
v_sub_f32 v73,v73,v206
v_sub_f32 v74,v74,v206
v_sub_f32 v75,v75,v206
v_sub_f32 v88,v88,v206
v_sub_f32 v89,v89,v206
v_sub_f32 v90,v90,v206
v_sub_f32 v91,v91,v206
v_sub_f32 v104,v104,v206
v_sub_f32 v105,v105,v206
v_sub_f32 v106,v106,v206
v_sub_f32 v107,v107,v206
v_sub_f32 v120,v120,v206
v_sub_f32 v121,v121,v206
v_sub_f32 v122,v122,v206
v_sub_f32 v123,v123,v206
v_sub_f32 v8,v8,v206
v_sub_f32 v9,v9,v206
v_sub_f32 v10,v10,v206
v_sub_f32 v11,v11,v206
v_sub_f32 v24,v24,v206
v_sub_f32 v25,v25,v206
v_sub_f32 v26,v26,v206
v_sub_f32 v27,v27,v206
v_sub_f32 v40,v40,v206
v_sub_f32 v41,v41,v206
v_sub_f32 v42,v42,v206
v_sub_f32 v43,v43,v206
v_sub_f32 v56,v56,v206
v_sub_f32 v57,v57,v206
v_sub_f32 v58,v58,v206
v_sub_f32 v59,v59,v206
v_sub_f32 v172,v172,v207
v_sub_f32 v173,v173,v207
v_sub_f32 v174,v174,v207
v_sub_f32 v175,v175,v207
v_sub_f32 v76,v76,v207
v_sub_f32 v77,v77,v207
v_sub_f32 v78,v78,v207
v_sub_f32 v79,v79,v207
v_sub_f32 v92,v92,v207
v_sub_f32 v93,v93,v207
v_sub_f32 v94,v94,v207
v_sub_f32 v95,v95,v207
v_sub_f32 v108,v108,v207
v_sub_f32 v109,v109,v207
v_sub_f32 v110,v110,v207
v_sub_f32 v111,v111,v207
v_sub_f32 v124,v124,v207
v_sub_f32 v125,v125,v207
v_sub_f32 v126,v126,v207
v_sub_f32 v127,v127,v207
v_sub_f32 v12,v12,v207
v_sub_f32 v13,v13,v207
v_sub_f32 v14,v14,v207
v_sub_f32 v15,v15,v207
v_sub_f32 v28,v28,v207
v_sub_f32 v29,v29,v207
v_sub_f32 v30,v30,v207
v_sub_f32 v31,v31,v207
v_sub_f32 v44,v44,v207
v_sub_f32 v45,v45,v207
v_sub_f32 v46,v46,v207
v_sub_f32 v47,v47,v207
v_sub_f32 v60,v60,v207
v_sub_f32 v61,v61,v207
v_sub_f32 v62,v62,v207
v_sub_f32 v63,v63,v207
ar v208,a0
ar v209,a1
ar v210,a2
ar v211,a3
v_mul_f32 v208,v208,v212
v_mul_f32 v209,v209,v212
v_mul_f32 v210,v210,v212
v_mul_f32 v211,v211,v212
aw a0,v208
aw a1,v209
aw a2,v210
aw a3,v211
ar v208,a4
ar v209,a5
ar v210,a6
ar v211,a7
v_mul_f32 v208,v208,v213
v_mul_f32 v209,v209,v213
v_mul_f32 v210,v210,v213
v_mul_f32 v211,v211,v213
aw a4,v208
aw a5,v209
aw a6,v210
aw a7,v211
ar v208,a8
ar v209,a9
ar v210,a10
ar v211,a11
v_mul_f32 v208,v208,v214
v_mul_f32 v209,v209,v214
v_mul_f32 v210,v210,v214
v_mul_f32 v211,v211,v214
aw a8,v208
aw a9,v209
aw a10,v210
aw a11,v211
ar v208,a12
ar v209,a13
ar v210,a14
ar v211,a15
v_mul_f32 v208,v208,v215
v_mul_f32 v209,v209,v215
v_mul_f32 v210,v210,v215
v_mul_f32 v211,v211,v215
aw a12,v208
aw a13,v209
aw a14,v210
aw a15,v211
ar v208,a16
ar v209,a17
ar v210,a18
ar v211,a19
v_mul_f32 v208,v208,v212
v_mul_f32 v209,v209,v212
v_mul_f32 v210,v210,v212
v_mul_f32 v211,v211,v212
aw a16,v208
aw a17,v209
aw a18,v210
aw a19,v211
ar v208,a20
ar v209,a21
ar v210,a22
ar v211,a23
v_mul_f32 v208,v208,v213
v_mul_f32 v209,v209,v213
v_mul_f32 v210,v210,v213
v_mul_f32 v211,v211,v213
aw a20,v208
aw a21,v209
aw a22,v210
aw a23,v211
ar v208,a24
ar v209,a25
ar v210,a26
ar v211,a27
v_mul_f32 v208,v208,v214
v_mul_f32 v209,v209,v214
v_mul_f32 v210,v210,v214
v_mul_f32 v211,v211,v214
aw a24,v208
aw a25,v209
aw a26,v210
aw a27,v211
ar v208,a28
ar v209,a29
ar v210,a30
ar v211,a31
v_mul_f32 v208,v208,v215
v_mul_f32 v209,v209,v215
v_mul_f32 v210,v210,v215
v_mul_f32 v211,v211,v215
aw a28,v208
aw a29,v209
aw a30,v210
aw a31,v211
ar v208,a32
ar v209,a33
ar v210,a34
ar v211,a35
v_mul_f32 v208,v208,v212
v_mul_f32 v209,v209,v212
v_mul_f32 v210,v210,v212
v_mul_f32 v211,v211,v212
aw a32,v208
aw a33,v209
aw a34,v210
aw a35,v211
ar v208,a36
ar v209,a37
ar v210,a38
ar v211,a39
v_mul_f32 v208,v208,v213
v_mul_f32 v209,v209,v213
v_mul_f32 v210,v210,v213
v_mul_f32 v211,v211,v213
aw a36,v208
aw a37,v209
aw a38,v210
aw a39,v211
ar v208,a40
ar v209,a41
ar v210,a42
ar v211,a43
v_mul_f32 v208,v208,v214
v_mul_f32 v209,v209,v214
v_mul_f32 v210,v210,v214
v_mul_f32 v211,v211,v214
aw a40,v208
aw a41,v209
aw a42,v210
aw a43,v211
ar v208,a44
ar v209,a45
ar v210,a46
ar v211,a47
v_mul_f32 v208,v208,v215
v_mul_f32 v209,v209,v215
v_mul_f32 v210,v210,v215
v_mul_f32 v211,v211,v215
aw a44,v208
aw a45,v209
aw a46,v210
aw a47,v211
ar v208,a48
ar v209,a49
ar v210,a50
ar v211,a51
v_mul_f32 v208,v208,v212
v_mul_f32 v209,v209,v212
v_mul_f32 v210,v210,v212
v_mul_f32 v211,v211,v212
aw a48,v208
aw a49,v209
aw a50,v210
aw a51,v211
ar v208,a52
ar v209,a53
ar v210,a54
ar v211,a55
v_mul_f32 v208,v208,v213
v_mul_f32 v209,v209,v213
v_mul_f32 v210,v210,v213
v_mul_f32 v211,v211,v213
aw a52,v208
aw a53,v209
aw a54,v210
aw a55,v211
ar v208,a56
ar v209,a57
ar v210,a58
ar v211,a59
v_mul_f32 v208,v208,v214
v_mul_f32 v209,v209,v214
v_mul_f32 v210,v210,v214
v_mul_f32 v211,v211,v214
aw a56,v208
aw a57,v209
aw a58,v210
aw a59,v211
ar v208,a60
ar v209,a61
ar v210,a62
ar v211,a63
v_mul_f32 v208,v208,v215
v_mul_f32 v209,v209,v215
v_mul_f32 v210,v210,v215
v_mul_f32 v211,v211,v215
aw a60,v208
aw a61,v209
aw a62,v210
aw a63,v211
ar v208,a64
ar v209,a65
ar v210,a66
ar v211,a67
v_mul_f32 v208,v208,v212
v_mul_f32 v209,v209,v212
v_mul_f32 v210,v210,v212
v_mul_f32 v211,v211,v212
aw a64,v208
aw a65,v209
aw a66,v210
aw a67,v211
ar v208,a68
ar v209,a69
ar v210,a70
ar v211,a71
v_mul_f32 v208,v208,v213
v_mul_f32 v209,v209,v213
v_mul_f32 v210,v210,v213
v_mul_f32 v211,v211,v213
aw a68,v208
aw a69,v209
aw a70,v210
aw a71,v211
ar v208,a72
ar v209,a73
ar v210,a74
ar v211,a75
v_mul_f32 v208,v208,v214
v_mul_f32 v209,v209,v214
v_mul_f32 v210,v210,v214
v_mul_f32 v211,v211,v214
aw a72,v208
aw a73,v209
aw a74,v210
aw a75,v211
ar v208,a76
ar v209,a77
ar v210,a78
ar v211,a79
v_mul_f32 v208,v208,v215
v_mul_f32 v209,v209,v215
v_mul_f32 v210,v210,v215
v_mul_f32 v211,v211,v215
aw a76,v208
aw a77,v209
aw a78,v210
aw a79,v211
ar v208,a80
ar v209,a81
ar v210,a82
ar v211,a83
v_mul_f32 v208,v208,v212
v_mul_f32 v209,v209,v212
v_mul_f32 v210,v210,v212
v_mul_f32 v211,v211,v212
aw a80,v208
aw a81,v209
aw a82,v210
aw a83,v211
ar v208,a84
ar v209,a85
ar v210,a86
ar v211,a87
v_mul_f32 v208,v208,v213
v_mul_f32 v209,v209,v213
v_mul_f32 v210,v210,v213
v_mul_f32 v211,v211,v213
aw a84,v208
aw a85,v209
aw a86,v210
aw a87,v211
ar v208,a88
ar v209,a89
ar v210,a90
ar v211,a91
v_mul_f32 v208,v208,v214
v_mul_f32 v209,v209,v214
v_mul_f32 v210,v210,v214
v_mul_f32 v211,v211,v214
aw a88,v208
aw a89,v209
aw a90,v210
aw a91,v211
ar v208,a92
ar v209,a93
ar v210,a94
ar v211,a95
v_mul_f32 v208,v208,v215
v_mul_f32 v209,v209,v215
v_mul_f32 v210,v210,v215
v_mul_f32 v211,v211,v215
aw a92,v208
aw a93,v209
aw a94,v210
aw a95,v211
ar v208,a96
ar v209,a97
ar v210,a98
ar v211,a99
v_mul_f32 v208,v208,v212
v_mul_f32 v209,v209,v212
v_mul_f32 v210,v210,v212
v_mul_f32 v211,v211,v212
aw a96,v208
aw a97,v209
aw a98,v210
aw a99,v211
ar v208,a100
ar v209,a101
ar v210,a102
ar v211,a103
v_mul_f32 v208,v208,v213
v_mul_f32 v209,v209,v213
v_mul_f32 v210,v210,v213
v_mul_f32 v211,v211,v213
aw a100,v208
aw a101,v209
aw a102,v210
aw a103,v211
ar v208,a104
ar v209,a105
ar v210,a106
ar v211,a107
v_mul_f32 v208,v208,v214
v_mul_f32 v209,v209,v214
v_mul_f32 v210,v210,v214
v_mul_f32 v211,v211,v214
aw a104,v208
aw a105,v209
aw a106,v210
aw a107,v211
ar v208,a108
ar v209,a109
ar v210,a110
ar v211,a111
v_mul_f32 v208,v208,v215
v_mul_f32 v209,v209,v215
v_mul_f32 v210,v210,v215
v_mul_f32 v211,v211,v215
aw a108,v208
aw a109,v209
aw a110,v210
aw a111,v211
ar v208,a112
ar v209,a113
ar v210,a114
ar v211,a115
v_mul_f32 v208,v208,v212
v_mul_f32 v209,v209,v212
v_mul_f32 v210,v210,v212
v_mul_f32 v211,v211,v212
aw a112,v208
aw a113,v209
aw a114,v210
aw a115,v211
ar v208,a116
ar v209,a117
ar v210,a118
ar v211,a119
v_mul_f32 v208,v208,v213
v_mul_f32 v209,v209,v213
v_mul_f32 v210,v210,v213
v_mul_f32 v211,v211,v213
aw a116,v208
aw a117,v209
aw a118,v210
aw a119,v211
ar v208,a120
ar v209,a121
ar v210,a122
ar v211,a123
v_mul_f32 v208,v208,v214
v_mul_f32 v209,v209,v214
v_mul_f32 v210,v210,v214
v_mul_f32 v211,v211,v214
aw a120,v208
aw a121,v209
aw a122,v210
aw a123,v211
ar v208,a124
ar v209,a125
ar v210,a126
ar v211,a127
v_mul_f32 v208,v208,v215
v_mul_f32 v209,v209,v215
v_mul_f32 v210,v210,v215
v_mul_f32 v211,v211,v215
aw a124,v208
aw a125,v209
aw a126,v210
aw a127,v211
ar v208,a224
ar v209,a225
ar v210,a226
ar v211,a227
v_mul_f32 v208,v208,v212
v_mul_f32 v209,v209,v212
v_mul_f32 v210,v210,v212
v_mul_f32 v211,v211,v212
aw a224,v208
aw a225,v209
aw a226,v210
aw a227,v211
ar v208,a228
ar v209,a229
ar v210,a230
ar v211,a231
v_mul_f32 v208,v208,v213
v_mul_f32 v209,v209,v213
v_mul_f32 v210,v210,v213
v_mul_f32 v211,v211,v213
aw a228,v208
aw a229,v209
aw a230,v210
aw a231,v211
ar v208,a232
ar v209,a233
ar v210,a234
ar v211,a235
v_mul_f32 v208,v208,v214
v_mul_f32 v209,v209,v214
v_mul_f32 v210,v210,v214
v_mul_f32 v211,v211,v214
aw a232,v208
aw a233,v209
aw a234,v210
aw a235,v211
ar v208,a236
ar v209,a237
ar v210,a238
ar v211,a239
v_mul_f32 v208,v208,v215
v_mul_f32 v209,v209,v215
v_mul_f32 v210,v210,v215
v_mul_f32 v211,v211,v215
aw a236,v208
aw a237,v209
aw a238,v210
aw a239,v211
v_exp_f32 v176,v64
v_exp_f32 v177,v65
s_nop 0
cv v128,v176,v177
v_exp_f32 v178,v66
v_exp_f32 v179,v67
s_nop 0
cv v129,v178,v179
v_exp_f32 v180,v80
v_exp_f32 v181,v81
s_nop 0
cv v130,v180,v181
v_exp_f32 v182,v82
v_exp_f32 v183,v83
s_nop 0
cv v131,v182,v183
v_exp_f32 v176,v68
v_exp_f32 v177,v69
s_nop 0
cv v132,v176,v177
v_exp_f32 v178,v70
v_exp_f32 v179,v71
s_nop 0
cv v133,v178,v179
v_exp_f32 v180,v84
v_exp_f32 v181,v85
s_nop 0
cv v134,v180,v181
v_exp_f32 v182,v86
v_exp_f32 v183,v87
s_nop 0
cv v135,v182,v183
v_exp_f32 v176,v72
v_exp_f32 v177,v73
s_nop 0
cv v136,v176,v177
v_exp_f32 v178,v74
v_exp_f32 v179,v75
s_nop 0
cv v137,v178,v179
v_exp_f32 v180,v88
v_exp_f32 v181,v89
s_nop 0
cv v138,v180,v181
v_exp_f32 v182,v90
v_exp_f32 v183,v91
s_nop 0
cv v139,v182,v183
v_exp_f32 v176,v76
v_exp_f32 v177,v77
s_nop 0
cv v140,v176,v177
v_exp_f32 v178,v78
v_exp_f32 v179,v79
s_nop 0
cv v141,v178,v179
v_exp_f32 v180,v92
v_exp_f32 v181,v93
s_nop 0
cv v142,v180,v181
v_exp_f32 v182,v94
v_exp_f32 v183,v95
s_nop 0
cv v143,v182,v183
v_exp_f32 v176,v96
v_exp_f32 v177,v97
s_nop 0
cv v144,v176,v177
v_exp_f32 v178,v98
v_exp_f32 v179,v99
v_exp_f32 v180,v112
cv v145,v178,v179
v_exp_f32 v181,v113
v_exp_f32 v182,v114
cv v146,v180,v181
v_or3_b32 v185,v144,v145,v146
v_exp_f32 v183,v115
v_exp_f32 v176,v100
cv v147,v182,v183
v_exp_f32 v177,v101
s_nop 0
cv v148,v176,v177
v_exp_f32 v178,v102
v_or3_b32 v185,v147,v148,v185
v_exp_f32 v179,v103
v_exp_f32 v180,v116
cv v149,v178,v179
v_exp_f32 v181,v117
s_nop 0
cv v150,v180,v181
v_exp_f32 v182,v118
v_or3_b32 v185,v149,v150,v185
v_exp_f32 v183,v119
v_exp_f32 v176,v104
cv v151,v182,v183
v_exp_f32 v177,v105
s_nop 0
cv v152,v176,v177
v_exp_f32 v178,v106
v_or3_b32 v185,v151,v152,v185
s_nop 3
s_setpc_b64 s[60:61]
attn_slow_6:
s_nop 15
s_add_u32 s62,s62,1
v_max3_f32 v204,v0,v1,v2
v_max3_f32 v204,v3,v16,v204
v_max3_f32 v204,v17,v18,v204
v_max3_f32 v204,v19,v32,v204
v_max3_f32 v204,v33,v34,v204
v_max3_f32 v204,v35,v48,v204
v_max3_f32 v204,v49,v50,v204
v_max_f32 v204,v51,v204
v_max3_f32 v205,v4,v5,v6
v_max3_f32 v205,v7,v20,v205
v_max3_f32 v205,v21,v22,v205
v_max3_f32 v205,v23,v36,v205
v_max3_f32 v205,v37,v38,v205
v_max3_f32 v205,v39,v52,v205
v_max3_f32 v205,v53,v54,v205
v_max_f32 v205,v55,v205
v_max3_f32 v206,v8,v9,v10
v_max3_f32 v206,v11,v24,v206
v_max3_f32 v206,v25,v26,v206
v_max3_f32 v206,v27,v40,v206
v_max3_f32 v206,v41,v42,v206
v_max3_f32 v206,v43,v56,v206
v_max3_f32 v206,v57,v58,v206
v_max_f32 v206,v59,v206
v_max3_f32 v207,v12,v13,v14
v_max3_f32 v207,v15,v28,v207
v_max3_f32 v207,v29,v30,v207
v_max3_f32 v207,v31,v44,v207
v_max3_f32 v207,v45,v46,v207
v_max3_f32 v207,v47,v60,v207
v_max3_f32 v207,v61,v62,v207
v_max_f32 v207,v63,v207
v_mov_b32 v208,v204
v_mov_b32 v209,v205
v_mov_b32 v210,v206
v_mov_b32 v211,v207
v_permlane16_swap_b32 v208,v204
v_permlane16_swap_b32 v209,v205
v_permlane16_swap_b32 v210,v206
v_permlane16_swap_b32 v211,v207
v_max_f32 v204,v204,v208
v_max_f32 v205,v205,v209
v_max_f32 v206,v206,v210
v_max_f32 v207,v207,v211
v_mov_b32 v208,v204
v_mov_b32 v209,v205
v_mov_b32 v210,v206
v_mov_b32 v211,v207
v_permlane32_swap_b32 v208,v204
v_permlane32_swap_b32 v209,v205
v_permlane32_swap_b32 v210,v206
v_permlane32_swap_b32 v211,v207
v_max_f32 v204,v204,v208
v_max_f32 v205,v205,v209
v_max_f32 v206,v206,v210
v_max_f32 v207,v207,v211
v_add_f32 v204,0x42b40000,v204
v_max_f32 v204,0,v204
v_add_f32 v205,0x42b40000,v205
v_max_f32 v205,0,v205
v_add_f32 v206,0x42b40000,v206
v_max_f32 v206,0,v206
v_add_f32 v207,0x42b40000,v207
v_max_f32 v207,0,v207
v_exp_f32 v212,-v204
v_exp_f32 v213,-v205
v_exp_f32 v214,-v206
v_exp_f32 v215,-v207
v_sub_f32 v160,v160,v204
v_sub_f32 v161,v161,v204
v_sub_f32 v162,v162,v204
v_sub_f32 v163,v163,v204
v_sub_f32 v0,v0,v204
v_sub_f32 v1,v1,v204
v_sub_f32 v2,v2,v204
v_sub_f32 v3,v3,v204
v_sub_f32 v16,v16,v204
v_sub_f32 v17,v17,v204
v_sub_f32 v18,v18,v204
v_sub_f32 v19,v19,v204
v_sub_f32 v32,v32,v204
v_sub_f32 v33,v33,v204
v_sub_f32 v34,v34,v204
v_sub_f32 v35,v35,v204
v_sub_f32 v48,v48,v204
v_sub_f32 v49,v49,v204
v_sub_f32 v50,v50,v204
v_sub_f32 v51,v51,v204
v_sub_f32 v64,v64,v204
v_sub_f32 v65,v65,v204
v_sub_f32 v66,v66,v204
v_sub_f32 v67,v67,v204
v_sub_f32 v80,v80,v204
v_sub_f32 v81,v81,v204
v_sub_f32 v82,v82,v204
v_sub_f32 v83,v83,v204
v_sub_f32 v96,v96,v204
v_sub_f32 v97,v97,v204
v_sub_f32 v98,v98,v204
v_sub_f32 v99,v99,v204
v_sub_f32 v112,v112,v204
v_sub_f32 v113,v113,v204
v_sub_f32 v114,v114,v204
v_sub_f32 v115,v115,v204
v_sub_f32 v164,v164,v205
v_sub_f32 v165,v165,v205
v_sub_f32 v166,v166,v205
v_sub_f32 v167,v167,v205
v_sub_f32 v4,v4,v205
v_sub_f32 v5,v5,v205
v_sub_f32 v6,v6,v205
v_sub_f32 v7,v7,v205
v_sub_f32 v20,v20,v205
v_sub_f32 v21,v21,v205
v_sub_f32 v22,v22,v205
v_sub_f32 v23,v23,v205
v_sub_f32 v36,v36,v205
v_sub_f32 v37,v37,v205
v_sub_f32 v38,v38,v205
v_sub_f32 v39,v39,v205
v_sub_f32 v52,v52,v205
v_sub_f32 v53,v53,v205
v_sub_f32 v54,v54,v205
v_sub_f32 v55,v55,v205
v_sub_f32 v68,v68,v205
v_sub_f32 v69,v69,v205
v_sub_f32 v70,v70,v205
v_sub_f32 v71,v71,v205
v_sub_f32 v84,v84,v205
v_sub_f32 v85,v85,v205
v_sub_f32 v86,v86,v205
v_sub_f32 v87,v87,v205
v_sub_f32 v100,v100,v205
v_sub_f32 v101,v101,v205
v_sub_f32 v102,v102,v205
v_sub_f32 v103,v103,v205
v_sub_f32 v116,v116,v205
v_sub_f32 v117,v117,v205
v_sub_f32 v118,v118,v205
v_sub_f32 v119,v119,v205
v_sub_f32 v168,v168,v206
v_sub_f32 v169,v169,v206
v_sub_f32 v170,v170,v206
v_sub_f32 v171,v171,v206
v_sub_f32 v8,v8,v206
v_sub_f32 v9,v9,v206
v_sub_f32 v10,v10,v206
v_sub_f32 v11,v11,v206
v_sub_f32 v24,v24,v206
v_sub_f32 v25,v25,v206
v_sub_f32 v26,v26,v206
v_sub_f32 v27,v27,v206
v_sub_f32 v40,v40,v206
v_sub_f32 v41,v41,v206
v_sub_f32 v42,v42,v206
v_sub_f32 v43,v43,v206
v_sub_f32 v56,v56,v206
v_sub_f32 v57,v57,v206
v_sub_f32 v58,v58,v206
v_sub_f32 v59,v59,v206
v_sub_f32 v72,v72,v206
v_sub_f32 v73,v73,v206
v_sub_f32 v74,v74,v206
v_sub_f32 v75,v75,v206
v_sub_f32 v88,v88,v206
v_sub_f32 v89,v89,v206
v_sub_f32 v90,v90,v206
v_sub_f32 v91,v91,v206
v_sub_f32 v104,v104,v206
v_sub_f32 v105,v105,v206
v_sub_f32 v106,v106,v206
v_sub_f32 v107,v107,v206
v_sub_f32 v120,v120,v206
v_sub_f32 v121,v121,v206
v_sub_f32 v122,v122,v206
v_sub_f32 v123,v123,v206
v_sub_f32 v172,v172,v207
v_sub_f32 v173,v173,v207
v_sub_f32 v174,v174,v207
v_sub_f32 v175,v175,v207
v_sub_f32 v12,v12,v207
v_sub_f32 v13,v13,v207
v_sub_f32 v14,v14,v207
v_sub_f32 v15,v15,v207
v_sub_f32 v28,v28,v207
v_sub_f32 v29,v29,v207
v_sub_f32 v30,v30,v207
v_sub_f32 v31,v31,v207
v_sub_f32 v44,v44,v207
v_sub_f32 v45,v45,v207
v_sub_f32 v46,v46,v207
v_sub_f32 v47,v47,v207
v_sub_f32 v60,v60,v207
v_sub_f32 v61,v61,v207
v_sub_f32 v62,v62,v207
v_sub_f32 v63,v63,v207
v_sub_f32 v76,v76,v207
v_sub_f32 v77,v77,v207
v_sub_f32 v78,v78,v207
v_sub_f32 v79,v79,v207
v_sub_f32 v92,v92,v207
v_sub_f32 v93,v93,v207
v_sub_f32 v94,v94,v207
v_sub_f32 v95,v95,v207
v_sub_f32 v108,v108,v207
v_sub_f32 v109,v109,v207
v_sub_f32 v110,v110,v207
v_sub_f32 v111,v111,v207
v_sub_f32 v124,v124,v207
v_sub_f32 v125,v125,v207
v_sub_f32 v126,v126,v207
v_sub_f32 v127,v127,v207
ar v208,a0
ar v209,a1
ar v210,a2
ar v211,a3
v_mul_f32 v208,v208,v212
v_mul_f32 v209,v209,v212
v_mul_f32 v210,v210,v212
v_mul_f32 v211,v211,v212
aw a0,v208
aw a1,v209
aw a2,v210
aw a3,v211
ar v208,a4
ar v209,a5
ar v210,a6
ar v211,a7
v_mul_f32 v208,v208,v213
v_mul_f32 v209,v209,v213
v_mul_f32 v210,v210,v213
v_mul_f32 v211,v211,v213
aw a4,v208
aw a5,v209
aw a6,v210
aw a7,v211
ar v208,a8
ar v209,a9
ar v210,a10
ar v211,a11
v_mul_f32 v208,v208,v214
v_mul_f32 v209,v209,v214
v_mul_f32 v210,v210,v214
v_mul_f32 v211,v211,v214
aw a8,v208
aw a9,v209
aw a10,v210
aw a11,v211
ar v208,a12
ar v209,a13
ar v210,a14
ar v211,a15
v_mul_f32 v208,v208,v215
v_mul_f32 v209,v209,v215
v_mul_f32 v210,v210,v215
v_mul_f32 v211,v211,v215
aw a12,v208
aw a13,v209
aw a14,v210
aw a15,v211
ar v208,a16
ar v209,a17
ar v210,a18
ar v211,a19
v_mul_f32 v208,v208,v212
v_mul_f32 v209,v209,v212
v_mul_f32 v210,v210,v212
v_mul_f32 v211,v211,v212
aw a16,v208
aw a17,v209
aw a18,v210
aw a19,v211
ar v208,a20
ar v209,a21
ar v210,a22
ar v211,a23
v_mul_f32 v208,v208,v213
v_mul_f32 v209,v209,v213
v_mul_f32 v210,v210,v213
v_mul_f32 v211,v211,v213
aw a20,v208
aw a21,v209
aw a22,v210
aw a23,v211
ar v208,a24
ar v209,a25
ar v210,a26
ar v211,a27
v_mul_f32 v208,v208,v214
v_mul_f32 v209,v209,v214
v_mul_f32 v210,v210,v214
v_mul_f32 v211,v211,v214
aw a24,v208
aw a25,v209
aw a26,v210
aw a27,v211
ar v208,a28
ar v209,a29
ar v210,a30
ar v211,a31
v_mul_f32 v208,v208,v215
v_mul_f32 v209,v209,v215
v_mul_f32 v210,v210,v215
v_mul_f32 v211,v211,v215
aw a28,v208
aw a29,v209
aw a30,v210
aw a31,v211
ar v208,a32
ar v209,a33
ar v210,a34
ar v211,a35
v_mul_f32 v208,v208,v212
v_mul_f32 v209,v209,v212
v_mul_f32 v210,v210,v212
v_mul_f32 v211,v211,v212
aw a32,v208
aw a33,v209
aw a34,v210
aw a35,v211
ar v208,a36
ar v209,a37
ar v210,a38
ar v211,a39
v_mul_f32 v208,v208,v213
v_mul_f32 v209,v209,v213
v_mul_f32 v210,v210,v213
v_mul_f32 v211,v211,v213
aw a36,v208
aw a37,v209
aw a38,v210
aw a39,v211
ar v208,a40
ar v209,a41
ar v210,a42
ar v211,a43
v_mul_f32 v208,v208,v214
v_mul_f32 v209,v209,v214
v_mul_f32 v210,v210,v214
v_mul_f32 v211,v211,v214
aw a40,v208
aw a41,v209
aw a42,v210
aw a43,v211
ar v208,a44
ar v209,a45
ar v210,a46
ar v211,a47
v_mul_f32 v208,v208,v215
v_mul_f32 v209,v209,v215
v_mul_f32 v210,v210,v215
v_mul_f32 v211,v211,v215
aw a44,v208
aw a45,v209
aw a46,v210
aw a47,v211
ar v208,a48
ar v209,a49
ar v210,a50
ar v211,a51
v_mul_f32 v208,v208,v212
v_mul_f32 v209,v209,v212
v_mul_f32 v210,v210,v212
v_mul_f32 v211,v211,v212
aw a48,v208
aw a49,v209
aw a50,v210
aw a51,v211
ar v208,a52
ar v209,a53
ar v210,a54
ar v211,a55
v_mul_f32 v208,v208,v213
v_mul_f32 v209,v209,v213
v_mul_f32 v210,v210,v213
v_mul_f32 v211,v211,v213
aw a52,v208
aw a53,v209
aw a54,v210
aw a55,v211
ar v208,a56
ar v209,a57
ar v210,a58
ar v211,a59
v_mul_f32 v208,v208,v214
v_mul_f32 v209,v209,v214
v_mul_f32 v210,v210,v214
v_mul_f32 v211,v211,v214
aw a56,v208
aw a57,v209
aw a58,v210
aw a59,v211
ar v208,a60
ar v209,a61
ar v210,a62
ar v211,a63
v_mul_f32 v208,v208,v215
v_mul_f32 v209,v209,v215
v_mul_f32 v210,v210,v215
v_mul_f32 v211,v211,v215
aw a60,v208
aw a61,v209
aw a62,v210
aw a63,v211
ar v208,a64
ar v209,a65
ar v210,a66
ar v211,a67
v_mul_f32 v208,v208,v212
v_mul_f32 v209,v209,v212
v_mul_f32 v210,v210,v212
v_mul_f32 v211,v211,v212
aw a64,v208
aw a65,v209
aw a66,v210
aw a67,v211
ar v208,a68
ar v209,a69
ar v210,a70
ar v211,a71
v_mul_f32 v208,v208,v213
v_mul_f32 v209,v209,v213
v_mul_f32 v210,v210,v213
v_mul_f32 v211,v211,v213
aw a68,v208
aw a69,v209
aw a70,v210
aw a71,v211
ar v208,a72
ar v209,a73
ar v210,a74
ar v211,a75
v_mul_f32 v208,v208,v214
v_mul_f32 v209,v209,v214
v_mul_f32 v210,v210,v214
v_mul_f32 v211,v211,v214
aw a72,v208
aw a73,v209
aw a74,v210
aw a75,v211
ar v208,a76
ar v209,a77
ar v210,a78
ar v211,a79
v_mul_f32 v208,v208,v215
v_mul_f32 v209,v209,v215
v_mul_f32 v210,v210,v215
v_mul_f32 v211,v211,v215
aw a76,v208
aw a77,v209
aw a78,v210
aw a79,v211
ar v208,a80
ar v209,a81
ar v210,a82
ar v211,a83
v_mul_f32 v208,v208,v212
v_mul_f32 v209,v209,v212
v_mul_f32 v210,v210,v212
v_mul_f32 v211,v211,v212
aw a80,v208
aw a81,v209
aw a82,v210
aw a83,v211
ar v208,a84
ar v209,a85
ar v210,a86
ar v211,a87
v_mul_f32 v208,v208,v213
v_mul_f32 v209,v209,v213
v_mul_f32 v210,v210,v213
v_mul_f32 v211,v211,v213
aw a84,v208
aw a85,v209
aw a86,v210
aw a87,v211
ar v208,a88
ar v209,a89
ar v210,a90
ar v211,a91
v_mul_f32 v208,v208,v214
v_mul_f32 v209,v209,v214
v_mul_f32 v210,v210,v214
v_mul_f32 v211,v211,v214
aw a88,v208
aw a89,v209
aw a90,v210
aw a91,v211
ar v208,a92
ar v209,a93
ar v210,a94
ar v211,a95
v_mul_f32 v208,v208,v215
v_mul_f32 v209,v209,v215
v_mul_f32 v210,v210,v215
v_mul_f32 v211,v211,v215
aw a92,v208
aw a93,v209
aw a94,v210
aw a95,v211
ar v208,a96
ar v209,a97
ar v210,a98
ar v211,a99
v_mul_f32 v208,v208,v212
v_mul_f32 v209,v209,v212
v_mul_f32 v210,v210,v212
v_mul_f32 v211,v211,v212
aw a96,v208
aw a97,v209
aw a98,v210
aw a99,v211
ar v208,a100
ar v209,a101
ar v210,a102
ar v211,a103
v_mul_f32 v208,v208,v213
v_mul_f32 v209,v209,v213
v_mul_f32 v210,v210,v213
v_mul_f32 v211,v211,v213
aw a100,v208
aw a101,v209
aw a102,v210
aw a103,v211
ar v208,a104
ar v209,a105
ar v210,a106
ar v211,a107
v_mul_f32 v208,v208,v214
v_mul_f32 v209,v209,v214
v_mul_f32 v210,v210,v214
v_mul_f32 v211,v211,v214
aw a104,v208
aw a105,v209
aw a106,v210
aw a107,v211
ar v208,a108
ar v209,a109
ar v210,a110
ar v211,a111
v_mul_f32 v208,v208,v215
v_mul_f32 v209,v209,v215
v_mul_f32 v210,v210,v215
v_mul_f32 v211,v211,v215
aw a108,v208
aw a109,v209
aw a110,v210
aw a111,v211
ar v208,a112
ar v209,a113
ar v210,a114
ar v211,a115
v_mul_f32 v208,v208,v212
v_mul_f32 v209,v209,v212
v_mul_f32 v210,v210,v212
v_mul_f32 v211,v211,v212
aw a112,v208
aw a113,v209
aw a114,v210
aw a115,v211
ar v208,a116
ar v209,a117
ar v210,a118
ar v211,a119
v_mul_f32 v208,v208,v213
v_mul_f32 v209,v209,v213
v_mul_f32 v210,v210,v213
v_mul_f32 v211,v211,v213
aw a116,v208
aw a117,v209
aw a118,v210
aw a119,v211
ar v208,a120
ar v209,a121
ar v210,a122
ar v211,a123
v_mul_f32 v208,v208,v214
v_mul_f32 v209,v209,v214
v_mul_f32 v210,v210,v214
v_mul_f32 v211,v211,v214
aw a120,v208
aw a121,v209
aw a122,v210
aw a123,v211
ar v208,a124
ar v209,a125
ar v210,a126
ar v211,a127
v_mul_f32 v208,v208,v215
v_mul_f32 v209,v209,v215
v_mul_f32 v210,v210,v215
v_mul_f32 v211,v211,v215
aw a124,v208
aw a125,v209
aw a126,v210
aw a127,v211
ar v208,a224
ar v209,a225
ar v210,a226
ar v211,a227
v_mul_f32 v208,v208,v212
v_mul_f32 v209,v209,v212
v_mul_f32 v210,v210,v212
v_mul_f32 v211,v211,v212
aw a224,v208
aw a225,v209
aw a226,v210
aw a227,v211
ar v208,a228
ar v209,a229
ar v210,a230
ar v211,a231
v_mul_f32 v208,v208,v213
v_mul_f32 v209,v209,v213
v_mul_f32 v210,v210,v213
v_mul_f32 v211,v211,v213
aw a228,v208
aw a229,v209
aw a230,v210
aw a231,v211
ar v208,a232
ar v209,a233
ar v210,a234
ar v211,a235
v_mul_f32 v208,v208,v214
v_mul_f32 v209,v209,v214
v_mul_f32 v210,v210,v214
v_mul_f32 v211,v211,v214
aw a232,v208
aw a233,v209
aw a234,v210
aw a235,v211
ar v208,a236
ar v209,a237
ar v210,a238
ar v211,a239
v_mul_f32 v208,v208,v215
v_mul_f32 v209,v209,v215
v_mul_f32 v210,v210,v215
v_mul_f32 v211,v211,v215
aw a236,v208
aw a237,v209
aw a238,v210
aw a239,v211
v_exp_f32 v176,v0
v_exp_f32 v177,v1
s_nop 0
cv v128,v176,v177
v_exp_f32 v178,v2
v_exp_f32 v179,v3
s_nop 0
cv v129,v178,v179
v_exp_f32 v180,v16
v_exp_f32 v181,v17
s_nop 0
cv v130,v180,v181
v_exp_f32 v182,v18
v_exp_f32 v183,v19
s_nop 0
cv v131,v182,v183
v_exp_f32 v176,v4
v_exp_f32 v177,v5
s_nop 0
cv v132,v176,v177
v_exp_f32 v178,v6
v_exp_f32 v179,v7
s_nop 0
cv v133,v178,v179
v_exp_f32 v180,v20
v_exp_f32 v181,v21
s_nop 0
cv v134,v180,v181
v_exp_f32 v182,v22
v_exp_f32 v183,v23
s_nop 0
cv v135,v182,v183
v_exp_f32 v176,v8
v_exp_f32 v177,v9
s_nop 0
cv v136,v176,v177
v_exp_f32 v178,v10
v_exp_f32 v179,v11
s_nop 0
cv v137,v178,v179
v_exp_f32 v180,v24
v_exp_f32 v181,v25
s_nop 0
cv v138,v180,v181
v_exp_f32 v182,v26
v_exp_f32 v183,v27
s_nop 0
cv v139,v182,v183
v_exp_f32 v176,v12
v_exp_f32 v177,v13
s_nop 0
cv v140,v176,v177
v_exp_f32 v178,v14
v_exp_f32 v179,v15
s_nop 0
cv v141,v178,v179
v_exp_f32 v180,v28
v_exp_f32 v181,v29
s_nop 0
cv v142,v180,v181
v_exp_f32 v182,v30
v_exp_f32 v183,v31
s_nop 0
cv v143,v182,v183
v_exp_f32 v176,v32
v_exp_f32 v177,v33
s_nop 0
cv v144,v176,v177
v_exp_f32 v178,v34
v_exp_f32 v179,v35
v_exp_f32 v180,v48
cv v145,v178,v179
v_exp_f32 v181,v49
v_exp_f32 v182,v50
cv v146,v180,v181
v_or3_b32 v185,v144,v145,v146
v_exp_f32 v183,v51
v_exp_f32 v176,v36
cv v147,v182,v183
v_exp_f32 v177,v37
s_nop 0
cv v148,v176,v177
v_exp_f32 v178,v38
v_or3_b32 v185,v147,v148,v185
v_exp_f32 v179,v39
v_exp_f32 v180,v52
cv v149,v178,v179
v_exp_f32 v181,v53
s_nop 0
cv v150,v180,v181
v_exp_f32 v182,v54
v_or3_b32 v185,v149,v150,v185
v_exp_f32 v183,v55
v_exp_f32 v176,v40
cv v151,v182,v183
v_exp_f32 v177,v41
s_nop 0
cv v152,v176,v177
v_exp_f32 v178,v42
v_or3_b32 v185,v151,v152,v185
s_nop 3
s_setpc_b64 s[60:61]
attn_slow_7:
s_nop 15
s_add_u32 s62,s62,1
v_max3_f32 v204,v64,v65,v66
v_max3_f32 v204,v67,v80,v204
v_max3_f32 v204,v81,v82,v204
v_max3_f32 v204,v83,v96,v204
v_max3_f32 v204,v97,v98,v204
v_max3_f32 v204,v99,v112,v204
v_max3_f32 v204,v113,v114,v204
v_max_f32 v204,v115,v204
v_max3_f32 v205,v68,v69,v70
v_max3_f32 v205,v71,v84,v205
v_max3_f32 v205,v85,v86,v205
v_max3_f32 v205,v87,v100,v205
v_max3_f32 v205,v101,v102,v205
v_max3_f32 v205,v103,v116,v205
v_max3_f32 v205,v117,v118,v205
v_max_f32 v205,v119,v205
v_max3_f32 v206,v72,v73,v74
v_max3_f32 v206,v75,v88,v206
v_max3_f32 v206,v89,v90,v206
v_max3_f32 v206,v91,v104,v206
v_max3_f32 v206,v105,v106,v206
v_max3_f32 v206,v107,v120,v206
v_max3_f32 v206,v121,v122,v206
v_max_f32 v206,v123,v206
v_max3_f32 v207,v76,v77,v78
v_max3_f32 v207,v79,v92,v207
v_max3_f32 v207,v93,v94,v207
v_max3_f32 v207,v95,v108,v207
v_max3_f32 v207,v109,v110,v207
v_max3_f32 v207,v111,v124,v207
v_max3_f32 v207,v125,v126,v207
v_max_f32 v207,v127,v207
v_mov_b32 v208,v204
v_mov_b32 v209,v205
v_mov_b32 v210,v206
v_mov_b32 v211,v207
v_permlane16_swap_b32 v208,v204
v_permlane16_swap_b32 v209,v205
v_permlane16_swap_b32 v210,v206
v_permlane16_swap_b32 v211,v207
v_max_f32 v204,v204,v208
v_max_f32 v205,v205,v209
v_max_f32 v206,v206,v210
v_max_f32 v207,v207,v211
v_mov_b32 v208,v204
v_mov_b32 v209,v205
v_mov_b32 v210,v206
v_mov_b32 v211,v207
v_permlane32_swap_b32 v208,v204
v_permlane32_swap_b32 v209,v205
v_permlane32_swap_b32 v210,v206
v_permlane32_swap_b32 v211,v207
v_max_f32 v204,v204,v208
v_max_f32 v205,v205,v209
v_max_f32 v206,v206,v210
v_max_f32 v207,v207,v211
v_add_f32 v204,0x42b40000,v204
v_max_f32 v204,0,v204
v_add_f32 v205,0x42b40000,v205
v_max_f32 v205,0,v205
v_add_f32 v206,0x42b40000,v206
v_max_f32 v206,0,v206
v_add_f32 v207,0x42b40000,v207
v_max_f32 v207,0,v207
v_exp_f32 v212,-v204
v_exp_f32 v213,-v205
v_exp_f32 v214,-v206
v_exp_f32 v215,-v207
v_sub_f32 v160,v160,v204
v_sub_f32 v161,v161,v204
v_sub_f32 v162,v162,v204
v_sub_f32 v163,v163,v204
v_sub_f32 v64,v64,v204
v_sub_f32 v65,v65,v204
v_sub_f32 v66,v66,v204
v_sub_f32 v67,v67,v204
v_sub_f32 v80,v80,v204
v_sub_f32 v81,v81,v204
v_sub_f32 v82,v82,v204
v_sub_f32 v83,v83,v204
v_sub_f32 v96,v96,v204
v_sub_f32 v97,v97,v204
v_sub_f32 v98,v98,v204
v_sub_f32 v99,v99,v204
v_sub_f32 v112,v112,v204
v_sub_f32 v113,v113,v204
v_sub_f32 v114,v114,v204
v_sub_f32 v115,v115,v204
v_sub_f32 v0,v0,v204
v_sub_f32 v1,v1,v204
v_sub_f32 v2,v2,v204
v_sub_f32 v3,v3,v204
v_sub_f32 v16,v16,v204
v_sub_f32 v17,v17,v204
v_sub_f32 v18,v18,v204
v_sub_f32 v19,v19,v204
v_sub_f32 v32,v32,v204
v_sub_f32 v33,v33,v204
v_sub_f32 v34,v34,v204
v_sub_f32 v35,v35,v204
v_sub_f32 v48,v48,v204
v_sub_f32 v49,v49,v204
v_sub_f32 v50,v50,v204
v_sub_f32 v51,v51,v204
v_sub_f32 v164,v164,v205
v_sub_f32 v165,v165,v205
v_sub_f32 v166,v166,v205
v_sub_f32 v167,v167,v205
v_sub_f32 v68,v68,v205
v_sub_f32 v69,v69,v205
v_sub_f32 v70,v70,v205
v_sub_f32 v71,v71,v205
v_sub_f32 v84,v84,v205
v_sub_f32 v85,v85,v205
v_sub_f32 v86,v86,v205
v_sub_f32 v87,v87,v205
v_sub_f32 v100,v100,v205
v_sub_f32 v101,v101,v205
v_sub_f32 v102,v102,v205
v_sub_f32 v103,v103,v205
v_sub_f32 v116,v116,v205
v_sub_f32 v117,v117,v205
v_sub_f32 v118,v118,v205
v_sub_f32 v119,v119,v205
v_sub_f32 v4,v4,v205
v_sub_f32 v5,v5,v205
v_sub_f32 v6,v6,v205
v_sub_f32 v7,v7,v205
v_sub_f32 v20,v20,v205
v_sub_f32 v21,v21,v205
v_sub_f32 v22,v22,v205
v_sub_f32 v23,v23,v205
v_sub_f32 v36,v36,v205
v_sub_f32 v37,v37,v205
v_sub_f32 v38,v38,v205
v_sub_f32 v39,v39,v205
v_sub_f32 v52,v52,v205
v_sub_f32 v53,v53,v205
v_sub_f32 v54,v54,v205
v_sub_f32 v55,v55,v205
v_sub_f32 v168,v168,v206
v_sub_f32 v169,v169,v206
v_sub_f32 v170,v170,v206
v_sub_f32 v171,v171,v206
v_sub_f32 v72,v72,v206
v_sub_f32 v73,v73,v206
v_sub_f32 v74,v74,v206
v_sub_f32 v75,v75,v206
v_sub_f32 v88,v88,v206
v_sub_f32 v89,v89,v206
v_sub_f32 v90,v90,v206
v_sub_f32 v91,v91,v206
v_sub_f32 v104,v104,v206
v_sub_f32 v105,v105,v206
v_sub_f32 v106,v106,v206
v_sub_f32 v107,v107,v206
v_sub_f32 v120,v120,v206
v_sub_f32 v121,v121,v206
v_sub_f32 v122,v122,v206
v_sub_f32 v123,v123,v206
v_sub_f32 v8,v8,v206
v_sub_f32 v9,v9,v206
v_sub_f32 v10,v10,v206
v_sub_f32 v11,v11,v206
v_sub_f32 v24,v24,v206
v_sub_f32 v25,v25,v206
v_sub_f32 v26,v26,v206
v_sub_f32 v27,v27,v206
v_sub_f32 v40,v40,v206
v_sub_f32 v41,v41,v206
v_sub_f32 v42,v42,v206
v_sub_f32 v43,v43,v206
v_sub_f32 v56,v56,v206
v_sub_f32 v57,v57,v206
v_sub_f32 v58,v58,v206
v_sub_f32 v59,v59,v206
v_sub_f32 v172,v172,v207
v_sub_f32 v173,v173,v207
v_sub_f32 v174,v174,v207
v_sub_f32 v175,v175,v207
v_sub_f32 v76,v76,v207
v_sub_f32 v77,v77,v207
v_sub_f32 v78,v78,v207
v_sub_f32 v79,v79,v207
v_sub_f32 v92,v92,v207
v_sub_f32 v93,v93,v207
v_sub_f32 v94,v94,v207
v_sub_f32 v95,v95,v207
v_sub_f32 v108,v108,v207
v_sub_f32 v109,v109,v207
v_sub_f32 v110,v110,v207
v_sub_f32 v111,v111,v207
v_sub_f32 v124,v124,v207
v_sub_f32 v125,v125,v207
v_sub_f32 v126,v126,v207
v_sub_f32 v127,v127,v207
v_sub_f32 v12,v12,v207
v_sub_f32 v13,v13,v207
v_sub_f32 v14,v14,v207
v_sub_f32 v15,v15,v207
v_sub_f32 v28,v28,v207
v_sub_f32 v29,v29,v207
v_sub_f32 v30,v30,v207
v_sub_f32 v31,v31,v207
v_sub_f32 v44,v44,v207
v_sub_f32 v45,v45,v207
v_sub_f32 v46,v46,v207
v_sub_f32 v47,v47,v207
v_sub_f32 v60,v60,v207
v_sub_f32 v61,v61,v207
v_sub_f32 v62,v62,v207
v_sub_f32 v63,v63,v207
ar v208,a0
ar v209,a1
ar v210,a2
ar v211,a3
v_mul_f32 v208,v208,v212
v_mul_f32 v209,v209,v212
v_mul_f32 v210,v210,v212
v_mul_f32 v211,v211,v212
aw a0,v208
aw a1,v209
aw a2,v210
aw a3,v211
ar v208,a4
ar v209,a5
ar v210,a6
ar v211,a7
v_mul_f32 v208,v208,v213
v_mul_f32 v209,v209,v213
v_mul_f32 v210,v210,v213
v_mul_f32 v211,v211,v213
aw a4,v208
aw a5,v209
aw a6,v210
aw a7,v211
ar v208,a8
ar v209,a9
ar v210,a10
ar v211,a11
v_mul_f32 v208,v208,v214
v_mul_f32 v209,v209,v214
v_mul_f32 v210,v210,v214
v_mul_f32 v211,v211,v214
aw a8,v208
aw a9,v209
aw a10,v210
aw a11,v211
ar v208,a12
ar v209,a13
ar v210,a14
ar v211,a15
v_mul_f32 v208,v208,v215
v_mul_f32 v209,v209,v215
v_mul_f32 v210,v210,v215
v_mul_f32 v211,v211,v215
aw a12,v208
aw a13,v209
aw a14,v210
aw a15,v211
ar v208,a16
ar v209,a17
ar v210,a18
ar v211,a19
v_mul_f32 v208,v208,v212
v_mul_f32 v209,v209,v212
v_mul_f32 v210,v210,v212
v_mul_f32 v211,v211,v212
aw a16,v208
aw a17,v209
aw a18,v210
aw a19,v211
ar v208,a20
ar v209,a21
ar v210,a22
ar v211,a23
v_mul_f32 v208,v208,v213
v_mul_f32 v209,v209,v213
v_mul_f32 v210,v210,v213
v_mul_f32 v211,v211,v213
aw a20,v208
aw a21,v209
aw a22,v210
aw a23,v211
ar v208,a24
ar v209,a25
ar v210,a26
ar v211,a27
v_mul_f32 v208,v208,v214
v_mul_f32 v209,v209,v214
v_mul_f32 v210,v210,v214
v_mul_f32 v211,v211,v214
aw a24,v208
aw a25,v209
aw a26,v210
aw a27,v211
ar v208,a28
ar v209,a29
ar v210,a30
ar v211,a31
v_mul_f32 v208,v208,v215
v_mul_f32 v209,v209,v215
v_mul_f32 v210,v210,v215
v_mul_f32 v211,v211,v215
aw a28,v208
aw a29,v209
aw a30,v210
aw a31,v211
ar v208,a32
ar v209,a33
ar v210,a34
ar v211,a35
v_mul_f32 v208,v208,v212
v_mul_f32 v209,v209,v212
v_mul_f32 v210,v210,v212
v_mul_f32 v211,v211,v212
aw a32,v208
aw a33,v209
aw a34,v210
aw a35,v211
ar v208,a36
ar v209,a37
ar v210,a38
ar v211,a39
v_mul_f32 v208,v208,v213
v_mul_f32 v209,v209,v213
v_mul_f32 v210,v210,v213
v_mul_f32 v211,v211,v213
aw a36,v208
aw a37,v209
aw a38,v210
aw a39,v211
ar v208,a40
ar v209,a41
ar v210,a42
ar v211,a43
v_mul_f32 v208,v208,v214
v_mul_f32 v209,v209,v214
v_mul_f32 v210,v210,v214
v_mul_f32 v211,v211,v214
aw a40,v208
aw a41,v209
aw a42,v210
aw a43,v211
ar v208,a44
ar v209,a45
ar v210,a46
ar v211,a47
v_mul_f32 v208,v208,v215
v_mul_f32 v209,v209,v215
v_mul_f32 v210,v210,v215
v_mul_f32 v211,v211,v215
aw a44,v208
aw a45,v209
aw a46,v210
aw a47,v211
ar v208,a48
ar v209,a49
ar v210,a50
ar v211,a51
v_mul_f32 v208,v208,v212
v_mul_f32 v209,v209,v212
v_mul_f32 v210,v210,v212
v_mul_f32 v211,v211,v212
aw a48,v208
aw a49,v209
aw a50,v210
aw a51,v211
ar v208,a52
ar v209,a53
ar v210,a54
ar v211,a55
v_mul_f32 v208,v208,v213
v_mul_f32 v209,v209,v213
v_mul_f32 v210,v210,v213
v_mul_f32 v211,v211,v213
aw a52,v208
aw a53,v209
aw a54,v210
aw a55,v211
ar v208,a56
ar v209,a57
ar v210,a58
ar v211,a59
v_mul_f32 v208,v208,v214
v_mul_f32 v209,v209,v214
v_mul_f32 v210,v210,v214
v_mul_f32 v211,v211,v214
aw a56,v208
aw a57,v209
aw a58,v210
aw a59,v211
ar v208,a60
ar v209,a61
ar v210,a62
ar v211,a63
v_mul_f32 v208,v208,v215
v_mul_f32 v209,v209,v215
v_mul_f32 v210,v210,v215
v_mul_f32 v211,v211,v215
aw a60,v208
aw a61,v209
aw a62,v210
aw a63,v211
ar v208,a64
ar v209,a65
ar v210,a66
ar v211,a67
v_mul_f32 v208,v208,v212
v_mul_f32 v209,v209,v212
v_mul_f32 v210,v210,v212
v_mul_f32 v211,v211,v212
aw a64,v208
aw a65,v209
aw a66,v210
aw a67,v211
ar v208,a68
ar v209,a69
ar v210,a70
ar v211,a71
v_mul_f32 v208,v208,v213
v_mul_f32 v209,v209,v213
v_mul_f32 v210,v210,v213
v_mul_f32 v211,v211,v213
aw a68,v208
aw a69,v209
aw a70,v210
aw a71,v211
ar v208,a72
ar v209,a73
ar v210,a74
ar v211,a75
v_mul_f32 v208,v208,v214
v_mul_f32 v209,v209,v214
v_mul_f32 v210,v210,v214
v_mul_f32 v211,v211,v214
aw a72,v208
aw a73,v209
aw a74,v210
aw a75,v211
ar v208,a76
ar v209,a77
ar v210,a78
ar v211,a79
v_mul_f32 v208,v208,v215
v_mul_f32 v209,v209,v215
v_mul_f32 v210,v210,v215
v_mul_f32 v211,v211,v215
aw a76,v208
aw a77,v209
aw a78,v210
aw a79,v211
ar v208,a80
ar v209,a81
ar v210,a82
ar v211,a83
v_mul_f32 v208,v208,v212
v_mul_f32 v209,v209,v212
v_mul_f32 v210,v210,v212
v_mul_f32 v211,v211,v212
aw a80,v208
aw a81,v209
aw a82,v210
aw a83,v211
ar v208,a84
ar v209,a85
ar v210,a86
ar v211,a87
v_mul_f32 v208,v208,v213
v_mul_f32 v209,v209,v213
v_mul_f32 v210,v210,v213
v_mul_f32 v211,v211,v213
aw a84,v208
aw a85,v209
aw a86,v210
aw a87,v211
ar v208,a88
ar v209,a89
ar v210,a90
ar v211,a91
v_mul_f32 v208,v208,v214
v_mul_f32 v209,v209,v214
v_mul_f32 v210,v210,v214
v_mul_f32 v211,v211,v214
aw a88,v208
aw a89,v209
aw a90,v210
aw a91,v211
ar v208,a92
ar v209,a93
ar v210,a94
ar v211,a95
v_mul_f32 v208,v208,v215
v_mul_f32 v209,v209,v215
v_mul_f32 v210,v210,v215
v_mul_f32 v211,v211,v215
aw a92,v208
aw a93,v209
aw a94,v210
aw a95,v211
ar v208,a96
ar v209,a97
ar v210,a98
ar v211,a99
v_mul_f32 v208,v208,v212
v_mul_f32 v209,v209,v212
v_mul_f32 v210,v210,v212
v_mul_f32 v211,v211,v212
aw a96,v208
aw a97,v209
aw a98,v210
aw a99,v211
ar v208,a100
ar v209,a101
ar v210,a102
ar v211,a103
v_mul_f32 v208,v208,v213
v_mul_f32 v209,v209,v213
v_mul_f32 v210,v210,v213
v_mul_f32 v211,v211,v213
aw a100,v208
aw a101,v209
aw a102,v210
aw a103,v211
ar v208,a104
ar v209,a105
ar v210,a106
ar v211,a107
v_mul_f32 v208,v208,v214
v_mul_f32 v209,v209,v214
v_mul_f32 v210,v210,v214
v_mul_f32 v211,v211,v214
aw a104,v208
aw a105,v209
aw a106,v210
aw a107,v211
ar v208,a108
ar v209,a109
ar v210,a110
ar v211,a111
v_mul_f32 v208,v208,v215
v_mul_f32 v209,v209,v215
v_mul_f32 v210,v210,v215
v_mul_f32 v211,v211,v215
aw a108,v208
aw a109,v209
aw a110,v210
aw a111,v211
ar v208,a112
ar v209,a113
ar v210,a114
ar v211,a115
v_mul_f32 v208,v208,v212
v_mul_f32 v209,v209,v212
v_mul_f32 v210,v210,v212
v_mul_f32 v211,v211,v212
aw a112,v208
aw a113,v209
aw a114,v210
aw a115,v211
ar v208,a116
ar v209,a117
ar v210,a118
ar v211,a119
v_mul_f32 v208,v208,v213
v_mul_f32 v209,v209,v213
v_mul_f32 v210,v210,v213
v_mul_f32 v211,v211,v213
aw a116,v208
aw a117,v209
aw a118,v210
aw a119,v211
ar v208,a120
ar v209,a121
ar v210,a122
ar v211,a123
v_mul_f32 v208,v208,v214
v_mul_f32 v209,v209,v214
v_mul_f32 v210,v210,v214
v_mul_f32 v211,v211,v214
aw a120,v208
aw a121,v209
aw a122,v210
aw a123,v211
ar v208,a124
ar v209,a125
ar v210,a126
ar v211,a127
v_mul_f32 v208,v208,v215
v_mul_f32 v209,v209,v215
v_mul_f32 v210,v210,v215
v_mul_f32 v211,v211,v215
aw a124,v208
aw a125,v209
aw a126,v210
aw a127,v211
ar v208,a224
ar v209,a225
ar v210,a226
ar v211,a227
v_mul_f32 v208,v208,v212
v_mul_f32 v209,v209,v212
v_mul_f32 v210,v210,v212
v_mul_f32 v211,v211,v212
aw a224,v208
aw a225,v209
aw a226,v210
aw a227,v211
ar v208,a228
ar v209,a229
ar v210,a230
ar v211,a231
v_mul_f32 v208,v208,v213
v_mul_f32 v209,v209,v213
v_mul_f32 v210,v210,v213
v_mul_f32 v211,v211,v213
aw a228,v208
aw a229,v209
aw a230,v210
aw a231,v211
ar v208,a232
ar v209,a233
ar v210,a234
ar v211,a235
v_mul_f32 v208,v208,v214
v_mul_f32 v209,v209,v214
v_mul_f32 v210,v210,v214
v_mul_f32 v211,v211,v214
aw a232,v208
aw a233,v209
aw a234,v210
aw a235,v211
ar v208,a236
ar v209,a237
ar v210,a238
ar v211,a239
v_mul_f32 v208,v208,v215
v_mul_f32 v209,v209,v215
v_mul_f32 v210,v210,v215
v_mul_f32 v211,v211,v215
aw a236,v208
aw a237,v209
aw a238,v210
aw a239,v211
v_exp_f32 v176,v64
v_exp_f32 v177,v65
s_nop 0
cv v128,v176,v177
v_exp_f32 v178,v66
v_exp_f32 v179,v67
s_nop 0
cv v129,v178,v179
v_exp_f32 v180,v80
v_exp_f32 v181,v81
s_nop 0
cv v130,v180,v181
v_exp_f32 v182,v82
v_exp_f32 v183,v83
s_nop 0
cv v131,v182,v183
v_exp_f32 v176,v68
v_exp_f32 v177,v69
s_nop 0
cv v132,v176,v177
v_exp_f32 v178,v70
v_exp_f32 v179,v71
s_nop 0
cv v133,v178,v179
v_exp_f32 v180,v84
v_exp_f32 v181,v85
s_nop 0
cv v134,v180,v181
v_exp_f32 v182,v86
v_exp_f32 v183,v87
s_nop 0
cv v135,v182,v183
v_exp_f32 v176,v72
v_exp_f32 v177,v73
s_nop 0
cv v136,v176,v177
v_exp_f32 v178,v74
v_exp_f32 v179,v75
s_nop 0
cv v137,v178,v179
v_exp_f32 v180,v88
v_exp_f32 v181,v89
s_nop 0
cv v138,v180,v181
v_exp_f32 v182,v90
v_exp_f32 v183,v91
s_nop 0
cv v139,v182,v183
v_exp_f32 v176,v76
v_exp_f32 v177,v77
s_nop 0
cv v140,v176,v177
v_exp_f32 v178,v78
v_exp_f32 v179,v79
s_nop 0
cv v141,v178,v179
v_exp_f32 v180,v92
v_exp_f32 v181,v93
s_nop 0
cv v142,v180,v181
v_exp_f32 v182,v94
v_exp_f32 v183,v95
s_nop 0
cv v143,v182,v183
s_nop 3
s_setpc_b64 s[60:61]
.p2align 8
.globl adaLN_cond__mha_block_cached__mixer_channel_mlp__prompt_kernel
.type adaLN_cond__mha_block_cached__mixer_channel_mlp__prompt_kernel,@function
adaLN_cond__mha_block_cached__mixer_channel_mlp__prompt_kernel:
s_cmp_ge_u32 s2,256
s_cbranch_scc1 attn_end
s_getpc_b64 s[96:97]
attn_pc0:
s_lshr_b32 s98,s2,3
s_and_b32 s98,s98,3
s_lshl_b32 s98,s98,15
v_lshl_add_u32 v248,v0,7,s98
v_min_u32 v248,tail_end-attn_pc0,v248
v_mov_b32 v249,s97
v_add_co_u32 v248,vcc,s96,v248
s_nop 1
v_addc_co_u32 v249,vcc,0,v249,vcc
global_load_dword v248,v[248:249],off
s_load_dwordx2 s[68:69],s[0:1],88
s_load_dwordx2 s[80:81],s[0:1],80
s_load_dwordx2 s[84:85],s[0:1],0
s_and_b32 s92,s2,7
s_bfe_u32 s93,s2,0x30003
s_lshl3_add_u32 s92,s92,s93
s_lshr_b32 s93,s2,6
s_mul_i32 s94,s93,3145728
s_lshl_b32 s95,s92,6
s_add_u32 s94,s94,s95
v_lshrrev_b32 v1,2,v0
v_and_b32 v2,3,v0
v_mul_u32_u24 v3,12288,v1
v_lshl_add_u32 v3,v2,4,v3
s_mov_b32 s70,12582912
s_mov_b32 s71,0x20000
s_mov_b32 s96,786432
s_waitcnt lgkmcnt(0)
bl v[64:67],v3,s[68:71],s94 offen
s_add_u32 s94,s94,s96
bl v[68:71],v3,s[68:71],s94 offen
s_add_u32 s94,s94,s96
bl v[72:75],v3,s[68:71],s94 offen
s_add_u32 s94,s94,s96
bl v[76:79],v3,s[68:71],s94 offen
s_load_dwordx2 s[88:89],s[0:1],104
s_mov_b32 s62,0
s_load_dwordx4 s[8:11],s[0:1],8
s_load_dwordx2 s[20:21],s[0:1],24
s_load_dwordx2 s[4:5],s[0:1],112
s_load_dwordx2 s[48:49],s[0:1],32
s_load_dwordx2 s[52:53],s[0:1],48
s_load_dwordx2 s[56:57],s[0:1],64
v_and_b32 v220,63,v0
v_lshrrev_b32 v204,6,v0
s_nop 0
v_readfirstlane_b32 s30,v204
s_mul_i32 s95,s93,512
v_lshlrev_b32 v4,1,v1
s_mov_b32 s82,0x800
s_mov_b32 s83,0x20000
buffer_load_ushort v128,v4,s[80:83],s95 offen offset:0
buffer_load_ushort v129,v4,s[80:83],s95 offen offset:128
buffer_load_ushort v130,v4,s[80:83],s95 offen offset:256
buffer_load_ushort v131,v4,s[80:83],s95 offen offset:384
v_and_b32 v12,7,v220
v_bfe_u32 v13,v220,3,1
s_lshl_b32 s96,s30,3
v_add_u32 v13,s96,v13
v_lshrrev_b32 v14,4,v220
v_and_b32 v15,1,v14
v_lshrrev_b32 v16,1,v14
v_lshl_or_b32 v15,v15,1,v16
v_lshlrev_b32 v5,11,v12
v_lshl_add_u32 v5,v13,6,v5
v_lshl_add_u32 v5,v15,4,v5
s_lshl_b32 s97,s2,14
v_lshlrev_b32 v17,3,v0
s_mov_b32 s86,0x400000
s_mov_b32 s87,0x20000
bl v[48:51],v5,s[84:87],s97 offen offset:0
bl v[52:55],v5,s[84:87],s97 offen offset:128
bl v[56:59],v5,s[84:87],s97 offen offset:256
bl v[60:63],v5,s[84:87],s97 offen offset:384
buffer_load_dwordx2 v[244:245],v17,s[80:83],0 offen
s_waitcnt lgkmcnt(0)
s_mov_b32 s64,s4
s_mov_b32 s65,s5
s_mov_b32 s66,0x100000
s_mov_b32 s67,0x20000
v_mov_b32 v18,0
v_lshlrev_b32 v19,2,v220
s_lshl_b32 s98,s30,24
v_add_u32 v19,s98,v19
s_lshl_b32 s99,s2,8
s_add_u32 s99,s99,524288
buffer_store_dword v18,v19,s[64:67],s99 offen sc1
s_mov_b32 s22,0x800000
s_mov_b32 s23,0x20000
v_lshlrev_b32 v6,10,v13
v_lshl_add_u32 v6,v14,8,v6
v_lshl_add_u32 v6,v12,4,v6
v_lshlrev_b32 v7,7,v13
v_lshl_add_u32 v7,v14,4,v7
v_add_u32 v7,99328,v7
v_lshlrev_b32 v3,5,v12
v_add_u32 v3,98816,v3
s_lshl_b32 s96,s30,3
v_add_u32 v4,s96,v3
s_lshr_b32 s97,s2,1
s_lshl_b32 s97,s97,15
s_and_b32 s96,s2,1
s_lshl_b32 s96,s96,7
s_add_u32 s97,s97,s96
s_mov_b32 s90,0x100
s_mov_b32 s91,0x20000
s_and_b32 s31,s2,3
s_lshl_b32 s31,s31,3
s_bfe_u32 s32,s2,0x30003
s_add_u32 s31,s31,s32
s_lshr_b32 s32,s2,6
s_and_b32 s33,s2,4
s_add_u32 s32,s32,s33
s_mul_i32 s24,s30,131072
v_lshlrev_b32 v204,4,v220
v_add_u32 v222,s24,v204
v_add_u32 v223,0x8000,v222
v_add_u32 v224,0x10000,v222
v_add_u32 v225,0x18000,v222
s_mul_i32 s24,s30,128
s_mov_b32 s25,8192
v_add_u32 v206,s24,v220
v_lshrrev_b32 v207,4,v206
v_and_b32 v209,15,v206
v_and_b32 v210,7,v207
v_lshlrev_b32 v210,1,v210
v_xor_b32 v209,v209,v210
v_mul_lo_u32 v207,v207,s25
v_lshl_add_u32 v226,v209,4,v207
v_add_u32 v206,s24,v220
v_add_u32 v206,64,v206
v_lshrrev_b32 v207,4,v206
v_and_b32 v209,15,v206
v_and_b32 v210,7,v207
v_lshlrev_b32 v210,1,v210
v_xor_b32 v209,v209,v210
v_mul_lo_u32 v207,v207,s25
v_lshl_add_u32 v227,v209,4,v207
v_subrev_u32 v227,1024,v227
s_mul_i32 s36,s30,2048
s_lshl_b32 s34,s32,19
s_lshl_b32 s35,s31,8
s_waitcnt lgkmcnt(0)
s_mov_b32 s12,s10
s_mov_b32 s13,s11
s_mov_b32 s22,0x800000
s_mov_b32 s23,0x20000
s_add_u32 s16,s4,0x100000
s_addc_u32 s17,s5,0
s_mov_b32 s18,0x400000
s_mov_b32 s19,0x20000
s_mov_b32 s10,0x1000000
s_mov_b32 s11,0x20000
s_mov_b32 s14,0x1000000
s_mov_b32 s15,0x20000
s_add_u32 s24,s4,0x1000000
s_addc_u32 s25,s5,0
s_mov_b32 s26,0x1000000
s_mov_b32 s27,0x20000
v_and_b32 v206,15,v220
v_lshrrev_b32 v207,4,v220
v_lshrrev_b32 v208,2,v206
v_lshl_add_u32 v209,v207,2,v208
v_and_b32 v210,7,v209
v_mul_u32_u24 v209,256,v209
v_and_b32 v208,3,v206
v_lshl_add_u32 v209,v208,3,v209
v_xor_b32 v208,0,v210
v_lshl_add_u32 v190,v208,5,v209
v_xor_b32 v208,1,v210
v_lshl_add_u32 v191,v208,5,v209
v_xor_b32 v208,2,v210
v_lshl_add_u32 v192,v208,5,v209
v_xor_b32 v208,3,v210
v_lshl_add_u32 v193,v208,5,v209
v_xor_b32 v208,4,v210
v_lshl_add_u32 v194,v208,5,v209
v_xor_b32 v208,5,v210
v_lshl_add_u32 v195,v208,5,v209
v_xor_b32 v208,6,v210
v_lshl_add_u32 v196,v208,5,v209
v_xor_b32 v208,7,v210
v_lshl_add_u32 v197,v208,5,v209
s_mov_b32 s50,0x800000
s_mov_b32 s51,0x20000
s_mov_b32 s54,0x700000
s_mov_b32 s55,0x20000
s_mov_b32 s58,0x700000
s_mov_b32 s59,0x20000
s_lshl_b32 s46,s2,2
s_add_u32 s46,s46,s30
s_lshl_b32 s46,s46,10
v_lshlrev_b32 v230,7,v220
v_add_u32 v230,s46,v230
v_mov_b32 v204,0x40000000
v_cmp_gt_u32 vcc,8,v220
s_nop 1
v_cndmask_b32 v230,v204,v230,vcc
s_mov_b32 s37,0x700000
s_mov_b32 s46,0
s_mov_b32 s64,s4
s_mov_b32 s65,s5
s_mov_b32 s66,0x100000
s_mov_b32 s67,0x20000
s_mov_b32 s70,0xc00000
s_mov_b32 s71,0x20000
s_and_b32 s38,s2,7
s_lshl_b32 s38,s38,5
s_lshr_b32 s39,s2,3
s_add_u32 s38,s38,s39
s_lshl_b32 s63,s38,6
s_add_u32 s63,s63,8192
s_lshr_b32 s39,s63,1
v_lshrrev_b32 v204,1,v220
s_lshl_b32 s38,s30,8
v_add_u32 v204,s38,v204
s_mov_b32 s38,12288
v_mul_lo_u32 v204,v204,s38
v_and_b32 v205,1,v220
v_lshl_add_u32 v241,v205,4,v204
s_lshl_b32 s43,s30,13
v_lshlrev_b32 v242,3,v220
v_add_u32 v242,s43,v242
v_lshrrev_b32 v204,4,v220
s_lshl_b32 s38,s30,9
s_add_u32 s38,s38,148480
v_lshl_add_u32 v243,v204,4,s38
v_lshrrev_b32 v204,3,v220
v_lshl_add_u32 v240,v204,6,s38
v_and_b32 v204,3,v220
v_lshl_add_u32 v240,v204,4,v240
v_bfe_u32 v204,v220,2,1
v_lshl_add_u32 v240,v204,3,v240
v_lshrrev_b32 v212,4,v220
v_and_b32 v213,15,v220
s_lshl_b32 s33,s30,4
v_add_u32 v204,s33,v212
v_lshlrev_b32 v204,8,v204
v_xor_b32 v205,v213,v212
v_xor_b32 v207,0,v205
v_lshl_add_u32 v198,v207,4,v204
v_xor_b32 v207,4,v205
v_lshl_add_u32 v199,v207,4,v204
v_xor_b32 v207,8,v205
v_lshl_add_u32 v200,v207,4,v204
v_xor_b32 v207,12,v205
v_lshl_add_u32 v201,v207,4,v204
v_lshlrev_b32 v205,1,v212
v_xor_b32 v205,v205,v213
v_lshl_add_u32 v202,v205,4,v204
v_xor_b32 v205,8,v205
v_lshl_add_u32 v203,v205,4,v204
s_lshl_b32 s40,s31,19
s_mov_b32 s41,s40
s_lshl_b32 s44,s30,12
s_mov_b32 s45,0x40004000
v_and_b32 v204,1,v212
v_lshrrev_b32 v205,1,v212
v_lshl_or_b32 v204,v204,1,v205
v_xor_b32 v204,v204,v213
v_lshlrev_b32 v205,8,v213
v_add_u32 v205,32768,v205
v_xor_b32 v207,0,v204
v_lshl_add_u32 v186,v207,4,v205
v_xor_b32 v207,4,v204
v_lshl_add_u32 v187,v207,4,v205
v_xor_b32 v207,8,v204
v_lshl_add_u32 v188,v207,4,v205
v_xor_b32 v207,12,v204
v_lshl_add_u32 v189,v207,4,v205
v_lshlrev_b32 v221,4,v220
s_lshl_b32 s33,s32,4
s_lshl_b32 s38,s30,2
s_add_u32 s33,s33,s38
s_lshl_b32 s33,s33,7
s_lshl_b32 s38,s31,2
s_add_u32 s33,s33,s38
s_lshl_b32 s33,s33,10
aw a224,0
aw a225,0
aw a226,0
aw a227,0
aw a228,0
aw a229,0
aw a230,0
aw a231,0
aw a232,0
aw a233,0
aw a234,0
aw a235,0
aw a236,0
aw a237,0
aw a238,0
aw a239,0
v_mov_b32 v204,0x3f803f80
aw a240,v204
aw a241,v204
aw a242,v204
aw a243,v204
s_waitcnt vmcnt(9)
v_lshlrev_b32 v128,16,v128
s_waitcnt vmcnt(8)
v_lshlrev_b32 v129,16,v129
s_waitcnt vmcnt(7)
v_lshlrev_b32 v130,16,v130
s_waitcnt vmcnt(6)
v_lshlrev_b32 v131,16,v131
v_mul_f32 v16,0xbfb8aa3b,v128
v_mul_f32 v17,0xbfb8aa3b,v129
v_mul_f32 v18,0xbfb8aa3b,v130
v_mul_f32 v19,0xbfb8aa3b,v131
v_exp_f32 v16,v16
v_exp_f32 v17,v17
v_exp_f32 v18,v18
v_exp_f32 v19,v19
v_add_f32 v16,1.0,v16
v_add_f32 v17,1.0,v17
v_add_f32 v18,1.0,v18
v_add_f32 v19,1.0,v19
v_rcp_f32 v16,v16
v_rcp_f32 v17,v17
v_rcp_f32 v18,v18
v_rcp_f32 v19,v19
v_mul_f32 v128,v128,v16
v_mul_f32 v129,v129,v17
v_mul_f32 v130,v130,v18
v_mul_f32 v131,v131,v19
cv v12,v128,v129
v_lshlrev_b32 v128,16,v12
v_and_b32 v129,0xffff0000,v12
cv v12,v130,v131
v_lshlrev_b32 v130,16,v12
v_and_b32 v131,0xffff0000,v12
v_lshlrev_b32 v12,16,v64
v_and_b32 v13,0xffff0000,v64
v_mul_f32 v16,v12,v128
v_mul_f32 v17,v13,v128
v_lshlrev_b32 v12,16,v65
v_and_b32 v13,0xffff0000,v65
v_mul_f32 v18,v12,v128
v_mul_f32 v19,v13,v128
v_lshlrev_b32 v12,16,v66
v_and_b32 v13,0xffff0000,v66
v_mul_f32 v20,v12,v128
v_mul_f32 v21,v13,v128
v_lshlrev_b32 v12,16,v67
v_and_b32 v13,0xffff0000,v67
v_mul_f32 v22,v12,v128
v_mul_f32 v23,v13,v128
v_lshlrev_b32 v12,16,v68
v_and_b32 v13,0xffff0000,v68
v_fmac_f32 v16,v12,v129
v_fmac_f32 v17,v13,v129
v_lshlrev_b32 v12,16,v69
v_and_b32 v13,0xffff0000,v69
v_fmac_f32 v18,v12,v129
v_fmac_f32 v19,v13,v129
v_lshlrev_b32 v12,16,v70
v_and_b32 v13,0xffff0000,v70
v_fmac_f32 v20,v12,v129
v_fmac_f32 v21,v13,v129
v_lshlrev_b32 v12,16,v71
v_and_b32 v13,0xffff0000,v71
v_fmac_f32 v22,v12,v129
v_fmac_f32 v23,v13,v129
v_lshlrev_b32 v12,16,v72
v_and_b32 v13,0xffff0000,v72
v_fmac_f32 v16,v12,v130
v_fmac_f32 v17,v13,v130
v_lshlrev_b32 v12,16,v73
v_and_b32 v13,0xffff0000,v73
v_fmac_f32 v18,v12,v130
v_fmac_f32 v19,v13,v130
v_lshlrev_b32 v12,16,v74
v_and_b32 v13,0xffff0000,v74
v_fmac_f32 v20,v12,v130
v_fmac_f32 v21,v13,v130
v_lshlrev_b32 v12,16,v75
v_and_b32 v13,0xffff0000,v75
v_fmac_f32 v22,v12,v130
v_fmac_f32 v23,v13,v130
v_lshlrev_b32 v12,16,v76
v_and_b32 v13,0xffff0000,v76
v_fmac_f32 v16,v12,v131
v_fmac_f32 v17,v13,v131
v_lshlrev_b32 v12,16,v77
v_and_b32 v13,0xffff0000,v77
v_fmac_f32 v18,v12,v131
v_fmac_f32 v19,v13,v131
v_lshlrev_b32 v12,16,v78
v_and_b32 v13,0xffff0000,v78
v_fmac_f32 v20,v12,v131
v_fmac_f32 v21,v13,v131
v_lshlrev_b32 v12,16,v79
v_and_b32 v13,0xffff0000,v79
v_fmac_f32 v22,v12,v131
v_fmac_f32 v23,v13,v131
v_add_f32_dpp v16,v16,v16 row_ror:4 row_mask:0xf bank_mask:0xf
v_add_f32_dpp v17,v17,v17 row_ror:4 row_mask:0xf bank_mask:0xf
v_add_f32_dpp v18,v18,v18 row_ror:4 row_mask:0xf bank_mask:0xf
v_add_f32_dpp v19,v19,v19 row_ror:4 row_mask:0xf bank_mask:0xf
v_add_f32_dpp v20,v20,v20 row_ror:4 row_mask:0xf bank_mask:0xf
v_add_f32_dpp v21,v21,v21 row_ror:4 row_mask:0xf bank_mask:0xf
v_add_f32_dpp v22,v22,v22 row_ror:4 row_mask:0xf bank_mask:0xf
v_add_f32_dpp v23,v23,v23 row_ror:4 row_mask:0xf bank_mask:0xf
v_add_f32_dpp v16,v16,v16 row_ror:8 row_mask:0xf bank_mask:0xf
v_add_f32_dpp v17,v17,v17 row_ror:8 row_mask:0xf bank_mask:0xf
v_add_f32_dpp v18,v18,v18 row_ror:8 row_mask:0xf bank_mask:0xf
v_add_f32_dpp v19,v19,v19 row_ror:8 row_mask:0xf bank_mask:0xf
v_add_f32_dpp v20,v20,v20 row_ror:8 row_mask:0xf bank_mask:0xf
v_add_f32_dpp v21,v21,v21 row_ror:8 row_mask:0xf bank_mask:0xf
v_add_f32_dpp v22,v22,v22 row_ror:8 row_mask:0xf bank_mask:0xf
v_add_f32_dpp v23,v23,v23 row_ror:8 row_mask:0xf bank_mask:0xf
v_mov_b32 v24,v16
v_mov_b32 v25,v17
v_mov_b32 v26,v18
v_mov_b32 v27,v19
v_mov_b32 v28,v20
v_mov_b32 v29,v21
v_mov_b32 v30,v22
v_mov_b32 v31,v23
v_permlane16_swap_b32 v24,v16
v_permlane16_swap_b32 v25,v17
v_permlane16_swap_b32 v26,v18
v_permlane16_swap_b32 v27,v19
v_permlane16_swap_b32 v28,v20
v_permlane16_swap_b32 v29,v21
v_permlane16_swap_b32 v30,v22
v_permlane16_swap_b32 v31,v23
v_add_f32 v16,v16,v24
v_add_f32 v17,v17,v25
v_add_f32 v18,v18,v26
v_add_f32 v19,v19,v27
v_add_f32 v20,v20,v28
v_add_f32 v21,v21,v29
v_add_f32 v22,v22,v30
v_add_f32 v23,v23,v31
v_mov_b32 v24,v16
v_mov_b32 v25,v17
v_mov_b32 v26,v18
v_mov_b32 v27,v19
v_mov_b32 v28,v20
v_mov_b32 v29,v21
v_mov_b32 v30,v22
v_mov_b32 v31,v23
v_permlane32_swap_b32 v24,v16
v_permlane32_swap_b32 v25,v17
v_permlane32_swap_b32 v26,v18
v_permlane32_swap_b32 v27,v19
v_permlane32_swap_b32 v28,v20
v_permlane32_swap_b32 v29,v21
v_permlane32_swap_b32 v30,v22
v_permlane32_swap_b32 v31,v23
v_add_f32 v16,v16,v24
v_add_f32 v17,v17,v25
v_add_f32 v18,v18,v26
v_add_f32 v19,v19,v27
v_add_f32 v20,v20,v28
v_add_f32 v21,v21,v29
v_add_f32 v22,v22,v30
v_add_f32 v23,v23,v31
s_lshl_b32 s96,s30,7
s_add_u32 s96,s96,98304
v_lshl_add_u32 v12,v2,5,s96
s_mov_b64 exec,15
ds_write_b128 v12,v[16:19]
ds_write_b128 v12,v[20:23] offset:16
s_mov_b64 exec,-1
s_waitcnt lgkmcnt(0)
s_barrier
s_cmp_lg_u32 s30,0
s_cbranch_scc1 front_arr
v_lshlrev_b32 v12,2,v220
v_add_u32 v13,98304,v12
ds_read_b32 v16,v13 offset:0
ds_read_b32 v17,v13 offset:128
ds_read_b32 v18,v13 offset:256
ds_read_b32 v19,v13 offset:384
s_lshl_b32 s96,s92,7
s_lshl_b32 s98,s93,13
s_add_u32 s96,s96,s98
s_add_u32 s96,s96,65536
s_mov_b64 exec,0xffffffff
s_waitcnt lgkmcnt(2)
v_add_f32 v16,v16,v17
s_waitcnt lgkmcnt(0)
v_add_f32 v18,v18,v19
v_add_f32 v16,v16,v18
buffer_store_dword v16,v12,s[64:67],s96 offen sc1
s_mov_b64 exec,-1
front_arr:
s_waitcnt vmcnt(5)
v_permlane16_swap_b32 v48,v50
v_permlane16_swap_b32 v49,v51
s_waitcnt vmcnt(4)
v_permlane16_swap_b32 v52,v54
v_permlane16_swap_b32 v53,v55
s_waitcnt vmcnt(3)
v_permlane16_swap_b32 v56,v58
v_permlane16_swap_b32 v57,v59
s_waitcnt vmcnt(2)
v_permlane16_swap_b32 v60,v62
v_permlane16_swap_b32 v61,v63
v_and_b32 v65,0xffff0000,v48
v_lshlrev_b32 v64,16,v48
v_and_b32 v67,0xffff0000,v49
v_lshlrev_b32 v66,16,v49
v_and_b32 v69,0xffff0000,v50
v_lshlrev_b32 v68,16,v50
v_and_b32 v71,0xffff0000,v51
v_lshlrev_b32 v70,16,v51
v_and_b32 v73,0xffff0000,v52
v_lshlrev_b32 v72,16,v52
v_and_b32 v75,0xffff0000,v53
v_lshlrev_b32 v74,16,v53
v_and_b32 v77,0xffff0000,v54
v_lshlrev_b32 v76,16,v54
v_and_b32 v79,0xffff0000,v55
v_lshlrev_b32 v78,16,v55
v_and_b32 v81,0xffff0000,v56
v_lshlrev_b32 v80,16,v56
v_and_b32 v83,0xffff0000,v57
v_lshlrev_b32 v82,16,v57
v_and_b32 v85,0xffff0000,v58
v_lshlrev_b32 v84,16,v58
v_and_b32 v87,0xffff0000,v59
v_lshlrev_b32 v86,16,v59
v_and_b32 v89,0xffff0000,v60
v_lshlrev_b32 v88,16,v60
v_and_b32 v91,0xffff0000,v61
v_lshlrev_b32 v90,16,v61
v_and_b32 v93,0xffff0000,v62
v_lshlrev_b32 v92,16,v62
v_and_b32 v95,0xffff0000,v63
v_lshlrev_b32 v94,16,v63
v_pk_add_f32 v[24:25],v[64:65],v[66:67]
v_pk_add_f32 v[26:27],v[68:69],v[70:71]
v_pk_add_f32 v[24:25],v[24:25],v[72:73]
v_pk_add_f32 v[26:27],v[26:27],v[74:75]
v_pk_add_f32 v[24:25],v[24:25],v[76:77]
v_pk_add_f32 v[26:27],v[26:27],v[78:79]
v_pk_add_f32 v[24:25],v[24:25],v[80:81]
v_pk_add_f32 v[26:27],v[26:27],v[82:83]
v_pk_add_f32 v[24:25],v[24:25],v[84:85]
v_pk_add_f32 v[26:27],v[26:27],v[86:87]
v_pk_add_f32 v[24:25],v[24:25],v[88:89]
v_pk_add_f32 v[26:27],v[26:27],v[90:91]
v_pk_add_f32 v[24:25],v[24:25],v[92:93]
v_pk_add_f32 v[26:27],v[26:27],v[94:95]
v_pk_add_f32 v[24:25],v[24:25],v[26:27]
v_add_f32 v24,v24,v25
s_nop 1
v_add_f32_dpp v24,v24,v24 row_ror:8 row_mask:0xf bank_mask:0xf
v_mov_b32 v25,v24
s_nop 1
v_permlane16_swap_b32 v25,v24
v_add_f32 v24,v24,v25
v_mov_b32 v25,v24
s_nop 1
v_permlane32_swap_b32 v25,v24
v_add_f32 v24,v24,v25
v_mul_f32 v24,0x3b800000,v24
v_pk_add_f32 v[96:97],v[64:65],v[24:25] op_sel_hi:[1,0] neg_lo:[0,1] neg_hi:[0,1]
v_pk_add_f32 v[98:99],v[66:67],v[24:25] op_sel_hi:[1,0] neg_lo:[0,1] neg_hi:[0,1]
v_pk_add_f32 v[100:101],v[68:69],v[24:25] op_sel_hi:[1,0] neg_lo:[0,1] neg_hi:[0,1]
v_pk_add_f32 v[102:103],v[70:71],v[24:25] op_sel_hi:[1,0] neg_lo:[0,1] neg_hi:[0,1]
v_pk_add_f32 v[104:105],v[72:73],v[24:25] op_sel_hi:[1,0] neg_lo:[0,1] neg_hi:[0,1]
v_pk_add_f32 v[106:107],v[74:75],v[24:25] op_sel_hi:[1,0] neg_lo:[0,1] neg_hi:[0,1]
v_pk_add_f32 v[108:109],v[76:77],v[24:25] op_sel_hi:[1,0] neg_lo:[0,1] neg_hi:[0,1]
v_pk_add_f32 v[110:111],v[78:79],v[24:25] op_sel_hi:[1,0] neg_lo:[0,1] neg_hi:[0,1]
v_pk_add_f32 v[112:113],v[80:81],v[24:25] op_sel_hi:[1,0] neg_lo:[0,1] neg_hi:[0,1]
v_pk_add_f32 v[114:115],v[82:83],v[24:25] op_sel_hi:[1,0] neg_lo:[0,1] neg_hi:[0,1]
v_pk_add_f32 v[116:117],v[84:85],v[24:25] op_sel_hi:[1,0] neg_lo:[0,1] neg_hi:[0,1]
v_pk_add_f32 v[118:119],v[86:87],v[24:25] op_sel_hi:[1,0] neg_lo:[0,1] neg_hi:[0,1]
v_pk_add_f32 v[120:121],v[88:89],v[24:25] op_sel_hi:[1,0] neg_lo:[0,1] neg_hi:[0,1]
v_pk_add_f32 v[122:123],v[90:91],v[24:25] op_sel_hi:[1,0] neg_lo:[0,1] neg_hi:[0,1]
v_pk_add_f32 v[124:125],v[92:93],v[24:25] op_sel_hi:[1,0] neg_lo:[0,1] neg_hi:[0,1]
v_pk_add_f32 v[126:127],v[94:95],v[24:25] op_sel_hi:[1,0] neg_lo:[0,1] neg_hi:[0,1]
v_pk_mul_f32 v[26:27],v[96:97],v[96:97]
v_pk_fma_f32 v[26:27],v[98:99],v[98:99],v[26:27]
v_pk_fma_f32 v[26:27],v[100:101],v[100:101],v[26:27]
v_pk_fma_f32 v[26:27],v[102:103],v[102:103],v[26:27]
v_pk_fma_f32 v[26:27],v[104:105],v[104:105],v[26:27]
v_pk_fma_f32 v[26:27],v[106:107],v[106:107],v[26:27]
v_pk_fma_f32 v[26:27],v[108:109],v[108:109],v[26:27]
v_pk_fma_f32 v[26:27],v[110:111],v[110:111],v[26:27]
v_pk_fma_f32 v[26:27],v[112:113],v[112:113],v[26:27]
v_pk_fma_f32 v[26:27],v[114:115],v[114:115],v[26:27]
v_pk_fma_f32 v[26:27],v[116:117],v[116:117],v[26:27]
v_pk_fma_f32 v[26:27],v[118:119],v[118:119],v[26:27]
v_pk_fma_f32 v[26:27],v[120:121],v[120:121],v[26:27]
v_pk_fma_f32 v[26:27],v[122:123],v[122:123],v[26:27]
v_pk_fma_f32 v[26:27],v[124:125],v[124:125],v[26:27]
v_pk_fma_f32 v[26:27],v[126:127],v[126:127],v[26:27]
v_add_f32 v25,v26,v27
s_nop 1
v_add_f32_dpp v25,v25,v25 row_ror:8 row_mask:0xf bank_mask:0xf
v_mov_b32 v26,v25
s_nop 1
v_permlane16_swap_b32 v26,v25
v_add_f32 v25,v25,v26
v_mov_b32 v26,v25
s_nop 1
v_permlane32_swap_b32 v26,v25
v_add_f32 v25,v25,v26
ds_write_b64 v4,v[24:25] offset:0
v_mov_b32 v8,0
s_cmp_lg_u32 s30,0
s_cbranch_scc1 front_a1
v_mov_b32 v9,1
v_mov_b32 v10,1
s_and_b32 s96,s2,1
s_lshl_b32 s96,s96,7
s_mov_b64 exec,1
s_waitcnt vmcnt(0)
buffer_atomic_add v9,v8,s[88:91],s96 offen sc0 sc1
s_mov_b64 exec,-1
front_a1:
s_waitcnt lgkmcnt(0)
s_barrier
ds_read_b128 v[96:99],v3 offset:0
ds_read_b128 v[100:103],v3 offset:16
s_waitcnt lgkmcnt(1)
v_add_f32 v24,v96,v98
v_add_f32 v25,v97,v99
s_waitcnt lgkmcnt(0)
v_add_f32 v24,v24,v100
v_add_f32 v25,v25,v101
v_add_f32 v24,v24,v102
v_add_f32 v25,v25,v103
v_mul_f32 v24,0x3e800000,v24
v_sub_f32 v96,v96,v24
v_sub_f32 v98,v98,v24
v_sub_f32 v100,v100,v24
v_sub_f32 v102,v102,v24
v_mul_f32 v26,v96,v96
v_fmac_f32 v26,v98,v98
v_fmac_f32 v26,v100,v100
v_fmac_f32 v26,v102,v102
v_mul_f32 v25,0x3a800000,v25
v_fmac_f32 v25,0x3e800000,v26
cv v24,v24,v24
v_lshlrev_b32 v24,16,v24
cv v25,v25,v25
v_lshlrev_b32 v25,16,v25
v_add_f32 v25,0x3727c5ac,v25
cv v25,v25,v25
v_lshlrev_b32 v25,16,v25
v_sqrt_f32 v25,v25
s_nop 0
cv v25,v25,v25
v_lshlrev_b32 v25,16,v25
v_rcp_f32 v26,v25
v_pk_add_f32 v[64:65],v[64:65],v[24:25] op_sel_hi:[1,0] neg_lo:[0,1] neg_hi:[0,1]
v_pk_add_f32 v[66:67],v[66:67],v[24:25] op_sel_hi:[1,0] neg_lo:[0,1] neg_hi:[0,1]
v_pk_add_f32 v[68:69],v[68:69],v[24:25] op_sel_hi:[1,0] neg_lo:[0,1] neg_hi:[0,1]
v_pk_add_f32 v[70:71],v[70:71],v[24:25] op_sel_hi:[1,0] neg_lo:[0,1] neg_hi:[0,1]
v_pk_add_f32 v[72:73],v[72:73],v[24:25] op_sel_hi:[1,0] neg_lo:[0,1] neg_hi:[0,1]
v_pk_add_f32 v[74:75],v[74:75],v[24:25] op_sel_hi:[1,0] neg_lo:[0,1] neg_hi:[0,1]
v_pk_add_f32 v[76:77],v[76:77],v[24:25] op_sel_hi:[1,0] neg_lo:[0,1] neg_hi:[0,1]
v_pk_add_f32 v[78:79],v[78:79],v[24:25] op_sel_hi:[1,0] neg_lo:[0,1] neg_hi:[0,1]
v_pk_add_f32 v[80:81],v[80:81],v[24:25] op_sel_hi:[1,0] neg_lo:[0,1] neg_hi:[0,1]
v_pk_add_f32 v[82:83],v[82:83],v[24:25] op_sel_hi:[1,0] neg_lo:[0,1] neg_hi:[0,1]
v_pk_add_f32 v[84:85],v[84:85],v[24:25] op_sel_hi:[1,0] neg_lo:[0,1] neg_hi:[0,1]
v_pk_add_f32 v[86:87],v[86:87],v[24:25] op_sel_hi:[1,0] neg_lo:[0,1] neg_hi:[0,1]
v_pk_add_f32 v[88:89],v[88:89],v[24:25] op_sel_hi:[1,0] neg_lo:[0,1] neg_hi:[0,1]
v_pk_add_f32 v[90:91],v[90:91],v[24:25] op_sel_hi:[1,0] neg_lo:[0,1] neg_hi:[0,1]
v_pk_add_f32 v[92:93],v[92:93],v[24:25] op_sel_hi:[1,0] neg_lo:[0,1] neg_hi:[0,1]
v_pk_add_f32 v[94:95],v[94:95],v[24:25] op_sel_hi:[1,0] neg_lo:[0,1] neg_hi:[0,1]
cv v25,v64,v65
v_lshlrev_b32 v64,16,v25
v_and_b32 v65,0xffff0000,v25
cv v25,v66,v67
v_lshlrev_b32 v66,16,v25
v_and_b32 v67,0xffff0000,v25
cv v25,v68,v69
v_lshlrev_b32 v68,16,v25
v_and_b32 v69,0xffff0000,v25
cv v25,v70,v71
v_lshlrev_b32 v70,16,v25
v_and_b32 v71,0xffff0000,v25
cv v25,v72,v73
v_lshlrev_b32 v72,16,v25
v_and_b32 v73,0xffff0000,v25
cv v25,v74,v75
v_lshlrev_b32 v74,16,v25
v_and_b32 v75,0xffff0000,v25
cv v25,v76,v77
v_lshlrev_b32 v76,16,v25
v_and_b32 v77,0xffff0000,v25
cv v25,v78,v79
v_lshlrev_b32 v78,16,v25
v_and_b32 v79,0xffff0000,v25
cv v25,v80,v81
v_lshlrev_b32 v80,16,v25
v_and_b32 v81,0xffff0000,v25
cv v25,v82,v83
v_lshlrev_b32 v82,16,v25
v_and_b32 v83,0xffff0000,v25
cv v25,v84,v85
v_lshlrev_b32 v84,16,v25
v_and_b32 v85,0xffff0000,v25
cv v25,v86,v87
v_lshlrev_b32 v86,16,v25
v_and_b32 v87,0xffff0000,v25
cv v25,v88,v89
v_lshlrev_b32 v88,16,v25
v_and_b32 v89,0xffff0000,v25
cv v25,v90,v91
v_lshlrev_b32 v90,16,v25
v_and_b32 v91,0xffff0000,v25
cv v25,v92,v93
v_lshlrev_b32 v92,16,v25
v_and_b32 v93,0xffff0000,v25
cv v25,v94,v95
v_lshlrev_b32 v94,16,v25
v_and_b32 v95,0xffff0000,v25
v_pk_mul_f32 v[64:65],v[64:65],v[26:27] op_sel_hi:[1,0]
v_pk_mul_f32 v[66:67],v[66:67],v[26:27] op_sel_hi:[1,0]
v_pk_mul_f32 v[68:69],v[68:69],v[26:27] op_sel_hi:[1,0]
v_pk_mul_f32 v[70:71],v[70:71],v[26:27] op_sel_hi:[1,0]
v_pk_mul_f32 v[72:73],v[72:73],v[26:27] op_sel_hi:[1,0]
v_pk_mul_f32 v[74:75],v[74:75],v[26:27] op_sel_hi:[1,0]
v_pk_mul_f32 v[76:77],v[76:77],v[26:27] op_sel_hi:[1,0]
v_pk_mul_f32 v[78:79],v[78:79],v[26:27] op_sel_hi:[1,0]
v_pk_mul_f32 v[80:81],v[80:81],v[26:27] op_sel_hi:[1,0]
v_pk_mul_f32 v[82:83],v[82:83],v[26:27] op_sel_hi:[1,0]
v_pk_mul_f32 v[84:85],v[84:85],v[26:27] op_sel_hi:[1,0]
v_pk_mul_f32 v[86:87],v[86:87],v[26:27] op_sel_hi:[1,0]
v_pk_mul_f32 v[88:89],v[88:89],v[26:27] op_sel_hi:[1,0]
v_pk_mul_f32 v[90:91],v[90:91],v[26:27] op_sel_hi:[1,0]
v_pk_mul_f32 v[92:93],v[92:93],v[26:27] op_sel_hi:[1,0]
v_pk_mul_f32 v[94:95],v[94:95],v[26:27] op_sel_hi:[1,0]
cv v24,v64,v65
v_lshlrev_b32 v64,16,v24
v_and_b32 v65,0xffff0000,v24
cv v24,v66,v67
v_lshlrev_b32 v66,16,v24
v_and_b32 v67,0xffff0000,v24
cv v24,v68,v69
v_lshlrev_b32 v68,16,v24
v_and_b32 v69,0xffff0000,v24
cv v24,v70,v71
v_lshlrev_b32 v70,16,v24
v_and_b32 v71,0xffff0000,v24
cv v24,v72,v73
v_lshlrev_b32 v72,16,v24
v_and_b32 v73,0xffff0000,v24
cv v24,v74,v75
v_lshlrev_b32 v74,16,v24
v_and_b32 v75,0xffff0000,v24
cv v24,v76,v77
v_lshlrev_b32 v76,16,v24
v_and_b32 v77,0xffff0000,v24
cv v24,v78,v79
v_lshlrev_b32 v78,16,v24
v_and_b32 v79,0xffff0000,v24
cv v24,v80,v81
v_lshlrev_b32 v80,16,v24
v_and_b32 v81,0xffff0000,v24
cv v24,v82,v83
v_lshlrev_b32 v82,16,v24
v_and_b32 v83,0xffff0000,v24
cv v24,v84,v85
v_lshlrev_b32 v84,16,v24
v_and_b32 v85,0xffff0000,v24
cv v24,v86,v87
v_lshlrev_b32 v86,16,v24
v_and_b32 v87,0xffff0000,v24
cv v24,v88,v89
v_lshlrev_b32 v88,16,v24
v_and_b32 v89,0xffff0000,v24
cv v24,v90,v91
v_lshlrev_b32 v90,16,v24
v_and_b32 v91,0xffff0000,v24
cv v24,v92,v93
v_lshlrev_b32 v92,16,v24
v_and_b32 v93,0xffff0000,v24
cv v24,v94,v95
v_lshlrev_b32 v94,16,v24
v_and_b32 v95,0xffff0000,v24
s_waitcnt vmcnt(1)
v_and_b32 v17,0xffff0000,v244
v_lshlrev_b32 v16,16,v244
v_and_b32 v19,0xffff0000,v245
v_lshlrev_b32 v18,16,v245
v_mul_f32 v20,0xbfb8aa3b,v16
v_mul_f32 v21,0xbfb8aa3b,v17
v_mul_f32 v22,0xbfb8aa3b,v18
v_mul_f32 v23,0xbfb8aa3b,v19
v_exp_f32 v20,v20
v_exp_f32 v21,v21
v_exp_f32 v22,v22
v_exp_f32 v23,v23
v_add_f32 v20,1.0,v20
v_add_f32 v21,1.0,v21
v_add_f32 v22,1.0,v22
v_add_f32 v23,1.0,v23
v_rcp_f32 v20,v20
v_rcp_f32 v21,v21
v_rcp_f32 v22,v22
v_rcp_f32 v23,v23
v_mul_f32 v16,v16,v20
v_mul_f32 v17,v17,v21
v_mul_f32 v18,v18,v22
v_mul_f32 v19,v19,v23
cv v244,v16,v17
cv v245,v18,v19
v_mov_b32 v12,0
v_lshlrev_b32 v13,5,v0
v_lshrrev_b32 v14,7,v0
v_cvt_f32_u32 v14,v14
v_add_u32 v15,99328,v13
s_cmp_eq_u32 s30,0
s_cbranch_scc1 front_notouch
v_lshlrev_b32 v28,7,v220
s_mul_i32 s96,s2,3
s_add_u32 s96,s96,s30
s_sub_u32 s96,s96,1
s_mul_i32 s96,s96,6144
s_mov_b32 exec_lo,0xffffffff
s_mov_b32 exec_hi,0xffff
buffer_load_dword v246,v28,s[20:23],s96 offen
s_mov_b64 exec,-1
front_notouch:
s_cmp_lg_u32 s30,0
s_cbranch_scc1 front_F1_w
s_waitcnt vmcnt(0)
v_readfirstlane_b32 s96,v9
s_nop 0
s_and_b32 s96,s96,127
s_cmp_lg_u32 s96,127
s_cbranch_scc1 front_F1_s
s_mov_b64 exec,1
buffer_atomic_add v10,v8,s[88:91],0 offen offset:64 sc0 sc1
s_waitcnt vmcnt(0)
v_readfirstlane_b32 s96,v10
s_mov_b64 exec,-1
v_lshlrev_b32 v18,8,v220
v_mov_b32 v19,1
s_and_b32 s96,s96,1
s_cmp_lg_u32 s96,1
s_cbranch_scc1 front_F1_s
s_mov_b32 s96,524288
buffer_store_dword v19,v18,s[64:67],s96 offen sc1
s_mov_b32 s96,540672
buffer_store_dword v19,v18,s[64:67],s96 offen sc1
s_mov_b32 s96,557056
buffer_store_dword v19,v18,s[64:67],s96 offen sc1
s_mov_b32 s96,573440
buffer_store_dword v19,v18,s[64:67],s96 offen sc1
s_branch front_F1_w
front_F1_s:
s_mov_b32 s98,0x40000
s_mov_b64 exec,1
front_F1_p:
buffer_load_dword v16,v12,s[64:67],s99 offen sc1
s_waitcnt vmcnt(0)
s_sub_u32 s98,s98,1
s_cmp_eq_u32 s98,0
s_cbranch_scc1 front_F1_w
v_cmp_gt_u32 vcc,1,v16
s_nop 0
s_cbranch_vccz front_F1_w
s_branch front_F1_p
front_F1_w:
s_mov_b64 exec,-1
s_barrier
s_mov_b32 s96,65536
bl v[16:19],v13,s[64:67],s96 offen offset:0 sc1
bl v[20:23],v13,s[64:67],s96 offen offset:16 sc1
s_mov_b32 s96,73728
bl v[24:27],v13,s[64:67],s96 offen offset:0 sc1
bl v[28:31],v13,s[64:67],s96 offen offset:16 sc1
s_mov_b32 s96,81920
bl v[32:35],v13,s[64:67],s96 offen offset:0 sc1
bl v[36:39],v13,s[64:67],s96 offen offset:16 sc1
s_mov_b32 s96,90112
bl v[40:43],v13,s[64:67],s96 offen offset:0 sc1
bl v[44:47],v13,s[64:67],s96 offen offset:16 sc1
s_lshl_b32 s96,s2,2
s_add_u32 s96,s96,s30
s_mul_i32 s96,s96,4608
s_add_u32 s96,s96,4718592
v_lshlrev_b32 v11,7,v220
s_mov_b32 exec_hi,0xf
buffer_load_dword v247,v11,s[20:23],s96 offen
s_mov_b64 exec,-1
s_waitcnt vmcnt(6)
v_pk_add_f32 v[16:17],v[16:17],v[24:25]
v_pk_add_f32 v[18:19],v[18:19],v[26:27]
s_waitcnt vmcnt(5)
v_pk_add_f32 v[20:21],v[20:21],v[28:29]
v_pk_add_f32 v[22:23],v[22:23],v[30:31]
s_waitcnt vmcnt(2)
v_pk_add_f32 v[32:33],v[32:33],v[40:41]
v_pk_add_f32 v[34:35],v[34:35],v[42:43]
s_waitcnt vmcnt(1)
v_pk_add_f32 v[36:37],v[36:37],v[44:45]
v_pk_add_f32 v[38:39],v[38:39],v[46:47]
v_pk_add_f32 v[16:17],v[16:17],v[32:33]
v_pk_add_f32 v[18:19],v[18:19],v[34:35]
v_pk_add_f32 v[20:21],v[20:21],v[36:37]
v_pk_add_f32 v[22:23],v[22:23],v[38:39]
cv v8,v16,v17
v_lshlrev_b32 v16,16,v8
v_and_b32 v17,0xffff0000,v8
cv v8,v18,v19
v_lshlrev_b32 v18,16,v8
v_and_b32 v19,0xffff0000,v8
cv v8,v20,v21
v_lshlrev_b32 v20,16,v8
v_and_b32 v21,0xffff0000,v8
cv v8,v22,v23
v_lshlrev_b32 v22,16,v8
v_and_b32 v23,0xffff0000,v8
v_add_f32 v24,v14,v16
v_add_f32 v25,v14,v17
v_add_f32 v26,v14,v18
v_add_f32 v27,v14,v19
v_add_f32 v28,v14,v20
v_add_f32 v29,v14,v21
v_add_f32 v30,v14,v22
v_add_f32 v31,v14,v23
cv v8,v24,v25
v_lshlrev_b32 v24,16,v8
v_and_b32 v25,0xffff0000,v8
cv v8,v26,v27
v_lshlrev_b32 v26,16,v8
v_and_b32 v27,0xffff0000,v8
cv v8,v28,v29
v_lshlrev_b32 v28,16,v8
v_and_b32 v29,0xffff0000,v8
cv v8,v30,v31
v_lshlrev_b32 v30,16,v8
v_and_b32 v31,0xffff0000,v8
ds_write_b128 v15,v[24:27]
ds_write_b128 v15,v[28:31] offset:16
s_waitcnt lgkmcnt(0)
s_barrier
ds_read_b128 v[96:99],v7 offset:4096
ds_read_b128 v[100:103],v7 offset:4160
ds_read_b128 v[104:107],v7 offset:4352
ds_read_b128 v[108:111],v7 offset:4416
ds_read_b128 v[112:115],v7 offset:4608
ds_read_b128 v[116:119],v7 offset:4672
ds_read_b128 v[120:123],v7 offset:4864
ds_read_b128 v[124:127],v7 offset:4928
s_waitcnt lgkmcnt(7)
v_pk_mul_f32 v[64:65],v[64:65],v[96:97]
v_pk_mul_f32 v[66:67],v[66:67],v[98:99]
s_waitcnt lgkmcnt(6)
v_pk_mul_f32 v[68:69],v[68:69],v[100:101]
v_pk_mul_f32 v[70:71],v[70:71],v[102:103]
s_waitcnt lgkmcnt(5)
v_pk_mul_f32 v[72:73],v[72:73],v[104:105]
v_pk_mul_f32 v[74:75],v[74:75],v[106:107]
s_waitcnt lgkmcnt(4)
v_pk_mul_f32 v[76:77],v[76:77],v[108:109]
v_pk_mul_f32 v[78:79],v[78:79],v[110:111]
ds_read_b128 v[16:19],v7 offset:0
ds_read_b128 v[20:23],v7 offset:64
ds_read_b128 v[24:27],v7 offset:256
ds_read_b128 v[28:31],v7 offset:320
ds_read_b128 v[32:35],v7 offset:512
ds_read_b128 v[36:39],v7 offset:576
ds_read_b128 v[40:43],v7 offset:768
ds_read_b128 v[44:47],v7 offset:832
s_waitcnt lgkmcnt(11)
v_pk_mul_f32 v[80:81],v[80:81],v[112:113]
v_pk_mul_f32 v[82:83],v[82:83],v[114:115]
s_waitcnt lgkmcnt(10)
v_pk_mul_f32 v[84:85],v[84:85],v[116:117]
v_pk_mul_f32 v[86:87],v[86:87],v[118:119]
s_waitcnt lgkmcnt(9)
v_pk_mul_f32 v[88:89],v[88:89],v[120:121]
v_pk_mul_f32 v[90:91],v[90:91],v[122:123]
s_waitcnt lgkmcnt(8)
v_pk_mul_f32 v[92:93],v[92:93],v[124:125]
v_pk_mul_f32 v[94:95],v[94:95],v[126:127]
cv v8,v64,v65
v_lshlrev_b32 v64,16,v8
v_and_b32 v65,0xffff0000,v8
cv v8,v66,v67
v_lshlrev_b32 v66,16,v8
v_and_b32 v67,0xffff0000,v8
cv v8,v68,v69
v_lshlrev_b32 v68,16,v8
v_and_b32 v69,0xffff0000,v8
cv v8,v70,v71
v_lshlrev_b32 v70,16,v8
v_and_b32 v71,0xffff0000,v8
cv v8,v72,v73
v_lshlrev_b32 v72,16,v8
v_and_b32 v73,0xffff0000,v8
cv v8,v74,v75
v_lshlrev_b32 v74,16,v8
v_and_b32 v75,0xffff0000,v8
cv v8,v76,v77
v_lshlrev_b32 v76,16,v8
v_and_b32 v77,0xffff0000,v8
cv v8,v78,v79
v_lshlrev_b32 v78,16,v8
v_and_b32 v79,0xffff0000,v8
cv v8,v80,v81
v_lshlrev_b32 v80,16,v8
v_and_b32 v81,0xffff0000,v8
cv v8,v82,v83
v_lshlrev_b32 v82,16,v8
v_and_b32 v83,0xffff0000,v8
cv v8,v84,v85
v_lshlrev_b32 v84,16,v8
v_and_b32 v85,0xffff0000,v8
cv v8,v86,v87
v_lshlrev_b32 v86,16,v8
v_and_b32 v87,0xffff0000,v8
cv v8,v88,v89
v_lshlrev_b32 v88,16,v8
v_and_b32 v89,0xffff0000,v8
cv v8,v90,v91
v_lshlrev_b32 v90,16,v8
v_and_b32 v91,0xffff0000,v8
cv v8,v92,v93
v_lshlrev_b32 v92,16,v8
v_and_b32 v93,0xffff0000,v8
cv v8,v94,v95
v_lshlrev_b32 v94,16,v8
v_and_b32 v95,0xffff0000,v8
s_waitcnt lgkmcnt(7)
v_pk_add_f32 v[64:65],v[64:65],v[16:17]
v_pk_add_f32 v[66:67],v[66:67],v[18:19]
s_waitcnt lgkmcnt(6)
v_pk_add_f32 v[68:69],v[68:69],v[20:21]
v_pk_add_f32 v[70:71],v[70:71],v[22:23]
s_waitcnt lgkmcnt(5)
v_pk_add_f32 v[72:73],v[72:73],v[24:25]
v_pk_add_f32 v[74:75],v[74:75],v[26:27]
s_waitcnt lgkmcnt(4)
v_pk_add_f32 v[76:77],v[76:77],v[28:29]
v_pk_add_f32 v[78:79],v[78:79],v[30:31]
s_waitcnt lgkmcnt(3)
v_pk_add_f32 v[80:81],v[80:81],v[32:33]
v_pk_add_f32 v[82:83],v[82:83],v[34:35]
s_waitcnt lgkmcnt(2)
v_pk_add_f32 v[84:85],v[84:85],v[36:37]
v_pk_add_f32 v[86:87],v[86:87],v[38:39]
s_waitcnt lgkmcnt(1)
v_pk_add_f32 v[88:89],v[88:89],v[40:41]
v_pk_add_f32 v[90:91],v[90:91],v[42:43]
s_waitcnt lgkmcnt(0)
v_pk_add_f32 v[92:93],v[92:93],v[44:45]
v_pk_add_f32 v[94:95],v[94:95],v[46:47]
cv v48,v64,v65
cv v49,v66,v67
cv v50,v68,v69
cv v51,v70,v71
buffer_store_dwordx4 v[48:51],v6,s[16:19],s97 offen offset:0 sc1
cv v52,v72,v73
cv v53,v74,v75
cv v54,v76,v77
cv v55,v78,v79
buffer_store_dwordx4 v[52:55],v6,s[16:19],s97 offen offset:2048 sc1
s_add_u32 s97,s97,4096
cv v56,v80,v81
cv v57,v82,v83
cv v58,v84,v85
cv v59,v86,v87
buffer_store_dwordx4 v[56:59],v6,s[16:19],s97 offen offset:0 sc1
cv v60,v88,v89
cv v61,v90,v91
cv v62,v92,v93
cv v63,v94,v95
buffer_store_dwordx4 v[60:63],v6,s[16:19],s97 offen offset:2048 sc1
s_lshr_b32 s96,s2,5
s_lshl_b32 s96,s96,13
s_add_u32 s96,s96,525184
s_lshl_b32 s99,s32,13
s_add_u32 s99,s99,525184
v_mov_b32 v14,0
v_mov_b32 v15,1
s_waitcnt vmcnt(0)
s_barrier
s_cmp_lg_u32 s30,0
s_cbranch_scc1 front_arr2
s_mov_b64 exec,1
buffer_atomic_add v15,v14,s[64:67],s96 offen sc1
s_mov_b64 exec,-1
front_arr2:
s_add_u32 m0,s36,0
s_nop 0
bl v226,s[20:23],s35 offen offset:0 lds
bl v227,s[20:23],s35 offen offset:1024 lds
s_add_u32 s35,s35,262144
s_add_u32 m0,s36,8192
s_nop 0
bl v226,s[20:23],s35 offen offset:0 lds
bl v227,s[20:23],s35 offen offset:1024 lds
s_add_u32 s35,s35,262144
s_add_u32 m0,s36,16384
s_nop 0
bl v226,s[20:23],s35 offen offset:0 lds
bl v227,s[20:23],s35 offen offset:1024 lds
s_add_u32 s35,s35,262144
s_add_u32 m0,s36,24576
s_nop 0
bl v226,s[20:23],s35 offen offset:0 lds
bl v227,s[20:23],s35 offen offset:1024 lds
s_add_u32 s35,s35,262144
s_add_u32 m0,s36,32768
s_nop 0
bl v226,s[20:23],s35 offen offset:0 lds
bl v227,s[20:23],s35 offen offset:1024 lds
s_add_u32 s35,s35,262144
s_add_u32 m0,s36,40960
s_nop 0
bl v226,s[20:23],s35 offen offset:0 lds
bl v227,s[20:23],s35 offen offset:1024 lds
s_add_u32 s35,s35,262144
s_add_u32 m0,s36,49152
s_nop 0
bl v226,s[20:23],s35 offen offset:0 lds
bl v227,s[20:23],s35 offen offset:1024 lds
s_add_u32 s35,s35,262144
s_cmp_lg_u32 s30,0
s_cbranch_scc1 front_F2_w
s_mov_b32 s98,0x40000
s_mov_b64 exec,1
front_F2_p:
buffer_load_dword v16,v14,s[64:67],s99 offen sc1
s_waitcnt vmcnt(0)
s_sub_u32 s98,s98,1
s_cmp_eq_u32 s98,0
s_cbranch_scc1 front_F2_w
v_cmp_gt_u32 vcc,32,v16
s_nop 0
s_cbranch_vccz front_F2_w
s_branch front_F2_p
front_F2_w:
s_mov_b64 exec,-1
s_barrier
bl a[0:3],v222,s[16:19],s34 offen offset:0 sc1
bl a[4:7],v223,s[16:19],s34 offen offset:0 sc1
bl a[8:11],v224,s[16:19],s34 offen offset:0 sc1
bl a[12:15],v225,s[16:19],s34 offen offset:0 sc1
s_add_u32 s34,s34,1024
bl a[16:19],v222,s[16:19],s34 offen offset:0 sc1
bl a[20:23],v223,s[16:19],s34 offen offset:0 sc1
bl a[24:27],v224,s[16:19],s34 offen offset:0 sc1
bl a[28:31],v225,s[16:19],s34 offen offset:0 sc1
s_add_u32 s34,s34,1024
bl a[32:35],v222,s[16:19],s34 offen offset:0 sc1
bl a[36:39],v223,s[16:19],s34 offen offset:0 sc1
bl a[40:43],v224,s[16:19],s34 offen offset:0 sc1
bl a[44:47],v225,s[16:19],s34 offen offset:0 sc1
s_add_u32 s34,s34,1024
s_waitcnt vmcnt(8)
s_barrier
tr a[192:193],v190 offset:0
tr a[194:195],v190 offset:4096
tr a[196:197],v191 offset:0
tr a[198:199],v191 offset:4096
tr a[200:201],v192 offset:0
tr a[202:203],v192 offset:4096
tr a[204:205],v193 offset:0
tr a[206:207],v193 offset:4096
s_waitcnt lgkmcnt(4)
mm v[0:3],a[192:195],a[0:3],0
tr a[208:209],v194 offset:0
bl a[48:51],v222,s[16:19],s34 offen offset:0 sc1
mm v[4:7],a[192:195],a[4:7],0
tr a[210:211],v194 offset:4096
mm v[8:11],a[192:195],a[8:11],0
tr a[212:213],v195 offset:0
mm v[12:15],a[192:195],a[12:15],0
tr a[214:215],v195 offset:4096
mm v[16:19],a[196:199],a[0:3],0
bl a[52:55],v223,s[16:19],s34 offen offset:0 sc1
mm v[20:23],a[196:199],a[4:7],0
mm v[24:27],a[196:199],a[8:11],0
tr a[216:217],v196 offset:0
mm v[28:31],a[196:199],a[12:15],0
tr a[218:219],v196 offset:4096
s_waitcnt lgkmcnt(6)
mm v[32:35],a[200:203],a[0:3],0
bl a[56:59],v224,s[16:19],s34 offen offset:0 sc1
mm v[36:39],a[200:203],a[4:7],0
mm v[40:43],a[200:203],a[8:11],0
tr a[220:221],v197 offset:0
mm v[44:47],a[200:203],a[12:15],0
tr a[222:223],v197 offset:4096
mm v[48:51],a[204:207],a[0:3],0
bl a[60:63],v225,s[16:19],s34 offen offset:0 sc1
s_add_u32 s34,s34,1024
mm v[52:55],a[204:207],a[4:7],0
s_waitcnt vmcnt(8)
mm v[56:59],a[204:207],a[8:11],0
s_barrier
mm v[60:63],a[204:207],a[12:15],0
tr a[192:193],v190 offset:8192
s_waitcnt lgkmcnt(5)
mm v[64:67],a[208:211],a[0:3],0
tr a[194:195],v190 offset:12288
bl a[64:67],v222,s[16:19],s34 offen offset:0 sc1
mm v[68:71],a[208:211],a[4:7],0
mm v[72:75],a[208:211],a[8:11],0
tr a[196:197],v191 offset:8192
mm v[76:79],a[208:211],a[12:15],0
tr a[198:199],v191 offset:12288
mm v[80:83],a[212:215],a[0:3],0
mm v[84:87],a[212:215],a[4:7],0
bl a[68:71],v223,s[16:19],s34 offen offset:0 sc1
mm v[88:91],a[212:215],a[8:11],0
tr a[200:201],v192 offset:8192
mm v[92:95],a[212:215],a[12:15],0
tr a[202:203],v192 offset:12288
s_waitcnt lgkmcnt(6)
mm v[96:99],a[216:219],a[0:3],0
mm v[100:103],a[216:219],a[4:7],0
bl a[72:75],v224,s[16:19],s34 offen offset:0 sc1
mm v[104:107],a[216:219],a[8:11],0
tr a[204:205],v193 offset:8192
mm v[108:111],a[216:219],a[12:15],0
tr a[206:207],v193 offset:12288
mm v[112:115],a[220:223],a[0:3],0
mm v[116:119],a[220:223],a[4:7],0
bl a[76:79],v225,s[16:19],s34 offen offset:0 sc1
s_add_u32 s34,s34,1024
mm v[120:123],a[220:223],a[8:11],0
tr a[208:209],v194 offset:8192
mm v[124:127],a[220:223],a[12:15],0
tr a[210:211],v194 offset:12288
s_waitcnt lgkmcnt(6)
mm v[0:3],a[192:195],a[16:19],v[0:3]
mm v[4:7],a[192:195],a[20:23],v[4:7]
bl a[80:83],v222,s[16:19],s34 offen offset:0 sc1
mm v[8:11],a[192:195],a[24:27],v[8:11]
tr a[212:213],v195 offset:8192
mm v[12:15],a[192:195],a[28:31],v[12:15]
tr a[214:215],v195 offset:12288
mm v[16:19],a[196:199],a[16:19],v[16:19]
mm v[20:23],a[196:199],a[20:23],v[20:23]
mm v[24:27],a[196:199],a[24:27],v[24:27]
tr a[216:217],v196 offset:8192
bl a[84:87],v223,s[16:19],s34 offen offset:0 sc1
mm v[28:31],a[196:199],a[28:31],v[28:31]
tr a[218:219],v196 offset:12288
s_waitcnt lgkmcnt(6)
mm v[32:35],a[200:203],a[16:19],v[32:35]
mm v[36:39],a[200:203],a[20:23],v[36:39]
mm v[40:43],a[200:203],a[24:27],v[40:43]
tr a[220:221],v197 offset:8192
bl a[88:91],v224,s[16:19],s34 offen offset:0 sc1
mm v[44:47],a[200:203],a[28:31],v[44:47]
tr a[222:223],v197 offset:12288
mm v[48:51],a[204:207],a[16:19],v[48:51]
mm v[52:55],a[204:207],a[20:23],v[52:55]
s_waitcnt vmcnt(11)
mm v[56:59],a[204:207],a[24:27],v[56:59]
bl a[92:95],v225,s[16:19],s34 offen offset:0 sc1
s_barrier
mm v[60:63],a[204:207],a[28:31],v[60:63]
tr a[192:193],v190 offset:16384
s_waitcnt lgkmcnt(5)
mm v[64:67],a[208:211],a[16:19],v[64:67]
tr a[194:195],v190 offset:20480
s_add_u32 s34,s34,1024
mm v[68:71],a[208:211],a[20:23],v[68:71]
mm v[72:75],a[208:211],a[24:27],v[72:75]
tr a[196:197],v191 offset:16384
bl a[96:99],v222,s[16:19],s34 offen offset:0 sc1
mm v[76:79],a[208:211],a[28:31],v[76:79]
tr a[198:199],v191 offset:20480
mm v[80:83],a[212:215],a[16:19],v[80:83]
mm v[84:87],a[212:215],a[20:23],v[84:87]
mm v[88:91],a[212:215],a[24:27],v[88:91]
tr a[200:201],v192 offset:16384
mm v[92:95],a[212:215],a[28:31],v[92:95]
bl a[100:103],v223,s[16:19],s34 offen offset:0 sc1
s_waitcnt lgkmcnt(5)
mm v[96:99],a[216:219],a[16:19],v[96:99]
tr a[202:203],v192 offset:20480
mm v[100:103],a[216:219],a[20:23],v[100:103]
mm v[104:107],a[216:219],a[24:27],v[104:107]
tr a[204:205],v193 offset:16384
mm v[108:111],a[216:219],a[28:31],v[108:111]
tr a[206:207],v193 offset:20480
bl a[104:107],v224,s[16:19],s34 offen offset:0 sc1
mm v[112:115],a[220:223],a[16:19],v[112:115]
mm v[116:119],a[220:223],a[20:23],v[116:119]
mm v[120:123],a[220:223],a[24:27],v[120:123]
tr a[208:209],v194 offset:16384
mm v[124:127],a[220:223],a[28:31],v[124:127]
bl a[108:111],v225,s[16:19],s34 offen offset:0 sc1
s_waitcnt lgkmcnt(5)
mm v[0:3],a[192:195],a[32:35],v[0:3]
tr a[210:211],v194 offset:20480
s_add_u32 s34,s34,1024
mm v[4:7],a[192:195],a[36:39],v[4:7]
s_add_u32 m0,s36,57344
mm v[8:11],a[192:195],a[40:43],v[8:11]
tr a[212:213],v195 offset:16384
mm v[12:15],a[192:195],a[44:47],v[12:15]
tr a[214:215],v195 offset:20480
bl v226,s[20:23],s35 offen offset:0 lds
mm v[16:19],a[196:199],a[32:35],v[16:19]
mm v[20:23],a[196:199],a[36:39],v[20:23]
mm v[24:27],a[196:199],a[40:43],v[24:27]
tr a[216:217],v196 offset:16384
mm v[28:31],a[196:199],a[44:47],v[28:31]
bl v227,s[20:23],s35 offen offset:1024 lds
s_waitcnt lgkmcnt(5)
mm v[32:35],a[200:203],a[32:35],v[32:35]
tr a[218:219],v196 offset:20480
s_add_u32 s35,s35,262144
mm v[36:39],a[200:203],a[36:39],v[36:39]
mm v[40:43],a[200:203],a[40:43],v[40:43]
tr a[220:221],v197 offset:16384
mm v[44:47],a[200:203],a[44:47],v[44:47]
tr a[222:223],v197 offset:20480
mm v[48:51],a[204:207],a[32:35],v[48:51]
bl a[112:115],v222,s[16:19],s34 offen offset:0 sc1
mm v[52:55],a[204:207],a[36:39],v[52:55]
s_waitcnt vmcnt(15)
mm v[56:59],a[204:207],a[40:43],v[56:59]
s_barrier
mm v[60:63],a[204:207],a[44:47],v[60:63]
tr a[192:193],v190 offset:24576
s_waitcnt lgkmcnt(5)
mm v[64:67],a[208:211],a[32:35],v[64:67]
tr a[194:195],v190 offset:28672
bl a[116:119],v223,s[16:19],s34 offen offset:0 sc1
mm v[68:71],a[208:211],a[36:39],v[68:71]
mm v[72:75],a[208:211],a[40:43],v[72:75]
tr a[196:197],v191 offset:24576
mm v[76:79],a[208:211],a[44:47],v[76:79]
tr a[198:199],v191 offset:28672
mm v[80:83],a[212:215],a[32:35],v[80:83]
bl a[120:123],v224,s[16:19],s34 offen offset:0 sc1
mm v[84:87],a[212:215],a[36:39],v[84:87]
mm v[88:91],a[212:215],a[40:43],v[88:91]
tr a[200:201],v192 offset:24576
mm v[92:95],a[212:215],a[44:47],v[92:95]
tr a[202:203],v192 offset:28672
s_waitcnt lgkmcnt(6)
mm v[96:99],a[216:219],a[32:35],v[96:99]
bl a[124:127],v225,s[16:19],s34 offen offset:0 sc1
s_add_u32 s34,s34,1024
mm v[100:103],a[216:219],a[36:39],v[100:103]
s_add_u32 m0,s36,0
mm v[104:107],a[216:219],a[40:43],v[104:107]
tr a[204:205],v193 offset:24576
mm v[108:111],a[216:219],a[44:47],v[108:111]
tr a[206:207],v193 offset:28672
mm v[112:115],a[220:223],a[32:35],v[112:115]
mm v[116:119],a[220:223],a[36:39],v[116:119]
bl v226,s[20:23],s35 offen offset:0 lds
mm v[120:123],a[220:223],a[40:43],v[120:123]
tr a[208:209],v194 offset:24576
mm v[124:127],a[220:223],a[44:47],v[124:127]
tr a[210:211],v194 offset:28672
s_waitcnt lgkmcnt(6)
mm v[0:3],a[192:195],a[48:51],v[0:3]
mm v[4:7],a[192:195],a[52:55],v[4:7]
bl v227,s[20:23],s35 offen offset:1024 lds
s_add_u32 s35,s35,262144
mm v[8:11],a[192:195],a[56:59],v[8:11]
tr a[212:213],v195 offset:24576
mm v[12:15],a[192:195],a[60:63],v[12:15]
tr a[214:215],v195 offset:28672
mm v[16:19],a[196:199],a[48:51],v[16:19]
mm v[20:23],a[196:199],a[52:55],v[20:23]
bl a[0:3],v222,s[16:19],s34 offen offset:0 sc1
mm v[24:27],a[196:199],a[56:59],v[24:27]
tr a[216:217],v196 offset:24576
mm v[28:31],a[196:199],a[60:63],v[28:31]
tr a[218:219],v196 offset:28672
s_waitcnt lgkmcnt(6)
mm v[32:35],a[200:203],a[48:51],v[32:35]
mm v[36:39],a[200:203],a[52:55],v[36:39]
bl a[4:7],v223,s[16:19],s34 offen offset:0 sc1
mm v[40:43],a[200:203],a[56:59],v[40:43]
tr a[220:221],v197 offset:24576
mm v[44:47],a[200:203],a[60:63],v[44:47]
tr a[222:223],v197 offset:28672
mm v[48:51],a[204:207],a[48:51],v[48:51]
mm v[52:55],a[204:207],a[52:55],v[52:55]
s_waitcnt vmcnt(18)
mm v[56:59],a[204:207],a[56:59],v[56:59]
bl a[8:11],v224,s[16:19],s34 offen offset:0 sc1
s_barrier
mm v[60:63],a[204:207],a[60:63],v[60:63]
tr a[192:193],v190 offset:32768
s_waitcnt lgkmcnt(5)
mm v[64:67],a[208:211],a[48:51],v[64:67]
tr a[194:195],v190 offset:36864
mm v[68:71],a[208:211],a[52:55],v[68:71]
mm v[72:75],a[208:211],a[56:59],v[72:75]
tr a[196:197],v191 offset:32768
bl a[12:15],v225,s[16:19],s34 offen offset:0 sc1
mm v[76:79],a[208:211],a[60:63],v[76:79]
tr a[198:199],v191 offset:36864
s_add_u32 s34,s34,1024
mm v[80:83],a[212:215],a[48:51],v[80:83]
s_add_u32 m0,s36,8192
mm v[84:87],a[212:215],a[52:55],v[84:87]
mm v[88:91],a[212:215],a[56:59],v[88:91]
tr a[200:201],v192 offset:32768
bl v226,s[20:23],s35 offen offset:0 lds
mm v[92:95],a[212:215],a[60:63],v[92:95]
tr a[202:203],v192 offset:36864
s_waitcnt lgkmcnt(6)
mm v[96:99],a[216:219],a[48:51],v[96:99]
mm v[100:103],a[216:219],a[52:55],v[100:103]
mm v[104:107],a[216:219],a[56:59],v[104:107]
tr a[204:205],v193 offset:32768
bl v227,s[20:23],s35 offen offset:1024 lds
mm v[108:111],a[216:219],a[60:63],v[108:111]
tr a[206:207],v193 offset:36864
s_add_u32 s35,s35,262144
mm v[112:115],a[220:223],a[48:51],v[112:115]
mm v[116:119],a[220:223],a[52:55],v[116:119]
mm v[120:123],a[220:223],a[56:59],v[120:123]
tr a[208:209],v194 offset:32768
mm v[124:127],a[220:223],a[60:63],v[124:127]
bl a[16:19],v222,s[16:19],s34 offen offset:0 sc1
s_waitcnt lgkmcnt(5)
mm v[0:3],a[192:195],a[64:67],v[0:3]
tr a[210:211],v194 offset:36864
mm v[4:7],a[192:195],a[68:71],v[4:7]
mm v[8:11],a[192:195],a[72:75],v[8:11]
tr a[212:213],v195 offset:32768
mm v[12:15],a[192:195],a[76:79],v[12:15]
tr a[214:215],v195 offset:36864
bl a[20:23],v223,s[16:19],s34 offen offset:0 sc1
mm v[16:19],a[196:199],a[64:67],v[16:19]
mm v[20:23],a[196:199],a[68:71],v[20:23]
mm v[24:27],a[196:199],a[72:75],v[24:27]
tr a[216:217],v196 offset:32768
mm v[28:31],a[196:199],a[76:79],v[28:31]
bl a[24:27],v224,s[16:19],s34 offen offset:0 sc1
s_waitcnt lgkmcnt(5)
mm v[32:35],a[200:203],a[64:67],v[32:35]
tr a[218:219],v196 offset:36864
mm v[36:39],a[200:203],a[68:71],v[36:39]
mm v[40:43],a[200:203],a[72:75],v[40:43]
tr a[220:221],v197 offset:32768
mm v[44:47],a[200:203],a[76:79],v[44:47]
tr a[222:223],v197 offset:36864
bl a[28:31],v225,s[16:19],s34 offen offset:0 sc1
mm v[48:51],a[204:207],a[64:67],v[48:51]
s_add_u32 s34,s34,1024
s_add_u32 m0,s36,16384
mm v[52:55],a[204:207],a[68:71],v[52:55]
s_waitcnt vmcnt(22)
mm v[56:59],a[204:207],a[72:75],v[56:59]
s_barrier
mm v[60:63],a[204:207],a[76:79],v[60:63]
bl v226,s[20:23],s35 offen offset:0 lds
s_waitcnt lgkmcnt(4)
mm v[64:67],a[208:211],a[64:67],v[64:67]
tr a[192:193],v190 offset:40960
mm v[68:71],a[208:211],a[68:71],v[68:71]
tr a[194:195],v190 offset:45056
mm v[72:75],a[208:211],a[72:75],v[72:75]
tr a[196:197],v191 offset:40960
mm v[76:79],a[208:211],a[76:79],v[76:79]
tr a[198:199],v191 offset:45056
mm v[80:83],a[212:215],a[64:67],v[80:83]
bl v227,s[20:23],s35 offen offset:1024 lds
s_add_u32 s35,s35,262144
mm v[84:87],a[212:215],a[68:71],v[84:87]
mm v[88:91],a[212:215],a[72:75],v[88:91]
tr a[200:201],v192 offset:40960
mm v[92:95],a[212:215],a[76:79],v[92:95]
tr a[202:203],v192 offset:45056
s_waitcnt lgkmcnt(6)
mm v[96:99],a[216:219],a[64:67],v[96:99]
bl a[32:35],v222,s[16:19],s34 offen offset:0 sc1
mm v[100:103],a[216:219],a[68:71],v[100:103]
mm v[104:107],a[216:219],a[72:75],v[104:107]
tr a[204:205],v193 offset:40960
mm v[108:111],a[216:219],a[76:79],v[108:111]
tr a[206:207],v193 offset:45056
mm v[112:115],a[220:223],a[64:67],v[112:115]
bl a[36:39],v223,s[16:19],s34 offen offset:0 sc1
mm v[116:119],a[220:223],a[68:71],v[116:119]
mm v[120:123],a[220:223],a[72:75],v[120:123]
tr a[208:209],v194 offset:40960
mm v[124:127],a[220:223],a[76:79],v[124:127]
tr a[210:211],v194 offset:45056
s_waitcnt lgkmcnt(6)
mm v[0:3],a[192:195],a[80:83],v[0:3]
bl a[40:43],v224,s[16:19],s34 offen offset:0 sc1
mm v[4:7],a[192:195],a[84:87],v[4:7]
mm v[8:11],a[192:195],a[88:91],v[8:11]
tr a[212:213],v195 offset:40960
mm v[12:15],a[192:195],a[92:95],v[12:15]
tr a[214:215],v195 offset:45056
mm v[16:19],a[196:199],a[80:83],v[16:19]
mm v[20:23],a[196:199],a[84:87],v[20:23]
bl a[44:47],v225,s[16:19],s34 offen offset:0 sc1
s_add_u32 s34,s34,1024
mm v[24:27],a[196:199],a[88:91],v[24:27]
tr a[216:217],v196 offset:40960
s_add_u32 m0,s36,24576
mm v[28:31],a[196:199],a[92:95],v[28:31]
tr a[218:219],v196 offset:45056
s_waitcnt lgkmcnt(6)
mm v[32:35],a[200:203],a[80:83],v[32:35]
mm v[36:39],a[200:203],a[84:87],v[36:39]
bl v226,s[20:23],s35 offen offset:0 lds
mm v[40:43],a[200:203],a[88:91],v[40:43]
tr a[220:221],v197 offset:40960
mm v[44:47],a[200:203],a[92:95],v[44:47]
tr a[222:223],v197 offset:45056
mm v[48:51],a[204:207],a[80:83],v[48:51]
mm v[52:55],a[204:207],a[84:87],v[52:55]
bl v227,s[20:23],s35 offen offset:1024 lds
s_waitcnt vmcnt(26)
mm v[56:59],a[204:207],a[88:91],v[56:59]
s_add_u32 s35,s35,262144
s_barrier
mm v[60:63],a[204:207],a[92:95],v[60:63]
tr a[192:193],v190 offset:49152
s_waitcnt lgkmcnt(5)
mm v[64:67],a[208:211],a[80:83],v[64:67]
tr a[194:195],v190 offset:53248
mm v[68:71],a[208:211],a[84:87],v[68:71]
bl a[48:51],v222,s[16:19],s34 offen offset:0 sc1
mm v[72:75],a[208:211],a[88:91],v[72:75]
tr a[196:197],v191 offset:49152
mm v[76:79],a[208:211],a[92:95],v[76:79]
tr a[198:199],v191 offset:53248
mm v[80:83],a[212:215],a[80:83],v[80:83]
mm v[84:87],a[212:215],a[84:87],v[84:87]
mm v[88:91],a[212:215],a[88:91],v[88:91]
tr a[200:201],v192 offset:49152
bl a[52:55],v223,s[16:19],s34 offen offset:0 sc1
mm v[92:95],a[212:215],a[92:95],v[92:95]
tr a[202:203],v192 offset:53248
s_waitcnt lgkmcnt(6)
mm v[96:99],a[216:219],a[80:83],v[96:99]
mm v[100:103],a[216:219],a[84:87],v[100:103]
mm v[104:107],a[216:219],a[88:91],v[104:107]
tr a[204:205],v193 offset:49152
bl a[56:59],v224,s[16:19],s34 offen offset:0 sc1
mm v[108:111],a[216:219],a[92:95],v[108:111]
tr a[206:207],v193 offset:53248
mm v[112:115],a[220:223],a[80:83],v[112:115]
mm v[116:119],a[220:223],a[84:87],v[116:119]
mm v[120:123],a[220:223],a[88:91],v[120:123]
tr a[208:209],v194 offset:49152
bl a[60:63],v225,s[16:19],s34 offen offset:0 sc1
mm v[124:127],a[220:223],a[92:95],v[124:127]
tr a[210:211],v194 offset:53248
s_waitcnt lgkmcnt(6)
mm v[0:3],a[192:195],a[96:99],v[0:3]
s_add_u32 s34,s34,1024
s_add_u32 m0,s36,32768
mm v[4:7],a[192:195],a[100:103],v[4:7]
mm v[8:11],a[192:195],a[104:107],v[8:11]
tr a[212:213],v195 offset:49152
bl v226,s[20:23],s35 offen offset:0 lds
mm v[12:15],a[192:195],a[108:111],v[12:15]
tr a[214:215],v195 offset:53248
mm v[16:19],a[196:199],a[96:99],v[16:19]
mm v[20:23],a[196:199],a[100:103],v[20:23]
mm v[24:27],a[196:199],a[104:107],v[24:27]
tr a[216:217],v196 offset:49152
bl v227,s[20:23],s35 offen offset:1024 lds
mm v[28:31],a[196:199],a[108:111],v[28:31]
tr a[218:219],v196 offset:53248
s_waitcnt lgkmcnt(6)
mm v[32:35],a[200:203],a[96:99],v[32:35]
s_add_u32 s35,s35,262144
mm v[36:39],a[200:203],a[100:103],v[36:39]
mm v[40:43],a[200:203],a[104:107],v[40:43]
tr a[220:221],v197 offset:49152
mm v[44:47],a[200:203],a[108:111],v[44:47]
tr a[222:223],v197 offset:53248
bl a[64:67],v222,s[16:19],s34 offen offset:0 sc1
mm v[48:51],a[204:207],a[96:99],v[48:51]
mm v[52:55],a[204:207],a[100:103],v[52:55]
s_waitcnt vmcnt(27)
mm v[56:59],a[204:207],a[104:107],v[56:59]
s_barrier
mm v[60:63],a[204:207],a[108:111],v[60:63]
bl a[68:71],v223,s[16:19],s34 offen offset:0 sc1
s_waitcnt lgkmcnt(4)
mm v[64:67],a[208:211],a[96:99],v[64:67]
tr a[192:193],v190 offset:57344
mm v[68:71],a[208:211],a[100:103],v[68:71]
tr a[194:195],v190 offset:61440
mm v[72:75],a[208:211],a[104:107],v[72:75]
tr a[196:197],v191 offset:57344
mm v[76:79],a[208:211],a[108:111],v[76:79]
tr a[198:199],v191 offset:61440
bl a[72:75],v224,s[16:19],s34 offen offset:0 sc1
mm v[80:83],a[212:215],a[96:99],v[80:83]
mm v[84:87],a[212:215],a[100:103],v[84:87]
mm v[88:91],a[212:215],a[104:107],v[88:91]
tr a[200:201],v192 offset:57344
mm v[92:95],a[212:215],a[108:111],v[92:95]
bl a[76:79],v225,s[16:19],s34 offen offset:0 sc1
s_waitcnt lgkmcnt(5)
mm v[96:99],a[216:219],a[96:99],v[96:99]
tr a[202:203],v192 offset:61440
s_add_u32 s34,s34,1024
mm v[100:103],a[216:219],a[100:103],v[100:103]
s_add_u32 m0,s36,40960
mm v[104:107],a[216:219],a[104:107],v[104:107]
tr a[204:205],v193 offset:57344
mm v[108:111],a[216:219],a[108:111],v[108:111]
tr a[206:207],v193 offset:61440
mm v[112:115],a[220:223],a[96:99],v[112:115]
bl v226,s[20:23],s35 offen offset:0 lds
mm v[116:119],a[220:223],a[100:103],v[116:119]
mm v[120:123],a[220:223],a[104:107],v[120:123]
tr a[208:209],v194 offset:57344
mm v[124:127],a[220:223],a[108:111],v[124:127]
tr a[210:211],v194 offset:61440
s_waitcnt lgkmcnt(6)
mm v[0:3],a[192:195],a[112:115],v[0:3]
bl v227,s[20:23],s35 offen offset:1024 lds
s_add_u32 s35,s35,262144
mm v[4:7],a[192:195],a[116:119],v[4:7]
mm v[8:11],a[192:195],a[120:123],v[8:11]
tr a[212:213],v195 offset:57344
mm v[12:15],a[192:195],a[124:127],v[12:15]
tr a[214:215],v195 offset:61440
mm v[16:19],a[196:199],a[112:115],v[16:19]
bl a[80:83],v222,s[16:19],s34 offen offset:0 sc1
mm v[20:23],a[196:199],a[116:119],v[20:23]
mm v[24:27],a[196:199],a[120:123],v[24:27]
tr a[216:217],v196 offset:57344
mm v[28:31],a[196:199],a[124:127],v[28:31]
tr a[218:219],v196 offset:61440
s_waitcnt lgkmcnt(6)
mm v[32:35],a[200:203],a[112:115],v[32:35]
bl a[84:87],v223,s[16:19],s34 offen offset:0 sc1
mm v[36:39],a[200:203],a[116:119],v[36:39]
mm v[40:43],a[200:203],a[120:123],v[40:43]
tr a[220:221],v197 offset:57344
mm v[44:47],a[200:203],a[124:127],v[44:47]
tr a[222:223],v197 offset:61440
mm v[48:51],a[204:207],a[112:115],v[48:51]
mm v[52:55],a[204:207],a[116:119],v[52:55]
bl a[88:91],v224,s[16:19],s34 offen offset:0 sc1
s_waitcnt vmcnt(29)
mm v[56:59],a[204:207],a[120:123],v[56:59]
s_barrier
mm v[60:63],a[204:207],a[124:127],v[60:63]
tr a[192:193],v190 offset:0
s_waitcnt lgkmcnt(5)
mm v[64:67],a[208:211],a[112:115],v[64:67]
tr a[194:195],v190 offset:4096
mm v[68:71],a[208:211],a[116:119],v[68:71]
bl a[92:95],v225,s[16:19],s34 offen offset:0 sc1
s_add_u32 s34,s34,1024
mm v[72:75],a[208:211],a[120:123],v[72:75]
tr a[196:197],v191 offset:0
s_add_u32 m0,s36,49152
mm v[76:79],a[208:211],a[124:127],v[76:79]
tr a[198:199],v191 offset:4096
mm v[80:83],a[212:215],a[112:115],v[80:83]
mm v[84:87],a[212:215],a[116:119],v[84:87]
bl v226,s[20:23],s35 offen offset:0 lds
mm v[88:91],a[212:215],a[120:123],v[88:91]
tr a[200:201],v192 offset:0
mm v[92:95],a[212:215],a[124:127],v[92:95]
tr a[202:203],v192 offset:4096
s_waitcnt lgkmcnt(6)
mm v[96:99],a[216:219],a[112:115],v[96:99]
mm v[100:103],a[216:219],a[116:119],v[100:103]
bl v227,s[20:23],s35 offen offset:1024 lds
mm v[104:107],a[216:219],a[120:123],v[104:107]
tr a[204:205],v193 offset:0
mm v[108:111],a[216:219],a[124:127],v[108:111]
tr a[206:207],v193 offset:4096
mm v[112:115],a[220:223],a[112:115],v[112:115]
mm v[116:119],a[220:223],a[116:119],v[116:119]
mm v[120:123],a[220:223],a[120:123],v[120:123]
mm v[124:127],a[220:223],a[124:127],v[124:127]
s_mov_b32 s3,2
adaLN_cond__mha_block_cached__mixer_channel_mlp__prompt_kernelq_loop:
s_waitcnt lgkmcnt(4)
mm v[0:3],a[192:195],a[0:3],v[0:3]
s_add_u32 s35,s35,262144
bl a[96:99],v222,s[16:19],s34 offen offset:0 sc1
mm v[4:7],a[192:195],a[4:7],v[4:7]
tr a[208:209],v194 offset:0
mm v[8:11],a[192:195],a[8:11],v[8:11]
tr a[210:211],v194 offset:4096
mm v[12:15],a[192:195],a[12:15],v[12:15]
tr a[212:213],v195 offset:0
mm v[16:19],a[196:199],a[0:3],v[16:19]
tr a[214:215],v195 offset:4096
mm v[20:23],a[196:199],a[4:7],v[20:23]
bl a[100:103],v223,s[16:19],s34 offen offset:0 sc1
mm v[24:27],a[196:199],a[8:11],v[24:27]
tr a[216:217],v196 offset:0
mm v[28:31],a[196:199],a[12:15],v[28:31]
tr a[218:219],v196 offset:4096
s_waitcnt lgkmcnt(6)
mm v[32:35],a[200:203],a[0:3],v[32:35]
mm v[36:39],a[200:203],a[4:7],v[36:39]
mm v[40:43],a[200:203],a[8:11],v[40:43]
tr a[220:221],v197 offset:0
bl a[104:107],v224,s[16:19],s34 offen offset:0 sc1
mm v[44:47],a[200:203],a[12:15],v[44:47]
tr a[222:223],v197 offset:4096
mm v[48:51],a[204:207],a[0:3],v[48:51]
mm v[52:55],a[204:207],a[4:7],v[52:55]
s_waitcnt vmcnt(29)
mm v[56:59],a[204:207],a[8:11],v[56:59]
s_barrier
mm v[60:63],a[204:207],a[12:15],v[60:63]
bl a[108:111],v225,s[16:19],s34 offen offset:0 sc1
s_waitcnt lgkmcnt(4)
mm v[64:67],a[208:211],a[0:3],v[64:67]
tr a[192:193],v190 offset:8192
s_add_u32 s34,s34,1024
mm v[68:71],a[208:211],a[4:7],v[68:71]
tr a[194:195],v190 offset:12288
s_add_u32 m0,s36,57344
mm v[72:75],a[208:211],a[8:11],v[72:75]
tr a[196:197],v191 offset:8192
bl v226,s[20:23],s35 offen offset:0 lds
mm v[76:79],a[208:211],a[12:15],v[76:79]
tr a[198:199],v191 offset:12288
mm v[80:83],a[212:215],a[0:3],v[80:83]
bl v227,s[20:23],s35 offen offset:1024 lds
s_add_u32 s35,s35,262144
mm v[84:87],a[212:215],a[4:7],v[84:87]
mm v[88:91],a[212:215],a[8:11],v[88:91]
tr a[200:201],v192 offset:8192
mm v[92:95],a[212:215],a[12:15],v[92:95]
tr a[202:203],v192 offset:12288
s_waitcnt lgkmcnt(6)
mm v[96:99],a[216:219],a[0:3],v[96:99]
mm v[100:103],a[216:219],a[4:7],v[100:103]
bl a[112:115],v222,s[16:19],s34 offen offset:0 sc1
mm v[104:107],a[216:219],a[8:11],v[104:107]
tr a[204:205],v193 offset:8192
mm v[108:111],a[216:219],a[12:15],v[108:111]
tr a[206:207],v193 offset:12288
mm v[112:115],a[220:223],a[0:3],v[112:115]
mm v[116:119],a[220:223],a[4:7],v[116:119]
mm v[120:123],a[220:223],a[8:11],v[120:123]
tr a[208:209],v194 offset:8192
bl a[116:119],v223,s[16:19],s34 offen offset:0 sc1
mm v[124:127],a[220:223],a[12:15],v[124:127]
tr a[210:211],v194 offset:12288
s_waitcnt lgkmcnt(6)
mm v[0:3],a[192:195],a[16:19],v[0:3]
mm v[4:7],a[192:195],a[20:23],v[4:7]
mm v[8:11],a[192:195],a[24:27],v[8:11]
tr a[212:213],v195 offset:8192
mm v[12:15],a[192:195],a[28:31],v[12:15]
tr a[214:215],v195 offset:12288
bl a[120:123],v224,s[16:19],s34 offen offset:0 sc1
mm v[16:19],a[196:199],a[16:19],v[16:19]
mm v[20:23],a[196:199],a[20:23],v[20:23]
mm v[24:27],a[196:199],a[24:27],v[24:27]
tr a[216:217],v196 offset:8192
mm v[28:31],a[196:199],a[28:31],v[28:31]
tr a[218:219],v196 offset:12288
s_waitcnt lgkmcnt(6)
mm v[32:35],a[200:203],a[16:19],v[32:35]
bl a[124:127],v225,s[16:19],s34 offen offset:0 sc1
s_add_u32 s34,s34,1024
mm v[36:39],a[200:203],a[20:23],v[36:39]
mm v[40:43],a[200:203],a[24:27],v[40:43]
tr a[220:221],v197 offset:8192
mm v[44:47],a[200:203],a[28:31],v[44:47]
tr a[222:223],v197 offset:12288
mm v[48:51],a[204:207],a[16:19],v[48:51]
mm v[52:55],a[204:207],a[20:23],v[52:55]
s_waitcnt vmcnt(30)
mm v[56:59],a[204:207],a[24:27],v[56:59]
s_barrier
mm v[60:63],a[204:207],a[28:31],v[60:63]
s_add_u32 m0,s36,0
s_waitcnt lgkmcnt(4)
mm v[64:67],a[208:211],a[16:19],v[64:67]
tr a[192:193],v190 offset:16384
bl v226,s[20:23],s35 offen offset:0 lds
mm v[68:71],a[208:211],a[20:23],v[68:71]
tr a[194:195],v190 offset:20480
mm v[72:75],a[208:211],a[24:27],v[72:75]
tr a[196:197],v191 offset:16384
mm v[76:79],a[208:211],a[28:31],v[76:79]
tr a[198:199],v191 offset:20480
mm v[80:83],a[212:215],a[16:19],v[80:83]
bl v227,s[20:23],s35 offen offset:1024 lds
s_add_u32 s35,s35,262144
mm v[84:87],a[212:215],a[20:23],v[84:87]
mm v[88:91],a[212:215],a[24:27],v[88:91]
tr a[200:201],v192 offset:16384
mm v[92:95],a[212:215],a[28:31],v[92:95]
tr a[202:203],v192 offset:20480
s_waitcnt lgkmcnt(6)
mm v[96:99],a[216:219],a[16:19],v[96:99]
mm v[100:103],a[216:219],a[20:23],v[100:103]
bl a[0:3],v222,s[16:19],s34 offen offset:0 sc1
mm v[104:107],a[216:219],a[24:27],v[104:107]
tr a[204:205],v193 offset:16384
mm v[108:111],a[216:219],a[28:31],v[108:111]
tr a[206:207],v193 offset:20480
mm v[112:115],a[220:223],a[16:19],v[112:115]
mm v[116:119],a[220:223],a[20:23],v[116:119]
mm v[120:123],a[220:223],a[24:27],v[120:123]
tr a[208:209],v194 offset:16384
bl a[4:7],v223,s[16:19],s34 offen offset:0 sc1
mm v[124:127],a[220:223],a[28:31],v[124:127]
tr a[210:211],v194 offset:20480
s_waitcnt lgkmcnt(6)
mm v[0:3],a[192:195],a[32:35],v[0:3]
mm v[4:7],a[192:195],a[36:39],v[4:7]
mm v[8:11],a[192:195],a[40:43],v[8:11]
tr a[212:213],v195 offset:16384
mm v[12:15],a[192:195],a[44:47],v[12:15]
tr a[214:215],v195 offset:20480
bl a[8:11],v224,s[16:19],s34 offen offset:0 sc1
mm v[16:19],a[196:199],a[32:35],v[16:19]
mm v[20:23],a[196:199],a[36:39],v[20:23]
mm v[24:27],a[196:199],a[40:43],v[24:27]
tr a[216:217],v196 offset:16384
mm v[28:31],a[196:199],a[44:47],v[28:31]
tr a[218:219],v196 offset:20480
s_waitcnt lgkmcnt(6)
mm v[32:35],a[200:203],a[32:35],v[32:35]
bl a[12:15],v225,s[16:19],s34 offen offset:0 sc1
s_add_u32 s34,s34,1024
mm v[36:39],a[200:203],a[36:39],v[36:39]
mm v[40:43],a[200:203],a[40:43],v[40:43]
tr a[220:221],v197 offset:16384
mm v[44:47],a[200:203],a[44:47],v[44:47]
tr a[222:223],v197 offset:20480
mm v[48:51],a[204:207],a[32:35],v[48:51]
mm v[52:55],a[204:207],a[36:39],v[52:55]
s_waitcnt vmcnt(30)
mm v[56:59],a[204:207],a[40:43],v[56:59]
s_barrier
mm v[60:63],a[204:207],a[44:47],v[60:63]
s_add_u32 m0,s36,8192
s_waitcnt lgkmcnt(4)
mm v[64:67],a[208:211],a[32:35],v[64:67]
tr a[192:193],v190 offset:24576
bl v226,s[20:23],s35 offen offset:0 lds
mm v[68:71],a[208:211],a[36:39],v[68:71]
tr a[194:195],v190 offset:28672
mm v[72:75],a[208:211],a[40:43],v[72:75]
tr a[196:197],v191 offset:24576
mm v[76:79],a[208:211],a[44:47],v[76:79]
tr a[198:199],v191 offset:28672
mm v[80:83],a[212:215],a[32:35],v[80:83]
bl v227,s[20:23],s35 offen offset:1024 lds
s_add_u32 s35,s35,262144
mm v[84:87],a[212:215],a[36:39],v[84:87]
mm v[88:91],a[212:215],a[40:43],v[88:91]
tr a[200:201],v192 offset:24576
mm v[92:95],a[212:215],a[44:47],v[92:95]
tr a[202:203],v192 offset:28672
s_waitcnt lgkmcnt(6)
mm v[96:99],a[216:219],a[32:35],v[96:99]
mm v[100:103],a[216:219],a[36:39],v[100:103]
bl a[16:19],v222,s[16:19],s34 offen offset:0 sc1
mm v[104:107],a[216:219],a[40:43],v[104:107]
tr a[204:205],v193 offset:24576
mm v[108:111],a[216:219],a[44:47],v[108:111]
tr a[206:207],v193 offset:28672
mm v[112:115],a[220:223],a[32:35],v[112:115]
mm v[116:119],a[220:223],a[36:39],v[116:119]
mm v[120:123],a[220:223],a[40:43],v[120:123]
tr a[208:209],v194 offset:24576
bl a[20:23],v223,s[16:19],s34 offen offset:0 sc1
mm v[124:127],a[220:223],a[44:47],v[124:127]
tr a[210:211],v194 offset:28672
s_waitcnt lgkmcnt(6)
mm v[0:3],a[192:195],a[48:51],v[0:3]
mm v[4:7],a[192:195],a[52:55],v[4:7]
mm v[8:11],a[192:195],a[56:59],v[8:11]
tr a[212:213],v195 offset:24576
mm v[12:15],a[192:195],a[60:63],v[12:15]
tr a[214:215],v195 offset:28672
bl a[24:27],v224,s[16:19],s34 offen offset:0 sc1
mm v[16:19],a[196:199],a[48:51],v[16:19]
mm v[20:23],a[196:199],a[52:55],v[20:23]
mm v[24:27],a[196:199],a[56:59],v[24:27]
tr a[216:217],v196 offset:24576
mm v[28:31],a[196:199],a[60:63],v[28:31]
tr a[218:219],v196 offset:28672
s_waitcnt lgkmcnt(6)
mm v[32:35],a[200:203],a[48:51],v[32:35]
bl a[28:31],v225,s[16:19],s34 offen offset:0 sc1
s_add_u32 s34,s34,1024
mm v[36:39],a[200:203],a[52:55],v[36:39]
mm v[40:43],a[200:203],a[56:59],v[40:43]
tr a[220:221],v197 offset:24576
mm v[44:47],a[200:203],a[60:63],v[44:47]
tr a[222:223],v197 offset:28672
mm v[48:51],a[204:207],a[48:51],v[48:51]
mm v[52:55],a[204:207],a[52:55],v[52:55]
s_waitcnt vmcnt(30)
mm v[56:59],a[204:207],a[56:59],v[56:59]
s_barrier
mm v[60:63],a[204:207],a[60:63],v[60:63]
s_add_u32 m0,s36,16384
s_waitcnt lgkmcnt(4)
mm v[64:67],a[208:211],a[48:51],v[64:67]
tr a[192:193],v190 offset:32768
bl v226,s[20:23],s35 offen offset:0 lds
mm v[68:71],a[208:211],a[52:55],v[68:71]
tr a[194:195],v190 offset:36864
mm v[72:75],a[208:211],a[56:59],v[72:75]
tr a[196:197],v191 offset:32768
mm v[76:79],a[208:211],a[60:63],v[76:79]
tr a[198:199],v191 offset:36864
mm v[80:83],a[212:215],a[48:51],v[80:83]
bl v227,s[20:23],s35 offen offset:1024 lds
s_add_u32 s35,s35,262144
mm v[84:87],a[212:215],a[52:55],v[84:87]
mm v[88:91],a[212:215],a[56:59],v[88:91]
tr a[200:201],v192 offset:32768
mm v[92:95],a[212:215],a[60:63],v[92:95]
tr a[202:203],v192 offset:36864
s_waitcnt lgkmcnt(6)
mm v[96:99],a[216:219],a[48:51],v[96:99]
mm v[100:103],a[216:219],a[52:55],v[100:103]
bl a[32:35],v222,s[16:19],s34 offen offset:0 sc1
mm v[104:107],a[216:219],a[56:59],v[104:107]
tr a[204:205],v193 offset:32768
mm v[108:111],a[216:219],a[60:63],v[108:111]
tr a[206:207],v193 offset:36864
mm v[112:115],a[220:223],a[48:51],v[112:115]
mm v[116:119],a[220:223],a[52:55],v[116:119]
mm v[120:123],a[220:223],a[56:59],v[120:123]
tr a[208:209],v194 offset:32768
bl a[36:39],v223,s[16:19],s34 offen offset:0 sc1
mm v[124:127],a[220:223],a[60:63],v[124:127]
tr a[210:211],v194 offset:36864
s_waitcnt lgkmcnt(6)
mm v[0:3],a[192:195],a[64:67],v[0:3]
mm v[4:7],a[192:195],a[68:71],v[4:7]
mm v[8:11],a[192:195],a[72:75],v[8:11]
tr a[212:213],v195 offset:32768
mm v[12:15],a[192:195],a[76:79],v[12:15]
tr a[214:215],v195 offset:36864
bl a[40:43],v224,s[16:19],s34 offen offset:0 sc1
mm v[16:19],a[196:199],a[64:67],v[16:19]
mm v[20:23],a[196:199],a[68:71],v[20:23]
mm v[24:27],a[196:199],a[72:75],v[24:27]
tr a[216:217],v196 offset:32768
mm v[28:31],a[196:199],a[76:79],v[28:31]
tr a[218:219],v196 offset:36864
s_waitcnt lgkmcnt(6)
mm v[32:35],a[200:203],a[64:67],v[32:35]
bl a[44:47],v225,s[16:19],s34 offen offset:0 sc1
s_add_u32 s34,s34,1024
mm v[36:39],a[200:203],a[68:71],v[36:39]
mm v[40:43],a[200:203],a[72:75],v[40:43]
tr a[220:221],v197 offset:32768
mm v[44:47],a[200:203],a[76:79],v[44:47]
tr a[222:223],v197 offset:36864
mm v[48:51],a[204:207],a[64:67],v[48:51]
mm v[52:55],a[204:207],a[68:71],v[52:55]
s_waitcnt vmcnt(30)
mm v[56:59],a[204:207],a[72:75],v[56:59]
s_barrier
mm v[60:63],a[204:207],a[76:79],v[60:63]
s_add_u32 m0,s36,24576
s_waitcnt lgkmcnt(4)
mm v[64:67],a[208:211],a[64:67],v[64:67]
tr a[192:193],v190 offset:40960
bl v226,s[20:23],s35 offen offset:0 lds
mm v[68:71],a[208:211],a[68:71],v[68:71]
tr a[194:195],v190 offset:45056
mm v[72:75],a[208:211],a[72:75],v[72:75]
tr a[196:197],v191 offset:40960
mm v[76:79],a[208:211],a[76:79],v[76:79]
tr a[198:199],v191 offset:45056
mm v[80:83],a[212:215],a[64:67],v[80:83]
bl v227,s[20:23],s35 offen offset:1024 lds
s_add_u32 s35,s35,262144
mm v[84:87],a[212:215],a[68:71],v[84:87]
mm v[88:91],a[212:215],a[72:75],v[88:91]
tr a[200:201],v192 offset:40960
mm v[92:95],a[212:215],a[76:79],v[92:95]
tr a[202:203],v192 offset:45056
s_waitcnt lgkmcnt(6)
mm v[96:99],a[216:219],a[64:67],v[96:99]
mm v[100:103],a[216:219],a[68:71],v[100:103]
bl a[48:51],v222,s[16:19],s34 offen offset:0 sc1
mm v[104:107],a[216:219],a[72:75],v[104:107]
tr a[204:205],v193 offset:40960
mm v[108:111],a[216:219],a[76:79],v[108:111]
tr a[206:207],v193 offset:45056
mm v[112:115],a[220:223],a[64:67],v[112:115]
mm v[116:119],a[220:223],a[68:71],v[116:119]
mm v[120:123],a[220:223],a[72:75],v[120:123]
tr a[208:209],v194 offset:40960
bl a[52:55],v223,s[16:19],s34 offen offset:0 sc1
mm v[124:127],a[220:223],a[76:79],v[124:127]
tr a[210:211],v194 offset:45056
s_waitcnt lgkmcnt(6)
mm v[0:3],a[192:195],a[80:83],v[0:3]
mm v[4:7],a[192:195],a[84:87],v[4:7]
mm v[8:11],a[192:195],a[88:91],v[8:11]
tr a[212:213],v195 offset:40960
mm v[12:15],a[192:195],a[92:95],v[12:15]
tr a[214:215],v195 offset:45056
bl a[56:59],v224,s[16:19],s34 offen offset:0 sc1
mm v[16:19],a[196:199],a[80:83],v[16:19]
mm v[20:23],a[196:199],a[84:87],v[20:23]
mm v[24:27],a[196:199],a[88:91],v[24:27]
tr a[216:217],v196 offset:40960
mm v[28:31],a[196:199],a[92:95],v[28:31]
tr a[218:219],v196 offset:45056
s_waitcnt lgkmcnt(6)
mm v[32:35],a[200:203],a[80:83],v[32:35]
bl a[60:63],v225,s[16:19],s34 offen offset:0 sc1
s_add_u32 s34,s34,1024
mm v[36:39],a[200:203],a[84:87],v[36:39]
mm v[40:43],a[200:203],a[88:91],v[40:43]
tr a[220:221],v197 offset:40960
mm v[44:47],a[200:203],a[92:95],v[44:47]
tr a[222:223],v197 offset:45056
mm v[48:51],a[204:207],a[80:83],v[48:51]
mm v[52:55],a[204:207],a[84:87],v[52:55]
s_waitcnt vmcnt(30)
mm v[56:59],a[204:207],a[88:91],v[56:59]
s_barrier
mm v[60:63],a[204:207],a[92:95],v[60:63]
s_add_u32 m0,s36,32768
s_waitcnt lgkmcnt(4)
mm v[64:67],a[208:211],a[80:83],v[64:67]
tr a[192:193],v190 offset:49152
bl v226,s[20:23],s35 offen offset:0 lds
mm v[68:71],a[208:211],a[84:87],v[68:71]
tr a[194:195],v190 offset:53248
mm v[72:75],a[208:211],a[88:91],v[72:75]
tr a[196:197],v191 offset:49152
mm v[76:79],a[208:211],a[92:95],v[76:79]
tr a[198:199],v191 offset:53248
mm v[80:83],a[212:215],a[80:83],v[80:83]
bl v227,s[20:23],s35 offen offset:1024 lds
s_add_u32 s35,s35,262144
mm v[84:87],a[212:215],a[84:87],v[84:87]
mm v[88:91],a[212:215],a[88:91],v[88:91]
tr a[200:201],v192 offset:49152
mm v[92:95],a[212:215],a[92:95],v[92:95]
tr a[202:203],v192 offset:53248
s_waitcnt lgkmcnt(6)
mm v[96:99],a[216:219],a[80:83],v[96:99]
mm v[100:103],a[216:219],a[84:87],v[100:103]
bl a[64:67],v222,s[16:19],s34 offen offset:0 sc1
mm v[104:107],a[216:219],a[88:91],v[104:107]
tr a[204:205],v193 offset:49152
mm v[108:111],a[216:219],a[92:95],v[108:111]
tr a[206:207],v193 offset:53248
mm v[112:115],a[220:223],a[80:83],v[112:115]
mm v[116:119],a[220:223],a[84:87],v[116:119]
mm v[120:123],a[220:223],a[88:91],v[120:123]
tr a[208:209],v194 offset:49152
bl a[68:71],v223,s[16:19],s34 offen offset:0 sc1
mm v[124:127],a[220:223],a[92:95],v[124:127]
tr a[210:211],v194 offset:53248
s_waitcnt lgkmcnt(6)
mm v[0:3],a[192:195],a[96:99],v[0:3]
mm v[4:7],a[192:195],a[100:103],v[4:7]
mm v[8:11],a[192:195],a[104:107],v[8:11]
tr a[212:213],v195 offset:49152
mm v[12:15],a[192:195],a[108:111],v[12:15]
tr a[214:215],v195 offset:53248
bl a[72:75],v224,s[16:19],s34 offen offset:0 sc1
mm v[16:19],a[196:199],a[96:99],v[16:19]
mm v[20:23],a[196:199],a[100:103],v[20:23]
mm v[24:27],a[196:199],a[104:107],v[24:27]
tr a[216:217],v196 offset:49152
mm v[28:31],a[196:199],a[108:111],v[28:31]
tr a[218:219],v196 offset:53248
s_waitcnt lgkmcnt(6)
mm v[32:35],a[200:203],a[96:99],v[32:35]
bl a[76:79],v225,s[16:19],s34 offen offset:0 sc1
s_add_u32 s34,s34,1024
mm v[36:39],a[200:203],a[100:103],v[36:39]
mm v[40:43],a[200:203],a[104:107],v[40:43]
tr a[220:221],v197 offset:49152
mm v[44:47],a[200:203],a[108:111],v[44:47]
tr a[222:223],v197 offset:53248
mm v[48:51],a[204:207],a[96:99],v[48:51]
mm v[52:55],a[204:207],a[100:103],v[52:55]
s_waitcnt vmcnt(30)
mm v[56:59],a[204:207],a[104:107],v[56:59]
s_barrier
mm v[60:63],a[204:207],a[108:111],v[60:63]
s_add_u32 m0,s36,40960
s_waitcnt lgkmcnt(4)
mm v[64:67],a[208:211],a[96:99],v[64:67]
tr a[192:193],v190 offset:57344
bl v226,s[20:23],s35 offen offset:0 lds
mm v[68:71],a[208:211],a[100:103],v[68:71]
tr a[194:195],v190 offset:61440
mm v[72:75],a[208:211],a[104:107],v[72:75]
tr a[196:197],v191 offset:57344
mm v[76:79],a[208:211],a[108:111],v[76:79]
tr a[198:199],v191 offset:61440
mm v[80:83],a[212:215],a[96:99],v[80:83]
bl v227,s[20:23],s35 offen offset:1024 lds
s_add_u32 s35,s35,262144
mm v[84:87],a[212:215],a[100:103],v[84:87]
mm v[88:91],a[212:215],a[104:107],v[88:91]
tr a[200:201],v192 offset:57344
mm v[92:95],a[212:215],a[108:111],v[92:95]
tr a[202:203],v192 offset:61440
s_waitcnt lgkmcnt(6)
mm v[96:99],a[216:219],a[96:99],v[96:99]
mm v[100:103],a[216:219],a[100:103],v[100:103]
bl a[80:83],v222,s[16:19],s34 offen offset:0 sc1
mm v[104:107],a[216:219],a[104:107],v[104:107]
tr a[204:205],v193 offset:57344
mm v[108:111],a[216:219],a[108:111],v[108:111]
tr a[206:207],v193 offset:61440
mm v[112:115],a[220:223],a[96:99],v[112:115]
mm v[116:119],a[220:223],a[100:103],v[116:119]
mm v[120:123],a[220:223],a[104:107],v[120:123]
tr a[208:209],v194 offset:57344
bl a[84:87],v223,s[16:19],s34 offen offset:0 sc1
mm v[124:127],a[220:223],a[108:111],v[124:127]
tr a[210:211],v194 offset:61440
s_waitcnt lgkmcnt(6)
mm v[0:3],a[192:195],a[112:115],v[0:3]
mm v[4:7],a[192:195],a[116:119],v[4:7]
mm v[8:11],a[192:195],a[120:123],v[8:11]
tr a[212:213],v195 offset:57344
mm v[12:15],a[192:195],a[124:127],v[12:15]
tr a[214:215],v195 offset:61440
bl a[88:91],v224,s[16:19],s34 offen offset:0 sc1
mm v[16:19],a[196:199],a[112:115],v[16:19]
mm v[20:23],a[196:199],a[116:119],v[20:23]
mm v[24:27],a[196:199],a[120:123],v[24:27]
tr a[216:217],v196 offset:57344
mm v[28:31],a[196:199],a[124:127],v[28:31]
tr a[218:219],v196 offset:61440
s_waitcnt lgkmcnt(6)
mm v[32:35],a[200:203],a[112:115],v[32:35]
bl a[92:95],v225,s[16:19],s34 offen offset:0 sc1
s_add_u32 s34,s34,1024
mm v[36:39],a[200:203],a[116:119],v[36:39]
mm v[40:43],a[200:203],a[120:123],v[40:43]
tr a[220:221],v197 offset:57344
mm v[44:47],a[200:203],a[124:127],v[44:47]
tr a[222:223],v197 offset:61440
mm v[48:51],a[204:207],a[112:115],v[48:51]
mm v[52:55],a[204:207],a[116:119],v[52:55]
s_waitcnt vmcnt(30)
mm v[56:59],a[204:207],a[120:123],v[56:59]
s_barrier
mm v[60:63],a[204:207],a[124:127],v[60:63]
s_add_u32 m0,s36,49152
s_waitcnt lgkmcnt(4)
mm v[64:67],a[208:211],a[112:115],v[64:67]
tr a[192:193],v190 offset:0
bl v226,s[20:23],s35 offen offset:0 lds
mm v[68:71],a[208:211],a[116:119],v[68:71]
tr a[194:195],v190 offset:4096
mm v[72:75],a[208:211],a[120:123],v[72:75]
tr a[196:197],v191 offset:0
mm v[76:79],a[208:211],a[124:127],v[76:79]
tr a[198:199],v191 offset:4096
mm v[80:83],a[212:215],a[112:115],v[80:83]
mm v[84:87],a[212:215],a[116:119],v[84:87]
mm v[88:91],a[212:215],a[120:123],v[88:91]
tr a[200:201],v192 offset:0
mm v[92:95],a[212:215],a[124:127],v[92:95]
tr a[202:203],v192 offset:4096
s_waitcnt lgkmcnt(6)
mm v[96:99],a[216:219],a[112:115],v[96:99]
bl v227,s[20:23],s35 offen offset:1024 lds
mm v[100:103],a[216:219],a[116:119],v[100:103]
mm v[104:107],a[216:219],a[120:123],v[104:107]
tr a[204:205],v193 offset:0
mm v[108:111],a[216:219],a[124:127],v[108:111]
tr a[206:207],v193 offset:4096
mm v[112:115],a[220:223],a[112:115],v[112:115]
mm v[116:119],a[220:223],a[116:119],v[116:119]
mm v[120:123],a[220:223],a[120:123],v[120:123]
mm v[124:127],a[220:223],a[124:127],v[124:127]
s_sub_u32 s3,s3,1
s_cmp_lg_u32 s3,0
s_cbranch_scc1 adaLN_cond__mha_block_cached__mixer_channel_mlp__prompt_kernelq_loop
s_waitcnt lgkmcnt(4)
mm v[0:3],a[192:195],a[0:3],v[0:3]
s_add_u32 s35,s35,262144
bl a[96:99],v222,s[16:19],s34 offen offset:0 sc1
mm v[4:7],a[192:195],a[4:7],v[4:7]
tr a[208:209],v194 offset:0
mm v[8:11],a[192:195],a[8:11],v[8:11]
tr a[210:211],v194 offset:4096
mm v[12:15],a[192:195],a[12:15],v[12:15]
tr a[212:213],v195 offset:0
mm v[16:19],a[196:199],a[0:3],v[16:19]
tr a[214:215],v195 offset:4096
mm v[20:23],a[196:199],a[4:7],v[20:23]
bl a[100:103],v223,s[16:19],s34 offen offset:0 sc1
mm v[24:27],a[196:199],a[8:11],v[24:27]
tr a[216:217],v196 offset:0
mm v[28:31],a[196:199],a[12:15],v[28:31]
tr a[218:219],v196 offset:4096
s_waitcnt lgkmcnt(6)
mm v[32:35],a[200:203],a[0:3],v[32:35]
mm v[36:39],a[200:203],a[4:7],v[36:39]
mm v[40:43],a[200:203],a[8:11],v[40:43]
tr a[220:221],v197 offset:0
bl a[104:107],v224,s[16:19],s34 offen offset:0 sc1
mm v[44:47],a[200:203],a[12:15],v[44:47]
tr a[222:223],v197 offset:4096
mm v[48:51],a[204:207],a[0:3],v[48:51]
mm v[52:55],a[204:207],a[4:7],v[52:55]
s_waitcnt vmcnt(29)
mm v[56:59],a[204:207],a[8:11],v[56:59]
s_barrier
mm v[60:63],a[204:207],a[12:15],v[60:63]
bl a[108:111],v225,s[16:19],s34 offen offset:0 sc1
s_waitcnt lgkmcnt(4)
mm v[64:67],a[208:211],a[0:3],v[64:67]
tr a[192:193],v190 offset:8192
s_add_u32 s34,s34,1024
mm v[68:71],a[208:211],a[4:7],v[68:71]
tr a[194:195],v190 offset:12288
s_add_u32 m0,s36,57344
mm v[72:75],a[208:211],a[8:11],v[72:75]
tr a[196:197],v191 offset:8192
bl v226,s[20:23],s35 offen offset:0 lds
mm v[76:79],a[208:211],a[12:15],v[76:79]
tr a[198:199],v191 offset:12288
mm v[80:83],a[212:215],a[0:3],v[80:83]
bl v227,s[20:23],s35 offen offset:1024 lds
s_add_u32 s35,s35,262144
mm v[84:87],a[212:215],a[4:7],v[84:87]
mm v[88:91],a[212:215],a[8:11],v[88:91]
tr a[200:201],v192 offset:8192
mm v[92:95],a[212:215],a[12:15],v[92:95]
tr a[202:203],v192 offset:12288
s_waitcnt lgkmcnt(6)
mm v[96:99],a[216:219],a[0:3],v[96:99]
mm v[100:103],a[216:219],a[4:7],v[100:103]
bl a[112:115],v222,s[16:19],s34 offen offset:0 sc1
mm v[104:107],a[216:219],a[8:11],v[104:107]
tr a[204:205],v193 offset:8192
mm v[108:111],a[216:219],a[12:15],v[108:111]
tr a[206:207],v193 offset:12288
mm v[112:115],a[220:223],a[0:3],v[112:115]
mm v[116:119],a[220:223],a[4:7],v[116:119]
mm v[120:123],a[220:223],a[8:11],v[120:123]
tr a[208:209],v194 offset:8192
bl a[116:119],v223,s[16:19],s34 offen offset:0 sc1
mm v[124:127],a[220:223],a[12:15],v[124:127]
tr a[210:211],v194 offset:12288
s_waitcnt lgkmcnt(6)
mm v[0:3],a[192:195],a[16:19],v[0:3]
mm v[4:7],a[192:195],a[20:23],v[4:7]
mm v[8:11],a[192:195],a[24:27],v[8:11]
tr a[212:213],v195 offset:8192
mm v[12:15],a[192:195],a[28:31],v[12:15]
tr a[214:215],v195 offset:12288
bl a[120:123],v224,s[16:19],s34 offen offset:0 sc1
mm v[16:19],a[196:199],a[16:19],v[16:19]
mm v[20:23],a[196:199],a[20:23],v[20:23]
mm v[24:27],a[196:199],a[24:27],v[24:27]
tr a[216:217],v196 offset:8192
mm v[28:31],a[196:199],a[28:31],v[28:31]
tr a[218:219],v196 offset:12288
s_waitcnt lgkmcnt(6)
mm v[32:35],a[200:203],a[16:19],v[32:35]
bl a[124:127],v225,s[16:19],s34 offen offset:0 sc1
s_add_u32 s34,s34,1024
mm v[36:39],a[200:203],a[20:23],v[36:39]
mm v[40:43],a[200:203],a[24:27],v[40:43]
tr a[220:221],v197 offset:8192
mm v[44:47],a[200:203],a[28:31],v[44:47]
tr a[222:223],v197 offset:12288
mm v[48:51],a[204:207],a[16:19],v[48:51]
mm v[52:55],a[204:207],a[20:23],v[52:55]
s_waitcnt vmcnt(30)
mm v[56:59],a[204:207],a[24:27],v[56:59]
s_barrier
mm v[60:63],a[204:207],a[28:31],v[60:63]
s_add_u32 m0,s44,65536
s_waitcnt lgkmcnt(4)
mm v[64:67],a[208:211],a[16:19],v[64:67]
tr a[192:193],v190 offset:16384
bl v198,s[8:11],s40 offen offset:0 lds
mm v[68:71],a[208:211],a[20:23],v[68:71]
tr a[194:195],v190 offset:20480
mm v[72:75],a[208:211],a[24:27],v[72:75]
tr a[196:197],v191 offset:16384
mm v[76:79],a[208:211],a[28:31],v[76:79]
tr a[198:199],v191 offset:20480
mm v[80:83],a[212:215],a[16:19],v[80:83]
mm v[84:87],a[212:215],a[20:23],v[84:87]
mm v[88:91],a[212:215],a[24:27],v[88:91]
tr a[200:201],v192 offset:16384
mm v[92:95],a[212:215],a[28:31],v[92:95]
bl v199,s[8:11],s40 offen offset:1024 lds
s_waitcnt lgkmcnt(5)
mm v[96:99],a[216:219],a[16:19],v[96:99]
tr a[202:203],v192 offset:20480
mm v[100:103],a[216:219],a[20:23],v[100:103]
mm v[104:107],a[216:219],a[24:27],v[104:107]
tr a[204:205],v193 offset:16384
mm v[108:111],a[216:219],a[28:31],v[108:111]
tr a[206:207],v193 offset:20480
mm v[112:115],a[220:223],a[16:19],v[112:115]
mm v[116:119],a[220:223],a[20:23],v[116:119]
mm v[120:123],a[220:223],a[24:27],v[120:123]
tr a[208:209],v194 offset:16384
bl v200,s[8:11],s40 offen offset:2048 lds
mm v[124:127],a[220:223],a[28:31],v[124:127]
tr a[210:211],v194 offset:20480
s_waitcnt lgkmcnt(6)
mm v[0:3],a[192:195],a[32:35],v[0:3]
mm v[4:7],a[192:195],a[36:39],v[4:7]
mm v[8:11],a[192:195],a[40:43],v[8:11]
tr a[212:213],v195 offset:16384
mm v[12:15],a[192:195],a[44:47],v[12:15]
tr a[214:215],v195 offset:20480
mm v[16:19],a[196:199],a[32:35],v[16:19]
mm v[20:23],a[196:199],a[36:39],v[20:23]
bl v201,s[8:11],s40 offen offset:3072 lds
s_add_u32 s40,s40,16384
mm v[24:27],a[196:199],a[40:43],v[24:27]
tr a[216:217],v196 offset:16384
mm v[28:31],a[196:199],a[44:47],v[28:31]
tr a[218:219],v196 offset:20480
s_waitcnt lgkmcnt(6)
mm v[32:35],a[200:203],a[32:35],v[32:35]
mm v[36:39],a[200:203],a[36:39],v[36:39]
mm v[40:43],a[200:203],a[40:43],v[40:43]
tr a[220:221],v197 offset:16384
mm v[44:47],a[200:203],a[44:47],v[44:47]
tr a[222:223],v197 offset:20480
mm v[48:51],a[204:207],a[32:35],v[48:51]
mm v[52:55],a[204:207],a[36:39],v[52:55]
s_waitcnt vmcnt(28)
mm v[56:59],a[204:207],a[40:43],v[56:59]
s_barrier
mm v[60:63],a[204:207],a[44:47],v[60:63]
s_add_u32 m0,s44,147456
s_waitcnt lgkmcnt(4)
mm v[64:67],a[208:211],a[32:35],v[64:67]
tr a[192:193],v190 offset:24576
bl v202,s[12:15],s41 offen offset:0 lds
mm v[68:71],a[208:211],a[36:39],v[68:71]
tr a[194:195],v190 offset:28672
mm v[72:75],a[208:211],a[40:43],v[72:75]
tr a[196:197],v191 offset:24576
mm v[76:79],a[208:211],a[44:47],v[76:79]
tr a[198:199],v191 offset:28672
mm v[80:83],a[212:215],a[32:35],v[80:83]
mm v[84:87],a[212:215],a[36:39],v[84:87]
mm v[88:91],a[212:215],a[40:43],v[88:91]
tr a[200:201],v192 offset:24576
mm v[92:95],a[212:215],a[44:47],v[92:95]
bl v203,s[12:15],s41 offen offset:1024 lds
s_waitcnt lgkmcnt(5)
mm v[96:99],a[216:219],a[32:35],v[96:99]
tr a[202:203],v192 offset:28672
mm v[100:103],a[216:219],a[36:39],v[100:103]
mm v[104:107],a[216:219],a[40:43],v[104:107]
tr a[204:205],v193 offset:24576
mm v[108:111],a[216:219],a[44:47],v[108:111]
tr a[206:207],v193 offset:28672
mm v[112:115],a[220:223],a[32:35],v[112:115]
mm v[116:119],a[220:223],a[36:39],v[116:119]
mm v[120:123],a[220:223],a[40:43],v[120:123]
tr a[208:209],v194 offset:24576
bl v202,s[12:15],s41 offen offset:2048 lds
mm v[124:127],a[220:223],a[44:47],v[124:127]
tr a[210:211],v194 offset:28672
s_waitcnt lgkmcnt(6)
mm v[0:3],a[192:195],a[48:51],v[0:3]
mm v[4:7],a[192:195],a[52:55],v[4:7]
mm v[8:11],a[192:195],a[56:59],v[8:11]
tr a[212:213],v195 offset:24576
mm v[12:15],a[192:195],a[60:63],v[12:15]
tr a[214:215],v195 offset:28672
mm v[16:19],a[196:199],a[48:51],v[16:19]
mm v[20:23],a[196:199],a[52:55],v[20:23]
bl v203,s[12:15],s41 offen offset:3072 lds
s_add_u32 s41,s41,16384
mm v[24:27],a[196:199],a[56:59],v[24:27]
tr a[216:217],v196 offset:24576
mm v[28:31],a[196:199],a[60:63],v[28:31]
tr a[218:219],v196 offset:28672
s_waitcnt lgkmcnt(6)
mm v[32:35],a[200:203],a[48:51],v[32:35]
mm v[36:39],a[200:203],a[52:55],v[36:39]
mm v[40:43],a[200:203],a[56:59],v[40:43]
tr a[220:221],v197 offset:24576
mm v[44:47],a[200:203],a[60:63],v[44:47]
tr a[222:223],v197 offset:28672
mm v[48:51],a[204:207],a[48:51],v[48:51]
mm v[52:55],a[204:207],a[52:55],v[52:55]
s_waitcnt vmcnt(26)
mm v[56:59],a[204:207],a[56:59],v[56:59]
s_barrier
mm v[60:63],a[204:207],a[60:63],v[60:63]
s_add_u32 m0,s44,81920
s_waitcnt lgkmcnt(4)
mm v[64:67],a[208:211],a[48:51],v[64:67]
tr a[192:193],v190 offset:32768
bl v198,s[8:11],s40 offen offset:0 lds
mm v[68:71],a[208:211],a[52:55],v[68:71]
tr a[194:195],v190 offset:36864
mm v[72:75],a[208:211],a[56:59],v[72:75]
tr a[196:197],v191 offset:32768
mm v[76:79],a[208:211],a[60:63],v[76:79]
tr a[198:199],v191 offset:36864
mm v[80:83],a[212:215],a[48:51],v[80:83]
mm v[84:87],a[212:215],a[52:55],v[84:87]
mm v[88:91],a[212:215],a[56:59],v[88:91]
tr a[200:201],v192 offset:32768
mm v[92:95],a[212:215],a[60:63],v[92:95]
bl v199,s[8:11],s40 offen offset:1024 lds
s_waitcnt lgkmcnt(5)
mm v[96:99],a[216:219],a[48:51],v[96:99]
tr a[202:203],v192 offset:36864
mm v[100:103],a[216:219],a[52:55],v[100:103]
mm v[104:107],a[216:219],a[56:59],v[104:107]
tr a[204:205],v193 offset:32768
mm v[108:111],a[216:219],a[60:63],v[108:111]
tr a[206:207],v193 offset:36864
mm v[112:115],a[220:223],a[48:51],v[112:115]
mm v[116:119],a[220:223],a[52:55],v[116:119]
mm v[120:123],a[220:223],a[56:59],v[120:123]
tr a[208:209],v194 offset:32768
bl v200,s[8:11],s40 offen offset:2048 lds
mm v[124:127],a[220:223],a[60:63],v[124:127]
tr a[210:211],v194 offset:36864
s_waitcnt lgkmcnt(6)
mm v[0:3],a[192:195],a[64:67],v[0:3]
mm v[4:7],a[192:195],a[68:71],v[4:7]
mm v[8:11],a[192:195],a[72:75],v[8:11]
tr a[212:213],v195 offset:32768
mm v[12:15],a[192:195],a[76:79],v[12:15]
tr a[214:215],v195 offset:36864
mm v[16:19],a[196:199],a[64:67],v[16:19]
mm v[20:23],a[196:199],a[68:71],v[20:23]
bl v201,s[8:11],s40 offen offset:3072 lds
s_add_u32 s40,s40,16384
mm v[24:27],a[196:199],a[72:75],v[24:27]
tr a[216:217],v196 offset:32768
mm v[28:31],a[196:199],a[76:79],v[28:31]
tr a[218:219],v196 offset:36864
s_waitcnt lgkmcnt(6)
mm v[32:35],a[200:203],a[64:67],v[32:35]
mm v[36:39],a[200:203],a[68:71],v[36:39]
mm v[40:43],a[200:203],a[72:75],v[40:43]
tr a[220:221],v197 offset:32768
mm v[44:47],a[200:203],a[76:79],v[44:47]
tr a[222:223],v197 offset:36864
mm v[48:51],a[204:207],a[64:67],v[48:51]
mm v[52:55],a[204:207],a[68:71],v[52:55]
s_waitcnt vmcnt(24)
mm v[56:59],a[204:207],a[72:75],v[56:59]
s_barrier
mm v[60:63],a[204:207],a[76:79],v[60:63]
tr a[192:193],v190 offset:40960
s_waitcnt lgkmcnt(5)
mm v[64:67],a[208:211],a[64:67],v[64:67]
tr a[194:195],v190 offset:45056
mm v[68:71],a[208:211],a[68:71],v[68:71]
mm v[72:75],a[208:211],a[72:75],v[72:75]
tr a[196:197],v191 offset:40960
mm v[76:79],a[208:211],a[76:79],v[76:79]
tr a[198:199],v191 offset:45056
mm v[80:83],a[212:215],a[64:67],v[80:83]
mm v[84:87],a[212:215],a[68:71],v[84:87]
mm v[88:91],a[212:215],a[72:75],v[88:91]
tr a[200:201],v192 offset:40960
mm v[92:95],a[212:215],a[76:79],v[92:95]
tr a[202:203],v192 offset:45056
s_waitcnt lgkmcnt(6)
mm v[96:99],a[216:219],a[64:67],v[96:99]
mm v[100:103],a[216:219],a[68:71],v[100:103]
mm v[104:107],a[216:219],a[72:75],v[104:107]
tr a[204:205],v193 offset:40960
mm v[108:111],a[216:219],a[76:79],v[108:111]
tr a[206:207],v193 offset:45056
mm v[112:115],a[220:223],a[64:67],v[112:115]
mm v[116:119],a[220:223],a[68:71],v[116:119]
mm v[120:123],a[220:223],a[72:75],v[120:123]
tr a[208:209],v194 offset:40960
mm v[124:127],a[220:223],a[76:79],v[124:127]
tr a[210:211],v194 offset:45056
s_waitcnt lgkmcnt(6)
mm v[0:3],a[192:195],a[80:83],v[0:3]
mm v[4:7],a[192:195],a[84:87],v[4:7]
mm v[8:11],a[192:195],a[88:91],v[8:11]
tr a[212:213],v195 offset:40960
mm v[12:15],a[192:195],a[92:95],v[12:15]
tr a[214:215],v195 offset:45056
mm v[16:19],a[196:199],a[80:83],v[16:19]
mm v[20:23],a[196:199],a[84:87],v[20:23]
mm v[24:27],a[196:199],a[88:91],v[24:27]
tr a[216:217],v196 offset:40960
mm v[28:31],a[196:199],a[92:95],v[28:31]
tr a[218:219],v196 offset:45056
s_waitcnt lgkmcnt(6)
mm v[32:35],a[200:203],a[80:83],v[32:35]
mm v[36:39],a[200:203],a[84:87],v[36:39]
mm v[40:43],a[200:203],a[88:91],v[40:43]
tr a[220:221],v197 offset:40960
mm v[44:47],a[200:203],a[92:95],v[44:47]
tr a[222:223],v197 offset:45056
mm v[48:51],a[204:207],a[80:83],v[48:51]
mm v[52:55],a[204:207],a[84:87],v[52:55]
s_waitcnt vmcnt(18)
mm v[56:59],a[204:207],a[88:91],v[56:59]
s_barrier
mm v[60:63],a[204:207],a[92:95],v[60:63]
tr a[192:193],v190 offset:49152
s_waitcnt lgkmcnt(5)
mm v[64:67],a[208:211],a[80:83],v[64:67]
tr a[194:195],v190 offset:53248
mm v[68:71],a[208:211],a[84:87],v[68:71]
mm v[72:75],a[208:211],a[88:91],v[72:75]
tr a[196:197],v191 offset:49152
mm v[76:79],a[208:211],a[92:95],v[76:79]
tr a[198:199],v191 offset:53248
mm v[80:83],a[212:215],a[80:83],v[80:83]
mm v[84:87],a[212:215],a[84:87],v[84:87]
mm v[88:91],a[212:215],a[88:91],v[88:91]
tr a[200:201],v192 offset:49152
mm v[92:95],a[212:215],a[92:95],v[92:95]
tr a[202:203],v192 offset:53248
s_waitcnt lgkmcnt(6)
mm v[96:99],a[216:219],a[80:83],v[96:99]
mm v[100:103],a[216:219],a[84:87],v[100:103]
mm v[104:107],a[216:219],a[88:91],v[104:107]
tr a[204:205],v193 offset:49152
mm v[108:111],a[216:219],a[92:95],v[108:111]
tr a[206:207],v193 offset:53248
mm v[112:115],a[220:223],a[80:83],v[112:115]
mm v[116:119],a[220:223],a[84:87],v[116:119]
mm v[120:123],a[220:223],a[88:91],v[120:123]
tr a[208:209],v194 offset:49152
mm v[124:127],a[220:223],a[92:95],v[124:127]
tr a[210:211],v194 offset:53248
s_waitcnt lgkmcnt(6)
mm v[0:3],a[192:195],a[96:99],v[0:3]
mm v[4:7],a[192:195],a[100:103],v[4:7]
mm v[8:11],a[192:195],a[104:107],v[8:11]
tr a[212:213],v195 offset:49152
mm v[12:15],a[192:195],a[108:111],v[12:15]
tr a[214:215],v195 offset:53248
mm v[16:19],a[196:199],a[96:99],v[16:19]
mm v[20:23],a[196:199],a[100:103],v[20:23]
mm v[24:27],a[196:199],a[104:107],v[24:27]
tr a[216:217],v196 offset:49152
mm v[28:31],a[196:199],a[108:111],v[28:31]
tr a[218:219],v196 offset:53248
s_waitcnt lgkmcnt(6)
mm v[32:35],a[200:203],a[96:99],v[32:35]
mm v[36:39],a[200:203],a[100:103],v[36:39]
mm v[40:43],a[200:203],a[104:107],v[40:43]
tr a[220:221],v197 offset:49152
mm v[44:47],a[200:203],a[108:111],v[44:47]
tr a[222:223],v197 offset:53248
mm v[48:51],a[204:207],a[96:99],v[48:51]
mm v[52:55],a[204:207],a[100:103],v[52:55]
s_waitcnt vmcnt(12)
mm v[56:59],a[204:207],a[104:107],v[56:59]
s_barrier
mm v[60:63],a[204:207],a[108:111],v[60:63]
s_add_u32 m0,s44,32768
s_waitcnt lgkmcnt(4)
mm v[64:67],a[208:211],a[96:99],v[64:67]
tr a[192:193],v190 offset:57344
bl v198,s[8:11],s40 offen offset:0 lds
mm v[68:71],a[208:211],a[100:103],v[68:71]
tr a[194:195],v190 offset:61440
mm v[72:75],a[208:211],a[104:107],v[72:75]
tr a[196:197],v191 offset:57344
mm v[76:79],a[208:211],a[108:111],v[76:79]
tr a[198:199],v191 offset:61440
mm v[80:83],a[212:215],a[96:99],v[80:83]
mm v[84:87],a[212:215],a[100:103],v[84:87]
mm v[88:91],a[212:215],a[104:107],v[88:91]
tr a[200:201],v192 offset:57344
mm v[92:95],a[212:215],a[108:111],v[92:95]
bl v199,s[8:11],s40 offen offset:1024 lds
s_waitcnt lgkmcnt(5)
mm v[96:99],a[216:219],a[96:99],v[96:99]
tr a[202:203],v192 offset:61440
mm v[100:103],a[216:219],a[100:103],v[100:103]
mm v[104:107],a[216:219],a[104:107],v[104:107]
tr a[204:205],v193 offset:57344
mm v[108:111],a[216:219],a[108:111],v[108:111]
tr a[206:207],v193 offset:61440
mm v[112:115],a[220:223],a[96:99],v[112:115]
mm v[116:119],a[220:223],a[100:103],v[116:119]
mm v[120:123],a[220:223],a[104:107],v[120:123]
tr a[208:209],v194 offset:57344
bl v200,s[8:11],s40 offen offset:2048 lds
mm v[124:127],a[220:223],a[108:111],v[124:127]
tr a[210:211],v194 offset:61440
s_waitcnt lgkmcnt(6)
mm v[0:3],a[192:195],a[112:115],v[0:3]
mm v[4:7],a[192:195],a[116:119],v[4:7]
mm v[8:11],a[192:195],a[120:123],v[8:11]
tr a[212:213],v195 offset:57344
mm v[12:15],a[192:195],a[124:127],v[12:15]
tr a[214:215],v195 offset:61440
mm v[16:19],a[196:199],a[112:115],v[16:19]
mm v[20:23],a[196:199],a[116:119],v[20:23]
bl v201,s[8:11],s40 offen offset:3072 lds
s_add_u32 s40,s40,16384
mm v[24:27],a[196:199],a[120:123],v[24:27]
tr a[216:217],v196 offset:57344
mm v[28:31],a[196:199],a[124:127],v[28:31]
tr a[218:219],v196 offset:61440
s_waitcnt lgkmcnt(6)
mm v[32:35],a[200:203],a[112:115],v[32:35]
mm v[36:39],a[200:203],a[116:119],v[36:39]
mm v[40:43],a[200:203],a[120:123],v[40:43]
tr a[220:221],v197 offset:57344
mm v[44:47],a[200:203],a[124:127],v[44:47]
tr a[222:223],v197 offset:61440
mm v[48:51],a[204:207],a[112:115],v[48:51]
mm v[52:55],a[204:207],a[116:119],v[52:55]
mm v[56:59],a[204:207],a[120:123],v[56:59]
s_barrier
mm v[60:63],a[204:207],a[124:127],v[60:63]
s_add_u32 m0,s44,98304
s_waitcnt lgkmcnt(4)
mm v[64:67],a[208:211],a[112:115],v[64:67]
bl v202,s[12:15],s41 offen offset:0 lds
mm v[68:71],a[208:211],a[116:119],v[68:71]
mm v[72:75],a[208:211],a[120:123],v[72:75]
mm v[76:79],a[208:211],a[124:127],v[76:79]
mm v[80:83],a[212:215],a[112:115],v[80:83]
bl v203,s[12:15],s41 offen offset:1024 lds
mm v[84:87],a[212:215],a[116:119],v[84:87]
mm v[88:91],a[212:215],a[120:123],v[88:91]
mm v[92:95],a[212:215],a[124:127],v[92:95]
s_waitcnt lgkmcnt(0)
mm v[96:99],a[216:219],a[112:115],v[96:99]
bl v202,s[12:15],s41 offen offset:2048 lds
mm v[100:103],a[216:219],a[116:119],v[100:103]
mm v[104:107],a[216:219],a[120:123],v[104:107]
mm v[108:111],a[216:219],a[124:127],v[108:111]
mm v[112:115],a[220:223],a[112:115],v[112:115]
bl v203,s[12:15],s41 offen offset:3072 lds
s_add_u32 s41,s41,16384
mm v[116:119],a[220:223],a[116:119],v[116:119]
mm v[120:123],a[220:223],a[120:123],v[120:123]
mm v[124:127],a[220:223],a[124:127],v[124:127]
attn_mid:
s_waitcnt vmcnt(8)
s_barrier
s_add_u32 m0,s44,49152
s_nop 0
bl v198,s[8:11],s40 offen offset:0 lds
bl v199,s[8:11],s40 offen offset:1024 lds
bl v200,s[8:11],s40 offen offset:2048 lds
bl v201,s[8:11],s40 offen offset:3072 lds
s_add_u32 s40,s40,16384
s_add_u32 m0,s44,114688
s_nop 0
bl v202,s[12:15],s41 offen offset:0 lds
bl v203,s[12:15],s41 offen offset:1024 lds
bl v202,s[12:15],s41 offen offset:2048 lds
bl v203,s[12:15],s41 offen offset:3072 lds
s_add_u32 s41,s41,16384
ds_read_b128 a[192:195],v186 offset:32768
ds_read_b128 a[196:199],v187 offset:32768
ds_read_b128 a[200:203],v188 offset:32768
ds_read_b128 a[204:207],v189 offset:32768
ds_read_b128 a[208:211],v186 offset:36864
ds_read_b128 a[212:215],v187 offset:36864
ds_read_b128 a[216:219],v188 offset:36864
ds_read_b128 a[220:223],v189 offset:36864
v_mov_b32 v204,0x3e0293ee
v_pk_mul_f32 v[0:1],v[0:1],v[204:205] op_sel_hi:[1,0]
v_pk_mul_f32 v[2:3],v[2:3],v[204:205] op_sel_hi:[1,0]
v_pk_mul_f32 v[16:17],v[16:17],v[204:205] op_sel_hi:[1,0]
v_pk_mul_f32 v[18:19],v[18:19],v[204:205] op_sel_hi:[1,0]
cv v128,v0,v1
cv v129,v2,v3
cv v130,v16,v17
cv v131,v18,v19
v_pk_mul_f32 v[4:5],v[4:5],v[204:205] op_sel_hi:[1,0]
v_pk_mul_f32 v[6:7],v[6:7],v[204:205] op_sel_hi:[1,0]
v_pk_mul_f32 v[20:21],v[20:21],v[204:205] op_sel_hi:[1,0]
v_pk_mul_f32 v[22:23],v[22:23],v[204:205] op_sel_hi:[1,0]
cv v132,v4,v5
cv v133,v6,v7
cv v134,v20,v21
cv v135,v22,v23
v_pk_mul_f32 v[8:9],v[8:9],v[204:205] op_sel_hi:[1,0]
v_pk_mul_f32 v[10:11],v[10:11],v[204:205] op_sel_hi:[1,0]
v_pk_mul_f32 v[24:25],v[24:25],v[204:205] op_sel_hi:[1,0]
v_pk_mul_f32 v[26:27],v[26:27],v[204:205] op_sel_hi:[1,0]
cv v136,v8,v9
cv v137,v10,v11
cv v138,v24,v25
cv v139,v26,v27
v_pk_mul_f32 v[12:13],v[12:13],v[204:205] op_sel_hi:[1,0]
v_pk_mul_f32 v[14:15],v[14:15],v[204:205] op_sel_hi:[1,0]
v_pk_mul_f32 v[28:29],v[28:29],v[204:205] op_sel_hi:[1,0]
v_pk_mul_f32 v[30:31],v[30:31],v[204:205] op_sel_hi:[1,0]
cv v140,v12,v13
cv v141,v14,v15
cv v142,v28,v29
cv v143,v30,v31
v_permlane16_swap_b32 v128,v130
v_permlane16_swap_b32 v129,v131
v_permlane16_swap_b32 v132,v134
v_permlane16_swap_b32 v133,v135
v_permlane16_swap_b32 v136,v138
v_permlane16_swap_b32 v137,v139
v_permlane16_swap_b32 v140,v142
v_permlane16_swap_b32 v141,v143
aw a128,v128
aw a129,v129
aw a130,v130
aw a131,v131
aw a132,v132
aw a133,v133
aw a134,v134
aw a135,v135
aw a136,v136
aw a137,v137
aw a138,v138
aw a139,v139
aw a140,v140
aw a141,v141
aw a142,v142
aw a143,v143
v_pk_mul_f32 v[32:33],v[32:33],v[204:205] op_sel_hi:[1,0]
v_pk_mul_f32 v[34:35],v[34:35],v[204:205] op_sel_hi:[1,0]
v_pk_mul_f32 v[48:49],v[48:49],v[204:205] op_sel_hi:[1,0]
v_pk_mul_f32 v[50:51],v[50:51],v[204:205] op_sel_hi:[1,0]
cv v128,v32,v33
cv v129,v34,v35
cv v130,v48,v49
cv v131,v50,v51
v_pk_mul_f32 v[36:37],v[36:37],v[204:205] op_sel_hi:[1,0]
v_pk_mul_f32 v[38:39],v[38:39],v[204:205] op_sel_hi:[1,0]
v_pk_mul_f32 v[52:53],v[52:53],v[204:205] op_sel_hi:[1,0]
v_pk_mul_f32 v[54:55],v[54:55],v[204:205] op_sel_hi:[1,0]
cv v132,v36,v37
cv v133,v38,v39
cv v134,v52,v53
cv v135,v54,v55
v_pk_mul_f32 v[40:41],v[40:41],v[204:205] op_sel_hi:[1,0]
v_pk_mul_f32 v[42:43],v[42:43],v[204:205] op_sel_hi:[1,0]
v_pk_mul_f32 v[56:57],v[56:57],v[204:205] op_sel_hi:[1,0]
v_pk_mul_f32 v[58:59],v[58:59],v[204:205] op_sel_hi:[1,0]
cv v136,v40,v41
cv v137,v42,v43
cv v138,v56,v57
cv v139,v58,v59
v_pk_mul_f32 v[44:45],v[44:45],v[204:205] op_sel_hi:[1,0]
v_pk_mul_f32 v[46:47],v[46:47],v[204:205] op_sel_hi:[1,0]
v_pk_mul_f32 v[60:61],v[60:61],v[204:205] op_sel_hi:[1,0]
v_pk_mul_f32 v[62:63],v[62:63],v[204:205] op_sel_hi:[1,0]
cv v140,v44,v45
cv v141,v46,v47
cv v142,v60,v61
cv v143,v62,v63
v_permlane16_swap_b32 v128,v130
v_permlane16_swap_b32 v129,v131
v_permlane16_swap_b32 v132,v134
v_permlane16_swap_b32 v133,v135
v_permlane16_swap_b32 v136,v138
v_permlane16_swap_b32 v137,v139
v_permlane16_swap_b32 v140,v142
v_permlane16_swap_b32 v141,v143
aw a144,v128
aw a145,v129
aw a146,v130
aw a147,v131
aw a148,v132
aw a149,v133
aw a150,v134
aw a151,v135
aw a152,v136
aw a153,v137
aw a154,v138
aw a155,v139
aw a156,v140
aw a157,v141
aw a158,v142
aw a159,v143
v_pk_mul_f32 v[64:65],v[64:65],v[204:205] op_sel_hi:[1,0]
v_pk_mul_f32 v[66:67],v[66:67],v[204:205] op_sel_hi:[1,0]
v_pk_mul_f32 v[80:81],v[80:81],v[204:205] op_sel_hi:[1,0]
v_pk_mul_f32 v[82:83],v[82:83],v[204:205] op_sel_hi:[1,0]
cv v128,v64,v65
cv v129,v66,v67
cv v130,v80,v81
cv v131,v82,v83
v_pk_mul_f32 v[68:69],v[68:69],v[204:205] op_sel_hi:[1,0]
v_pk_mul_f32 v[70:71],v[70:71],v[204:205] op_sel_hi:[1,0]
v_pk_mul_f32 v[84:85],v[84:85],v[204:205] op_sel_hi:[1,0]
v_pk_mul_f32 v[86:87],v[86:87],v[204:205] op_sel_hi:[1,0]
cv v132,v68,v69
cv v133,v70,v71
cv v134,v84,v85
cv v135,v86,v87
v_pk_mul_f32 v[72:73],v[72:73],v[204:205] op_sel_hi:[1,0]
v_pk_mul_f32 v[74:75],v[74:75],v[204:205] op_sel_hi:[1,0]
v_pk_mul_f32 v[88:89],v[88:89],v[204:205] op_sel_hi:[1,0]
v_pk_mul_f32 v[90:91],v[90:91],v[204:205] op_sel_hi:[1,0]
cv v136,v72,v73
cv v137,v74,v75
cv v138,v88,v89
cv v139,v90,v91
v_pk_mul_f32 v[76:77],v[76:77],v[204:205] op_sel_hi:[1,0]
v_pk_mul_f32 v[78:79],v[78:79],v[204:205] op_sel_hi:[1,0]
v_pk_mul_f32 v[92:93],v[92:93],v[204:205] op_sel_hi:[1,0]
v_pk_mul_f32 v[94:95],v[94:95],v[204:205] op_sel_hi:[1,0]
cv v140,v76,v77
cv v141,v78,v79
cv v142,v92,v93
cv v143,v94,v95
v_permlane16_swap_b32 v128,v130
v_permlane16_swap_b32 v129,v131
v_permlane16_swap_b32 v132,v134
v_permlane16_swap_b32 v133,v135
v_permlane16_swap_b32 v136,v138
v_permlane16_swap_b32 v137,v139
v_permlane16_swap_b32 v140,v142
v_permlane16_swap_b32 v141,v143
aw a160,v128
aw a161,v129
aw a162,v130
aw a163,v131
aw a164,v132
aw a165,v133
aw a166,v134
aw a167,v135
aw a168,v136
aw a169,v137
aw a170,v138
aw a171,v139
aw a172,v140
aw a173,v141
aw a174,v142
aw a175,v143
v_pk_mul_f32 v[96:97],v[96:97],v[204:205] op_sel_hi:[1,0]
v_pk_mul_f32 v[98:99],v[98:99],v[204:205] op_sel_hi:[1,0]
v_pk_mul_f32 v[112:113],v[112:113],v[204:205] op_sel_hi:[1,0]
v_pk_mul_f32 v[114:115],v[114:115],v[204:205] op_sel_hi:[1,0]
cv v128,v96,v97
cv v129,v98,v99
cv v130,v112,v113
cv v131,v114,v115
v_pk_mul_f32 v[100:101],v[100:101],v[204:205] op_sel_hi:[1,0]
v_pk_mul_f32 v[102:103],v[102:103],v[204:205] op_sel_hi:[1,0]
v_pk_mul_f32 v[116:117],v[116:117],v[204:205] op_sel_hi:[1,0]
v_pk_mul_f32 v[118:119],v[118:119],v[204:205] op_sel_hi:[1,0]
cv v132,v100,v101
cv v133,v102,v103
cv v134,v116,v117
cv v135,v118,v119
v_pk_mul_f32 v[104:105],v[104:105],v[204:205] op_sel_hi:[1,0]
v_pk_mul_f32 v[106:107],v[106:107],v[204:205] op_sel_hi:[1,0]
v_pk_mul_f32 v[120:121],v[120:121],v[204:205] op_sel_hi:[1,0]
v_pk_mul_f32 v[122:123],v[122:123],v[204:205] op_sel_hi:[1,0]
cv v136,v104,v105
cv v137,v106,v107
cv v138,v120,v121
cv v139,v122,v123
v_pk_mul_f32 v[108:109],v[108:109],v[204:205] op_sel_hi:[1,0]
v_pk_mul_f32 v[110:111],v[110:111],v[204:205] op_sel_hi:[1,0]
v_pk_mul_f32 v[124:125],v[124:125],v[204:205] op_sel_hi:[1,0]
v_pk_mul_f32 v[126:127],v[126:127],v[204:205] op_sel_hi:[1,0]
cv v140,v108,v109
cv v141,v110,v111
cv v142,v124,v125
cv v143,v126,v127
v_permlane16_swap_b32 v128,v130
v_permlane16_swap_b32 v129,v131
v_permlane16_swap_b32 v132,v134
v_permlane16_swap_b32 v133,v135
v_permlane16_swap_b32 v136,v138
v_permlane16_swap_b32 v137,v139
v_permlane16_swap_b32 v140,v142
v_permlane16_swap_b32 v141,v143
aw a176,v128
aw a177,v129
aw a178,v130
aw a179,v131
aw a180,v132
aw a181,v133
aw a182,v134
aw a183,v135
aw a184,v136
aw a185,v137
aw a186,v138
aw a187,v139
aw a188,v140
aw a189,v141
aw a190,v142
aw a191,v143
v_add_u32 v190,98304,v190
v_add_u32 v191,98304,v191
v_add_u32 v192,98304,v192
v_add_u32 v193,98304,v193
v_add_u32 v194,98304,v194
v_add_u32 v195,98304,v195
v_add_u32 v196,98304,v196
v_add_u32 v197,98304,v197
s_waitcnt lgkmcnt(7)
mm v[0:3],a[192:195],a[128:131],0
aw a0,0
aw a1,0
mm v[4:7],a[192:195],a[132:135],0
aw a2,0
aw a3,0
mm v[8:11],a[192:195],a[136:139],0
aw a4,0
aw a5,0
mm v[12:15],a[192:195],a[140:143],0
aw a6,0
aw a7,0
ds_read_b128 a[192:195],v186 offset:40960
s_waitcnt lgkmcnt(7)
mm v[0:3],a[196:199],a[144:147],v[0:3]
aw a8,0
aw a9,0
mm v[4:7],a[196:199],a[148:151],v[4:7]
aw a10,0
aw a11,0
mm v[8:11],a[196:199],a[152:155],v[8:11]
aw a12,0
aw a13,0
mm v[12:15],a[196:199],a[156:159],v[12:15]
aw a14,0
aw a15,0
ds_read_b128 a[196:199],v187 offset:40960
s_waitcnt lgkmcnt(7)
mm v[0:3],a[200:203],a[160:163],v[0:3]
aw a16,0
aw a17,0
mm v[4:7],a[200:203],a[164:167],v[4:7]
aw a18,0
aw a19,0
mm v[8:11],a[200:203],a[168:171],v[8:11]
aw a20,0
aw a21,0
mm v[12:15],a[200:203],a[172:175],v[12:15]
aw a22,0
aw a23,0
ds_read_b128 a[200:203],v188 offset:40960
s_waitcnt lgkmcnt(7)
mm v[0:3],a[204:207],a[176:179],v[0:3]
aw a24,0
aw a25,0
mm v[4:7],a[204:207],a[180:183],v[4:7]
aw a26,0
aw a27,0
mm v[8:11],a[204:207],a[184:187],v[8:11]
aw a28,0
aw a29,0
mm v[12:15],a[204:207],a[188:191],v[12:15]
aw a30,0
aw a31,0
ds_read_b128 a[204:207],v189 offset:40960
s_waitcnt lgkmcnt(7)
mm v[16:19],a[208:211],a[128:131],0
aw a32,0
aw a33,0
mm v[20:23],a[208:211],a[132:135],0
aw a34,0
aw a35,0
mm v[24:27],a[208:211],a[136:139],0
aw a36,0
aw a37,0
mm v[28:31],a[208:211],a[140:143],0
aw a38,0
aw a39,0
ds_read_b128 a[208:211],v186 offset:45056
s_waitcnt lgkmcnt(7)
mm v[16:19],a[212:215],a[144:147],v[16:19]
aw a40,0
aw a41,0
mm v[20:23],a[212:215],a[148:151],v[20:23]
aw a42,0
aw a43,0
mm v[24:27],a[212:215],a[152:155],v[24:27]
aw a44,0
aw a45,0
mm v[28:31],a[212:215],a[156:159],v[28:31]
aw a46,0
aw a47,0
ds_read_b128 a[212:215],v187 offset:45056
s_waitcnt lgkmcnt(7)
mm v[16:19],a[216:219],a[160:163],v[16:19]
aw a48,0
aw a49,0
mm v[20:23],a[216:219],a[164:167],v[20:23]
aw a50,0
aw a51,0
mm v[24:27],a[216:219],a[168:171],v[24:27]
aw a52,0
aw a53,0
mm v[28:31],a[216:219],a[172:175],v[28:31]
aw a54,0
aw a55,0
ds_read_b128 a[216:219],v188 offset:45056
s_waitcnt lgkmcnt(7)
mm v[16:19],a[220:223],a[176:179],v[16:19]
aw a56,0
aw a57,0
mm v[20:23],a[220:223],a[180:183],v[20:23]
aw a58,0
aw a59,0
mm v[24:27],a[220:223],a[184:187],v[24:27]
aw a60,0
aw a61,0
mm v[28:31],a[220:223],a[188:191],v[28:31]
aw a62,0
aw a63,0
ds_read_b128 a[220:223],v189 offset:45056
s_waitcnt lgkmcnt(7)
mm v[32:35],a[192:195],a[128:131],0
aw a64,0
aw a65,0
mm v[36:39],a[192:195],a[132:135],0
aw a66,0
aw a67,0
mm v[40:43],a[192:195],a[136:139],0
aw a68,0
aw a69,0
mm v[44:47],a[192:195],a[140:143],0
aw a70,0
aw a71,0
ds_read_b128 a[192:195],v186 offset:49152
s_waitcnt lgkmcnt(7)
mm v[32:35],a[196:199],a[144:147],v[32:35]
aw a72,0
aw a73,0
mm v[36:39],a[196:199],a[148:151],v[36:39]
aw a74,0
aw a75,0
mm v[40:43],a[196:199],a[152:155],v[40:43]
aw a76,0
aw a77,0
mm v[44:47],a[196:199],a[156:159],v[44:47]
aw a78,0
aw a79,0
ds_read_b128 a[196:199],v187 offset:49152
s_waitcnt lgkmcnt(7)
mm v[32:35],a[200:203],a[160:163],v[32:35]
aw a80,0
aw a81,0
mm v[36:39],a[200:203],a[164:167],v[36:39]
aw a82,0
aw a83,0
mm v[40:43],a[200:203],a[168:171],v[40:43]
aw a84,0
aw a85,0
mm v[44:47],a[200:203],a[172:175],v[44:47]
aw a86,0
aw a87,0
ds_read_b128 a[200:203],v188 offset:49152
s_waitcnt lgkmcnt(7)
mm v[32:35],a[204:207],a[176:179],v[32:35]
aw a88,0
aw a89,0
mm v[36:39],a[204:207],a[180:183],v[36:39]
aw a90,0
aw a91,0
mm v[40:43],a[204:207],a[184:187],v[40:43]
aw a92,0
aw a93,0
mm v[44:47],a[204:207],a[188:191],v[44:47]
aw a94,0
aw a95,0
ds_read_b128 a[204:207],v189 offset:49152
s_waitcnt lgkmcnt(7)
mm v[48:51],a[208:211],a[128:131],0
aw a96,0
aw a97,0
mm v[52:55],a[208:211],a[132:135],0
aw a98,0
aw a99,0
mm v[56:59],a[208:211],a[136:139],0
aw a100,0
aw a101,0
mm v[60:63],a[208:211],a[140:143],0
aw a102,0
aw a103,0
ds_read_b128 a[208:211],v186 offset:53248
s_waitcnt lgkmcnt(7)
mm v[48:51],a[212:215],a[144:147],v[48:51]
aw a104,0
aw a105,0
mm v[52:55],a[212:215],a[148:151],v[52:55]
aw a106,0
aw a107,0
mm v[56:59],a[212:215],a[152:155],v[56:59]
aw a108,0
aw a109,0
mm v[60:63],a[212:215],a[156:159],v[60:63]
aw a110,0
aw a111,0
s_waitcnt lgkmcnt(6)
mm v[48:51],a[216:219],a[160:163],v[48:51]
aw a112,0
aw a113,0
mm v[52:55],a[216:219],a[164:167],v[52:55]
aw a114,0
aw a115,0
mm v[56:59],a[216:219],a[168:171],v[56:59]
aw a116,0
aw a117,0
mm v[60:63],a[216:219],a[172:175],v[60:63]
aw a118,0
aw a119,0
s_waitcnt lgkmcnt(5)
mm v[48:51],a[220:223],a[176:179],v[48:51]
aw a120,0
aw a121,0
mm v[52:55],a[220:223],a[180:183],v[52:55]
aw a122,0
aw a123,0
mm v[56:59],a[220:223],a[184:187],v[56:59]
aw a124,0
aw a125,0
mm v[60:63],a[220:223],a[188:191],v[60:63]
aw a126,0
aw a127,0
v_max3_f32 v212,v0,v1,v2
v_max3_f32 v212,v3,v16,v212
v_max3_f32 v212,v17,v18,v212
v_max3_f32 v212,v19,v32,v212
v_max3_f32 v212,v33,v34,v212
v_max3_f32 v212,v35,v48,v212
v_max3_f32 v212,v49,v50,v212
v_max_f32 v212,v51,v212
v_max3_f32 v213,v4,v5,v6
v_max3_f32 v213,v7,v20,v213
v_max3_f32 v213,v21,v22,v213
v_max3_f32 v213,v23,v36,v213
v_max3_f32 v213,v37,v38,v213
v_max3_f32 v213,v39,v52,v213
v_max3_f32 v213,v53,v54,v213
v_max_f32 v213,v55,v213
v_max3_f32 v214,v8,v9,v10
v_max3_f32 v214,v11,v24,v214
v_max3_f32 v214,v25,v26,v214
v_max3_f32 v214,v27,v40,v214
v_max3_f32 v214,v41,v42,v214
v_max3_f32 v214,v43,v56,v214
v_max3_f32 v214,v57,v58,v214
v_max_f32 v214,v59,v214
v_max3_f32 v215,v12,v13,v14
v_max3_f32 v215,v15,v28,v215
v_max3_f32 v215,v29,v30,v215
v_max3_f32 v215,v31,v44,v215
v_max3_f32 v215,v45,v46,v215
v_max3_f32 v215,v47,v60,v215
v_max3_f32 v215,v61,v62,v215
v_max_f32 v215,v63,v215
v_mov_b32 v216,v212
v_mov_b32 v217,v213
v_mov_b32 v218,v214
v_mov_b32 v219,v215
v_permlane16_swap_b32 v216,v212
v_permlane16_swap_b32 v217,v213
v_permlane16_swap_b32 v218,v214
v_permlane16_swap_b32 v219,v215
v_max_f32 v212,v212,v216
v_max_f32 v213,v213,v217
v_max_f32 v214,v214,v218
v_max_f32 v215,v215,v219
v_mov_b32 v216,v212
v_mov_b32 v217,v213
v_mov_b32 v218,v214
v_mov_b32 v219,v215
v_permlane32_swap_b32 v216,v212
v_permlane32_swap_b32 v217,v213
v_permlane32_swap_b32 v218,v214
v_permlane32_swap_b32 v219,v215
v_max_f32 v212,v212,v216
v_max_f32 v213,v213,v217
v_max_f32 v214,v214,v218
v_max_f32 v215,v215,v219
v_add_f32 v212,0x42b40000,v212
v_add_f32 v213,0x42b40000,v213
v_add_f32 v214,0x42b40000,v214
v_add_f32 v215,0x42b40000,v215
v_sub_f32 v160,0,v212
v_sub_f32 v161,0,v212
v_sub_f32 v162,0,v212
v_sub_f32 v163,0,v212
v_pk_add_f32 v[0:1],v[0:1],v[160:161]
v_pk_add_f32 v[2:3],v[2:3],v[160:161]
v_pk_add_f32 v[16:17],v[16:17],v[160:161]
v_pk_add_f32 v[18:19],v[18:19],v[160:161]
v_pk_add_f32 v[32:33],v[32:33],v[160:161]
v_pk_add_f32 v[34:35],v[34:35],v[160:161]
v_pk_add_f32 v[48:49],v[48:49],v[160:161]
v_pk_add_f32 v[50:51],v[50:51],v[160:161]
v_sub_f32 v164,0,v213
v_sub_f32 v165,0,v213
v_sub_f32 v166,0,v213
v_sub_f32 v167,0,v213
v_pk_add_f32 v[4:5],v[4:5],v[164:165]
v_pk_add_f32 v[6:7],v[6:7],v[164:165]
v_pk_add_f32 v[20:21],v[20:21],v[164:165]
v_pk_add_f32 v[22:23],v[22:23],v[164:165]
v_pk_add_f32 v[36:37],v[36:37],v[164:165]
v_pk_add_f32 v[38:39],v[38:39],v[164:165]
v_pk_add_f32 v[52:53],v[52:53],v[164:165]
v_pk_add_f32 v[54:55],v[54:55],v[164:165]
v_sub_f32 v168,0,v214
v_sub_f32 v169,0,v214
v_sub_f32 v170,0,v214
v_sub_f32 v171,0,v214
v_pk_add_f32 v[8:9],v[8:9],v[168:169]
v_pk_add_f32 v[10:11],v[10:11],v[168:169]
v_pk_add_f32 v[24:25],v[24:25],v[168:169]
v_pk_add_f32 v[26:27],v[26:27],v[168:169]
v_pk_add_f32 v[40:41],v[40:41],v[168:169]
v_pk_add_f32 v[42:43],v[42:43],v[168:169]
v_pk_add_f32 v[56:57],v[56:57],v[168:169]
v_pk_add_f32 v[58:59],v[58:59],v[168:169]
v_sub_f32 v172,0,v215
v_sub_f32 v173,0,v215
v_sub_f32 v174,0,v215
v_sub_f32 v175,0,v215
v_pk_add_f32 v[12:13],v[12:13],v[172:173]
v_pk_add_f32 v[14:15],v[14:15],v[172:173]
v_pk_add_f32 v[28:29],v[28:29],v[172:173]
v_pk_add_f32 v[30:31],v[30:31],v[172:173]
v_pk_add_f32 v[44:45],v[44:45],v[172:173]
v_pk_add_f32 v[46:47],v[46:47],v[172:173]
v_pk_add_f32 v[60:61],v[60:61],v[172:173]
v_pk_add_f32 v[62:63],v[62:63],v[172:173]
v_exp_f32 v176,v0
v_exp_f32 v177,v1
s_nop 0
cv v128,v176,v177
v_exp_f32 v178,v2
v_exp_f32 v179,v3
s_nop 0
cv v129,v178,v179
v_exp_f32 v180,v16
v_exp_f32 v181,v17
s_nop 0
cv v130,v180,v181
v_or3_b32 v184,v128,v129,v130
v_exp_f32 v182,v18
v_exp_f32 v183,v19
s_nop 0
cv v131,v182,v183
v_exp_f32 v176,v4
v_exp_f32 v177,v5
s_nop 0
cv v132,v176,v177
v_or3_b32 v184,v131,v132,v184
v_exp_f32 v178,v6
v_exp_f32 v179,v7
s_nop 0
cv v133,v178,v179
v_exp_f32 v180,v20
v_exp_f32 v181,v21
s_nop 0
cv v134,v180,v181
v_or3_b32 v184,v133,v134,v184
v_exp_f32 v182,v22
v_exp_f32 v183,v23
s_nop 0
cv v135,v182,v183
s_waitcnt vmcnt(12)
s_barrier
s_mov_b32 s3,7
s_mov_b32 s47,4096
attn_loop:
s_waitcnt lgkmcnt(3)
mm v[64:67],a[192:195],a[128:131],v[160:163]
v_exp_f32 v176,v8
mm v[64:67],a[196:199],a[144:147],v[64:67]
v_exp_f32 v177,v9
mm v[68:71],a[192:195],a[132:135],v[164:167]
ds_read_b128 a[212:215],v187 offset:53248
s_add_u32 m0,s44,65536
mm v[68:71],a[196:199],a[148:151],v[68:71]
bl v198,s[8:11],s40 offen offset:0 lds
cv v136,v176,v177
mm v[72:75],a[192:195],a[136:139],v[168:171]
v_exp_f32 v178,v10
mm v[72:75],a[196:199],a[152:155],v[72:75]
v_exp_f32 v179,v11
mm v[76:79],a[192:195],a[140:143],v[172:175]
ds_read_b128 a[216:219],v188 offset:53248
v_or3_b32 v184,v135,v136,v184
mm v[76:79],a[196:199],a[156:159],v[76:79]
cv v137,v178,v179
s_waitcnt lgkmcnt(3)
mm v[64:67],a[200:203],a[160:163],v[64:67]
v_exp_f32 v180,v24
mm v[64:67],a[204:207],a[176:179],v[64:67]
v_exp_f32 v181,v25
mm v[68:71],a[200:203],a[164:167],v[68:71]
ds_read_b128 a[220:223],v189 offset:53248
cv v138,v180,v181
mm v[68:71],a[204:207],a[180:183],v[68:71]
v_exp_f32 v182,v26
mm v[72:75],a[200:203],a[168:171],v[72:75]
v_exp_f32 v183,v27
mm v[72:75],a[204:207],a[184:187],v[72:75]
ds_read_b128 a[192:195],v186 offset:57344
v_or3_b32 v184,v137,v138,v184
mm v[76:79],a[200:203],a[172:175],v[76:79]
bl v199,s[8:11],s40 offen offset:1024 lds
cv v139,v182,v183
mm v[76:79],a[204:207],a[188:191],v[76:79]
ds_read_b128 a[196:199],v187 offset:57344
s_waitcnt lgkmcnt(4)
mm v[80:83],a[208:211],a[128:131],v[160:163]
v_exp_f32 v176,v12
mm v[80:83],a[212:215],a[144:147],v[80:83]
v_exp_f32 v177,v13
mm v[84:87],a[208:211],a[132:135],v[164:167]
v_exp_f32 v178,v14
mm v[84:87],a[212:215],a[148:151],v[84:87]
ds_read_b128 a[200:203],v188 offset:57344
cv v140,v176,v177
mm v[88:91],a[208:211],a[136:139],v[168:171]
v_exp_f32 v179,v15
mm v[88:91],a[212:215],a[152:155],v[88:91]
v_exp_f32 v180,v28
mm v[92:95],a[208:211],a[140:143],v[172:175]
v_or3_b32 v184,v139,v140,v184
cv v141,v178,v179
mm v[92:95],a[212:215],a[156:159],v[92:95]
ds_read_b128 a[204:207],v189 offset:57344
s_waitcnt lgkmcnt(4)
mm v[80:83],a[216:219],a[160:163],v[80:83]
v_exp_f32 v181,v29
mm v[80:83],a[220:223],a[176:179],v[80:83]
bl v200,s[8:11],s40 offen offset:2048 lds
cv v142,v180,v181
mm v[84:87],a[216:219],a[164:167],v[84:87]
v_exp_f32 v182,v30
mm v[84:87],a[220:223],a[180:183],v[84:87]
v_exp_f32 v183,v31
mm v[88:91],a[216:219],a[168:171],v[88:91]
ds_read_b128 a[208:211],v186 offset:61440
v_or3_b32 v184,v141,v142,v184
mm v[88:91],a[220:223],a[184:187],v[88:91]
v_exp_f32 v176,v32
mm v[92:95],a[216:219],a[172:175],v[92:95]
ds_read_b128 a[212:215],v187 offset:61440
cv v143,v182,v183
mm v[92:95],a[220:223],a[188:191],v[92:95]
v_bitop3_b32 v184,v184,v143,s45 bitop3:0xa8
s_waitcnt lgkmcnt(4)
mm v[96:99],a[192:195],a[128:131],v[160:163]
v_exp_f32 v177,v33
mm v[96:99],a[196:199],a[144:147],v[96:99]
v_exp_f32 v178,v34
mm v[100:103],a[192:195],a[132:135],v[164:167]
ds_read_b128 a[216:219],v188 offset:61440
cv v144,v176,v177
mm v[100:103],a[196:199],a[148:151],v[100:103]
v_exp_f32 v179,v35
mm v[104:107],a[192:195],a[136:139],v[168:171]
bl v201,s[8:11],s40 offen offset:3072 lds
cv v145,v178,v179
mm v[104:107],a[196:199],a[152:155],v[104:107]
v_exp_f32 v180,v48
mm v[108:111],a[192:195],a[140:143],v[172:175]
v_exp_f32 v181,v49
mm v[108:111],a[196:199],a[156:159],v[108:111]
ds_read_b128 a[220:223],v189 offset:61440
s_waitcnt lgkmcnt(4)
mm v[96:99],a[200:203],a[160:163],v[96:99]
v_exp_f32 v182,v50
mm v[96:99],a[204:207],a[176:179],v[96:99]
cv v146,v180,v181
v_or3_b32 v185,v144,v145,v146
mm v[100:103],a[200:203],a[164:167],v[100:103]
v_exp_f32 v183,v51
mm v[100:103],a[204:207],a[180:183],v[100:103]
v_exp_f32 v176,v36
mm v[104:107],a[200:203],a[168:171],v[104:107]
tr a[192:193],v190 offset:49152
s_add_u32 s40,s40,16384
mm v[104:107],a[204:207],a[184:187],v[104:107]
tr a[194:195],v190 offset:53248
s_add_u32 m0,s44,131072
mm v[108:111],a[200:203],a[172:175],v[108:111]
tr a[196:197],v191 offset:49152
cv v147,v182,v183
mm v[108:111],a[204:207],a[188:191],v[108:111]
bl v202,s[12:15],s41 offen offset:0 lds
s_waitcnt lgkmcnt(5)
mm v[112:115],a[208:211],a[128:131],v[160:163]
v_exp_f32 v177,v37
mm v[112:115],a[212:215],a[144:147],v[112:115]
v_exp_f32 v178,v38
mm v[116:119],a[208:211],a[132:135],v[164:167]
tr a[198:199],v191 offset:53248
cv v148,v176,v177
mm v[116:119],a[212:215],a[148:151],v[116:119]
v_exp_f32 v179,v39
mm v[120:123],a[208:211],a[136:139],v[168:171]
v_exp_f32 v180,v52
mm v[120:123],a[212:215],a[152:155],v[120:123]
tr a[200:201],v192 offset:49152
v_or3_b32 v185,v147,v148,v185
mm v[124:127],a[208:211],a[140:143],v[172:175]
tr a[202:203],v192 offset:53248
cv v149,v178,v179
mm v[124:127],a[212:215],a[156:159],v[124:127]
tr a[204:205],v193 offset:49152
s_waitcnt lgkmcnt(7)
mm v[112:115],a[216:219],a[160:163],v[112:115]
v_exp_f32 v181,v53
mm v[112:115],a[220:223],a[176:179],v[112:115]
v_exp_f32 v182,v54
mm v[116:119],a[216:219],a[164:167],v[116:119]
tr a[206:207],v193 offset:53248
cv v150,v180,v181
mm v[116:119],a[220:223],a[180:183],v[116:119]
bl v203,s[12:15],s41 offen offset:1024 lds
v_or3_b32 v185,v149,v150,v185
mm v[120:123],a[216:219],a[168:171],v[120:123]
v_exp_f32 v183,v55
mm v[120:123],a[220:223],a[184:187],v[120:123]
v_exp_f32 v176,v40
mm v[124:127],a[216:219],a[172:175],v[124:127]
cv v151,v182,v183
v_cmp_ne_u32 vcc,0,v184
mm v[124:127],a[220:223],a[188:191],v[124:127]
tr a[208:209],v194 offset:49152
s_cbranch_vccnz attn_stub_loop0_0
attn_back_loop0_0:
mm a[224:227],a[240:243],v[128:131],a[224:227]
tr a[210:211],v194 offset:53248
v_exp_f32 v177,v41
mm a[228:231],a[240:243],v[132:135],a[228:231]
v_exp_f32 v178,v42
mm a[232:235],a[240:243],v[136:139],a[232:235]
cv v152,v176,v177
v_or3_b32 v185,v151,v152,v185
mm a[236:239],a[240:243],v[140:143],a[236:239]
tr a[212:213],v195 offset:49152
s_waitcnt lgkmcnt(7)
mm a[0:3],a[192:195],v[128:131],a[0:3]
v_exp_f32 v179,v43
mm a[4:7],a[192:195],v[132:135],a[4:7]
v_exp_f32 v180,v56
mm a[8:11],a[192:195],v[136:139],a[8:11]
bl v202,s[12:15],s41 offen offset:2048 lds
cv v153,v178,v179
mm a[12:15],a[192:195],v[140:143],a[12:15]
v_exp_f32 v181,v57
mm a[16:19],a[196:199],v[128:131],a[16:19]
tr a[214:215],v195 offset:53248
cv v154,v180,v181
mm a[20:23],a[196:199],v[132:135],a[20:23]
v_exp_f32 v182,v58
mm a[24:27],a[196:199],v[136:139],a[24:27]
v_exp_f32 v183,v59
mm a[28:31],a[196:199],v[140:143],a[28:31]
tr a[216:217],v196 offset:49152
s_waitcnt lgkmcnt(5)
mm a[32:35],a[200:203],v[128:131],a[32:35]
tr a[218:219],v196 offset:53248
v_or3_b32 v185,v153,v154,v185
mm a[36:39],a[200:203],v[132:135],a[36:39]
v_exp_f32 v176,v44
mm a[40:43],a[200:203],v[136:139],a[40:43]
tr a[220:221],v197 offset:49152
cv v155,v182,v183
mm a[44:47],a[200:203],v[140:143],a[44:47]
v_exp_f32 v177,v45
mm a[48:51],a[204:207],v[128:131],a[48:51]
tr a[222:223],v197 offset:53248
bl v203,s[12:15],s41 offen offset:3072 lds
mm a[52:55],a[204:207],v[132:135],a[52:55]
v_exp_f32 v178,v46
mm a[56:59],a[204:207],v[136:139],a[56:59]
tr a[192:193],v190 offset:57344
cv v156,v176,v177
mm a[60:63],a[204:207],v[140:143],a[60:63]
tr a[194:195],v190 offset:61440
s_waitcnt lgkmcnt(6)
mm a[64:67],a[208:211],v[128:131],a[64:67]
v_exp_f32 v179,v47
mm a[68:71],a[208:211],v[132:135],a[68:71]
v_exp_f32 v180,v60
mm a[72:75],a[208:211],v[136:139],a[72:75]
v_or3_b32 v185,v155,v156,v185
cv v157,v178,v179
mm a[76:79],a[208:211],v[140:143],a[76:79]
v_exp_f32 v181,v61
mm a[80:83],a[212:215],v[128:131],a[80:83]
tr a[196:197],v191 offset:57344
tr a[198:199],v191 offset:61440
mm a[84:87],a[212:215],v[132:135],a[84:87]
v_exp_f32 v182,v62
mm a[88:91],a[212:215],v[136:139],a[88:91]
tr a[200:201],v192 offset:57344
cv v158,v180,v181
mm a[92:95],a[212:215],v[140:143],a[92:95]
tr a[202:203],v192 offset:61440
s_waitcnt lgkmcnt(6)
mm a[96:99],a[216:219],v[128:131],a[96:99]
s_add_u32 s41,s41,16384
v_exp_f32 v183,v63
mm a[100:103],a[216:219],v[132:135],a[100:103]
buffer_load_dword v231,v230,s[48:51],s46 offen
v_or3_b32 v185,v157,v158,v185
mm a[104:107],a[216:219],v[136:139],a[104:107]
tr a[204:205],v193 offset:57344
cv v159,v182,v183
mm a[108:111],a[216:219],v[140:143],a[108:111]
tr a[206:207],v193 offset:61440
v_bitop3_b32 v185,v185,v159,s45 bitop3:0xa8
mm a[112:115],a[220:223],v[128:131],a[112:115]
tr a[208:209],v194 offset:57344
mm a[116:119],a[220:223],v[132:135],a[116:119]
tr a[210:211],v194 offset:61440
mm a[120:123],a[220:223],v[136:139],a[120:123]
v_cmp_ne_u32 vcc,0,v185
mm a[124:127],a[220:223],v[140:143],a[124:127]
s_cbranch_vccnz attn_stub_loop0_1
attn_back_loop0_1:
mm a[224:227],a[240:243],v[144:147],a[224:227]
v_exp_f32 v176,v64
mm a[228:231],a[240:243],v[148:151],a[228:231]
v_exp_f32 v177,v65
mm a[232:235],a[240:243],v[152:155],a[232:235]
v_exp_f32 v178,v66
mm a[236:239],a[240:243],v[156:159],a[236:239]
cv v128,v176,v177
s_waitcnt lgkmcnt(6)
mm a[0:3],a[192:195],v[144:147],a[0:3]
v_exp_f32 v179,v67
mm a[4:7],a[192:195],v[148:151],a[4:7]
tr a[212:213],v195 offset:57344
cv v129,v178,v179
mm a[8:11],a[192:195],v[152:155],a[8:11]
v_exp_f32 v180,v80
mm a[12:15],a[192:195],v[156:159],a[12:15]
v_exp_f32 v181,v81
mm a[16:19],a[196:199],v[144:147],a[16:19]
tr a[214:215],v195 offset:61440
cv v130,v180,v181
mm a[20:23],a[196:199],v[148:151],a[20:23]
tr a[216:217],v196 offset:57344
v_or3_b32 v184,v128,v129,v130
mm a[24:27],a[196:199],v[152:155],a[24:27]
v_exp_f32 v182,v82
mm a[28:31],a[196:199],v[156:159],a[28:31]
tr a[218:219],v196 offset:61440
s_waitcnt lgkmcnt(6)
mm a[32:35],a[200:203],v[144:147],a[32:35]
v_exp_f32 v183,v83
mm a[36:39],a[200:203],v[148:151],a[36:39]
tr a[220:221],v197 offset:57344
cv v131,v182,v183
mm a[40:43],a[200:203],v[152:155],a[40:43]
v_exp_f32 v176,v68
mm a[44:47],a[200:203],v[156:159],a[44:47]
v_exp_f32 v177,v69
mm a[48:51],a[204:207],v[144:147],a[48:51]
tr a[222:223],v197 offset:61440
cv v132,v176,v177
mm a[52:55],a[204:207],v[148:151],a[52:55]
ds_read_b128 a[192:195],v186 offset:0
v_or3_b32 v184,v131,v132,v184
mm a[56:59],a[204:207],v[152:155],a[56:59]
v_exp_f32 v178,v70
mm a[60:63],a[204:207],v[156:159],a[60:63]
ds_read_b128 a[196:199],v187 offset:0
s_waitcnt lgkmcnt(6)
mm a[64:67],a[208:211],v[144:147],a[64:67]
v_exp_f32 v179,v71
mm a[68:71],a[208:211],v[148:151],a[68:71]
v_exp_f32 v180,v84
mm a[72:75],a[208:211],v[152:155],a[72:75]
ds_read_b128 a[200:203],v188 offset:0
cv v133,v178,v179
mm a[76:79],a[208:211],v[156:159],a[76:79]
v_exp_f32 v181,v85
mm a[80:83],a[212:215],v[144:147],a[80:83]
v_exp_f32 v182,v86
mm a[84:87],a[212:215],v[148:151],a[84:87]
ds_read_b128 a[204:207],v189 offset:0
cv v134,v180,v181
mm a[88:91],a[212:215],v[152:155],a[88:91]
v_exp_f32 v183,v87
mm a[92:95],a[212:215],v[156:159],a[92:95]
v_or3_b32 v184,v133,v134,v184
s_waitcnt lgkmcnt(4)
mm a[96:99],a[216:219],v[144:147],a[96:99]
ds_read_b128 a[208:211],v186 offset:4096
cv v135,v182,v183
mm a[100:103],a[216:219],v[148:151],a[100:103]
mm a[104:107],a[216:219],v[152:155],a[104:107]
mm a[108:111],a[216:219],v[156:159],a[108:111]
mm a[112:115],a[220:223],v[144:147],a[112:115]
s_waitcnt vmcnt(12)
mm a[116:119],a[220:223],v[148:151],a[116:119]
s_barrier
mm a[120:123],a[220:223],v[152:155],a[120:123]
mm a[124:127],a[220:223],v[156:159],a[124:127]
s_waitcnt lgkmcnt(3)
mm v[0:3],a[192:195],a[128:131],v[160:163]
v_exp_f32 v176,v72
mm v[0:3],a[196:199],a[144:147],v[0:3]
v_exp_f32 v177,v73
mm v[4:7],a[192:195],a[132:135],v[164:167]
ds_read_b128 a[212:215],v187 offset:4096
s_add_u32 m0,s44,81920
mm v[4:7],a[196:199],a[148:151],v[4:7]
bl v198,s[8:11],s40 offen offset:0 lds
cv v136,v176,v177
mm v[8:11],a[192:195],a[136:139],v[168:171]
v_exp_f32 v178,v74
mm v[8:11],a[196:199],a[152:155],v[8:11]
v_exp_f32 v179,v75
mm v[12:15],a[192:195],a[140:143],v[172:175]
ds_read_b128 a[216:219],v188 offset:4096
v_or3_b32 v184,v135,v136,v184
mm v[12:15],a[196:199],a[156:159],v[12:15]
cv v137,v178,v179
s_waitcnt lgkmcnt(3)
mm v[0:3],a[200:203],a[160:163],v[0:3]
v_exp_f32 v180,v88
mm v[0:3],a[204:207],a[176:179],v[0:3]
v_exp_f32 v181,v89
mm v[4:7],a[200:203],a[164:167],v[4:7]
ds_read_b128 a[220:223],v189 offset:4096
cv v138,v180,v181
mm v[4:7],a[204:207],a[180:183],v[4:7]
v_exp_f32 v182,v90
mm v[8:11],a[200:203],a[168:171],v[8:11]
v_exp_f32 v183,v91
mm v[8:11],a[204:207],a[184:187],v[8:11]
ds_read_b128 a[192:195],v186 offset:8192
v_or3_b32 v184,v137,v138,v184
mm v[12:15],a[200:203],a[172:175],v[12:15]
bl v199,s[8:11],s40 offen offset:1024 lds
cv v139,v182,v183
mm v[12:15],a[204:207],a[188:191],v[12:15]
ds_read_b128 a[196:199],v187 offset:8192
s_waitcnt lgkmcnt(4)
mm v[16:19],a[208:211],a[128:131],v[160:163]
v_exp_f32 v176,v76
mm v[16:19],a[212:215],a[144:147],v[16:19]
v_exp_f32 v177,v77
mm v[20:23],a[208:211],a[132:135],v[164:167]
v_exp_f32 v178,v78
mm v[20:23],a[212:215],a[148:151],v[20:23]
ds_read_b128 a[200:203],v188 offset:8192
cv v140,v176,v177
mm v[24:27],a[208:211],a[136:139],v[168:171]
v_exp_f32 v179,v79
mm v[24:27],a[212:215],a[152:155],v[24:27]
v_exp_f32 v180,v92
mm v[28:31],a[208:211],a[140:143],v[172:175]
v_or3_b32 v184,v139,v140,v184
cv v141,v178,v179
mm v[28:31],a[212:215],a[156:159],v[28:31]
ds_read_b128 a[204:207],v189 offset:8192
s_waitcnt lgkmcnt(4)
mm v[16:19],a[216:219],a[160:163],v[16:19]
v_exp_f32 v181,v93
mm v[16:19],a[220:223],a[176:179],v[16:19]
bl v200,s[8:11],s40 offen offset:2048 lds
cv v142,v180,v181
mm v[20:23],a[216:219],a[164:167],v[20:23]
v_exp_f32 v182,v94
mm v[20:23],a[220:223],a[180:183],v[20:23]
v_exp_f32 v183,v95
mm v[24:27],a[216:219],a[168:171],v[24:27]
ds_read_b128 a[208:211],v186 offset:12288
v_or3_b32 v184,v141,v142,v184
mm v[24:27],a[220:223],a[184:187],v[24:27]
v_exp_f32 v176,v96
mm v[28:31],a[216:219],a[172:175],v[28:31]
ds_read_b128 a[212:215],v187 offset:12288
cv v143,v182,v183
mm v[28:31],a[220:223],a[188:191],v[28:31]
v_bitop3_b32 v184,v184,v143,s45 bitop3:0xa8
s_waitcnt lgkmcnt(4)
mm v[32:35],a[192:195],a[128:131],v[160:163]
v_exp_f32 v177,v97
mm v[32:35],a[196:199],a[144:147],v[32:35]
v_exp_f32 v178,v98
mm v[36:39],a[192:195],a[132:135],v[164:167]
ds_read_b128 a[216:219],v188 offset:12288
cv v144,v176,v177
mm v[36:39],a[196:199],a[148:151],v[36:39]
v_exp_f32 v179,v99
mm v[40:43],a[192:195],a[136:139],v[168:171]
bl v201,s[8:11],s40 offen offset:3072 lds
cv v145,v178,v179
mm v[40:43],a[196:199],a[152:155],v[40:43]
v_exp_f32 v180,v112
mm v[44:47],a[192:195],a[140:143],v[172:175]
v_exp_f32 v181,v113
mm v[44:47],a[196:199],a[156:159],v[44:47]
ds_read_b128 a[220:223],v189 offset:12288
s_waitcnt lgkmcnt(4)
mm v[32:35],a[200:203],a[160:163],v[32:35]
v_exp_f32 v182,v114
mm v[32:35],a[204:207],a[176:179],v[32:35]
cv v146,v180,v181
v_or3_b32 v185,v144,v145,v146
mm v[36:39],a[200:203],a[164:167],v[36:39]
v_exp_f32 v183,v115
mm v[36:39],a[204:207],a[180:183],v[36:39]
v_exp_f32 v176,v100
mm v[40:43],a[200:203],a[168:171],v[40:43]
tr a[192:193],v190 offset:0
s_add_u32 s40,s40,16384
mm v[40:43],a[204:207],a[184:187],v[40:43]
tr a[194:195],v190 offset:4096
s_add_u32 m0,s44,147456
mm v[44:47],a[200:203],a[172:175],v[44:47]
tr a[196:197],v191 offset:0
cv v147,v182,v183
mm v[44:47],a[204:207],a[188:191],v[44:47]
bl v202,s[12:15],s41 offen offset:0 lds
s_waitcnt lgkmcnt(5)
mm v[48:51],a[208:211],a[128:131],v[160:163]
v_exp_f32 v177,v101
mm v[48:51],a[212:215],a[144:147],v[48:51]
v_exp_f32 v178,v102
mm v[52:55],a[208:211],a[132:135],v[164:167]
tr a[198:199],v191 offset:4096
cv v148,v176,v177
mm v[52:55],a[212:215],a[148:151],v[52:55]
v_exp_f32 v179,v103
mm v[56:59],a[208:211],a[136:139],v[168:171]
v_exp_f32 v180,v116
mm v[56:59],a[212:215],a[152:155],v[56:59]
tr a[200:201],v192 offset:0
v_or3_b32 v185,v147,v148,v185
mm v[60:63],a[208:211],a[140:143],v[172:175]
tr a[202:203],v192 offset:4096
cv v149,v178,v179
mm v[60:63],a[212:215],a[156:159],v[60:63]
tr a[204:205],v193 offset:0
s_waitcnt lgkmcnt(7)
mm v[48:51],a[216:219],a[160:163],v[48:51]
v_exp_f32 v181,v117
mm v[48:51],a[220:223],a[176:179],v[48:51]
v_exp_f32 v182,v118
mm v[52:55],a[216:219],a[164:167],v[52:55]
tr a[206:207],v193 offset:4096
cv v150,v180,v181
mm v[52:55],a[220:223],a[180:183],v[52:55]
bl v203,s[12:15],s41 offen offset:1024 lds
v_or3_b32 v185,v149,v150,v185
mm v[56:59],a[216:219],a[168:171],v[56:59]
v_exp_f32 v183,v119
mm v[56:59],a[220:223],a[184:187],v[56:59]
v_exp_f32 v176,v104
mm v[60:63],a[216:219],a[172:175],v[60:63]
cv v151,v182,v183
v_cmp_ne_u32 vcc,0,v184
mm v[60:63],a[220:223],a[188:191],v[60:63]
tr a[208:209],v194 offset:0
s_cbranch_vccnz attn_stub_loop1_0
attn_back_loop1_0:
mm a[224:227],a[240:243],v[128:131],a[224:227]
tr a[210:211],v194 offset:4096
v_exp_f32 v177,v105
mm a[228:231],a[240:243],v[132:135],a[228:231]
v_exp_f32 v178,v106
mm a[232:235],a[240:243],v[136:139],a[232:235]
cv v152,v176,v177
v_or3_b32 v185,v151,v152,v185
mm a[236:239],a[240:243],v[140:143],a[236:239]
tr a[212:213],v195 offset:0
s_waitcnt lgkmcnt(7)
mm a[0:3],a[192:195],v[128:131],a[0:3]
v_exp_f32 v179,v107
mm a[4:7],a[192:195],v[132:135],a[4:7]
v_exp_f32 v180,v120
mm a[8:11],a[192:195],v[136:139],a[8:11]
bl v202,s[12:15],s41 offen offset:2048 lds
cv v153,v178,v179
mm a[12:15],a[192:195],v[140:143],a[12:15]
v_exp_f32 v181,v121
mm a[16:19],a[196:199],v[128:131],a[16:19]
tr a[214:215],v195 offset:4096
cv v154,v180,v181
mm a[20:23],a[196:199],v[132:135],a[20:23]
v_exp_f32 v182,v122
mm a[24:27],a[196:199],v[136:139],a[24:27]
v_exp_f32 v183,v123
mm a[28:31],a[196:199],v[140:143],a[28:31]
tr a[216:217],v196 offset:0
s_waitcnt lgkmcnt(5)
mm a[32:35],a[200:203],v[128:131],a[32:35]
tr a[218:219],v196 offset:4096
v_or3_b32 v185,v153,v154,v185
mm a[36:39],a[200:203],v[132:135],a[36:39]
v_exp_f32 v176,v108
mm a[40:43],a[200:203],v[136:139],a[40:43]
tr a[220:221],v197 offset:0
cv v155,v182,v183
mm a[44:47],a[200:203],v[140:143],a[44:47]
v_exp_f32 v177,v109
mm a[48:51],a[204:207],v[128:131],a[48:51]
tr a[222:223],v197 offset:4096
bl v203,s[12:15],s41 offen offset:3072 lds
mm a[52:55],a[204:207],v[132:135],a[52:55]
v_exp_f32 v178,v110
mm a[56:59],a[204:207],v[136:139],a[56:59]
tr a[192:193],v190 offset:8192
cv v156,v176,v177
mm a[60:63],a[204:207],v[140:143],a[60:63]
tr a[194:195],v190 offset:12288
s_waitcnt lgkmcnt(6)
mm a[64:67],a[208:211],v[128:131],a[64:67]
v_exp_f32 v179,v111
mm a[68:71],a[208:211],v[132:135],a[68:71]
v_exp_f32 v180,v124
mm a[72:75],a[208:211],v[136:139],a[72:75]
v_or3_b32 v185,v155,v156,v185
cv v157,v178,v179
mm a[76:79],a[208:211],v[140:143],a[76:79]
v_exp_f32 v181,v125
mm a[80:83],a[212:215],v[128:131],a[80:83]
tr a[196:197],v191 offset:8192
tr a[198:199],v191 offset:12288
mm a[84:87],a[212:215],v[132:135],a[84:87]
v_exp_f32 v182,v126
mm a[88:91],a[212:215],v[136:139],a[88:91]
tr a[200:201],v192 offset:8192
cv v158,v180,v181
mm a[92:95],a[212:215],v[140:143],a[92:95]
tr a[202:203],v192 offset:12288
s_waitcnt lgkmcnt(6)
mm a[96:99],a[216:219],v[128:131],a[96:99]
s_add_u32 s41,s41,16384
v_exp_f32 v183,v127
mm a[100:103],a[216:219],v[132:135],a[100:103]
buffer_load_dword v232,v230,s[52:55],s46 offen
v_or3_b32 v185,v157,v158,v185
mm a[104:107],a[216:219],v[136:139],a[104:107]
tr a[204:205],v193 offset:8192
cv v159,v182,v183
mm a[108:111],a[216:219],v[140:143],a[108:111]
tr a[206:207],v193 offset:12288
v_bitop3_b32 v185,v185,v159,s45 bitop3:0xa8
mm a[112:115],a[220:223],v[128:131],a[112:115]
tr a[208:209],v194 offset:8192
s_mov_b32 m0,s43
mm a[116:119],a[220:223],v[132:135],a[116:119]
tr a[210:211],v194 offset:12288
mm a[120:123],a[220:223],v[136:139],a[120:123]
v_cmp_ne_u32 vcc,0,v185
mm a[124:127],a[220:223],v[140:143],a[124:127]
s_cbranch_vccnz attn_stub_loop1_1
attn_back_loop1_1:
mm a[224:227],a[240:243],v[144:147],a[224:227]
v_exp_f32 v176,v0
mm a[228:231],a[240:243],v[148:151],a[228:231]
v_exp_f32 v177,v1
mm a[232:235],a[240:243],v[152:155],a[232:235]
bl v241,s[68:71],s39 offen lds
cv v128,v176,v177
mm a[236:239],a[240:243],v[156:159],a[236:239]
tr a[212:213],v195 offset:8192
s_waitcnt lgkmcnt(7)
mm a[0:3],a[192:195],v[144:147],a[0:3]
v_exp_f32 v178,v2
mm a[4:7],a[192:195],v[148:151],a[4:7]
v_exp_f32 v179,v3
mm a[8:11],a[192:195],v[152:155],a[8:11]
tr a[214:215],v195 offset:12288
cv v129,v178,v179
mm a[12:15],a[192:195],v[156:159],a[12:15]
v_exp_f32 v180,v16
mm a[16:19],a[196:199],v[144:147],a[16:19]
v_exp_f32 v181,v17
mm a[20:23],a[196:199],v[148:151],a[20:23]
tr a[216:217],v196 offset:8192
s_add_u32 s43,s43,1024
mm a[24:27],a[196:199],v[152:155],a[24:27]
tr a[218:219],v196 offset:12288
s_add_u32 s39,s39,393216
mm a[28:31],a[196:199],v[156:159],a[28:31]
cv v130,v180,v181
s_waitcnt lgkmcnt(6)
mm a[32:35],a[200:203],v[144:147],a[32:35]
v_exp_f32 v182,v18
mm a[36:39],a[200:203],v[148:151],a[36:39]
v_exp_f32 v183,v19
mm a[40:43],a[200:203],v[152:155],a[40:43]
tr a[220:221],v197 offset:8192
v_or3_b32 v184,v128,v129,v130
mm a[44:47],a[200:203],v[156:159],a[44:47]
tr a[222:223],v197 offset:12288
cv v131,v182,v183
mm a[48:51],a[204:207],v[144:147],a[48:51]
v_exp_f32 v176,v4
mm a[52:55],a[204:207],v[148:151],a[52:55]
v_exp_f32 v177,v5
mm a[56:59],a[204:207],v[152:155],a[56:59]
ds_read_b128 a[192:195],v186 offset:16384
cv v132,v176,v177
mm a[60:63],a[204:207],v[156:159],a[60:63]
ds_read_b128 a[196:199],v187 offset:16384
s_waitcnt lgkmcnt(6)
mm a[64:67],a[208:211],v[144:147],a[64:67]
v_exp_f32 v178,v6
mm a[68:71],a[208:211],v[148:151],a[68:71]
v_exp_f32 v179,v7
mm a[72:75],a[208:211],v[152:155],a[72:75]
v_exp_f32 v180,v20
mm a[76:79],a[208:211],v[156:159],a[76:79]
v_or3_b32 v184,v131,v132,v184
cv v133,v178,v179
mm a[80:83],a[212:215],v[144:147],a[80:83]
v_exp_f32 v181,v21
mm a[84:87],a[212:215],v[148:151],a[84:87]
ds_read_b128 a[200:203],v188 offset:16384
cv v134,v180,v181
mm a[88:91],a[212:215],v[152:155],a[88:91]
v_exp_f32 v182,v22
mm a[92:95],a[212:215],v[156:159],a[92:95]
ds_read_b128 a[204:207],v189 offset:16384
s_waitcnt lgkmcnt(4)
mm a[96:99],a[216:219],v[144:147],a[96:99]
v_exp_f32 v183,v23
mm a[100:103],a[216:219],v[148:151],a[100:103]
v_or3_b32 v184,v133,v134,v184
cv v135,v182,v183
mm a[104:107],a[216:219],v[152:155],a[104:107]
ds_read_b128 a[208:211],v186 offset:20480
mm a[108:111],a[216:219],v[156:159],a[108:111]
mm a[112:115],a[220:223],v[144:147],a[112:115]
s_waitcnt vmcnt(12)
mm a[116:119],a[220:223],v[148:151],a[116:119]
s_barrier
mm a[120:123],a[220:223],v[152:155],a[120:123]
mm a[124:127],a[220:223],v[156:159],a[124:127]
s_waitcnt lgkmcnt(3)
mm v[64:67],a[192:195],a[128:131],v[160:163]
v_exp_f32 v176,v8
mm v[64:67],a[196:199],a[144:147],v[64:67]
v_exp_f32 v177,v9
mm v[68:71],a[192:195],a[132:135],v[164:167]
ds_read_b128 a[212:215],v187 offset:20480
s_add_u32 m0,s44,32768
mm v[68:71],a[196:199],a[148:151],v[68:71]
bl v198,s[8:11],s40 offen offset:0 lds
cv v136,v176,v177
mm v[72:75],a[192:195],a[136:139],v[168:171]
v_exp_f32 v178,v10
mm v[72:75],a[196:199],a[152:155],v[72:75]
v_exp_f32 v179,v11
mm v[76:79],a[192:195],a[140:143],v[172:175]
ds_read_b128 a[216:219],v188 offset:20480
v_or3_b32 v184,v135,v136,v184
mm v[76:79],a[196:199],a[156:159],v[76:79]
cv v137,v178,v179
s_waitcnt lgkmcnt(3)
mm v[64:67],a[200:203],a[160:163],v[64:67]
v_exp_f32 v180,v24
mm v[64:67],a[204:207],a[176:179],v[64:67]
v_exp_f32 v181,v25
mm v[68:71],a[200:203],a[164:167],v[68:71]
ds_read_b128 a[220:223],v189 offset:20480
cv v138,v180,v181
mm v[68:71],a[204:207],a[180:183],v[68:71]
v_exp_f32 v182,v26
mm v[72:75],a[200:203],a[168:171],v[72:75]
v_exp_f32 v183,v27
mm v[72:75],a[204:207],a[184:187],v[72:75]
ds_read_b128 a[192:195],v186 offset:24576
v_or3_b32 v184,v137,v138,v184
mm v[76:79],a[200:203],a[172:175],v[76:79]
bl v199,s[8:11],s40 offen offset:1024 lds
cv v139,v182,v183
mm v[76:79],a[204:207],a[188:191],v[76:79]
ds_read_b128 a[196:199],v187 offset:24576
s_waitcnt lgkmcnt(4)
mm v[80:83],a[208:211],a[128:131],v[160:163]
v_exp_f32 v176,v12
mm v[80:83],a[212:215],a[144:147],v[80:83]
v_exp_f32 v177,v13
mm v[84:87],a[208:211],a[132:135],v[164:167]
v_exp_f32 v178,v14
mm v[84:87],a[212:215],a[148:151],v[84:87]
ds_read_b128 a[200:203],v188 offset:24576
cv v140,v176,v177
mm v[88:91],a[208:211],a[136:139],v[168:171]
v_exp_f32 v179,v15
mm v[88:91],a[212:215],a[152:155],v[88:91]
v_exp_f32 v180,v28
mm v[92:95],a[208:211],a[140:143],v[172:175]
v_or3_b32 v184,v139,v140,v184
cv v141,v178,v179
mm v[92:95],a[212:215],a[156:159],v[92:95]
ds_read_b128 a[204:207],v189 offset:24576
s_waitcnt lgkmcnt(4)
mm v[80:83],a[216:219],a[160:163],v[80:83]
v_exp_f32 v181,v29
mm v[80:83],a[220:223],a[176:179],v[80:83]
bl v200,s[8:11],s40 offen offset:2048 lds
cv v142,v180,v181
mm v[84:87],a[216:219],a[164:167],v[84:87]
v_exp_f32 v182,v30
mm v[84:87],a[220:223],a[180:183],v[84:87]
v_exp_f32 v183,v31
mm v[88:91],a[216:219],a[168:171],v[88:91]
ds_read_b128 a[208:211],v186 offset:28672
v_or3_b32 v184,v141,v142,v184
mm v[88:91],a[220:223],a[184:187],v[88:91]
v_exp_f32 v176,v32
mm v[92:95],a[216:219],a[172:175],v[92:95]
ds_read_b128 a[212:215],v187 offset:28672
cv v143,v182,v183
mm v[92:95],a[220:223],a[188:191],v[92:95]
v_bitop3_b32 v184,v184,v143,s45 bitop3:0xa8
s_waitcnt lgkmcnt(4)
mm v[96:99],a[192:195],a[128:131],v[160:163]
v_exp_f32 v177,v33
mm v[96:99],a[196:199],a[144:147],v[96:99]
v_exp_f32 v178,v34
mm v[100:103],a[192:195],a[132:135],v[164:167]
ds_read_b128 a[216:219],v188 offset:28672
cv v144,v176,v177
mm v[100:103],a[196:199],a[148:151],v[100:103]
v_exp_f32 v179,v35
mm v[104:107],a[192:195],a[136:139],v[168:171]
bl v201,s[8:11],s40 offen offset:3072 lds
cv v145,v178,v179
mm v[104:107],a[196:199],a[152:155],v[104:107]
v_exp_f32 v180,v48
mm v[108:111],a[192:195],a[140:143],v[172:175]
v_exp_f32 v181,v49
mm v[108:111],a[196:199],a[156:159],v[108:111]
ds_read_b128 a[220:223],v189 offset:28672
s_waitcnt lgkmcnt(4)
mm v[96:99],a[200:203],a[160:163],v[96:99]
v_exp_f32 v182,v50
mm v[96:99],a[204:207],a[176:179],v[96:99]
cv v146,v180,v181
v_or3_b32 v185,v144,v145,v146
mm v[100:103],a[200:203],a[164:167],v[100:103]
v_exp_f32 v183,v51
mm v[100:103],a[204:207],a[180:183],v[100:103]
v_exp_f32 v176,v36
mm v[104:107],a[200:203],a[168:171],v[104:107]
tr a[192:193],v190 offset:16384
s_add_u32 s40,s40,16384
mm v[104:107],a[204:207],a[184:187],v[104:107]
tr a[194:195],v190 offset:20480
s_add_u32 m0,s44,98304
mm v[108:111],a[200:203],a[172:175],v[108:111]
tr a[196:197],v191 offset:16384
cv v147,v182,v183
mm v[108:111],a[204:207],a[188:191],v[108:111]
bl v202,s[12:15],s41 offen offset:0 lds
s_waitcnt lgkmcnt(5)
mm v[112:115],a[208:211],a[128:131],v[160:163]
v_exp_f32 v177,v37
mm v[112:115],a[212:215],a[144:147],v[112:115]
v_exp_f32 v178,v38
mm v[116:119],a[208:211],a[132:135],v[164:167]
tr a[198:199],v191 offset:20480
cv v148,v176,v177
mm v[116:119],a[212:215],a[148:151],v[116:119]
v_exp_f32 v179,v39
mm v[120:123],a[208:211],a[136:139],v[168:171]
v_exp_f32 v180,v52
mm v[120:123],a[212:215],a[152:155],v[120:123]
tr a[200:201],v192 offset:16384
v_or3_b32 v185,v147,v148,v185
mm v[124:127],a[208:211],a[140:143],v[172:175]
tr a[202:203],v192 offset:20480
cv v149,v178,v179
mm v[124:127],a[212:215],a[156:159],v[124:127]
tr a[204:205],v193 offset:16384
s_waitcnt lgkmcnt(7)
mm v[112:115],a[216:219],a[160:163],v[112:115]
v_exp_f32 v181,v53
mm v[112:115],a[220:223],a[176:179],v[112:115]
v_exp_f32 v182,v54
mm v[116:119],a[216:219],a[164:167],v[116:119]
tr a[206:207],v193 offset:20480
cv v150,v180,v181
mm v[116:119],a[220:223],a[180:183],v[116:119]
bl v203,s[12:15],s41 offen offset:1024 lds
v_or3_b32 v185,v149,v150,v185
mm v[120:123],a[216:219],a[168:171],v[120:123]
v_exp_f32 v183,v55
mm v[120:123],a[220:223],a[184:187],v[120:123]
v_exp_f32 v176,v40
mm v[124:127],a[216:219],a[172:175],v[124:127]
cv v151,v182,v183
v_cmp_ne_u32 vcc,0,v184
mm v[124:127],a[220:223],a[188:191],v[124:127]
tr a[208:209],v194 offset:16384
s_cbranch_vccnz attn_stub_loop2_0
attn_back_loop2_0:
mm a[224:227],a[240:243],v[128:131],a[224:227]
tr a[210:211],v194 offset:20480
v_exp_f32 v177,v41
mm a[228:231],a[240:243],v[132:135],a[228:231]
v_exp_f32 v178,v42
mm a[232:235],a[240:243],v[136:139],a[232:235]
cv v152,v176,v177
v_or3_b32 v185,v151,v152,v185
mm a[236:239],a[240:243],v[140:143],a[236:239]
tr a[212:213],v195 offset:16384
s_waitcnt lgkmcnt(7)
mm a[0:3],a[192:195],v[128:131],a[0:3]
v_exp_f32 v179,v43
mm a[4:7],a[192:195],v[132:135],a[4:7]
v_exp_f32 v180,v56
mm a[8:11],a[192:195],v[136:139],a[8:11]
bl v202,s[12:15],s41 offen offset:2048 lds
cv v153,v178,v179
mm a[12:15],a[192:195],v[140:143],a[12:15]
v_exp_f32 v181,v57
mm a[16:19],a[196:199],v[128:131],a[16:19]
tr a[214:215],v195 offset:20480
cv v154,v180,v181
mm a[20:23],a[196:199],v[132:135],a[20:23]
v_exp_f32 v182,v58
mm a[24:27],a[196:199],v[136:139],a[24:27]
v_exp_f32 v183,v59
mm a[28:31],a[196:199],v[140:143],a[28:31]
tr a[216:217],v196 offset:16384
s_waitcnt lgkmcnt(5)
mm a[32:35],a[200:203],v[128:131],a[32:35]
tr a[218:219],v196 offset:20480
v_or3_b32 v185,v153,v154,v185
mm a[36:39],a[200:203],v[132:135],a[36:39]
v_exp_f32 v176,v44
mm a[40:43],a[200:203],v[136:139],a[40:43]
tr a[220:221],v197 offset:16384
cv v155,v182,v183
mm a[44:47],a[200:203],v[140:143],a[44:47]
v_exp_f32 v177,v45
mm a[48:51],a[204:207],v[128:131],a[48:51]
tr a[222:223],v197 offset:20480
bl v203,s[12:15],s41 offen offset:3072 lds
mm a[52:55],a[204:207],v[132:135],a[52:55]
v_exp_f32 v178,v46
mm a[56:59],a[204:207],v[136:139],a[56:59]
tr a[192:193],v190 offset:24576
cv v156,v176,v177
mm a[60:63],a[204:207],v[140:143],a[60:63]
tr a[194:195],v190 offset:28672
s_waitcnt lgkmcnt(6)
mm a[64:67],a[208:211],v[128:131],a[64:67]
v_exp_f32 v179,v47
mm a[68:71],a[208:211],v[132:135],a[68:71]
v_exp_f32 v180,v60
mm a[72:75],a[208:211],v[136:139],a[72:75]
v_or3_b32 v185,v155,v156,v185
cv v157,v178,v179
mm a[76:79],a[208:211],v[140:143],a[76:79]
v_exp_f32 v181,v61
mm a[80:83],a[212:215],v[128:131],a[80:83]
tr a[196:197],v191 offset:24576
tr a[198:199],v191 offset:28672
mm a[84:87],a[212:215],v[132:135],a[84:87]
v_exp_f32 v182,v62
mm a[88:91],a[212:215],v[136:139],a[88:91]
tr a[200:201],v192 offset:24576
cv v158,v180,v181
mm a[92:95],a[212:215],v[140:143],a[92:95]
tr a[202:203],v192 offset:28672
s_waitcnt lgkmcnt(6)
mm a[96:99],a[216:219],v[128:131],a[96:99]
s_add_u32 s41,s41,16384
v_exp_f32 v183,v63
mm a[100:103],a[216:219],v[132:135],a[100:103]
buffer_load_dword v233,v230,s[56:59],s46 offen
v_or3_b32 v185,v157,v158,v185
mm a[104:107],a[216:219],v[136:139],a[104:107]
tr a[204:205],v193 offset:24576
cv v159,v182,v183
mm a[108:111],a[216:219],v[140:143],a[108:111]
tr a[206:207],v193 offset:28672
v_bitop3_b32 v185,v185,v159,s45 bitop3:0xa8
mm a[112:115],a[220:223],v[128:131],a[112:115]
tr a[208:209],v194 offset:24576
mm a[116:119],a[220:223],v[132:135],a[116:119]
tr a[210:211],v194 offset:28672
mm a[120:123],a[220:223],v[136:139],a[120:123]
v_cmp_ne_u32 vcc,0,v185
mm a[124:127],a[220:223],v[140:143],a[124:127]
s_cbranch_vccnz attn_stub_loop2_1
attn_back_loop2_1:
mm a[224:227],a[240:243],v[144:147],a[224:227]
v_exp_f32 v176,v64
mm a[228:231],a[240:243],v[148:151],a[228:231]
v_exp_f32 v177,v65
mm a[232:235],a[240:243],v[152:155],a[232:235]
v_exp_f32 v178,v66
mm a[236:239],a[240:243],v[156:159],a[236:239]
cv v128,v176,v177
s_waitcnt lgkmcnt(6)
mm a[0:3],a[192:195],v[144:147],a[0:3]
v_exp_f32 v179,v67
mm a[4:7],a[192:195],v[148:151],a[4:7]
tr a[212:213],v195 offset:24576
cv v129,v178,v179
mm a[8:11],a[192:195],v[152:155],a[8:11]
v_exp_f32 v180,v80
mm a[12:15],a[192:195],v[156:159],a[12:15]
v_exp_f32 v181,v81
mm a[16:19],a[196:199],v[144:147],a[16:19]
tr a[214:215],v195 offset:28672
cv v130,v180,v181
mm a[20:23],a[196:199],v[148:151],a[20:23]
tr a[216:217],v196 offset:24576
v_or3_b32 v184,v128,v129,v130
mm a[24:27],a[196:199],v[152:155],a[24:27]
v_exp_f32 v182,v82
mm a[28:31],a[196:199],v[156:159],a[28:31]
tr a[218:219],v196 offset:28672
s_waitcnt lgkmcnt(6)
mm a[32:35],a[200:203],v[144:147],a[32:35]
v_exp_f32 v183,v83
mm a[36:39],a[200:203],v[148:151],a[36:39]
tr a[220:221],v197 offset:24576
cv v131,v182,v183
mm a[40:43],a[200:203],v[152:155],a[40:43]
v_exp_f32 v176,v68
mm a[44:47],a[200:203],v[156:159],a[44:47]
v_exp_f32 v177,v69
mm a[48:51],a[204:207],v[144:147],a[48:51]
tr a[222:223],v197 offset:28672
cv v132,v176,v177
mm a[52:55],a[204:207],v[148:151],a[52:55]
ds_read_b128 a[192:195],v186 offset:32768
v_or3_b32 v184,v131,v132,v184
mm a[56:59],a[204:207],v[152:155],a[56:59]
v_exp_f32 v178,v70
mm a[60:63],a[204:207],v[156:159],a[60:63]
ds_read_b128 a[196:199],v187 offset:32768
s_waitcnt lgkmcnt(6)
mm a[64:67],a[208:211],v[144:147],a[64:67]
v_exp_f32 v179,v71
mm a[68:71],a[208:211],v[148:151],a[68:71]
v_exp_f32 v180,v84
mm a[72:75],a[208:211],v[152:155],a[72:75]
ds_read_b128 a[200:203],v188 offset:32768
cv v133,v178,v179
mm a[76:79],a[208:211],v[156:159],a[76:79]
v_exp_f32 v181,v85
mm a[80:83],a[212:215],v[144:147],a[80:83]
v_exp_f32 v182,v86
mm a[84:87],a[212:215],v[148:151],a[84:87]
ds_read_b128 a[204:207],v189 offset:32768
cv v134,v180,v181
mm a[88:91],a[212:215],v[152:155],a[88:91]
v_exp_f32 v183,v87
mm a[92:95],a[212:215],v[156:159],a[92:95]
v_or3_b32 v184,v133,v134,v184
s_waitcnt lgkmcnt(4)
mm a[96:99],a[216:219],v[144:147],a[96:99]
ds_read_b128 a[208:211],v186 offset:36864
cv v135,v182,v183
mm a[100:103],a[216:219],v[148:151],a[100:103]
mm a[104:107],a[216:219],v[152:155],a[104:107]
mm a[108:111],a[216:219],v[156:159],a[108:111]
mm a[112:115],a[220:223],v[144:147],a[112:115]
s_waitcnt vmcnt(12)
mm a[116:119],a[220:223],v[148:151],a[116:119]
s_barrier
mm a[120:123],a[220:223],v[152:155],a[120:123]
mm a[124:127],a[220:223],v[156:159],a[124:127]
s_waitcnt lgkmcnt(3)
mm v[0:3],a[192:195],a[128:131],v[160:163]
v_exp_f32 v176,v72
mm v[0:3],a[196:199],a[144:147],v[0:3]
v_exp_f32 v177,v73
mm v[4:7],a[192:195],a[132:135],v[164:167]
ds_read_b128 a[212:215],v187 offset:36864
s_add_u32 m0,s44,49152
mm v[4:7],a[196:199],a[148:151],v[4:7]
bl v198,s[8:11],s40 offen offset:0 lds
cv v136,v176,v177
mm v[8:11],a[192:195],a[136:139],v[168:171]
v_exp_f32 v178,v74
mm v[8:11],a[196:199],a[152:155],v[8:11]
v_exp_f32 v179,v75
mm v[12:15],a[192:195],a[140:143],v[172:175]
ds_read_b128 a[216:219],v188 offset:36864
v_or3_b32 v184,v135,v136,v184
mm v[12:15],a[196:199],a[156:159],v[12:15]
cv v137,v178,v179
s_waitcnt lgkmcnt(3)
mm v[0:3],a[200:203],a[160:163],v[0:3]
v_exp_f32 v180,v88
mm v[0:3],a[204:207],a[176:179],v[0:3]
v_exp_f32 v181,v89
mm v[4:7],a[200:203],a[164:167],v[4:7]
ds_read_b128 a[220:223],v189 offset:36864
cv v138,v180,v181
mm v[4:7],a[204:207],a[180:183],v[4:7]
v_exp_f32 v182,v90
mm v[8:11],a[200:203],a[168:171],v[8:11]
v_exp_f32 v183,v91
mm v[8:11],a[204:207],a[184:187],v[8:11]
ds_read_b128 a[192:195],v186 offset:40960
v_or3_b32 v184,v137,v138,v184
mm v[12:15],a[200:203],a[172:175],v[12:15]
bl v199,s[8:11],s40 offen offset:1024 lds
cv v139,v182,v183
mm v[12:15],a[204:207],a[188:191],v[12:15]
ds_read_b128 a[196:199],v187 offset:40960
s_waitcnt lgkmcnt(4)
mm v[16:19],a[208:211],a[128:131],v[160:163]
v_exp_f32 v176,v76
mm v[16:19],a[212:215],a[144:147],v[16:19]
v_exp_f32 v177,v77
mm v[20:23],a[208:211],a[132:135],v[164:167]
v_exp_f32 v178,v78
mm v[20:23],a[212:215],a[148:151],v[20:23]
ds_read_b128 a[200:203],v188 offset:40960
cv v140,v176,v177
mm v[24:27],a[208:211],a[136:139],v[168:171]
v_exp_f32 v179,v79
mm v[24:27],a[212:215],a[152:155],v[24:27]
v_exp_f32 v180,v92
mm v[28:31],a[208:211],a[140:143],v[172:175]
v_or3_b32 v184,v139,v140,v184
cv v141,v178,v179
mm v[28:31],a[212:215],a[156:159],v[28:31]
ds_read_b128 a[204:207],v189 offset:40960
s_waitcnt lgkmcnt(4)
mm v[16:19],a[216:219],a[160:163],v[16:19]
v_exp_f32 v181,v93
mm v[16:19],a[220:223],a[176:179],v[16:19]
bl v200,s[8:11],s40 offen offset:2048 lds
cv v142,v180,v181
mm v[20:23],a[216:219],a[164:167],v[20:23]
v_exp_f32 v182,v94
mm v[20:23],a[220:223],a[180:183],v[20:23]
v_exp_f32 v183,v95
mm v[24:27],a[216:219],a[168:171],v[24:27]
ds_read_b128 a[208:211],v186 offset:45056
v_or3_b32 v184,v141,v142,v184
mm v[24:27],a[220:223],a[184:187],v[24:27]
v_exp_f32 v176,v96
mm v[28:31],a[216:219],a[172:175],v[28:31]
ds_read_b128 a[212:215],v187 offset:45056
cv v143,v182,v183
mm v[28:31],a[220:223],a[188:191],v[28:31]
v_bitop3_b32 v184,v184,v143,s45 bitop3:0xa8
s_waitcnt lgkmcnt(4)
mm v[32:35],a[192:195],a[128:131],v[160:163]
v_exp_f32 v177,v97
mm v[32:35],a[196:199],a[144:147],v[32:35]
v_exp_f32 v178,v98
mm v[36:39],a[192:195],a[132:135],v[164:167]
ds_read_b128 a[216:219],v188 offset:45056
cv v144,v176,v177
mm v[36:39],a[196:199],a[148:151],v[36:39]
v_exp_f32 v179,v99
mm v[40:43],a[192:195],a[136:139],v[168:171]
bl v201,s[8:11],s40 offen offset:3072 lds
cv v145,v178,v179
mm v[40:43],a[196:199],a[152:155],v[40:43]
v_exp_f32 v180,v112
mm v[44:47],a[192:195],a[140:143],v[172:175]
v_exp_f32 v181,v113
mm v[44:47],a[196:199],a[156:159],v[44:47]
ds_read_b128 a[220:223],v189 offset:45056
s_waitcnt lgkmcnt(4)
mm v[32:35],a[200:203],a[160:163],v[32:35]
v_exp_f32 v182,v114
mm v[32:35],a[204:207],a[176:179],v[32:35]
cv v146,v180,v181
v_or3_b32 v185,v144,v145,v146
mm v[36:39],a[200:203],a[164:167],v[36:39]
v_exp_f32 v183,v115
mm v[36:39],a[204:207],a[180:183],v[36:39]
v_exp_f32 v176,v100
mm v[40:43],a[200:203],a[168:171],v[40:43]
tr a[192:193],v190 offset:32768
s_add_u32 s40,s40,16384
mm v[40:43],a[204:207],a[184:187],v[40:43]
tr a[194:195],v190 offset:36864
s_add_u32 m0,s44,114688
mm v[44:47],a[200:203],a[172:175],v[44:47]
tr a[196:197],v191 offset:32768
cv v147,v182,v183
mm v[44:47],a[204:207],a[188:191],v[44:47]
bl v202,s[12:15],s41 offen offset:0 lds
s_waitcnt lgkmcnt(5)
mm v[48:51],a[208:211],a[128:131],v[160:163]
v_exp_f32 v177,v101
mm v[48:51],a[212:215],a[144:147],v[48:51]
v_exp_f32 v178,v102
mm v[52:55],a[208:211],a[132:135],v[164:167]
tr a[198:199],v191 offset:36864
cv v148,v176,v177
mm v[52:55],a[212:215],a[148:151],v[52:55]
v_exp_f32 v179,v103
mm v[56:59],a[208:211],a[136:139],v[168:171]
v_exp_f32 v180,v116
mm v[56:59],a[212:215],a[152:155],v[56:59]
tr a[200:201],v192 offset:32768
v_or3_b32 v185,v147,v148,v185
mm v[60:63],a[208:211],a[140:143],v[172:175]
tr a[202:203],v192 offset:36864
cv v149,v178,v179
mm v[60:63],a[212:215],a[156:159],v[60:63]
tr a[204:205],v193 offset:32768
s_waitcnt lgkmcnt(7)
mm v[48:51],a[216:219],a[160:163],v[48:51]
v_exp_f32 v181,v117
mm v[48:51],a[220:223],a[176:179],v[48:51]
v_exp_f32 v182,v118
mm v[52:55],a[216:219],a[164:167],v[52:55]
tr a[206:207],v193 offset:36864
cv v150,v180,v181
mm v[52:55],a[220:223],a[180:183],v[52:55]
bl v203,s[12:15],s41 offen offset:1024 lds
v_or3_b32 v185,v149,v150,v185
mm v[56:59],a[216:219],a[168:171],v[56:59]
v_exp_f32 v183,v119
mm v[56:59],a[220:223],a[184:187],v[56:59]
v_exp_f32 v176,v104
mm v[60:63],a[216:219],a[172:175],v[60:63]
cv v151,v182,v183
v_cmp_ne_u32 vcc,0,v184
mm v[60:63],a[220:223],a[188:191],v[60:63]
tr a[208:209],v194 offset:32768
s_cbranch_vccnz attn_stub_loop3_0
attn_back_loop3_0:
mm a[224:227],a[240:243],v[128:131],a[224:227]
tr a[210:211],v194 offset:36864
v_exp_f32 v177,v105
mm a[228:231],a[240:243],v[132:135],a[228:231]
v_exp_f32 v178,v106
mm a[232:235],a[240:243],v[136:139],a[232:235]
cv v152,v176,v177
v_or3_b32 v185,v151,v152,v185
mm a[236:239],a[240:243],v[140:143],a[236:239]
tr a[212:213],v195 offset:32768
s_waitcnt lgkmcnt(7)
mm a[0:3],a[192:195],v[128:131],a[0:3]
v_exp_f32 v179,v107
mm a[4:7],a[192:195],v[132:135],a[4:7]
v_exp_f32 v180,v120
mm a[8:11],a[192:195],v[136:139],a[8:11]
bl v202,s[12:15],s41 offen offset:2048 lds
cv v153,v178,v179
mm a[12:15],a[192:195],v[140:143],a[12:15]
v_exp_f32 v181,v121
mm a[16:19],a[196:199],v[128:131],a[16:19]
tr a[214:215],v195 offset:36864
cv v154,v180,v181
mm a[20:23],a[196:199],v[132:135],a[20:23]
v_exp_f32 v182,v122
mm a[24:27],a[196:199],v[136:139],a[24:27]
v_exp_f32 v183,v123
mm a[28:31],a[196:199],v[140:143],a[28:31]
tr a[216:217],v196 offset:32768
s_waitcnt lgkmcnt(5)
mm a[32:35],a[200:203],v[128:131],a[32:35]
tr a[218:219],v196 offset:36864
v_or3_b32 v185,v153,v154,v185
mm a[36:39],a[200:203],v[132:135],a[36:39]
v_exp_f32 v176,v108
mm a[40:43],a[200:203],v[136:139],a[40:43]
tr a[220:221],v197 offset:32768
cv v155,v182,v183
mm a[44:47],a[200:203],v[140:143],a[44:47]
v_exp_f32 v177,v109
mm a[48:51],a[204:207],v[128:131],a[48:51]
tr a[222:223],v197 offset:36864
bl v203,s[12:15],s41 offen offset:3072 lds
mm a[52:55],a[204:207],v[132:135],a[52:55]
v_exp_f32 v178,v110
mm a[56:59],a[204:207],v[136:139],a[56:59]
tr a[192:193],v190 offset:40960
cv v156,v176,v177
mm a[60:63],a[204:207],v[140:143],a[60:63]
tr a[194:195],v190 offset:45056
s_waitcnt lgkmcnt(6)
mm a[64:67],a[208:211],v[128:131],a[64:67]
v_exp_f32 v179,v111
mm a[68:71],a[208:211],v[132:135],a[68:71]
v_exp_f32 v180,v124
mm a[72:75],a[208:211],v[136:139],a[72:75]
v_or3_b32 v185,v155,v156,v185
cv v157,v178,v179
mm a[76:79],a[208:211],v[140:143],a[76:79]
v_exp_f32 v181,v125
mm a[80:83],a[212:215],v[128:131],a[80:83]
tr a[196:197],v191 offset:40960
tr a[198:199],v191 offset:45056
mm a[84:87],a[212:215],v[132:135],a[84:87]
v_exp_f32 v182,v126
mm a[88:91],a[212:215],v[136:139],a[88:91]
tr a[200:201],v192 offset:40960
cv v158,v180,v181
mm a[92:95],a[212:215],v[140:143],a[92:95]
tr a[202:203],v192 offset:45056
s_waitcnt lgkmcnt(6)
mm a[96:99],a[216:219],v[128:131],a[96:99]
s_add_u32 s41,s41,16384
v_exp_f32 v183,v127
mm a[100:103],a[216:219],v[132:135],a[100:103]
buffer_load_dword v234,v230,s[48:51],s37 offen
v_or3_b32 v185,v157,v158,v185
mm a[104:107],a[216:219],v[136:139],a[104:107]
tr a[204:205],v193 offset:40960
cv v159,v182,v183
mm a[108:111],a[216:219],v[140:143],a[108:111]
tr a[206:207],v193 offset:45056
v_bitop3_b32 v185,v185,v159,s45 bitop3:0xa8
mm a[112:115],a[220:223],v[128:131],a[112:115]
tr a[208:209],v194 offset:40960
s_add_u32 s46,s46,0x100000
mm a[116:119],a[220:223],v[132:135],a[116:119]
tr a[210:211],v194 offset:45056
s_mov_b32 s37,0x10000000
mm a[120:123],a[220:223],v[136:139],a[120:123]
v_cmp_ne_u32 vcc,0,v185
mm a[124:127],a[220:223],v[140:143],a[124:127]
s_cbranch_vccnz attn_stub_loop3_1
attn_back_loop3_1:
mm a[224:227],a[240:243],v[144:147],a[224:227]
v_exp_f32 v176,v0
mm a[228:231],a[240:243],v[148:151],a[228:231]
v_exp_f32 v177,v1
mm a[232:235],a[240:243],v[152:155],a[232:235]
v_exp_f32 v178,v2
mm a[236:239],a[240:243],v[156:159],a[236:239]
cv v128,v176,v177
s_waitcnt lgkmcnt(6)
mm a[0:3],a[192:195],v[144:147],a[0:3]
v_exp_f32 v179,v3
mm a[4:7],a[192:195],v[148:151],a[4:7]
tr a[212:213],v195 offset:40960
cv v129,v178,v179
mm a[8:11],a[192:195],v[152:155],a[8:11]
v_exp_f32 v180,v16
mm a[12:15],a[192:195],v[156:159],a[12:15]
v_exp_f32 v181,v17
mm a[16:19],a[196:199],v[144:147],a[16:19]
tr a[214:215],v195 offset:45056
cv v130,v180,v181
mm a[20:23],a[196:199],v[148:151],a[20:23]
tr a[216:217],v196 offset:40960
v_or3_b32 v184,v128,v129,v130
mm a[24:27],a[196:199],v[152:155],a[24:27]
v_exp_f32 v182,v18
mm a[28:31],a[196:199],v[156:159],a[28:31]
tr a[218:219],v196 offset:45056
s_waitcnt lgkmcnt(6)
mm a[32:35],a[200:203],v[144:147],a[32:35]
v_exp_f32 v183,v19
mm a[36:39],a[200:203],v[148:151],a[36:39]
tr a[220:221],v197 offset:40960
cv v131,v182,v183
mm a[40:43],a[200:203],v[152:155],a[40:43]
v_exp_f32 v176,v4
mm a[44:47],a[200:203],v[156:159],a[44:47]
v_exp_f32 v177,v5
mm a[48:51],a[204:207],v[144:147],a[48:51]
tr a[222:223],v197 offset:45056
cv v132,v176,v177
mm a[52:55],a[204:207],v[148:151],a[52:55]
ds_read_b128 a[192:195],v186 offset:49152
v_or3_b32 v184,v131,v132,v184
mm a[56:59],a[204:207],v[152:155],a[56:59]
v_exp_f32 v178,v6
mm a[60:63],a[204:207],v[156:159],a[60:63]
ds_read_b128 a[196:199],v187 offset:49152
s_waitcnt lgkmcnt(6)
mm a[64:67],a[208:211],v[144:147],a[64:67]
v_exp_f32 v179,v7
mm a[68:71],a[208:211],v[148:151],a[68:71]
v_exp_f32 v180,v20
mm a[72:75],a[208:211],v[152:155],a[72:75]
ds_read_b128 a[200:203],v188 offset:49152
cv v133,v178,v179
mm a[76:79],a[208:211],v[156:159],a[76:79]
v_exp_f32 v181,v21
mm a[80:83],a[212:215],v[144:147],a[80:83]
v_exp_f32 v182,v22
mm a[84:87],a[212:215],v[148:151],a[84:87]
ds_read_b128 a[204:207],v189 offset:49152
cv v134,v180,v181
mm a[88:91],a[212:215],v[152:155],a[88:91]
v_exp_f32 v183,v23
mm a[92:95],a[212:215],v[156:159],a[92:95]
v_or3_b32 v184,v133,v134,v184
s_waitcnt lgkmcnt(4)
mm a[96:99],a[216:219],v[144:147],a[96:99]
ds_read_b128 a[208:211],v186 offset:53248
cv v135,v182,v183
mm a[100:103],a[216:219],v[148:151],a[100:103]
mm a[104:107],a[216:219],v[152:155],a[104:107]
mm a[108:111],a[216:219],v[156:159],a[108:111]
mm a[112:115],a[220:223],v[144:147],a[112:115]
s_waitcnt vmcnt(12)
mm a[116:119],a[220:223],v[148:151],a[116:119]
s_barrier
mm a[120:123],a[220:223],v[152:155],a[120:123]
mm a[124:127],a[220:223],v[156:159],a[124:127]
s_sub_u32 s3,s3,1
s_cmp_lg_u32 s3,0
s_cbranch_scc1 attn_loop
s_waitcnt lgkmcnt(3)
mm v[64:67],a[192:195],a[128:131],v[160:163]
v_exp_f32 v176,v8
mm v[64:67],a[196:199],a[144:147],v[64:67]
v_exp_f32 v177,v9
mm v[68:71],a[192:195],a[132:135],v[164:167]
ds_read_b128 a[212:215],v187 offset:53248
s_add_u32 m0,s44,131072
mm v[68:71],a[196:199],a[148:151],v[68:71]
bl v202,s[12:15],s41 offen offset:0 lds
cv v136,v176,v177
mm v[72:75],a[192:195],a[136:139],v[168:171]
v_exp_f32 v178,v10
mm v[72:75],a[196:199],a[152:155],v[72:75]
v_exp_f32 v179,v11
mm v[76:79],a[192:195],a[140:143],v[172:175]
ds_read_b128 a[216:219],v188 offset:53248
v_or3_b32 v184,v135,v136,v184
mm v[76:79],a[196:199],a[156:159],v[76:79]
cv v137,v178,v179
s_waitcnt lgkmcnt(3)
mm v[64:67],a[200:203],a[160:163],v[64:67]
v_exp_f32 v180,v24
mm v[64:67],a[204:207],a[176:179],v[64:67]
v_exp_f32 v181,v25
mm v[68:71],a[200:203],a[164:167],v[68:71]
ds_read_b128 a[220:223],v189 offset:53248
cv v138,v180,v181
mm v[68:71],a[204:207],a[180:183],v[68:71]
v_exp_f32 v182,v26
mm v[72:75],a[200:203],a[168:171],v[72:75]
v_exp_f32 v183,v27
mm v[72:75],a[204:207],a[184:187],v[72:75]
ds_read_b128 a[192:195],v186 offset:57344
v_or3_b32 v184,v137,v138,v184
mm v[76:79],a[200:203],a[172:175],v[76:79]
bl v203,s[12:15],s41 offen offset:1024 lds
cv v139,v182,v183
mm v[76:79],a[204:207],a[188:191],v[76:79]
ds_read_b128 a[196:199],v187 offset:57344
s_waitcnt lgkmcnt(4)
mm v[80:83],a[208:211],a[128:131],v[160:163]
v_exp_f32 v176,v12
mm v[80:83],a[212:215],a[144:147],v[80:83]
v_exp_f32 v177,v13
mm v[84:87],a[208:211],a[132:135],v[164:167]
v_exp_f32 v178,v14
mm v[84:87],a[212:215],a[148:151],v[84:87]
ds_read_b128 a[200:203],v188 offset:57344
cv v140,v176,v177
mm v[88:91],a[208:211],a[136:139],v[168:171]
v_exp_f32 v179,v15
mm v[88:91],a[212:215],a[152:155],v[88:91]
v_exp_f32 v180,v28
mm v[92:95],a[208:211],a[140:143],v[172:175]
v_or3_b32 v184,v139,v140,v184
cv v141,v178,v179
mm v[92:95],a[212:215],a[156:159],v[92:95]
ds_read_b128 a[204:207],v189 offset:57344
s_waitcnt lgkmcnt(4)
mm v[80:83],a[216:219],a[160:163],v[80:83]
v_exp_f32 v181,v29
mm v[80:83],a[220:223],a[176:179],v[80:83]
bl v202,s[12:15],s41 offen offset:2048 lds
cv v142,v180,v181
mm v[84:87],a[216:219],a[164:167],v[84:87]
v_exp_f32 v182,v30
mm v[84:87],a[220:223],a[180:183],v[84:87]
v_exp_f32 v183,v31
mm v[88:91],a[216:219],a[168:171],v[88:91]
ds_read_b128 a[208:211],v186 offset:61440
v_or3_b32 v184,v141,v142,v184
mm v[88:91],a[220:223],a[184:187],v[88:91]
v_exp_f32 v176,v32
mm v[92:95],a[216:219],a[172:175],v[92:95]
ds_read_b128 a[212:215],v187 offset:61440
cv v143,v182,v183
mm v[92:95],a[220:223],a[188:191],v[92:95]
v_bitop3_b32 v184,v184,v143,s45 bitop3:0xa8
s_waitcnt lgkmcnt(4)
mm v[96:99],a[192:195],a[128:131],v[160:163]
v_exp_f32 v177,v33
mm v[96:99],a[196:199],a[144:147],v[96:99]
v_exp_f32 v178,v34
mm v[100:103],a[192:195],a[132:135],v[164:167]
ds_read_b128 a[216:219],v188 offset:61440
cv v144,v176,v177
mm v[100:103],a[196:199],a[148:151],v[100:103]
v_exp_f32 v179,v35
mm v[104:107],a[192:195],a[136:139],v[168:171]
bl v203,s[12:15],s41 offen offset:3072 lds
cv v145,v178,v179
mm v[104:107],a[196:199],a[152:155],v[104:107]
v_exp_f32 v180,v48
mm v[108:111],a[192:195],a[140:143],v[172:175]
v_exp_f32 v181,v49
mm v[108:111],a[196:199],a[156:159],v[108:111]
ds_read_b128 a[220:223],v189 offset:61440
s_waitcnt lgkmcnt(4)
mm v[96:99],a[200:203],a[160:163],v[96:99]
v_exp_f32 v182,v50
mm v[96:99],a[204:207],a[176:179],v[96:99]
cv v146,v180,v181
v_or3_b32 v185,v144,v145,v146
mm v[100:103],a[200:203],a[164:167],v[100:103]
v_exp_f32 v183,v51
mm v[100:103],a[204:207],a[180:183],v[100:103]
v_exp_f32 v176,v36
mm v[104:107],a[200:203],a[168:171],v[104:107]
tr a[192:193],v190 offset:49152
s_add_u32 s41,s41,16384
mm v[104:107],a[204:207],a[184:187],v[104:107]
tr a[194:195],v190 offset:53248
s_mov_b32 m0,s43
mm v[108:111],a[200:203],a[172:175],v[108:111]
tr a[196:197],v191 offset:49152
cv v147,v182,v183
mm v[108:111],a[204:207],a[188:191],v[108:111]
bl v241,s[68:71],s39 offen lds
s_waitcnt lgkmcnt(5)
mm v[112:115],a[208:211],a[128:131],v[160:163]
v_exp_f32 v177,v37
mm v[112:115],a[212:215],a[144:147],v[112:115]
v_exp_f32 v178,v38
mm v[116:119],a[208:211],a[132:135],v[164:167]
tr a[198:199],v191 offset:53248
cv v148,v176,v177
mm v[116:119],a[212:215],a[148:151],v[116:119]
v_exp_f32 v179,v39
mm v[120:123],a[208:211],a[136:139],v[168:171]
v_exp_f32 v180,v52
mm v[120:123],a[212:215],a[152:155],v[120:123]
tr a[200:201],v192 offset:49152
v_or3_b32 v185,v147,v148,v185
mm v[124:127],a[208:211],a[140:143],v[172:175]
tr a[202:203],v192 offset:53248
cv v149,v178,v179
mm v[124:127],a[212:215],a[156:159],v[124:127]
s_add_u32 s43,s43,1024
s_waitcnt lgkmcnt(6)
mm v[112:115],a[216:219],a[160:163],v[112:115]
v_exp_f32 v181,v53
mm v[112:115],a[220:223],a[176:179],v[112:115]
v_exp_f32 v182,v54
mm v[116:119],a[216:219],a[164:167],v[116:119]
s_add_u32 s39,s39,393216
cv v150,v180,v181
mm v[116:119],a[220:223],a[180:183],v[116:119]
tr a[204:205],v193 offset:49152
tr a[206:207],v193 offset:53248
mm v[120:123],a[216:219],a[168:171],v[120:123]
v_exp_f32 v183,v55
mm v[120:123],a[220:223],a[184:187],v[120:123]
v_exp_f32 v176,v40
mm v[124:127],a[216:219],a[172:175],v[124:127]
v_or3_b32 v185,v149,v150,v185
v_cmp_ne_u32 vcc,0,v184
mm v[124:127],a[220:223],a[188:191],v[124:127]
cv v151,v182,v183
s_cbranch_vccnz attn_stub_tail0_0
attn_back_tail0_0:
mm a[224:227],a[240:243],v[128:131],a[224:227]
tr a[208:209],v194 offset:49152
tr a[210:211],v194 offset:53248
v_exp_f32 v177,v41
mm a[228:231],a[240:243],v[132:135],a[228:231]
v_exp_f32 v178,v42
mm a[232:235],a[240:243],v[136:139],a[232:235]
cv v152,v176,v177
v_or3_b32 v185,v151,v152,v185
mm a[236:239],a[240:243],v[140:143],a[236:239]
tr a[212:213],v195 offset:49152
s_waitcnt lgkmcnt(7)
mm a[0:3],a[192:195],v[128:131],a[0:3]
v_exp_f32 v179,v43
mm a[4:7],a[192:195],v[132:135],a[4:7]
v_exp_f32 v180,v56
mm a[8:11],a[192:195],v[136:139],a[8:11]
tr a[214:215],v195 offset:53248
cv v153,v178,v179
mm a[12:15],a[192:195],v[140:143],a[12:15]
v_exp_f32 v181,v57
mm a[16:19],a[196:199],v[128:131],a[16:19]
v_exp_f32 v182,v58
mm a[20:23],a[196:199],v[132:135],a[20:23]
tr a[216:217],v196 offset:49152
cv v154,v180,v181
mm a[24:27],a[196:199],v[136:139],a[24:27]
v_exp_f32 v183,v59
mm a[28:31],a[196:199],v[140:143],a[28:31]
tr a[218:219],v196 offset:53248
s_waitcnt lgkmcnt(6)
mm a[32:35],a[200:203],v[128:131],a[32:35]
v_exp_f32 v176,v44
mm a[36:39],a[200:203],v[132:135],a[36:39]
v_or3_b32 v185,v153,v154,v185
cv v155,v182,v183
mm a[40:43],a[200:203],v[136:139],a[40:43]
v_exp_f32 v177,v45
mm a[44:47],a[200:203],v[140:143],a[44:47]
tr a[220:221],v197 offset:49152
tr a[222:223],v197 offset:53248
mm a[48:51],a[204:207],v[128:131],a[48:51]
v_exp_f32 v178,v46
mm a[52:55],a[204:207],v[132:135],a[52:55]
tr a[192:193],v190 offset:57344
cv v156,v176,v177
mm a[56:59],a[204:207],v[136:139],a[56:59]
v_exp_f32 v179,v47
mm a[60:63],a[204:207],v[140:143],a[60:63]
tr a[194:195],v190 offset:61440
s_waitcnt lgkmcnt(6)
mm a[64:67],a[208:211],v[128:131],a[64:67]
v_exp_f32 v180,v60
mm a[68:71],a[208:211],v[132:135],a[68:71]
v_or3_b32 v185,v155,v156,v185
cv v157,v178,v179
mm a[72:75],a[208:211],v[136:139],a[72:75]
v_exp_f32 v181,v61
mm a[76:79],a[208:211],v[140:143],a[76:79]
tr a[196:197],v191 offset:57344
tr a[198:199],v191 offset:61440
mm a[80:83],a[212:215],v[128:131],a[80:83]
v_exp_f32 v182,v62
mm a[84:87],a[212:215],v[132:135],a[84:87]
tr a[200:201],v192 offset:57344
cv v158,v180,v181
mm a[88:91],a[212:215],v[136:139],a[88:91]
v_exp_f32 v183,v63
mm a[92:95],a[212:215],v[140:143],a[92:95]
tr a[202:203],v192 offset:61440
s_waitcnt lgkmcnt(6)
mm a[96:99],a[216:219],v[128:131],a[96:99]
v_or3_b32 v185,v157,v158,v185
cv v159,v182,v183
mm a[100:103],a[216:219],v[132:135],a[100:103]
tr a[204:205],v193 offset:57344
v_bitop3_b32 v185,v185,v159,s45 bitop3:0xa8
mm a[104:107],a[216:219],v[136:139],a[104:107]
tr a[206:207],v193 offset:61440
mm a[108:111],a[216:219],v[140:143],a[108:111]
tr a[208:209],v194 offset:57344
mm a[112:115],a[220:223],v[128:131],a[112:115]
tr a[210:211],v194 offset:61440
mm a[116:119],a[220:223],v[132:135],a[116:119]
mm a[120:123],a[220:223],v[136:139],a[120:123]
v_cmp_ne_u32 vcc,0,v185
mm a[124:127],a[220:223],v[140:143],a[124:127]
s_cbranch_vccnz attn_stub_tail0_1
attn_back_tail0_1:
mm a[224:227],a[240:243],v[144:147],a[224:227]
v_exp_f32 v176,v64
mm a[228:231],a[240:243],v[148:151],a[228:231]
v_exp_f32 v177,v65
mm a[232:235],a[240:243],v[152:155],a[232:235]
v_exp_f32 v178,v66
mm a[236:239],a[240:243],v[156:159],a[236:239]
cv v128,v176,v177
s_waitcnt lgkmcnt(6)
mm a[0:3],a[192:195],v[144:147],a[0:3]
v_exp_f32 v179,v67
mm a[4:7],a[192:195],v[148:151],a[4:7]
tr a[212:213],v195 offset:57344
cv v129,v178,v179
mm a[8:11],a[192:195],v[152:155],a[8:11]
v_exp_f32 v180,v80
mm a[12:15],a[192:195],v[156:159],a[12:15]
v_exp_f32 v181,v81
mm a[16:19],a[196:199],v[144:147],a[16:19]
tr a[214:215],v195 offset:61440
cv v130,v180,v181
mm a[20:23],a[196:199],v[148:151],a[20:23]
tr a[216:217],v196 offset:57344
v_or3_b32 v184,v128,v129,v130
mm a[24:27],a[196:199],v[152:155],a[24:27]
v_exp_f32 v182,v82
mm a[28:31],a[196:199],v[156:159],a[28:31]
tr a[218:219],v196 offset:61440
s_waitcnt lgkmcnt(6)
mm a[32:35],a[200:203],v[144:147],a[32:35]
v_exp_f32 v183,v83
mm a[36:39],a[200:203],v[148:151],a[36:39]
tr a[220:221],v197 offset:57344
cv v131,v182,v183
mm a[40:43],a[200:203],v[152:155],a[40:43]
v_exp_f32 v176,v68
mm a[44:47],a[200:203],v[156:159],a[44:47]
v_exp_f32 v177,v69
mm a[48:51],a[204:207],v[144:147],a[48:51]
tr a[222:223],v197 offset:61440
cv v132,v176,v177
mm a[52:55],a[204:207],v[148:151],a[52:55]
ds_read_b128 a[192:195],v186 offset:0
v_or3_b32 v184,v131,v132,v184
mm a[56:59],a[204:207],v[152:155],a[56:59]
v_exp_f32 v178,v70
mm a[60:63],a[204:207],v[156:159],a[60:63]
ds_read_b128 a[196:199],v187 offset:0
s_waitcnt lgkmcnt(6)
mm a[64:67],a[208:211],v[144:147],a[64:67]
v_exp_f32 v179,v71
mm a[68:71],a[208:211],v[148:151],a[68:71]
v_exp_f32 v180,v84
mm a[72:75],a[208:211],v[152:155],a[72:75]
ds_read_b128 a[200:203],v188 offset:0
cv v133,v178,v179
mm a[76:79],a[208:211],v[156:159],a[76:79]
v_exp_f32 v181,v85
mm a[80:83],a[212:215],v[144:147],a[80:83]
v_exp_f32 v182,v86
mm a[84:87],a[212:215],v[148:151],a[84:87]
ds_read_b128 a[204:207],v189 offset:0
cv v134,v180,v181
mm a[88:91],a[212:215],v[152:155],a[88:91]
v_exp_f32 v183,v87
mm a[92:95],a[212:215],v[156:159],a[92:95]
v_or3_b32 v184,v133,v134,v184
s_waitcnt lgkmcnt(4)
mm a[96:99],a[216:219],v[144:147],a[96:99]
ds_read_b128 a[208:211],v186 offset:4096
cv v135,v182,v183
mm a[100:103],a[216:219],v[148:151],a[100:103]
mm a[104:107],a[216:219],v[152:155],a[104:107]
mm a[108:111],a[216:219],v[156:159],a[108:111]
mm a[112:115],a[220:223],v[144:147],a[112:115]
s_waitcnt vmcnt(8)
mm a[116:119],a[220:223],v[148:151],a[116:119]
s_barrier
mm a[120:123],a[220:223],v[152:155],a[120:123]
mm a[124:127],a[220:223],v[156:159],a[124:127]
s_waitcnt lgkmcnt(3)
mm v[0:3],a[192:195],a[128:131],v[160:163]
v_exp_f32 v176,v72
mm v[0:3],a[196:199],a[144:147],v[0:3]
v_exp_f32 v177,v73
mm v[4:7],a[192:195],a[132:135],v[164:167]
ds_read_b128 a[212:215],v187 offset:4096
cv v136,v176,v177
mm v[4:7],a[196:199],a[148:151],v[4:7]
v_exp_f32 v178,v74
mm v[8:11],a[192:195],a[136:139],v[168:171]
v_exp_f32 v179,v75
mm v[8:11],a[196:199],a[152:155],v[8:11]
ds_read_b128 a[216:219],v188 offset:4096
v_or3_b32 v184,v135,v136,v184
mm v[12:15],a[192:195],a[140:143],v[172:175]
v_exp_f32 v180,v88
mm v[12:15],a[196:199],a[156:159],v[12:15]
cv v137,v178,v179
s_waitcnt lgkmcnt(3)
mm v[0:3],a[200:203],a[160:163],v[0:3]
v_exp_f32 v181,v89
mm v[0:3],a[204:207],a[176:179],v[0:3]
ds_read_b128 a[220:223],v189 offset:4096
cv v138,v180,v181
mm v[4:7],a[200:203],a[164:167],v[4:7]
v_exp_f32 v182,v90
mm v[4:7],a[204:207],a[180:183],v[4:7]
v_exp_f32 v183,v91
mm v[8:11],a[200:203],a[168:171],v[8:11]
ds_read_b128 a[192:195],v186 offset:8192
v_or3_b32 v184,v137,v138,v184
mm v[8:11],a[204:207],a[184:187],v[8:11]
v_exp_f32 v176,v76
mm v[12:15],a[200:203],a[172:175],v[12:15]
ds_read_b128 a[196:199],v187 offset:8192
cv v139,v182,v183
mm v[12:15],a[204:207],a[188:191],v[12:15]
s_waitcnt lgkmcnt(4)
mm v[16:19],a[208:211],a[128:131],v[160:163]
v_exp_f32 v177,v77
mm v[16:19],a[212:215],a[144:147],v[16:19]
v_exp_f32 v178,v78
mm v[20:23],a[208:211],a[132:135],v[164:167]
ds_read_b128 a[200:203],v188 offset:8192
cv v140,v176,v177
mm v[20:23],a[212:215],a[148:151],v[20:23]
v_exp_f32 v179,v79
mm v[24:27],a[208:211],a[136:139],v[168:171]
v_exp_f32 v180,v92
mm v[24:27],a[212:215],a[152:155],v[24:27]
v_or3_b32 v184,v139,v140,v184
cv v141,v178,v179
mm v[28:31],a[208:211],a[140:143],v[172:175]
v_exp_f32 v181,v93
mm v[28:31],a[212:215],a[156:159],v[28:31]
ds_read_b128 a[204:207],v189 offset:8192
s_waitcnt lgkmcnt(4)
mm v[16:19],a[216:219],a[160:163],v[16:19]
v_exp_f32 v182,v94
mm v[16:19],a[220:223],a[176:179],v[16:19]
ds_read_b128 a[208:211],v186 offset:12288
cv v142,v180,v181
mm v[20:23],a[216:219],a[164:167],v[20:23]
v_exp_f32 v183,v95
mm v[20:23],a[220:223],a[180:183],v[20:23]
v_exp_f32 v176,v96
mm v[24:27],a[216:219],a[168:171],v[24:27]
v_or3_b32 v184,v141,v142,v184
cv v143,v182,v183
mm v[24:27],a[220:223],a[184:187],v[24:27]
v_exp_f32 v177,v97
mm v[28:31],a[216:219],a[172:175],v[28:31]
ds_read_b128 a[212:215],v187 offset:12288
v_bitop3_b32 v184,v184,v143,s45 bitop3:0xa8
mm v[28:31],a[220:223],a[188:191],v[28:31]
cv v144,v176,v177
s_waitcnt lgkmcnt(4)
mm v[32:35],a[192:195],a[128:131],v[160:163]
v_exp_f32 v178,v98
mm v[32:35],a[196:199],a[144:147],v[32:35]
v_exp_f32 v179,v99
mm v[36:39],a[192:195],a[132:135],v[164:167]
v_exp_f32 v180,v112
mm v[36:39],a[196:199],a[148:151],v[36:39]
ds_read_b128 a[216:219],v188 offset:12288
cv v145,v178,v179
mm v[40:43],a[192:195],a[136:139],v[168:171]
v_exp_f32 v181,v113
mm v[40:43],a[196:199],a[152:155],v[40:43]
v_exp_f32 v182,v114
mm v[44:47],a[192:195],a[140:143],v[172:175]
ds_read_b128 a[220:223],v189 offset:12288
cv v146,v180,v181
mm v[44:47],a[196:199],a[156:159],v[44:47]
v_or3_b32 v185,v144,v145,v146
s_waitcnt lgkmcnt(4)
mm v[32:35],a[200:203],a[160:163],v[32:35]
v_exp_f32 v183,v115
mm v[32:35],a[204:207],a[176:179],v[32:35]
v_exp_f32 v176,v100
mm v[36:39],a[200:203],a[164:167],v[36:39]
tr a[192:193],v190 offset:0
cv v147,v182,v183
mm v[36:39],a[204:207],a[180:183],v[36:39]
v_exp_f32 v177,v101
mm v[40:43],a[200:203],a[168:171],v[40:43]
tr a[194:195],v190 offset:4096
cv v148,v176,v177
mm v[40:43],a[204:207],a[184:187],v[40:43]
v_exp_f32 v178,v102
mm v[44:47],a[200:203],a[172:175],v[44:47]
tr a[196:197],v191 offset:0
v_or3_b32 v185,v147,v148,v185
mm v[44:47],a[204:207],a[188:191],v[44:47]
tr a[198:199],v191 offset:4096
s_waitcnt lgkmcnt(6)
mm v[48:51],a[208:211],a[128:131],v[160:163]
v_exp_f32 v179,v103
mm v[48:51],a[212:215],a[144:147],v[48:51]
v_exp_f32 v180,v116
mm v[52:55],a[208:211],a[132:135],v[164:167]
tr a[200:201],v192 offset:0
cv v149,v178,v179
mm v[52:55],a[212:215],a[148:151],v[52:55]
v_exp_f32 v181,v117
mm v[56:59],a[208:211],a[136:139],v[168:171]
tr a[202:203],v192 offset:4096
cv v150,v180,v181
mm v[56:59],a[212:215],a[152:155],v[56:59]
v_exp_f32 v182,v118
mm v[60:63],a[208:211],a[140:143],v[172:175]
tr a[204:205],v193 offset:0
v_or3_b32 v185,v149,v150,v185
mm v[60:63],a[212:215],a[156:159],v[60:63]
tr a[206:207],v193 offset:4096
s_waitcnt lgkmcnt(8)
mm v[48:51],a[216:219],a[160:163],v[48:51]
v_exp_f32 v183,v119
mm v[48:51],a[220:223],a[176:179],v[48:51]
v_exp_f32 v176,v104
mm v[52:55],a[216:219],a[164:167],v[52:55]
tr a[208:209],v194 offset:0
cv v151,v182,v183
mm v[52:55],a[220:223],a[180:183],v[52:55]
v_exp_f32 v177,v105
mm v[56:59],a[216:219],a[168:171],v[56:59]
tr a[210:211],v194 offset:4096
cv v152,v176,v177
mm v[56:59],a[220:223],a[184:187],v[56:59]
v_exp_f32 v178,v106
mm v[60:63],a[216:219],a[172:175],v[60:63]
v_or3_b32 v185,v151,v152,v185
v_cmp_ne_u32 vcc,0,v184
mm v[60:63],a[220:223],a[188:191],v[60:63]
s_cbranch_vccnz attn_stub_tail1_0
attn_back_tail1_0:
mm a[224:227],a[240:243],v[128:131],a[224:227]
v_exp_f32 v179,v107
mm a[228:231],a[240:243],v[132:135],a[228:231]
v_exp_f32 v180,v120
mm a[232:235],a[240:243],v[136:139],a[232:235]
tr a[212:213],v195 offset:0
cv v153,v178,v179
mm a[236:239],a[240:243],v[140:143],a[236:239]
tr a[214:215],v195 offset:4096
s_waitcnt lgkmcnt(8)
mm a[0:3],a[192:195],v[128:131],a[0:3]
v_exp_f32 v181,v121
mm a[4:7],a[192:195],v[132:135],a[4:7]
v_exp_f32 v182,v122
mm a[8:11],a[192:195],v[136:139],a[8:11]
tr a[216:217],v196 offset:0
cv v154,v180,v181
mm a[12:15],a[192:195],v[140:143],a[12:15]
v_exp_f32 v183,v123
mm a[16:19],a[196:199],v[128:131],a[16:19]
tr a[218:219],v196 offset:4096
v_or3_b32 v185,v153,v154,v185
mm a[20:23],a[196:199],v[132:135],a[20:23]
v_exp_f32 v176,v108
mm a[24:27],a[196:199],v[136:139],a[24:27]
tr a[220:221],v197 offset:0
cv v155,v182,v183
mm a[28:31],a[196:199],v[140:143],a[28:31]
tr a[222:223],v197 offset:4096
s_waitcnt lgkmcnt(8)
mm a[32:35],a[200:203],v[128:131],a[32:35]
v_exp_f32 v177,v109
mm a[36:39],a[200:203],v[132:135],a[36:39]
v_exp_f32 v178,v110
mm a[40:43],a[200:203],v[136:139],a[40:43]
tr a[192:193],v190 offset:8192
cv v156,v176,v177
mm a[44:47],a[200:203],v[140:143],a[44:47]
v_exp_f32 v179,v111
mm a[48:51],a[204:207],v[128:131],a[48:51]
tr a[194:195],v190 offset:12288
v_or3_b32 v185,v155,v156,v185
mm a[52:55],a[204:207],v[132:135],a[52:55]
v_exp_f32 v180,v124
mm a[56:59],a[204:207],v[136:139],a[56:59]
tr a[196:197],v191 offset:8192
cv v157,v178,v179
mm a[60:63],a[204:207],v[140:143],a[60:63]
tr a[198:199],v191 offset:12288
s_waitcnt lgkmcnt(8)
mm a[64:67],a[208:211],v[128:131],a[64:67]
v_exp_f32 v181,v125
mm a[68:71],a[208:211],v[132:135],a[68:71]
v_exp_f32 v182,v126
mm a[72:75],a[208:211],v[136:139],a[72:75]
tr a[200:201],v192 offset:8192
cv v158,v180,v181
mm a[76:79],a[208:211],v[140:143],a[76:79]
v_exp_f32 v183,v127
mm a[80:83],a[212:215],v[128:131],a[80:83]
tr a[202:203],v192 offset:12288
v_or3_b32 v185,v157,v158,v185
mm a[84:87],a[212:215],v[132:135],a[84:87]
tr a[204:205],v193 offset:8192
cv v159,v182,v183
mm a[88:91],a[212:215],v[136:139],a[88:91]
tr a[206:207],v193 offset:12288
v_bitop3_b32 v185,v185,v159,s45 bitop3:0xa8
mm a[92:95],a[212:215],v[140:143],a[92:95]
s_waitcnt lgkmcnt(8)
mm a[96:99],a[216:219],v[128:131],a[96:99]
tr a[208:209],v194 offset:8192
mm a[100:103],a[216:219],v[132:135],a[100:103]
tr a[210:211],v194 offset:12288
mm a[104:107],a[216:219],v[136:139],a[104:107]
mm a[108:111],a[216:219],v[140:143],a[108:111]
mm a[112:115],a[220:223],v[128:131],a[112:115]
mm a[116:119],a[220:223],v[132:135],a[116:119]
mm a[120:123],a[220:223],v[136:139],a[120:123]
v_cmp_ne_u32 vcc,0,v185
mm a[124:127],a[220:223],v[140:143],a[124:127]
s_cbranch_vccnz attn_stub_tail1_1
attn_back_tail1_1:
mm a[224:227],a[240:243],v[144:147],a[224:227]
v_exp_f32 v176,v0
mm a[228:231],a[240:243],v[148:151],a[228:231]
v_exp_f32 v177,v1
mm a[232:235],a[240:243],v[152:155],a[232:235]
v_exp_f32 v178,v2
mm a[236:239],a[240:243],v[156:159],a[236:239]
cv v128,v176,v177
s_waitcnt lgkmcnt(6)
mm a[0:3],a[192:195],v[144:147],a[0:3]
v_exp_f32 v179,v3
mm a[4:7],a[192:195],v[148:151],a[4:7]
tr a[212:213],v195 offset:8192
cv v129,v178,v179
mm a[8:11],a[192:195],v[152:155],a[8:11]
v_exp_f32 v180,v16
mm a[12:15],a[192:195],v[156:159],a[12:15]
v_exp_f32 v181,v17
mm a[16:19],a[196:199],v[144:147],a[16:19]
tr a[214:215],v195 offset:12288
cv v130,v180,v181
mm a[20:23],a[196:199],v[148:151],a[20:23]
tr a[216:217],v196 offset:8192
v_or3_b32 v184,v128,v129,v130
mm a[24:27],a[196:199],v[152:155],a[24:27]
v_exp_f32 v182,v18
mm a[28:31],a[196:199],v[156:159],a[28:31]
tr a[218:219],v196 offset:12288
s_waitcnt lgkmcnt(6)
mm a[32:35],a[200:203],v[144:147],a[32:35]
v_exp_f32 v183,v19
mm a[36:39],a[200:203],v[148:151],a[36:39]
tr a[220:221],v197 offset:8192
cv v131,v182,v183
mm a[40:43],a[200:203],v[152:155],a[40:43]
v_exp_f32 v176,v4
mm a[44:47],a[200:203],v[156:159],a[44:47]
v_exp_f32 v177,v5
mm a[48:51],a[204:207],v[144:147],a[48:51]
tr a[222:223],v197 offset:12288
cv v132,v176,v177
mm a[52:55],a[204:207],v[148:151],a[52:55]
ds_read_b128 a[192:195],v186 offset:16384
v_or3_b32 v184,v131,v132,v184
mm a[56:59],a[204:207],v[152:155],a[56:59]
v_exp_f32 v178,v6
mm a[60:63],a[204:207],v[156:159],a[60:63]
ds_read_b128 a[196:199],v187 offset:16384
s_waitcnt lgkmcnt(6)
mm a[64:67],a[208:211],v[144:147],a[64:67]
v_exp_f32 v179,v7
mm a[68:71],a[208:211],v[148:151],a[68:71]
v_exp_f32 v180,v20
mm a[72:75],a[208:211],v[152:155],a[72:75]
ds_read_b128 a[200:203],v188 offset:16384
cv v133,v178,v179
mm a[76:79],a[208:211],v[156:159],a[76:79]
v_exp_f32 v181,v21
mm a[80:83],a[212:215],v[144:147],a[80:83]
v_exp_f32 v182,v22
mm a[84:87],a[212:215],v[148:151],a[84:87]
ds_read_b128 a[204:207],v189 offset:16384
cv v134,v180,v181
mm a[88:91],a[212:215],v[152:155],a[88:91]
v_exp_f32 v183,v23
mm a[92:95],a[212:215],v[156:159],a[92:95]
v_or3_b32 v184,v133,v134,v184
s_waitcnt lgkmcnt(4)
mm a[96:99],a[216:219],v[144:147],a[96:99]
ds_read_b128 a[208:211],v186 offset:20480
cv v135,v182,v183
mm a[100:103],a[216:219],v[148:151],a[100:103]
mm a[104:107],a[216:219],v[152:155],a[104:107]
mm a[108:111],a[216:219],v[156:159],a[108:111]
mm a[112:115],a[220:223],v[144:147],a[112:115]
s_waitcnt vmcnt(4)
mm a[116:119],a[220:223],v[148:151],a[116:119]
s_barrier
mm a[120:123],a[220:223],v[152:155],a[120:123]
mm a[124:127],a[220:223],v[156:159],a[124:127]
s_waitcnt lgkmcnt(3)
mm v[64:67],a[192:195],a[128:131],v[160:163]
v_exp_f32 v176,v8
mm v[64:67],a[196:199],a[144:147],v[64:67]
v_exp_f32 v177,v9
mm v[68:71],a[192:195],a[132:135],v[164:167]
ds_read_b128 a[212:215],v187 offset:20480
cv v136,v176,v177
mm v[68:71],a[196:199],a[148:151],v[68:71]
v_exp_f32 v178,v10
mm v[72:75],a[192:195],a[136:139],v[168:171]
v_exp_f32 v179,v11
mm v[72:75],a[196:199],a[152:155],v[72:75]
ds_read_b128 a[216:219],v188 offset:20480
v_or3_b32 v184,v135,v136,v184
mm v[76:79],a[192:195],a[140:143],v[172:175]
v_exp_f32 v180,v24
mm v[76:79],a[196:199],a[156:159],v[76:79]
cv v137,v178,v179
s_waitcnt lgkmcnt(3)
mm v[64:67],a[200:203],a[160:163],v[64:67]
v_exp_f32 v181,v25
mm v[64:67],a[204:207],a[176:179],v[64:67]
ds_read_b128 a[220:223],v189 offset:20480
cv v138,v180,v181
mm v[68:71],a[200:203],a[164:167],v[68:71]
v_exp_f32 v182,v26
mm v[68:71],a[204:207],a[180:183],v[68:71]
v_exp_f32 v183,v27
mm v[72:75],a[200:203],a[168:171],v[72:75]
ds_read_b128 a[192:195],v186 offset:24576
v_or3_b32 v184,v137,v138,v184
mm v[72:75],a[204:207],a[184:187],v[72:75]
v_exp_f32 v176,v12
mm v[76:79],a[200:203],a[172:175],v[76:79]
ds_read_b128 a[196:199],v187 offset:24576
cv v139,v182,v183
mm v[76:79],a[204:207],a[188:191],v[76:79]
s_waitcnt lgkmcnt(4)
mm v[80:83],a[208:211],a[128:131],v[160:163]
v_exp_f32 v177,v13
mm v[80:83],a[212:215],a[144:147],v[80:83]
v_exp_f32 v178,v14
mm v[84:87],a[208:211],a[132:135],v[164:167]
ds_read_b128 a[200:203],v188 offset:24576
cv v140,v176,v177
mm v[84:87],a[212:215],a[148:151],v[84:87]
v_exp_f32 v179,v15
mm v[88:91],a[208:211],a[136:139],v[168:171]
v_exp_f32 v180,v28
mm v[88:91],a[212:215],a[152:155],v[88:91]
v_or3_b32 v184,v139,v140,v184
cv v141,v178,v179
mm v[92:95],a[208:211],a[140:143],v[172:175]
v_exp_f32 v181,v29
mm v[92:95],a[212:215],a[156:159],v[92:95]
ds_read_b128 a[204:207],v189 offset:24576
s_waitcnt lgkmcnt(4)
mm v[80:83],a[216:219],a[160:163],v[80:83]
v_exp_f32 v182,v30
mm v[80:83],a[220:223],a[176:179],v[80:83]
ds_read_b128 a[208:211],v186 offset:28672
cv v142,v180,v181
mm v[84:87],a[216:219],a[164:167],v[84:87]
v_exp_f32 v183,v31
mm v[84:87],a[220:223],a[180:183],v[84:87]
v_exp_f32 v176,v32
mm v[88:91],a[216:219],a[168:171],v[88:91]
v_or3_b32 v184,v141,v142,v184
cv v143,v182,v183
mm v[88:91],a[220:223],a[184:187],v[88:91]
v_exp_f32 v177,v33
mm v[92:95],a[216:219],a[172:175],v[92:95]
ds_read_b128 a[212:215],v187 offset:28672
v_bitop3_b32 v184,v184,v143,s45 bitop3:0xa8
mm v[92:95],a[220:223],a[188:191],v[92:95]
cv v144,v176,v177
s_waitcnt lgkmcnt(4)
mm v[96:99],a[192:195],a[128:131],v[160:163]
v_exp_f32 v178,v34
mm v[96:99],a[196:199],a[144:147],v[96:99]
v_exp_f32 v179,v35
mm v[100:103],a[192:195],a[132:135],v[164:167]
v_exp_f32 v180,v48
mm v[100:103],a[196:199],a[148:151],v[100:103]
ds_read_b128 a[216:219],v188 offset:28672
cv v145,v178,v179
mm v[104:107],a[192:195],a[136:139],v[168:171]
v_exp_f32 v181,v49
mm v[104:107],a[196:199],a[152:155],v[104:107]
v_exp_f32 v182,v50
mm v[108:111],a[192:195],a[140:143],v[172:175]
ds_read_b128 a[220:223],v189 offset:28672
cv v146,v180,v181
mm v[108:111],a[196:199],a[156:159],v[108:111]
v_or3_b32 v185,v144,v145,v146
s_waitcnt lgkmcnt(4)
mm v[96:99],a[200:203],a[160:163],v[96:99]
v_exp_f32 v183,v51
mm v[96:99],a[204:207],a[176:179],v[96:99]
v_exp_f32 v176,v36
mm v[100:103],a[200:203],a[164:167],v[100:103]
tr a[192:193],v190 offset:16384
cv v147,v182,v183
mm v[100:103],a[204:207],a[180:183],v[100:103]
v_exp_f32 v177,v37
mm v[104:107],a[200:203],a[168:171],v[104:107]
tr a[194:195],v190 offset:20480
cv v148,v176,v177
mm v[104:107],a[204:207],a[184:187],v[104:107]
v_exp_f32 v178,v38
mm v[108:111],a[200:203],a[172:175],v[108:111]
tr a[196:197],v191 offset:16384
v_or3_b32 v185,v147,v148,v185
mm v[108:111],a[204:207],a[188:191],v[108:111]
tr a[198:199],v191 offset:20480
s_waitcnt lgkmcnt(6)
mm v[112:115],a[208:211],a[128:131],v[160:163]
v_exp_f32 v179,v39
mm v[112:115],a[212:215],a[144:147],v[112:115]
v_exp_f32 v180,v52
mm v[116:119],a[208:211],a[132:135],v[164:167]
tr a[200:201],v192 offset:16384
cv v149,v178,v179
mm v[116:119],a[212:215],a[148:151],v[116:119]
v_exp_f32 v181,v53
mm v[120:123],a[208:211],a[136:139],v[168:171]
tr a[202:203],v192 offset:20480
cv v150,v180,v181
mm v[120:123],a[212:215],a[152:155],v[120:123]
v_exp_f32 v182,v54
mm v[124:127],a[208:211],a[140:143],v[172:175]
tr a[204:205],v193 offset:16384
v_or3_b32 v185,v149,v150,v185
mm v[124:127],a[212:215],a[156:159],v[124:127]
tr a[206:207],v193 offset:20480
s_waitcnt lgkmcnt(8)
mm v[112:115],a[216:219],a[160:163],v[112:115]
v_exp_f32 v183,v55
mm v[112:115],a[220:223],a[176:179],v[112:115]
v_exp_f32 v176,v40
mm v[116:119],a[216:219],a[164:167],v[116:119]
tr a[208:209],v194 offset:16384
cv v151,v182,v183
mm v[116:119],a[220:223],a[180:183],v[116:119]
v_exp_f32 v177,v41
mm v[120:123],a[216:219],a[168:171],v[120:123]
tr a[210:211],v194 offset:20480
cv v152,v176,v177
mm v[120:123],a[220:223],a[184:187],v[120:123]
v_exp_f32 v178,v42
mm v[124:127],a[216:219],a[172:175],v[124:127]
v_or3_b32 v185,v151,v152,v185
v_cmp_ne_u32 vcc,0,v184
mm v[124:127],a[220:223],a[188:191],v[124:127]
s_cbranch_vccnz attn_stub_tail2_0
attn_back_tail2_0:
mm a[224:227],a[240:243],v[128:131],a[224:227]
v_exp_f32 v179,v43
mm a[228:231],a[240:243],v[132:135],a[228:231]
v_exp_f32 v180,v56
mm a[232:235],a[240:243],v[136:139],a[232:235]
tr a[212:213],v195 offset:16384
cv v153,v178,v179
mm a[236:239],a[240:243],v[140:143],a[236:239]
tr a[214:215],v195 offset:20480
s_waitcnt lgkmcnt(8)
mm a[0:3],a[192:195],v[128:131],a[0:3]
v_exp_f32 v181,v57
mm a[4:7],a[192:195],v[132:135],a[4:7]
v_exp_f32 v182,v58
mm a[8:11],a[192:195],v[136:139],a[8:11]
tr a[216:217],v196 offset:16384
cv v154,v180,v181
mm a[12:15],a[192:195],v[140:143],a[12:15]
v_exp_f32 v183,v59
mm a[16:19],a[196:199],v[128:131],a[16:19]
tr a[218:219],v196 offset:20480
v_or3_b32 v185,v153,v154,v185
mm a[20:23],a[196:199],v[132:135],a[20:23]
v_exp_f32 v176,v44
mm a[24:27],a[196:199],v[136:139],a[24:27]
tr a[220:221],v197 offset:16384
cv v155,v182,v183
mm a[28:31],a[196:199],v[140:143],a[28:31]
tr a[222:223],v197 offset:20480
s_waitcnt lgkmcnt(8)
mm a[32:35],a[200:203],v[128:131],a[32:35]
v_exp_f32 v177,v45
mm a[36:39],a[200:203],v[132:135],a[36:39]
v_exp_f32 v178,v46
mm a[40:43],a[200:203],v[136:139],a[40:43]
tr a[192:193],v190 offset:24576
cv v156,v176,v177
mm a[44:47],a[200:203],v[140:143],a[44:47]
v_exp_f32 v179,v47
mm a[48:51],a[204:207],v[128:131],a[48:51]
tr a[194:195],v190 offset:28672
v_or3_b32 v185,v155,v156,v185
mm a[52:55],a[204:207],v[132:135],a[52:55]
v_exp_f32 v180,v60
mm a[56:59],a[204:207],v[136:139],a[56:59]
tr a[196:197],v191 offset:24576
cv v157,v178,v179
mm a[60:63],a[204:207],v[140:143],a[60:63]
tr a[198:199],v191 offset:28672
s_waitcnt lgkmcnt(8)
mm a[64:67],a[208:211],v[128:131],a[64:67]
v_exp_f32 v181,v61
mm a[68:71],a[208:211],v[132:135],a[68:71]
v_exp_f32 v182,v62
mm a[72:75],a[208:211],v[136:139],a[72:75]
tr a[200:201],v192 offset:24576
cv v158,v180,v181
mm a[76:79],a[208:211],v[140:143],a[76:79]
v_exp_f32 v183,v63
mm a[80:83],a[212:215],v[128:131],a[80:83]
tr a[202:203],v192 offset:28672
v_or3_b32 v185,v157,v158,v185
mm a[84:87],a[212:215],v[132:135],a[84:87]
tr a[204:205],v193 offset:24576
cv v159,v182,v183
mm a[88:91],a[212:215],v[136:139],a[88:91]
tr a[206:207],v193 offset:28672
v_bitop3_b32 v185,v185,v159,s45 bitop3:0xa8
mm a[92:95],a[212:215],v[140:143],a[92:95]
s_waitcnt lgkmcnt(8)
mm a[96:99],a[216:219],v[128:131],a[96:99]
tr a[208:209],v194 offset:24576
mm a[100:103],a[216:219],v[132:135],a[100:103]
tr a[210:211],v194 offset:28672
mm a[104:107],a[216:219],v[136:139],a[104:107]
mm a[108:111],a[216:219],v[140:143],a[108:111]
mm a[112:115],a[220:223],v[128:131],a[112:115]
mm a[116:119],a[220:223],v[132:135],a[116:119]
mm a[120:123],a[220:223],v[136:139],a[120:123]
v_cmp_ne_u32 vcc,0,v185
mm a[124:127],a[220:223],v[140:143],a[124:127]
s_cbranch_vccnz attn_stub_tail2_1
attn_back_tail2_1:
mm a[224:227],a[240:243],v[144:147],a[224:227]
v_exp_f32 v176,v64
mm a[228:231],a[240:243],v[148:151],a[228:231]
v_exp_f32 v177,v65
mm a[232:235],a[240:243],v[152:155],a[232:235]
v_exp_f32 v178,v66
mm a[236:239],a[240:243],v[156:159],a[236:239]
cv v128,v176,v177
s_waitcnt lgkmcnt(6)
mm a[0:3],a[192:195],v[144:147],a[0:3]
v_exp_f32 v179,v67
mm a[4:7],a[192:195],v[148:151],a[4:7]
tr a[212:213],v195 offset:24576
cv v129,v178,v179
mm a[8:11],a[192:195],v[152:155],a[8:11]
v_exp_f32 v180,v80
mm a[12:15],a[192:195],v[156:159],a[12:15]
v_exp_f32 v181,v81
mm a[16:19],a[196:199],v[144:147],a[16:19]
tr a[214:215],v195 offset:28672
cv v130,v180,v181
mm a[20:23],a[196:199],v[148:151],a[20:23]
tr a[216:217],v196 offset:24576
v_or3_b32 v184,v128,v129,v130
mm a[24:27],a[196:199],v[152:155],a[24:27]
v_exp_f32 v182,v82
mm a[28:31],a[196:199],v[156:159],a[28:31]
tr a[218:219],v196 offset:28672
s_waitcnt lgkmcnt(6)
mm a[32:35],a[200:203],v[144:147],a[32:35]
v_exp_f32 v183,v83
mm a[36:39],a[200:203],v[148:151],a[36:39]
tr a[220:221],v197 offset:24576
cv v131,v182,v183
mm a[40:43],a[200:203],v[152:155],a[40:43]
v_exp_f32 v176,v68
mm a[44:47],a[200:203],v[156:159],a[44:47]
v_exp_f32 v177,v69
mm a[48:51],a[204:207],v[144:147],a[48:51]
tr a[222:223],v197 offset:28672
cv v132,v176,v177
mm a[52:55],a[204:207],v[148:151],a[52:55]
v_exp_f32 v178,v70
mm a[56:59],a[204:207],v[152:155],a[56:59]
v_exp_f32 v179,v71
mm a[60:63],a[204:207],v[156:159],a[60:63]
v_or3_b32 v184,v131,v132,v184
s_waitcnt lgkmcnt(4)
mm a[64:67],a[208:211],v[144:147],a[64:67]
v_exp_f32 v180,v84
mm a[68:71],a[208:211],v[148:151],a[68:71]
v_exp_f32 v181,v85
mm a[72:75],a[208:211],v[152:155],a[72:75]
v_exp_f32 v182,v86
mm a[76:79],a[208:211],v[156:159],a[76:79]
v_exp_f32 v183,v87
mm a[80:83],a[212:215],v[144:147],a[80:83]
cv v133,v178,v179
cv v134,v180,v181
mm a[84:87],a[212:215],v[148:151],a[84:87]
v_or3_b32 v184,v133,v134,v184
cv v135,v182,v183
mm a[88:91],a[212:215],v[152:155],a[88:91]
mm a[92:95],a[212:215],v[156:159],a[92:95]
s_waitcnt lgkmcnt(0)
mm a[96:99],a[216:219],v[144:147],a[96:99]
mm a[100:103],a[216:219],v[148:151],a[100:103]
mm a[104:107],a[216:219],v[152:155],a[104:107]
mm a[108:111],a[216:219],v[156:159],a[108:111]
mm a[112:115],a[220:223],v[144:147],a[112:115]
s_waitcnt vmcnt(0)
mm a[116:119],a[220:223],v[148:151],a[116:119]
s_barrier
mm a[120:123],a[220:223],v[152:155],a[120:123]
mm a[124:127],a[220:223],v[156:159],a[124:127]
tr a[192:193],v190 offset:32768
tr a[194:195],v190 offset:36864
tr a[196:197],v191 offset:32768
tr a[198:199],v191 offset:36864
tr a[200:201],v192 offset:32768
tr a[202:203],v192 offset:36864
tr a[204:205],v193 offset:32768
tr a[206:207],v193 offset:36864
tr a[208:209],v194 offset:32768
tr a[210:211],v194 offset:36864
v_exp_f32 v176,v72
v_exp_f32 v177,v73
s_nop 0
cv v136,v176,v177
v_or3_b32 v184,v135,v136,v184
v_exp_f32 v178,v74
v_exp_f32 v179,v75
s_nop 0
cv v137,v178,v179
v_exp_f32 v180,v88
v_exp_f32 v181,v89
s_nop 0
cv v138,v180,v181
v_or3_b32 v184,v137,v138,v184
v_exp_f32 v182,v90
v_exp_f32 v183,v91
s_nop 0
cv v139,v182,v183
v_exp_f32 v176,v76
v_exp_f32 v177,v77
s_nop 0
cv v140,v176,v177
v_or3_b32 v184,v139,v140,v184
v_exp_f32 v178,v78
v_exp_f32 v179,v79
s_nop 0
cv v141,v178,v179
v_exp_f32 v180,v92
v_exp_f32 v181,v93
s_nop 0
cv v142,v180,v181
v_or3_b32 v184,v141,v142,v184
v_exp_f32 v182,v94
v_exp_f32 v183,v95
s_nop 0
cv v143,v182,v183
v_bitop3_b32 v184,v184,v143,s45 bitop3:0xa8
v_cmp_ne_u32 vcc,0,v184
s_nop 0
s_cbranch_vccnz attn_stub_tail3_0
attn_back_tail3_0:
mm a[224:227],a[240:243],v[128:131],a[224:227]
v_exp_f32 v176,v96
v_exp_f32 v177,v97
mm a[228:231],a[240:243],v[132:135],a[228:231]
v_exp_f32 v178,v98
v_exp_f32 v179,v99
mm a[232:235],a[240:243],v[136:139],a[232:235]
v_exp_f32 v180,v112
cv v144,v176,v177
cv v145,v178,v179
mm a[236:239],a[240:243],v[140:143],a[236:239]
ds_write_b64 v240,v[244:245]
v_exp_f32 v181,v113
s_waitcnt lgkmcnt(7)
mm a[0:3],a[192:195],v[128:131],a[0:3]
v_exp_f32 v182,v114
v_exp_f32 v183,v115
mm a[4:7],a[192:195],v[132:135],a[4:7]
ds_read_b128 a[128:131],v243 offset:0
v_exp_f32 v176,v100
cv v146,v180,v181
mm a[8:11],a[192:195],v[136:139],a[8:11]
tr a[212:213],v195 offset:32768
v_exp_f32 v177,v101
cv v147,v182,v183
mm a[12:15],a[192:195],v[140:143],a[12:15]
tr a[214:215],v195 offset:36864
v_exp_f32 v178,v102
v_or3_b32 v185,v144,v145,v146
mm a[16:19],a[196:199],v[128:131],a[16:19]
ds_read_b128 a[132:135],v243 offset:64
v_exp_f32 v179,v103
cv v148,v176,v177
mm a[20:23],a[196:199],v[132:135],a[20:23]
tr a[216:217],v196 offset:32768
v_exp_f32 v180,v116
cv v149,v178,v179
mm a[24:27],a[196:199],v[136:139],a[24:27]
tr a[218:219],v196 offset:36864
v_exp_f32 v181,v117
v_or3_b32 v185,v147,v148,v185
mm a[28:31],a[196:199],v[140:143],a[28:31]
ds_read_b128 a[136:139],v243 offset:128
v_exp_f32 v182,v118
s_waitcnt lgkmcnt(10)
mm a[32:35],a[200:203],v[128:131],a[32:35]
ds_read_b128 a[140:143],v243 offset:192
v_exp_f32 v183,v119
cv v150,v180,v181
mm a[36:39],a[200:203],v[132:135],a[36:39]
tr a[220:221],v197 offset:32768
v_exp_f32 v176,v104
cv v151,v182,v183
mm a[40:43],a[200:203],v[136:139],a[40:43]
tr a[222:223],v197 offset:36864
v_exp_f32 v177,v105
v_or3_b32 v185,v149,v150,v185
mm a[44:47],a[200:203],v[140:143],a[44:47]
ds_read_b128 a[144:147],v243 offset:256
v_exp_f32 v178,v106
cv v152,v176,v177
mm a[48:51],a[204:207],v[128:131],a[48:51]
v_exp_f32 v179,v107
v_exp_f32 v180,v120
mm a[52:55],a[204:207],v[132:135],a[52:55]
ds_read_b128 a[148:151],v243 offset:320
v_exp_f32 v181,v121
cv v153,v178,v179
mm a[56:59],a[204:207],v[136:139],a[56:59]
tr a[192:193],v190 offset:40960
v_exp_f32 v182,v122
v_or3_b32 v185,v151,v152,v185
mm a[60:63],a[204:207],v[140:143],a[60:63]
tr a[194:195],v190 offset:45056
v_exp_f32 v183,v123
s_waitcnt lgkmcnt(11)
mm a[64:67],a[208:211],v[128:131],a[64:67]
ds_read_b128 a[152:155],v243 offset:384
v_exp_f32 v176,v108
cv v154,v180,v181
mm a[68:71],a[208:211],v[132:135],a[68:71]
v_exp_f32 v177,v109
v_exp_f32 v178,v110
mm a[72:75],a[208:211],v[136:139],a[72:75]
tr a[196:197],v191 offset:40960
cv v155,v182,v183
v_exp_f32 v179,v111
mm a[76:79],a[208:211],v[140:143],a[76:79]
tr a[198:199],v191 offset:45056
v_exp_f32 v180,v124
v_or3_b32 v185,v153,v154,v185
mm a[80:83],a[212:215],v[128:131],a[80:83]
ds_read_b128 a[156:159],v243 offset:448
v_exp_f32 v181,v125
cv v156,v176,v177
mm a[84:87],a[212:215],v[132:135],a[84:87]
tr a[160:161],v242 offset:0
v_exp_f32 v182,v126
cv v157,v178,v179
mm a[88:91],a[212:215],v[136:139],a[88:91]
tr a[200:201],v192 offset:40960
v_exp_f32 v183,v127
v_or3_b32 v185,v155,v156,v185
mm a[92:95],a[212:215],v[140:143],a[92:95]
tr a[202:203],v192 offset:45056
cv v158,v180,v181
cv v159,v182,v183
s_waitcnt lgkmcnt(11)
mm a[96:99],a[216:219],v[128:131],a[96:99]
tr a[162:163],v242 offset:512
v_or3_b32 v185,v157,v158,v185
v_bitop3_b32 v185,v185,v159,s45 bitop3:0xa8
mm a[100:103],a[216:219],v[132:135],a[100:103]
tr a[164:165],v242 offset:1024
mm a[104:107],a[216:219],v[136:139],a[104:107]
tr a[204:205],v193 offset:40960
mm a[108:111],a[216:219],v[140:143],a[108:111]
tr a[206:207],v193 offset:45056
mm a[112:115],a[220:223],v[128:131],a[112:115]
tr a[166:167],v242 offset:1536
mm a[116:119],a[220:223],v[132:135],a[116:119]
tr a[208:209],v194 offset:40960
mm a[120:123],a[220:223],v[136:139],a[120:123]
tr a[210:211],v194 offset:45056
v_cmp_ne_u32 vcc,0,v185
mm a[124:127],a[220:223],v[140:143],a[124:127]
tr a[168:169],v242 offset:2048
s_cbranch_vccnz attn_stub_tail3_1
attn_back_tail3_1:
mm a[224:227],a[240:243],v[144:147],a[224:227]
tr a[170:171],v242 offset:2560
mm a[228:231],a[240:243],v[148:151],a[228:231]
tr a[212:213],v195 offset:40960
mm a[232:235],a[240:243],v[152:155],a[232:235]
tr a[214:215],v195 offset:45056
mm a[236:239],a[240:243],v[156:159],a[236:239]
tr a[172:173],v242 offset:3072
s_waitcnt lgkmcnt(15)
mm a[0:3],a[192:195],v[144:147],a[0:3]
tr a[216:217],v196 offset:40960
mm a[4:7],a[192:195],v[148:151],a[4:7]
tr a[174:175],v242 offset:3584
mm a[8:11],a[192:195],v[152:155],a[8:11]
tr a[218:219],v196 offset:45056
mm a[12:15],a[192:195],v[156:159],a[12:15]
tr a[176:177],v242 offset:4096
mm a[16:19],a[196:199],v[144:147],a[16:19]
tr a[220:221],v197 offset:40960
mm a[20:23],a[196:199],v[148:151],a[20:23]
tr a[222:223],v197 offset:45056
mm a[24:27],a[196:199],v[152:155],a[24:27]
tr a[178:179],v242 offset:4608
mm a[28:31],a[196:199],v[156:159],a[28:31]
s_waitcnt lgkmcnt(15)
mm a[32:35],a[200:203],v[144:147],a[32:35]
tr a[180:181],v242 offset:5120
mm a[36:39],a[200:203],v[148:151],a[36:39]
mm a[40:43],a[200:203],v[152:155],a[40:43]
mm a[44:47],a[200:203],v[156:159],a[44:47]
tr a[182:183],v242 offset:5632
mm a[48:51],a[204:207],v[144:147],a[48:51]
mm a[52:55],a[204:207],v[148:151],a[52:55]
tr a[184:185],v242 offset:6144
mm a[56:59],a[204:207],v[152:155],a[56:59]
mm a[60:63],a[204:207],v[156:159],a[60:63]
tr a[186:187],v242 offset:6656
s_waitcnt lgkmcnt(12)
mm a[64:67],a[208:211],v[144:147],a[64:67]
mm a[68:71],a[208:211],v[148:151],a[68:71]
mm a[72:75],a[208:211],v[152:155],a[72:75]
tr a[188:189],v242 offset:7168
mm a[76:79],a[208:211],v[156:159],a[76:79]
mm a[80:83],a[212:215],v[144:147],a[80:83]
tr a[190:191],v242 offset:7680
mm a[84:87],a[212:215],v[148:151],a[84:87]
mm a[88:91],a[212:215],v[152:155],a[88:91]
mm a[92:95],a[212:215],v[156:159],a[92:95]
s_waitcnt lgkmcnt(7)
mm a[96:99],a[216:219],v[144:147],a[96:99]
mm a[100:103],a[216:219],v[148:151],a[100:103]
mm a[104:107],a[216:219],v[152:155],a[104:107]
mm a[108:111],a[216:219],v[156:159],a[108:111]
mm a[112:115],a[220:223],v[144:147],a[112:115]
mm a[116:119],a[220:223],v[148:151],a[116:119]
mm a[120:123],a[220:223],v[152:155],a[120:123]
mm a[124:127],a[220:223],v[156:159],a[124:127]
attn_epi:
ar v204,a224
ar v206,a228
ar v208,a232
ar v210,a236
v_rcp_f32 v204,v204
v_rcp_f32 v206,v206
v_rcp_f32 v208,v208
v_rcp_f32 v210,v210
mm v[212:215],a[160:163],a[128:131],0
mm v[212:215],a[164:167],a[132:135],v[212:215]
mm v[212:215],a[168:171],a[136:139],v[212:215]
mm v[212:215],a[172:175],a[140:143],v[212:215]
s_waitcnt lgkmcnt(6)
mm v[212:215],a[176:179],a[144:147],v[212:215]
s_waitcnt lgkmcnt(4)
mm v[212:215],a[180:183],a[148:151],v[212:215]
s_waitcnt lgkmcnt(2)
mm v[212:215],a[184:187],a[152:155],v[212:215]
s_waitcnt lgkmcnt(0)
mm v[212:215],a[188:191],a[156:159],v[212:215]
ar v0,a0
ar v1,a1
ar v2,a2
ar v3,a3
ar v4,a16
ar v5,a17
ar v6,a18
ar v7,a19
v_pk_mul_f32 v[0:1],v[0:1],v[204:205] op_sel_hi:[1,0]
v_pk_mul_f32 v[2:3],v[2:3],v[204:205] op_sel_hi:[1,0]
v_pk_mul_f32 v[4:5],v[4:5],v[204:205] op_sel_hi:[1,0]
v_pk_mul_f32 v[6:7],v[6:7],v[204:205] op_sel_hi:[1,0]
cv v8,v0,v1
cv v9,v2,v3
cv v10,v4,v5
cv v11,v6,v7
buffer_store_dwordx4 v[8:11],v221,s[24:27],s33 offen offset:0 sc1
ar v12,a32
ar v13,a33
ar v14,a34
ar v15,a35
ar v16,a48
ar v17,a49
ar v18,a50
ar v19,a51
v_pk_mul_f32 v[12:13],v[12:13],v[204:205] op_sel_hi:[1,0]
v_pk_mul_f32 v[14:15],v[14:15],v[204:205] op_sel_hi:[1,0]
v_pk_mul_f32 v[16:17],v[16:17],v[204:205] op_sel_hi:[1,0]
v_pk_mul_f32 v[18:19],v[18:19],v[204:205] op_sel_hi:[1,0]
cv v20,v12,v13
cv v21,v14,v15
cv v22,v16,v17
cv v23,v18,v19
buffer_store_dwordx4 v[20:23],v221,s[24:27],s33 offen offset:1024 sc1
ar v24,a64
ar v25,a65
ar v26,a66
ar v27,a67
ar v28,a80
ar v29,a81
ar v30,a82
ar v31,a83
v_pk_mul_f32 v[24:25],v[24:25],v[204:205] op_sel_hi:[1,0]
v_pk_mul_f32 v[26:27],v[26:27],v[204:205] op_sel_hi:[1,0]
v_pk_mul_f32 v[28:29],v[28:29],v[204:205] op_sel_hi:[1,0]
v_pk_mul_f32 v[30:31],v[30:31],v[204:205] op_sel_hi:[1,0]
cv v32,v24,v25
cv v33,v26,v27
cv v34,v28,v29
cv v35,v30,v31
buffer_store_dwordx4 v[32:35],v221,s[24:27],s33 offen offset:2048 sc1
ar v36,a96
ar v37,a97
ar v38,a98
ar v39,a99
ar v40,a112
ar v41,a113
ar v42,a114
ar v43,a115
v_pk_mul_f32 v[36:37],v[36:37],v[204:205] op_sel_hi:[1,0]
v_pk_mul_f32 v[38:39],v[38:39],v[204:205] op_sel_hi:[1,0]
v_pk_mul_f32 v[40:41],v[40:41],v[204:205] op_sel_hi:[1,0]
v_pk_mul_f32 v[42:43],v[42:43],v[204:205] op_sel_hi:[1,0]
cv v44,v36,v37
cv v45,v38,v39
cv v46,v40,v41
cv v47,v42,v43
buffer_store_dwordx4 v[44:47],v221,s[24:27],s33 offen offset:3072 sc1
s_add_u32 s33,s33,131072
s_lshl_b32 s38,s30,6
s_add_u32 s38,s38,147456
v_add_u32 v216,s38,v220
s_mov_b32 exec_lo,0x00010001
s_mov_b32 exec_hi,0x00010001
ds_write_b128 v216,v[212:215]
s_mov_b64 exec,-1
ar v48,a4
ar v49,a5
ar v50,a6
ar v51,a7
ar v52,a20
ar v53,a21
ar v54,a22
ar v55,a23
v_pk_mul_f32 v[48:49],v[48:49],v[206:207] op_sel_hi:[1,0]
v_pk_mul_f32 v[50:51],v[50:51],v[206:207] op_sel_hi:[1,0]
v_pk_mul_f32 v[52:53],v[52:53],v[206:207] op_sel_hi:[1,0]
v_pk_mul_f32 v[54:55],v[54:55],v[206:207] op_sel_hi:[1,0]
cv v56,v48,v49
cv v57,v50,v51
cv v58,v52,v53
cv v59,v54,v55
buffer_store_dwordx4 v[56:59],v221,s[24:27],s33 offen offset:0 sc1
ar v60,a36
ar v61,a37
ar v62,a38
ar v63,a39
ar v64,a52
ar v65,a53
ar v66,a54
ar v67,a55
v_pk_mul_f32 v[60:61],v[60:61],v[206:207] op_sel_hi:[1,0]
v_pk_mul_f32 v[62:63],v[62:63],v[206:207] op_sel_hi:[1,0]
v_pk_mul_f32 v[64:65],v[64:65],v[206:207] op_sel_hi:[1,0]
v_pk_mul_f32 v[66:67],v[66:67],v[206:207] op_sel_hi:[1,0]
cv v68,v60,v61
cv v69,v62,v63
cv v70,v64,v65
cv v71,v66,v67
buffer_store_dwordx4 v[68:71],v221,s[24:27],s33 offen offset:1024 sc1
ar v72,a68
ar v73,a69
ar v74,a70
ar v75,a71
ar v76,a84
ar v77,a85
ar v78,a86
ar v79,a87
v_pk_mul_f32 v[72:73],v[72:73],v[206:207] op_sel_hi:[1,0]
v_pk_mul_f32 v[74:75],v[74:75],v[206:207] op_sel_hi:[1,0]
v_pk_mul_f32 v[76:77],v[76:77],v[206:207] op_sel_hi:[1,0]
v_pk_mul_f32 v[78:79],v[78:79],v[206:207] op_sel_hi:[1,0]
cv v80,v72,v73
cv v81,v74,v75
cv v82,v76,v77
cv v83,v78,v79
buffer_store_dwordx4 v[80:83],v221,s[24:27],s33 offen offset:2048 sc1
ar v84,a100
ar v85,a101
ar v86,a102
ar v87,a103
ar v88,a116
ar v89,a117
ar v90,a118
ar v91,a119
v_pk_mul_f32 v[84:85],v[84:85],v[206:207] op_sel_hi:[1,0]
v_pk_mul_f32 v[86:87],v[86:87],v[206:207] op_sel_hi:[1,0]
v_pk_mul_f32 v[88:89],v[88:89],v[206:207] op_sel_hi:[1,0]
v_pk_mul_f32 v[90:91],v[90:91],v[206:207] op_sel_hi:[1,0]
cv v92,v84,v85
cv v93,v86,v87
cv v94,v88,v89
cv v95,v90,v91
buffer_store_dwordx4 v[92:95],v221,s[24:27],s33 offen offset:3072 sc1
s_add_u32 s33,s33,131072
s_waitcnt lgkmcnt(0)
s_barrier
v_lshlrev_b32 v216,2,v220
v_add_u32 v217,147456,v216
ds_read_b32 v212,v217 offset:0
ds_read_b32 v213,v217 offset:64
ds_read_b32 v214,v217 offset:128
ds_read_b32 v215,v217 offset:192
ar v0,a8
ar v1,a9
ar v2,a10
ar v3,a11
ar v4,a24
ar v5,a25
ar v6,a26
ar v7,a27
v_pk_mul_f32 v[0:1],v[0:1],v[208:209] op_sel_hi:[1,0]
v_pk_mul_f32 v[2:3],v[2:3],v[208:209] op_sel_hi:[1,0]
v_pk_mul_f32 v[4:5],v[4:5],v[208:209] op_sel_hi:[1,0]
v_pk_mul_f32 v[6:7],v[6:7],v[208:209] op_sel_hi:[1,0]
cv v8,v0,v1
cv v9,v2,v3
cv v10,v4,v5
cv v11,v6,v7
buffer_store_dwordx4 v[8:11],v221,s[24:27],s33 offen offset:0 sc1
ar v12,a40
ar v13,a41
ar v14,a42
ar v15,a43
ar v16,a56
ar v17,a57
ar v18,a58
ar v19,a59
v_pk_mul_f32 v[12:13],v[12:13],v[208:209] op_sel_hi:[1,0]
v_pk_mul_f32 v[14:15],v[14:15],v[208:209] op_sel_hi:[1,0]
v_pk_mul_f32 v[16:17],v[16:17],v[208:209] op_sel_hi:[1,0]
v_pk_mul_f32 v[18:19],v[18:19],v[208:209] op_sel_hi:[1,0]
cv v20,v12,v13
cv v21,v14,v15
cv v22,v16,v17
cv v23,v18,v19
buffer_store_dwordx4 v[20:23],v221,s[24:27],s33 offen offset:1024 sc1
ar v24,a72
ar v25,a73
ar v26,a74
ar v27,a75
ar v28,a88
ar v29,a89
ar v30,a90
ar v31,a91
v_pk_mul_f32 v[24:25],v[24:25],v[208:209] op_sel_hi:[1,0]
v_pk_mul_f32 v[26:27],v[26:27],v[208:209] op_sel_hi:[1,0]
v_pk_mul_f32 v[28:29],v[28:29],v[208:209] op_sel_hi:[1,0]
v_pk_mul_f32 v[30:31],v[30:31],v[208:209] op_sel_hi:[1,0]
cv v32,v24,v25
cv v33,v26,v27
cv v34,v28,v29
cv v35,v30,v31
buffer_store_dwordx4 v[32:35],v221,s[24:27],s33 offen offset:2048 sc1
ar v36,a104
ar v37,a105
ar v38,a106
ar v39,a107
ar v40,a120
ar v41,a121
ar v42,a122
ar v43,a123
v_pk_mul_f32 v[36:37],v[36:37],v[208:209] op_sel_hi:[1,0]
v_pk_mul_f32 v[38:39],v[38:39],v[208:209] op_sel_hi:[1,0]
v_pk_mul_f32 v[40:41],v[40:41],v[208:209] op_sel_hi:[1,0]
v_pk_mul_f32 v[42:43],v[42:43],v[208:209] op_sel_hi:[1,0]
cv v44,v36,v37
cv v45,v38,v39
cv v46,v40,v41
cv v47,v42,v43
buffer_store_dwordx4 v[44:47],v221,s[24:27],s33 offen offset:3072 sc1
s_add_u32 s33,s33,131072
s_waitcnt lgkmcnt(2)
v_add_f32 v212,v212,v213
s_waitcnt lgkmcnt(0)
v_add_f32 v214,v214,v215
v_add_f32 v212,v212,v214
cv v212,v212,v212
v_lshlrev_b32 v212,16,v212
s_mov_b64 exec,0xffff
buffer_store_dword v212,v216,s[64:67],s63 offen sc1
s_mov_b64 exec,-1
ar v48,a12
ar v49,a13
ar v50,a14
ar v51,a15
ar v52,a28
ar v53,a29
ar v54,a30
ar v55,a31
v_pk_mul_f32 v[48:49],v[48:49],v[210:211] op_sel_hi:[1,0]
v_pk_mul_f32 v[50:51],v[50:51],v[210:211] op_sel_hi:[1,0]
v_pk_mul_f32 v[52:53],v[52:53],v[210:211] op_sel_hi:[1,0]
v_pk_mul_f32 v[54:55],v[54:55],v[210:211] op_sel_hi:[1,0]
cv v56,v48,v49
cv v57,v50,v51
cv v58,v52,v53
cv v59,v54,v55
buffer_store_dwordx4 v[56:59],v221,s[24:27],s33 offen offset:0 sc1
ar v60,a44
ar v61,a45
ar v62,a46
ar v63,a47
ar v64,a60
ar v65,a61
ar v66,a62
ar v67,a63
v_pk_mul_f32 v[60:61],v[60:61],v[210:211] op_sel_hi:[1,0]
v_pk_mul_f32 v[62:63],v[62:63],v[210:211] op_sel_hi:[1,0]
v_pk_mul_f32 v[64:65],v[64:65],v[210:211] op_sel_hi:[1,0]
v_pk_mul_f32 v[66:67],v[66:67],v[210:211] op_sel_hi:[1,0]
cv v68,v60,v61
cv v69,v62,v63
cv v70,v64,v65
cv v71,v66,v67
buffer_store_dwordx4 v[68:71],v221,s[24:27],s33 offen offset:1024 sc1
ar v72,a76
ar v73,a77
ar v74,a78
ar v75,a79
ar v76,a92
ar v77,a93
ar v78,a94
ar v79,a95
v_pk_mul_f32 v[72:73],v[72:73],v[210:211] op_sel_hi:[1,0]
v_pk_mul_f32 v[74:75],v[74:75],v[210:211] op_sel_hi:[1,0]
v_pk_mul_f32 v[76:77],v[76:77],v[210:211] op_sel_hi:[1,0]
v_pk_mul_f32 v[78:79],v[78:79],v[210:211] op_sel_hi:[1,0]
cv v80,v72,v73
cv v81,v74,v75
cv v82,v76,v77
cv v83,v78,v79
buffer_store_dwordx4 v[80:83],v221,s[24:27],s33 offen offset:2048 sc1
ar v84,a108
ar v85,a109
ar v86,a110
ar v87,a111
ar v88,a124
ar v89,a125
ar v90,a126
ar v91,a127
v_pk_mul_f32 v[84:85],v[84:85],v[210:211] op_sel_hi:[1,0]
v_pk_mul_f32 v[86:87],v[86:87],v[210:211] op_sel_hi:[1,0]
v_pk_mul_f32 v[88:89],v[88:89],v[210:211] op_sel_hi:[1,0]
v_pk_mul_f32 v[90:91],v[90:91],v[210:211] op_sel_hi:[1,0]
cv v92,v84,v85
cv v93,v86,v87
cv v94,v88,v89
cv v95,v90,v91
buffer_store_dwordx4 v[92:95],v221,s[24:27],s33 offen offset:3072 sc1
s_lshl_b32 s95,s32,1
s_lshr_b32 s39,s31,4
s_add_u32 s95,s95,s39
s_lshl_b32 s95,s95,12
s_add_u32 s95,s95,525696
s_branch tail_start
attn_end:
s_endpgm
attn_stub_loop0_0:
s_call_b64 s[60:61],attn_slow_0
s_branch attn_back_loop0_0
attn_stub_loop0_1:
s_call_b64 s[60:61],attn_slow_1
s_branch attn_back_loop0_1
attn_stub_loop1_0:
s_call_b64 s[60:61],attn_slow_2
s_branch attn_back_loop1_0
attn_stub_loop1_1:
s_call_b64 s[60:61],attn_slow_3
s_branch attn_back_loop1_1
attn_stub_loop2_0:
s_call_b64 s[60:61],attn_slow_0
s_branch attn_back_loop2_0
attn_stub_loop2_1:
s_call_b64 s[60:61],attn_slow_1
s_branch attn_back_loop2_1
attn_stub_loop3_0:
s_call_b64 s[60:61],attn_slow_2
s_branch attn_back_loop3_0
attn_stub_loop3_1:
s_call_b64 s[60:61],attn_slow_3
s_branch attn_back_loop3_1
attn_stub_tail0_0:
s_call_b64 s[60:61],attn_slow_4
s_branch attn_back_tail0_0
attn_stub_tail0_1:
s_call_b64 s[60:61],attn_slow_1
s_branch attn_back_tail0_1
attn_stub_tail1_0:
s_call_b64 s[60:61],attn_slow_5
s_branch attn_back_tail1_0
attn_stub_tail1_1:
s_call_b64 s[60:61],attn_slow_3
s_branch attn_back_tail1_1
attn_stub_tail2_0:
s_call_b64 s[60:61],attn_slow_6
s_branch attn_back_tail2_0
attn_stub_tail2_1:
s_call_b64 s[60:61],attn_slow_1
s_branch attn_back_tail2_1
attn_stub_tail3_0:
s_call_b64 s[60:61],attn_slow_7
s_branch attn_back_tail3_0
attn_stub_tail3_1:
s_call_b64 s[60:61],attn_slow_3
s_branch attn_back_tail3_1
tail_start:
v_mov_b32 v255,v220
s_mov_b32 s20,s30
s_load_dwordx2 s[4:5],s[0:1],112
s_load_dwordx2 s[12:13],s[0:1],32
s_load_dwordx2 s[16:17],s[0:1],48
s_load_dwordx2 s[28:29],s[0:1],64
s_load_dwordx2 s[32:33],s[0:1],0
s_load_dwordx2 s[36:37],s[0:1],56
s_load_dwordx2 s[40:41],s[0:1],72
s_load_dwordx2 s[44:45],s[0:1],96
s_bfe_u32 s21,s2,0x20001
s_lshl_b32 s21,s21,2
s_lshr_b32 s24,s2,6
s_add_u32 s21,s21,s24
s_and_b32 s26,s2,1
s_bfe_u32 s23,s2,0x30003
s_lshl_b32 s22,s26,3
s_add_u32 s22,s22,s23
s_mul_i32 s24,s20,262144
v_lshlrev_b32 v200,4,v255
v_add_u32 v214,s24,v200
v_add_u32 v215,0x20000,v214
s_mul_i32 s24,s20,256
s_mov_b32 s25,2048
v_add_u32 v202,s24,v255
v_lshrrev_b32 v203,4,v202
v_and_b32 v205,15,v202
v_and_b32 v206,7,v203
v_lshlrev_b32 v206,1,v206
v_xor_b32 v205,v205,v206
v_mul_lo_u32 v203,v203,s25
v_lshl_add_u32 v216,v205,4,v203
v_add_u32 v202,s24,v255
v_add_u32 v202,64,v202
v_lshrrev_b32 v203,4,v202
v_and_b32 v205,15,v202
v_and_b32 v206,7,v203
v_lshlrev_b32 v206,1,v206
v_xor_b32 v205,v205,v206
v_mul_lo_u32 v203,v203,s25
v_lshl_add_u32 v217,v205,4,v203
v_subrev_u32 v217,1024,v217
v_add_u32 v202,s24,v255
v_add_u32 v202,128,v202
v_lshrrev_b32 v203,4,v202
v_and_b32 v205,15,v202
v_and_b32 v206,7,v203
v_lshlrev_b32 v206,1,v206
v_xor_b32 v205,v205,v206
v_mul_lo_u32 v203,v203,s25
v_lshl_add_u32 v218,v205,4,v203
v_subrev_u32 v218,2048,v218
v_add_u32 v202,s24,v255
v_add_u32 v202,192,v202
v_lshrrev_b32 v203,4,v202
v_and_b32 v205,15,v202
v_and_b32 v206,7,v203
v_lshlrev_b32 v206,1,v206
v_xor_b32 v205,v205,v206
v_mul_lo_u32 v203,v203,s25
v_lshl_add_u32 v219,v205,4,v203
v_subrev_u32 v219,3072,v219
s_mul_i32 s50,s20,4096
s_lshl_b32 s48,s21,20
s_lshl_b32 s24,s26,16
s_add_u32 s48,s48,s24
s_add_u32 s48,s48,16777216
s_lshl_b32 s49,s23,8
s_lshl_b32 s24,s26,22
s_add_u32 s49,s49,s24
s_waitcnt lgkmcnt(0)
s_mov_b32 s8,s4
s_mov_b32 s9,s5
s_mov_b32 s10,0x10000000
s_mov_b32 s11,0x20000
s_mov_b32 s14,0x800000
s_mov_b32 s15,0x20000
s_add_u32 m0,s50,0
v_and_b32 v202,15,v255
v_lshrrev_b32 v203,4,v255
v_lshrrev_b32 v204,2,v202
v_lshl_add_u32 v205,v203,2,v204
v_and_b32 v206,7,v205
bl v216,s[12:15],s49 offen offset:0 lds
v_mul_u32_u24 v205,256,v205
v_and_b32 v204,3,v202
v_lshl_add_u32 v205,v204,3,v205
v_xor_b32 v204,0,v206
bl v217,s[12:15],s49 offen offset:1024 lds
v_lshl_add_u32 v220,v204,5,v205
v_xor_b32 v204,1,v206
v_lshl_add_u32 v221,v204,5,v205
v_xor_b32 v204,2,v206
bl v218,s[12:15],s49 offen offset:2048 lds
v_lshl_add_u32 v222,v204,5,v205
v_xor_b32 v204,3,v206
v_lshl_add_u32 v223,v204,5,v205
v_xor_b32 v204,4,v206
bl v219,s[12:15],s49 offen offset:3072 lds
v_lshl_add_u32 v224,v204,5,v205
v_xor_b32 v204,5,v206
v_lshl_add_u32 v225,v204,5,v205
v_xor_b32 v204,6,v206
s_add_u32 s49,s49,131072
v_lshl_add_u32 v226,v204,5,v205
v_xor_b32 v204,7,v206
v_lshl_add_u32 v227,v204,5,v205
v_add_u32 v228,65536,v220
s_add_u32 m0,s50,16384
v_add_u32 v229,65536,v221
v_add_u32 v230,65536,v222
v_add_u32 v231,65536,v223
v_add_u32 v232,65536,v224
bl v216,s[12:15],s49 offen offset:0 lds
v_add_u32 v233,65536,v225
v_add_u32 v234,65536,v226
v_add_u32 v235,65536,v227
s_lshl_b32 s57,s21,12
bl v217,s[12:15],s49 offen offset:1024 lds
s_add_u32 s57,s57,526208
s_lshl_b32 s58,s26,8
s_add_u32 s58,s58,s57
s_add_u32 s58,s58,1024
bl v218,s[12:15],s49 offen offset:2048 lds
s_mov_b32 s18,0x700000
s_mov_b32 s19,0x20000
s_mov_b32 s30,0x700000
s_mov_b32 s31,0x20000
s_mov_b32 s34,0x400000
bl v219,s[12:15],s49 offen offset:3072 lds
s_mov_b32 s35,0x20000
s_mov_b32 s38,0x1c00
s_mov_b32 s39,0x20000
s_mov_b32 s42,0x800
s_add_u32 s49,s49,131072
s_mov_b32 s43,0x20000
s_mov_b32 s46,0x400000
s_mov_b32 s47,0x20000
v_lshlrev_b32 v254,4,v255
s_add_u32 m0,s50,32768
s_mul_i32 s24,s20,65536
v_lshlrev_b32 v200,4,v255
v_add_u32 v236,s24,v200
v_add_u32 v237,0x8000,v236
bl v216,s[12:15],s49 offen offset:0 lds
s_mul_i32 s24,s20,448
s_mov_b32 s25,7168
v_add_u32 v202,s24,v255
v_mul_u32_u24 v203,9363,v202
bl v217,s[12:15],s49 offen offset:1024 lds
v_lshrrev_b32 v203,18,v203
v_mul_u32_u24 v205,28,v203
v_sub_u32 v205,v202,v205
v_bfe_u32 v206,v203,2,1
bl v218,s[12:15],s49 offen offset:2048 lds
v_lshlrev_b32 v206,1,v206
v_xor_b32 v205,v205,v206
v_mul_lo_u32 v203,v203,s25
v_lshl_add_u32 v238,v205,4,v203
bl v219,s[12:15],s49 offen offset:3072 lds
v_add_u32 v202,s24,v255
v_add_u32 v202,64,v202
v_mul_u32_u24 v203,9363,v202
v_lshrrev_b32 v203,18,v203
s_add_u32 s49,s49,131072
v_mul_u32_u24 v205,28,v203
v_sub_u32 v205,v202,v205
v_bfe_u32 v206,v203,2,1
v_lshlrev_b32 v206,1,v206
s_add_u32 m0,s50,49152
v_xor_b32 v205,v205,v206
v_mul_lo_u32 v203,v203,s25
v_lshl_add_u32 v239,v205,4,v203
v_subrev_u32 v239,1024,v239
bl v216,s[12:15],s49 offen offset:0 lds
v_add_u32 v202,s24,v255
v_add_u32 v202,128,v202
v_mul_u32_u24 v203,9363,v202
v_lshrrev_b32 v203,18,v203
v_mul_u32_u24 v205,28,v203
bl v217,s[12:15],s49 offen offset:1024 lds
v_sub_u32 v205,v202,v205
v_bfe_u32 v206,v203,2,1
v_lshlrev_b32 v206,1,v206
v_xor_b32 v205,v205,v206
bl v218,s[12:15],s49 offen offset:2048 lds
v_mul_lo_u32 v203,v203,s25
v_lshl_add_u32 v240,v205,4,v203
v_subrev_u32 v240,2048,v240
v_add_u32 v202,s24,v255
bl v219,s[12:15],s49 offen offset:3072 lds
v_add_u32 v202,192,v202
v_mul_u32_u24 v203,9363,v202
v_lshrrev_b32 v203,18,v203
v_mul_u32_u24 v205,28,v203
s_add_u32 s49,s49,131072
v_sub_u32 v205,v202,v205
v_bfe_u32 v206,v203,2,1
v_lshlrev_b32 v206,1,v206
v_xor_b32 v205,v205,v206
s_add_u32 m0,s50,65536
v_mul_lo_u32 v203,v203,s25
v_lshl_add_u32 v241,v205,4,v203
v_subrev_u32 v241,3072,v241
v_add_u32 v202,s24,v255
bl v216,s[12:15],s49 offen offset:0 lds
v_add_u32 v202,256,v202
v_mul_u32_u24 v203,9363,v202
v_lshrrev_b32 v203,18,v203
v_mul_u32_u24 v205,28,v203
bl v217,s[12:15],s49 offen offset:1024 lds
v_sub_u32 v205,v202,v205
v_bfe_u32 v206,v203,2,1
v_lshlrev_b32 v206,1,v206
v_xor_b32 v205,v205,v206
bl v218,s[12:15],s49 offen offset:2048 lds
v_mul_lo_u32 v203,v203,s25
v_lshl_add_u32 v242,v205,4,v203
v_add_u32 v202,s24,v255
v_add_u32 v202,320,v202
bl v219,s[12:15],s49 offen offset:3072 lds
v_mul_u32_u24 v203,9363,v202
v_lshrrev_b32 v203,18,v203
v_mul_u32_u24 v205,28,v203
v_sub_u32 v205,v202,v205
v_bfe_u32 v206,v203,2,1
s_add_u32 s49,s49,131072
v_lshlrev_b32 v206,1,v206
v_xor_b32 v205,v205,v206
v_mul_lo_u32 v203,v203,s25
v_lshl_add_u32 v243,v205,4,v203
s_add_u32 m0,s50,81920
v_subrev_u32 v243,1024,v243
v_add_u32 v202,s24,v255
v_add_u32 v202,384,v202
v_mul_u32_u24 v203,9363,v202
bl v216,s[12:15],s49 offen offset:0 lds
v_lshrrev_b32 v203,18,v203
v_mul_u32_u24 v205,28,v203
v_sub_u32 v205,v202,v205
v_bfe_u32 v206,v203,2,1
bl v217,s[12:15],s49 offen offset:1024 lds
v_lshlrev_b32 v206,1,v206
v_xor_b32 v205,v205,v206
v_mul_lo_u32 v203,v203,s25
v_lshl_add_u32 v244,v205,4,v203
bl v218,s[12:15],s49 offen offset:2048 lds
v_subrev_u32 v244,2048,v244
s_mul_i32 s51,s20,7168
v_and_b32 v202,15,v255
v_lshrrev_b32 v203,4,v255
bl v219,s[12:15],s49 offen offset:3072 lds
v_lshrrev_b32 v204,2,v202
v_lshl_add_u32 v205,v203,2,v204
v_and_b32 v206,1,v203
v_mul_u32_u24 v205,448,v205
s_add_u32 s49,s49,131072
v_and_b32 v204,3,v202
v_lshl_add_u32 v205,v204,3,v205
v_xor_b32 v204,0,v206
v_lshl_add_u32 v245,v204,5,v205
s_add_u32 m0,s50,98304
v_xor_b32 v204,1,v206
v_lshl_add_u32 v246,v204,5,v205
v_add_u32 v247,57344,v245
v_add_u32 v248,57344,v246
bl v216,s[12:15],s49 offen offset:0 lds
v_add_u32 v249,114688,v245
v_add_u32 v250,114688,v246
s_mul_i32 s24,s20,229376
v_add_u32 v212,s24,v254
bl v217,s[12:15],s49 offen offset:1024 lds
v_add_u32 v213,0x1c000,v212
s_mul_i32 s54,s22,448
s_lshl_b32 s55,s23,8
s_mul_i32 s24,s26,3670016
s_add_u32 s55,s55,s24
bl v218,s[12:15],s49 offen offset:2048 lds
v_and_b32 v200,7,v255
v_bfe_u32 v201,v255,3,1
s_lshl_b32 s24,s20,3
v_add_u32 v201,s24,v201
bl v219,s[12:15],s49 offen offset:3072 lds
v_lshrrev_b32 v202,4,v255
v_and_b32 v203,1,v202
v_lshrrev_b32 v206,1,v202
v_lshl_or_b32 v203,v203,1,v206
s_add_u32 s49,s49,131072
v_lshlrev_b32 v252,11,v200
v_lshl_add_u32 v252,v201,6,v252
v_lshl_add_u32 v252,v203,4,v252
v_lshlrev_b32 v251,10,v201
s_add_u32 m0,s50,114688
v_lshl_add_u32 v251,v202,8,v251
v_lshl_add_u32 v251,v200,4,v251
v_lshlrev_b32 v253,7,v201
v_lshl_add_u32 v253,v202,4,v253
bl v216,s[12:15],s49 offen offset:0 lds
s_lshl_b32 s24,s21,4
s_add_u32 s24,s24,s22
s_lshl_b32 s52,s24,14
s_lshr_b32 s53,s24,1
bl v217,s[12:15],s49 offen offset:1024 lds
s_lshl_b32 s53,s53,15
s_and_b32 s24,s24,1
s_lshl_b32 s24,s24,7
s_add_u32 s53,s53,s24
bl v218,s[12:15],s49 offen offset:2048 lds
s_lshl_b32 s24,s21,3
s_lshl_b32 s25,s20,1
s_add_u32 s24,s24,s25
s_lshl_b32 s24,s24,5
bl v219,s[12:15],s49 offen offset:3072 lds
s_lshl_b32 s25,s23,2
s_add_u32 s24,s24,s25
s_lshl_b32 s56,s24,10
s_lshl_b32 s24,s26,22
s_add_u32 s49,s49,131072
s_add_u32 s56,s56,s24
v_lshrrev_b32 v200,4,v255
v_lshlrev_b32 v200,3,v200
v_lshrrev_b32 v201,1,v253
s_and_b32 s62,s21,14
s_add_u32 s62,s62,s26
s_lshl_b32 s62,s62,12
s_add_u32 s62,s62,525696
v_and_b32 v209,15,v255
v_lshlrev_b32 v209,12,v209
s_mov_b32 s61,525696
v_mov_b32 v204,0
v_mov_b32 v205,1
s_waitcnt vmcnt(32)
s_barrier
s_cmp_lg_u32 s20,0
s_cbranch_scc1 tail_gb0_a
s_mov_b64 exec,1
buffer_atomic_add v205,v204,s[8:11],s95 offen sc1
s_mov_b64 exec,-1
tail_gb0_a:
buffer_load_dwordx2 a[168:169],v200,s[36:39],s54 offen offset:0
buffer_load_dwordx2 a[170:171],v200,s[36:39],s54 offen offset:32
buffer_load_dwordx2 a[172:173],v200,s[36:39],s54 offen offset:64
buffer_load_dwordx2 a[174:175],v200,s[36:39],s54 offen offset:96
buffer_load_dwordx2 a[176:177],v200,s[36:39],s54 offen offset:128
buffer_load_dwordx2 a[178:179],v200,s[36:39],s54 offen offset:160
buffer_load_dwordx2 a[180:181],v200,s[36:39],s54 offen offset:192
buffer_load_dwordx2 a[182:183],v200,s[36:39],s54 offen offset:224
buffer_load_dwordx2 a[184:185],v200,s[36:39],s54 offen offset:256
buffer_load_dwordx2 a[186:187],v200,s[36:39],s54 offen offset:288
buffer_load_dwordx2 a[188:189],v200,s[36:39],s54 offen offset:320
buffer_load_dwordx2 a[190:191],v200,s[36:39],s54 offen offset:352
buffer_load_dwordx2 a[192:193],v200,s[36:39],s54 offen offset:384
buffer_load_dwordx2 a[194:195],v200,s[36:39],s54 offen offset:416
bl v[184:187],v252,s[32:35],s52 offen offset:0
bl v[188:191],v252,s[32:35],s52 offen offset:128
bl v[192:195],v252,s[32:35],s52 offen offset:256
bl v[196:199],v252,s[32:35],s52 offen offset:384
s_cmp_lg_u32 s20,0
s_cbranch_scc1 tail_gb0_w
s_mov_b64 exec,1
s_mov_b32 s59,0x40000
tail_gb0_p:
buffer_load_dword v202,v204,s[8:11],s62 offen sc1
s_waitcnt vmcnt(0)
v_readfirstlane_b32 s60,v202
s_sub_u32 s59,s59,1
s_cmp_eq_u32 s59,0
s_cbranch_scc1 tail_gb0_w
s_cmp_lt_u32 s60,16
s_cbranch_scc1 tail_gb0_p
tail_gb0_w:
s_mov_b64 exec,-1
s_waitcnt vmcnt(40)
s_barrier
bl a[0:3],v214,s[8:11],s48 offen offset:0 sc1
bl a[4:7],v215,s[8:11],s48 offen offset:0 sc1
bl a[8:11],v214,s[8:11],s48 offen offset:1024 sc1
bl a[12:15],v215,s[8:11],s48 offen offset:1024 sc1
s_add_u32 s48,s48,2048
bl a[16:19],v214,s[8:11],s48 offen offset:0 sc1
bl a[20:23],v215,s[8:11],s48 offen offset:0 sc1
bl a[24:27],v214,s[8:11],s48 offen offset:1024 sc1
bl a[28:31],v215,s[8:11],s48 offen offset:1024 sc1
s_add_u32 s48,s48,2048
bl a[32:35],v214,s[8:11],s48 offen offset:0 sc1
bl a[36:39],v215,s[8:11],s48 offen offset:0 sc1
bl a[40:43],v214,s[8:11],s48 offen offset:1024 sc1
bl a[44:47],v215,s[8:11],s48 offen offset:1024 sc1
s_add_u32 s48,s48,2048
s_waitcnt vmcnt(8)
s_barrier
tr a[128:129],v220 offset:0
tr a[130:131],v220 offset:4096
tr a[132:133],v220 offset:8192
tr a[134:135],v220 offset:12288
tr a[136:137],v221 offset:0
tr a[138:139],v221 offset:4096
tr a[140:141],v221 offset:8192
tr a[142:143],v221 offset:12288
tr a[144:145],v222 offset:0
tr a[146:147],v222 offset:4096
tr a[148:149],v222 offset:8192
tr a[150:151],v222 offset:12288
s_waitcnt lgkmcnt(8)
mm v[0:3],a[128:131],a[0:3],0
tr a[152:153],v223 offset:0
bl a[48:51],v214,s[8:11],s48 offen offset:0 sc1
mm v[0:3],a[132:135],a[8:11],v[0:3]
tr a[154:155],v223 offset:4096
mm v[4:7],a[128:131],a[4:7],0
tr a[156:157],v223 offset:8192
mm v[4:7],a[132:135],a[12:15],v[4:7]
tr a[158:159],v223 offset:12288
s_waitcnt lgkmcnt(8)
mm v[8:11],a[136:139],a[0:3],0
tr a[128:129],v224 offset:0
bl a[52:55],v215,s[8:11],s48 offen offset:0 sc1
mm v[8:11],a[140:143],a[8:11],v[8:11]
tr a[130:131],v224 offset:4096
mm v[12:15],a[136:139],a[4:7],0
tr a[132:133],v224 offset:8192
mm v[12:15],a[140:143],a[12:15],v[12:15]
tr a[134:135],v224 offset:12288
s_waitcnt lgkmcnt(8)
mm v[16:19],a[144:147],a[0:3],0
tr a[136:137],v225 offset:0
bl a[56:59],v214,s[8:11],s48 offen offset:1024 sc1
mm v[16:19],a[148:151],a[8:11],v[16:19]
tr a[138:139],v225 offset:4096
mm v[20:23],a[144:147],a[4:7],0
tr a[140:141],v225 offset:8192
mm v[20:23],a[148:151],a[12:15],v[20:23]
tr a[142:143],v225 offset:12288
s_waitcnt lgkmcnt(8)
mm v[24:27],a[152:155],a[0:3],0
tr a[144:145],v226 offset:0
bl a[60:63],v215,s[8:11],s48 offen offset:1024 sc1
mm v[24:27],a[156:159],a[8:11],v[24:27]
tr a[146:147],v226 offset:4096
s_add_u32 s48,s48,2048
mm v[28:31],a[152:155],a[4:7],0
tr a[148:149],v226 offset:8192
mm v[28:31],a[156:159],a[12:15],v[28:31]
tr a[150:151],v226 offset:12288
s_waitcnt lgkmcnt(8)
mm v[32:35],a[128:131],a[0:3],0
tr a[152:153],v227 offset:0
mm v[32:35],a[132:135],a[8:11],v[32:35]
tr a[154:155],v227 offset:4096
s_waitcnt vmcnt(8)
mm v[36:39],a[128:131],a[4:7],0
bl a[64:67],v214,s[8:11],s48 offen offset:0 sc1
s_barrier
mm v[36:39],a[132:135],a[12:15],v[36:39]
tr a[156:157],v227 offset:8192
s_waitcnt lgkmcnt(7)
mm v[40:43],a[136:139],a[0:3],0
tr a[158:159],v227 offset:12288
mm v[40:43],a[140:143],a[8:11],v[40:43]
tr a[128:129],v220 offset:16384
bl a[68:71],v215,s[8:11],s48 offen offset:0 sc1
mm v[44:47],a[136:139],a[4:7],0
tr a[130:131],v220 offset:20480
mm v[44:47],a[140:143],a[12:15],v[44:47]
tr a[132:133],v220 offset:24576
s_waitcnt lgkmcnt(7)
mm v[48:51],a[144:147],a[0:3],0
tr a[134:135],v220 offset:28672
mm v[48:51],a[148:151],a[8:11],v[48:51]
tr a[136:137],v221 offset:16384
bl a[72:75],v214,s[8:11],s48 offen offset:1024 sc1
mm v[52:55],a[144:147],a[4:7],0
tr a[138:139],v221 offset:20480
mm v[52:55],a[148:151],a[12:15],v[52:55]
tr a[140:141],v221 offset:24576
s_waitcnt lgkmcnt(7)
mm v[56:59],a[152:155],a[0:3],0
tr a[142:143],v221 offset:28672
mm v[56:59],a[156:159],a[8:11],v[56:59]
tr a[144:145],v222 offset:16384
mm v[60:63],a[152:155],a[4:7],0
tr a[146:147],v222 offset:20480
bl a[76:79],v215,s[8:11],s48 offen offset:1024 sc1
mm v[60:63],a[156:159],a[12:15],v[60:63]
tr a[148:149],v222 offset:24576
s_waitcnt lgkmcnt(7)
mm v[0:3],a[128:131],a[16:19],v[0:3]
tr a[150:151],v222 offset:28672
s_add_u32 s48,s48,2048
mm v[0:3],a[132:135],a[24:27],v[0:3]
tr a[152:153],v223 offset:16384
mm v[4:7],a[128:131],a[20:23],v[4:7]
tr a[154:155],v223 offset:20480
bl a[80:83],v214,s[8:11],s48 offen offset:0 sc1
mm v[4:7],a[132:135],a[28:31],v[4:7]
tr a[156:157],v223 offset:24576
s_waitcnt lgkmcnt(7)
mm v[8:11],a[136:139],a[16:19],v[8:11]
tr a[158:159],v223 offset:28672
mm v[8:11],a[140:143],a[24:27],v[8:11]
tr a[128:129],v224 offset:16384
mm v[12:15],a[136:139],a[20:23],v[12:15]
tr a[130:131],v224 offset:20480
bl a[84:87],v215,s[8:11],s48 offen offset:0 sc1
mm v[12:15],a[140:143],a[28:31],v[12:15]
tr a[132:133],v224 offset:24576
s_waitcnt lgkmcnt(7)
mm v[16:19],a[144:147],a[16:19],v[16:19]
tr a[134:135],v224 offset:28672
mm v[16:19],a[148:151],a[24:27],v[16:19]
tr a[136:137],v225 offset:16384
mm v[20:23],a[144:147],a[20:23],v[20:23]
tr a[138:139],v225 offset:20480
bl a[88:91],v214,s[8:11],s48 offen offset:1024 sc1
mm v[20:23],a[148:151],a[28:31],v[20:23]
tr a[140:141],v225 offset:24576
s_waitcnt lgkmcnt(7)
mm v[24:27],a[152:155],a[16:19],v[24:27]
tr a[142:143],v225 offset:28672
mm v[24:27],a[156:159],a[24:27],v[24:27]
tr a[144:145],v226 offset:16384
mm v[28:31],a[152:155],a[20:23],v[28:31]
tr a[146:147],v226 offset:20480
mm v[28:31],a[156:159],a[28:31],v[28:31]
tr a[148:149],v226 offset:24576
s_waitcnt lgkmcnt(7)
mm v[32:35],a[128:131],a[16:19],v[32:35]
tr a[150:151],v226 offset:28672
bl a[92:95],v215,s[8:11],s48 offen offset:1024 sc1
mm v[32:35],a[132:135],a[24:27],v[32:35]
tr a[152:153],v227 offset:16384
s_waitcnt vmcnt(12)
mm v[36:39],a[128:131],a[20:23],v[36:39]
tr a[154:155],v227 offset:20480
s_barrier
mm v[36:39],a[132:135],a[28:31],v[36:39]
s_add_u32 s48,s48,2048
s_waitcnt lgkmcnt(6)
mm v[40:43],a[136:139],a[16:19],v[40:43]
tr a[156:157],v227 offset:24576
tr a[158:159],v227 offset:28672
mm v[40:43],a[140:143],a[24:27],v[40:43]
tr a[128:129],v220 offset:32768
bl a[96:99],v214,s[8:11],s48 offen offset:0 sc1
mm v[44:47],a[136:139],a[20:23],v[44:47]
tr a[130:131],v220 offset:36864
mm v[44:47],a[140:143],a[28:31],v[44:47]
tr a[132:133],v220 offset:40960
s_waitcnt lgkmcnt(7)
mm v[48:51],a[144:147],a[16:19],v[48:51]
tr a[134:135],v220 offset:45056
bl a[100:103],v215,s[8:11],s48 offen offset:0 sc1
mm v[48:51],a[148:151],a[24:27],v[48:51]
tr a[136:137],v221 offset:32768
mm v[52:55],a[144:147],a[20:23],v[52:55]
tr a[138:139],v221 offset:36864
mm v[52:55],a[148:151],a[28:31],v[52:55]
tr a[140:141],v221 offset:40960
s_waitcnt lgkmcnt(7)
mm v[56:59],a[152:155],a[16:19],v[56:59]
tr a[142:143],v221 offset:45056
bl a[104:107],v214,s[8:11],s48 offen offset:1024 sc1
mm v[56:59],a[156:159],a[24:27],v[56:59]
tr a[144:145],v222 offset:32768
mm v[60:63],a[152:155],a[20:23],v[60:63]
tr a[146:147],v222 offset:36864
mm v[60:63],a[156:159],a[28:31],v[60:63]
tr a[148:149],v222 offset:40960
s_waitcnt lgkmcnt(7)
mm v[0:3],a[128:131],a[32:35],v[0:3]
tr a[150:151],v222 offset:45056
bl a[108:111],v215,s[8:11],s48 offen offset:1024 sc1
mm v[0:3],a[132:135],a[40:43],v[0:3]
tr a[152:153],v223 offset:32768
s_add_u32 s48,s48,2048
mm v[4:7],a[128:131],a[36:39],v[4:7]
tr a[154:155],v223 offset:36864
mm v[4:7],a[132:135],a[44:47],v[4:7]
tr a[156:157],v223 offset:40960
s_waitcnt lgkmcnt(7)
mm v[8:11],a[136:139],a[32:35],v[8:11]
tr a[158:159],v223 offset:45056
bl a[112:115],v214,s[8:11],s48 offen offset:0 sc1
mm v[8:11],a[140:143],a[40:43],v[8:11]
tr a[128:129],v224 offset:32768
mm v[12:15],a[136:139],a[36:39],v[12:15]
tr a[130:131],v224 offset:36864
mm v[12:15],a[140:143],a[44:47],v[12:15]
tr a[132:133],v224 offset:40960
s_waitcnt lgkmcnt(7)
mm v[16:19],a[144:147],a[32:35],v[16:19]
tr a[134:135],v224 offset:45056
bl a[116:119],v215,s[8:11],s48 offen offset:0 sc1
mm v[16:19],a[148:151],a[40:43],v[16:19]
tr a[136:137],v225 offset:32768
mm v[20:23],a[144:147],a[36:39],v[20:23]
tr a[138:139],v225 offset:36864
mm v[20:23],a[148:151],a[44:47],v[20:23]
tr a[140:141],v225 offset:40960
s_waitcnt lgkmcnt(7)
mm v[24:27],a[152:155],a[32:35],v[24:27]
tr a[142:143],v225 offset:45056
mm v[24:27],a[156:159],a[40:43],v[24:27]
tr a[144:145],v226 offset:32768
bl a[120:123],v214,s[8:11],s48 offen offset:1024 sc1
mm v[28:31],a[152:155],a[36:39],v[28:31]
tr a[146:147],v226 offset:36864
mm v[28:31],a[156:159],a[44:47],v[28:31]
tr a[148:149],v226 offset:40960
s_waitcnt lgkmcnt(7)
mm v[32:35],a[128:131],a[32:35],v[32:35]
tr a[150:151],v226 offset:45056
mm v[32:35],a[132:135],a[40:43],v[32:35]
tr a[152:153],v227 offset:32768
s_waitcnt vmcnt(15)
mm v[36:39],a[128:131],a[36:39],v[36:39]
tr a[154:155],v227 offset:36864
s_barrier
mm v[36:39],a[132:135],a[44:47],v[36:39]
bl a[124:127],v215,s[8:11],s48 offen offset:1024 sc1
s_waitcnt lgkmcnt(6)
mm v[40:43],a[136:139],a[32:35],v[40:43]
tr a[156:157],v227 offset:40960
tr a[158:159],v227 offset:45056
mm v[40:43],a[140:143],a[40:43],v[40:43]
tr a[128:129],v220 offset:49152
s_add_u32 s48,s48,2048
mm v[44:47],a[136:139],a[36:39],v[44:47]
tr a[130:131],v220 offset:53248
bl a[0:3],v214,s[8:11],s48 offen offset:0 sc1
mm v[44:47],a[140:143],a[44:47],v[44:47]
tr a[132:133],v220 offset:57344
s_waitcnt lgkmcnt(7)
mm v[48:51],a[144:147],a[32:35],v[48:51]
tr a[134:135],v220 offset:61440
mm v[48:51],a[148:151],a[40:43],v[48:51]
tr a[136:137],v221 offset:49152
mm v[52:55],a[144:147],a[36:39],v[52:55]
tr a[138:139],v221 offset:53248
bl a[4:7],v215,s[8:11],s48 offen offset:0 sc1
mm v[52:55],a[148:151],a[44:47],v[52:55]
tr a[140:141],v221 offset:57344
s_waitcnt lgkmcnt(7)
mm v[56:59],a[152:155],a[32:35],v[56:59]
tr a[142:143],v221 offset:61440
mm v[56:59],a[156:159],a[40:43],v[56:59]
tr a[144:145],v222 offset:49152
mm v[60:63],a[152:155],a[36:39],v[60:63]
tr a[146:147],v222 offset:53248
bl a[8:11],v214,s[8:11],s48 offen offset:1024 sc1
mm v[60:63],a[156:159],a[44:47],v[60:63]
tr a[148:149],v222 offset:57344
s_waitcnt lgkmcnt(7)
mm v[0:3],a[128:131],a[48:51],v[0:3]
tr a[150:151],v222 offset:61440
mm v[0:3],a[132:135],a[56:59],v[0:3]
tr a[152:153],v223 offset:49152
mm v[4:7],a[128:131],a[52:55],v[4:7]
tr a[154:155],v223 offset:53248
bl a[12:15],v215,s[8:11],s48 offen offset:1024 sc1
mm v[4:7],a[132:135],a[60:63],v[4:7]
tr a[156:157],v223 offset:57344
s_waitcnt lgkmcnt(7)
mm v[8:11],a[136:139],a[48:51],v[8:11]
tr a[158:159],v223 offset:61440
s_add_u32 s48,s48,2048
mm v[8:11],a[140:143],a[56:59],v[8:11]
tr a[128:129],v224 offset:49152
s_add_u32 m0,s50,0
mm v[12:15],a[136:139],a[52:55],v[12:15]
tr a[130:131],v224 offset:53248
bl v216,s[12:15],s49 offen offset:0 lds
mm v[12:15],a[140:143],a[60:63],v[12:15]
tr a[132:133],v224 offset:57344
s_waitcnt lgkmcnt(7)
mm v[16:19],a[144:147],a[48:51],v[16:19]
tr a[134:135],v224 offset:61440
mm v[16:19],a[148:151],a[56:59],v[16:19]
tr a[136:137],v225 offset:49152
mm v[20:23],a[144:147],a[52:55],v[20:23]
tr a[138:139],v225 offset:53248
mm v[20:23],a[148:151],a[60:63],v[20:23]
tr a[140:141],v225 offset:57344
s_waitcnt lgkmcnt(7)
mm v[24:27],a[152:155],a[48:51],v[24:27]
tr a[142:143],v225 offset:61440
bl v217,s[12:15],s49 offen offset:1024 lds
mm v[24:27],a[156:159],a[56:59],v[24:27]
tr a[144:145],v226 offset:49152
mm v[28:31],a[152:155],a[52:55],v[28:31]
tr a[146:147],v226 offset:53248
mm v[28:31],a[156:159],a[60:63],v[28:31]
tr a[148:149],v226 offset:57344
s_waitcnt lgkmcnt(7)
mm v[32:35],a[128:131],a[48:51],v[32:35]
tr a[150:151],v226 offset:61440
bl v218,s[12:15],s49 offen offset:2048 lds
mm v[32:35],a[132:135],a[56:59],v[32:35]
tr a[152:153],v227 offset:49152
s_waitcnt vmcnt(19)
mm v[36:39],a[128:131],a[52:55],v[36:39]
tr a[154:155],v227 offset:53248
s_barrier
mm v[36:39],a[132:135],a[60:63],v[36:39]
tr a[156:157],v227 offset:57344
s_waitcnt lgkmcnt(7)
mm v[40:43],a[136:139],a[48:51],v[40:43]
tr a[158:159],v227 offset:61440
bl v219,s[12:15],s49 offen offset:3072 lds
mm v[40:43],a[140:143],a[56:59],v[40:43]
tr a[128:129],v228 offset:0
s_add_u32 s49,s49,131072
mm v[44:47],a[136:139],a[52:55],v[44:47]
tr a[130:131],v228 offset:4096
mm v[44:47],a[140:143],a[60:63],v[44:47]
tr a[132:133],v228 offset:8192
s_waitcnt lgkmcnt(7)
mm v[48:51],a[144:147],a[48:51],v[48:51]
tr a[134:135],v228 offset:12288
bl a[16:19],v214,s[8:11],s48 offen offset:0 sc1
mm v[48:51],a[148:151],a[56:59],v[48:51]
tr a[136:137],v229 offset:0
mm v[52:55],a[144:147],a[52:55],v[52:55]
tr a[138:139],v229 offset:4096
mm v[52:55],a[148:151],a[60:63],v[52:55]
tr a[140:141],v229 offset:8192
s_waitcnt lgkmcnt(7)
mm v[56:59],a[152:155],a[48:51],v[56:59]
tr a[142:143],v229 offset:12288
bl a[20:23],v215,s[8:11],s48 offen offset:0 sc1
mm v[56:59],a[156:159],a[56:59],v[56:59]
tr a[144:145],v230 offset:0
mm v[60:63],a[152:155],a[52:55],v[60:63]
tr a[146:147],v230 offset:4096
mm v[60:63],a[156:159],a[60:63],v[60:63]
tr a[148:149],v230 offset:8192
s_waitcnt lgkmcnt(7)
mm v[0:3],a[128:131],a[64:67],v[0:3]
tr a[150:151],v230 offset:12288
bl a[24:27],v214,s[8:11],s48 offen offset:1024 sc1
mm v[0:3],a[132:135],a[72:75],v[0:3]
tr a[152:153],v231 offset:0
mm v[4:7],a[128:131],a[68:71],v[4:7]
tr a[154:155],v231 offset:4096
mm v[4:7],a[132:135],a[76:79],v[4:7]
tr a[156:157],v231 offset:8192
s_waitcnt lgkmcnt(7)
mm v[8:11],a[136:139],a[64:67],v[8:11]
tr a[158:159],v231 offset:12288
mm v[8:11],a[140:143],a[72:75],v[8:11]
tr a[128:129],v232 offset:0
bl a[28:31],v215,s[8:11],s48 offen offset:1024 sc1
mm v[12:15],a[136:139],a[68:71],v[12:15]
tr a[130:131],v232 offset:4096
s_add_u32 s48,s48,2048
mm v[12:15],a[140:143],a[76:79],v[12:15]
tr a[132:133],v232 offset:8192
s_waitcnt lgkmcnt(7)
mm v[16:19],a[144:147],a[64:67],v[16:19]
tr a[134:135],v232 offset:12288
s_add_u32 m0,s50,16384
mm v[16:19],a[148:151],a[72:75],v[16:19]
tr a[136:137],v233 offset:0
bl v216,s[12:15],s49 offen offset:0 lds
mm v[20:23],a[144:147],a[68:71],v[20:23]
tr a[138:139],v233 offset:4096
mm v[20:23],a[148:151],a[76:79],v[20:23]
tr a[140:141],v233 offset:8192
s_waitcnt lgkmcnt(7)
mm v[24:27],a[152:155],a[64:67],v[24:27]
tr a[142:143],v233 offset:12288
mm v[24:27],a[156:159],a[72:75],v[24:27]
tr a[144:145],v234 offset:0
bl v217,s[12:15],s49 offen offset:1024 lds
mm v[28:31],a[152:155],a[68:71],v[28:31]
tr a[146:147],v234 offset:4096
mm v[28:31],a[156:159],a[76:79],v[28:31]
tr a[148:149],v234 offset:8192
s_waitcnt lgkmcnt(7)
mm v[32:35],a[128:131],a[64:67],v[32:35]
tr a[150:151],v234 offset:12288
mm v[32:35],a[132:135],a[72:75],v[32:35]
tr a[152:153],v235 offset:0
s_waitcnt vmcnt(22)
mm v[36:39],a[128:131],a[68:71],v[36:39]
tr a[154:155],v235 offset:4096
s_barrier
mm v[36:39],a[132:135],a[76:79],v[36:39]
bl v218,s[12:15],s49 offen offset:2048 lds
s_waitcnt lgkmcnt(6)
mm v[40:43],a[136:139],a[64:67],v[40:43]
tr a[156:157],v235 offset:8192
tr a[158:159],v235 offset:12288
mm v[40:43],a[140:143],a[72:75],v[40:43]
tr a[128:129],v228 offset:16384
mm v[44:47],a[136:139],a[68:71],v[44:47]
tr a[130:131],v228 offset:20480
bl v219,s[12:15],s49 offen offset:3072 lds
mm v[44:47],a[140:143],a[76:79],v[44:47]
tr a[132:133],v228 offset:24576
s_waitcnt lgkmcnt(7)
mm v[48:51],a[144:147],a[64:67],v[48:51]
tr a[134:135],v228 offset:28672
s_add_u32 s49,s49,131072
mm v[48:51],a[148:151],a[72:75],v[48:51]
tr a[136:137],v229 offset:16384
mm v[52:55],a[144:147],a[68:71],v[52:55]
tr a[138:139],v229 offset:20480
bl a[32:35],v214,s[8:11],s48 offen offset:0 sc1
mm v[52:55],a[148:151],a[76:79],v[52:55]
tr a[140:141],v229 offset:24576
s_waitcnt lgkmcnt(7)
mm v[56:59],a[152:155],a[64:67],v[56:59]
tr a[142:143],v229 offset:28672
mm v[56:59],a[156:159],a[72:75],v[56:59]
tr a[144:145],v230 offset:16384
mm v[60:63],a[152:155],a[68:71],v[60:63]
tr a[146:147],v230 offset:20480
bl a[36:39],v215,s[8:11],s48 offen offset:0 sc1
mm v[60:63],a[156:159],a[76:79],v[60:63]
tr a[148:149],v230 offset:24576
s_waitcnt lgkmcnt(7)
mm v[0:3],a[128:131],a[80:83],v[0:3]
tr a[150:151],v230 offset:28672
mm v[0:3],a[132:135],a[88:91],v[0:3]
tr a[152:153],v231 offset:16384
mm v[4:7],a[128:131],a[84:87],v[4:7]
tr a[154:155],v231 offset:20480
mm v[4:7],a[132:135],a[92:95],v[4:7]
tr a[156:157],v231 offset:24576
s_waitcnt lgkmcnt(7)
mm v[8:11],a[136:139],a[80:83],v[8:11]
tr a[158:159],v231 offset:28672
bl a[40:43],v214,s[8:11],s48 offen offset:1024 sc1
mm v[8:11],a[140:143],a[88:91],v[8:11]
tr a[128:129],v232 offset:16384
mm v[12:15],a[136:139],a[84:87],v[12:15]
tr a[130:131],v232 offset:20480
mm v[12:15],a[140:143],a[92:95],v[12:15]
tr a[132:133],v232 offset:24576
s_waitcnt lgkmcnt(7)
mm v[16:19],a[144:147],a[80:83],v[16:19]
tr a[134:135],v232 offset:28672
bl a[44:47],v215,s[8:11],s48 offen offset:1024 sc1
mm v[16:19],a[148:151],a[88:91],v[16:19]
tr a[136:137],v233 offset:16384
s_add_u32 s48,s48,2048
mm v[20:23],a[144:147],a[84:87],v[20:23]
tr a[138:139],v233 offset:20480
s_add_u32 m0,s50,32768
mm v[20:23],a[148:151],a[92:95],v[20:23]
tr a[140:141],v233 offset:24576
s_waitcnt lgkmcnt(7)
mm v[24:27],a[152:155],a[80:83],v[24:27]
tr a[142:143],v233 offset:28672
bl v216,s[12:15],s49 offen offset:0 lds
mm v[24:27],a[156:159],a[88:91],v[24:27]
tr a[144:145],v234 offset:16384
mm v[28:31],a[152:155],a[84:87],v[28:31]
tr a[146:147],v234 offset:20480
mm v[28:31],a[156:159],a[92:95],v[28:31]
tr a[148:149],v234 offset:24576
s_waitcnt lgkmcnt(7)
mm v[32:35],a[128:131],a[80:83],v[32:35]
tr a[150:151],v234 offset:28672
bl v217,s[12:15],s49 offen offset:1024 lds
mm v[32:35],a[132:135],a[88:91],v[32:35]
tr a[152:153],v235 offset:16384
s_waitcnt vmcnt(26)
mm v[36:39],a[128:131],a[84:87],v[36:39]
tr a[154:155],v235 offset:20480
s_barrier
mm v[36:39],a[132:135],a[92:95],v[36:39]
tr a[156:157],v235 offset:24576
s_waitcnt lgkmcnt(7)
mm v[40:43],a[136:139],a[80:83],v[40:43]
tr a[158:159],v235 offset:28672
bl v218,s[12:15],s49 offen offset:2048 lds
mm v[40:43],a[140:143],a[88:91],v[40:43]
tr a[128:129],v228 offset:32768
mm v[44:47],a[136:139],a[84:87],v[44:47]
tr a[130:131],v228 offset:36864
mm v[44:47],a[140:143],a[92:95],v[44:47]
tr a[132:133],v228 offset:40960
s_waitcnt lgkmcnt(7)
mm v[48:51],a[144:147],a[80:83],v[48:51]
tr a[134:135],v228 offset:45056
bl v219,s[12:15],s49 offen offset:3072 lds
mm v[48:51],a[148:151],a[88:91],v[48:51]
tr a[136:137],v229 offset:32768
s_add_u32 s49,s49,131072
mm v[52:55],a[144:147],a[84:87],v[52:55]
tr a[138:139],v229 offset:36864
mm v[52:55],a[148:151],a[92:95],v[52:55]
tr a[140:141],v229 offset:40960
s_waitcnt lgkmcnt(7)
mm v[56:59],a[152:155],a[80:83],v[56:59]
tr a[142:143],v229 offset:45056
bl a[48:51],v214,s[8:11],s48 offen offset:0 sc1
mm v[56:59],a[156:159],a[88:91],v[56:59]
tr a[144:145],v230 offset:32768
mm v[60:63],a[152:155],a[84:87],v[60:63]
tr a[146:147],v230 offset:36864
mm v[60:63],a[156:159],a[92:95],v[60:63]
tr a[148:149],v230 offset:40960
s_waitcnt lgkmcnt(7)
mm v[0:3],a[128:131],a[96:99],v[0:3]
tr a[150:151],v230 offset:45056
mm v[0:3],a[132:135],a[104:107],v[0:3]
tr a[152:153],v231 offset:32768
bl a[52:55],v215,s[8:11],s48 offen offset:0 sc1
mm v[4:7],a[128:131],a[100:103],v[4:7]
tr a[154:155],v231 offset:36864
mm v[4:7],a[132:135],a[108:111],v[4:7]
tr a[156:157],v231 offset:40960
s_waitcnt lgkmcnt(7)
mm v[8:11],a[136:139],a[96:99],v[8:11]
tr a[158:159],v231 offset:45056
mm v[8:11],a[140:143],a[104:107],v[8:11]
tr a[128:129],v232 offset:32768
bl a[56:59],v214,s[8:11],s48 offen offset:1024 sc1
mm v[12:15],a[136:139],a[100:103],v[12:15]
tr a[130:131],v232 offset:36864
mm v[12:15],a[140:143],a[108:111],v[12:15]
tr a[132:133],v232 offset:40960
s_waitcnt lgkmcnt(7)
mm v[16:19],a[144:147],a[96:99],v[16:19]
tr a[134:135],v232 offset:45056
mm v[16:19],a[148:151],a[104:107],v[16:19]
tr a[136:137],v233 offset:32768
bl a[60:63],v215,s[8:11],s48 offen offset:1024 sc1
mm v[20:23],a[144:147],a[100:103],v[20:23]
tr a[138:139],v233 offset:36864
s_add_u32 s48,s48,2048
mm v[20:23],a[148:151],a[108:111],v[20:23]
tr a[140:141],v233 offset:40960
s_waitcnt lgkmcnt(7)
mm v[24:27],a[152:155],a[96:99],v[24:27]
tr a[142:143],v233 offset:45056
s_add_u32 m0,s50,49152
mm v[24:27],a[156:159],a[104:107],v[24:27]
tr a[144:145],v234 offset:32768
bl v216,s[12:15],s49 offen offset:0 lds
mm v[28:31],a[152:155],a[100:103],v[28:31]
tr a[146:147],v234 offset:36864
mm v[28:31],a[156:159],a[108:111],v[28:31]
tr a[148:149],v234 offset:40960
s_waitcnt lgkmcnt(7)
mm v[32:35],a[128:131],a[96:99],v[32:35]
tr a[150:151],v234 offset:45056
mm v[32:35],a[132:135],a[104:107],v[32:35]
tr a[152:153],v235 offset:32768
s_waitcnt vmcnt(29)
mm v[36:39],a[128:131],a[100:103],v[36:39]
tr a[154:155],v235 offset:36864
s_barrier
mm v[36:39],a[132:135],a[108:111],v[36:39]
bl v217,s[12:15],s49 offen offset:1024 lds
s_waitcnt lgkmcnt(6)
mm v[40:43],a[136:139],a[96:99],v[40:43]
tr a[156:157],v235 offset:40960
tr a[158:159],v235 offset:45056
mm v[40:43],a[140:143],a[104:107],v[40:43]
tr a[128:129],v228 offset:49152
mm v[44:47],a[136:139],a[100:103],v[44:47]
tr a[130:131],v228 offset:53248
bl v218,s[12:15],s49 offen offset:2048 lds
mm v[44:47],a[140:143],a[108:111],v[44:47]
tr a[132:133],v228 offset:57344
s_waitcnt lgkmcnt(7)
mm v[48:51],a[144:147],a[96:99],v[48:51]
tr a[134:135],v228 offset:61440
mm v[48:51],a[148:151],a[104:107],v[48:51]
tr a[136:137],v229 offset:49152
mm v[52:55],a[144:147],a[100:103],v[52:55]
tr a[138:139],v229 offset:53248
bl v219,s[12:15],s49 offen offset:3072 lds
mm v[52:55],a[148:151],a[108:111],v[52:55]
tr a[140:141],v229 offset:57344
s_waitcnt lgkmcnt(7)
mm v[56:59],a[152:155],a[96:99],v[56:59]
tr a[142:143],v229 offset:61440
s_add_u32 s49,s49,131072
mm v[56:59],a[156:159],a[104:107],v[56:59]
tr a[144:145],v230 offset:49152
mm v[60:63],a[152:155],a[100:103],v[60:63]
tr a[146:147],v230 offset:53248
mm v[60:63],a[156:159],a[108:111],v[60:63]
tr a[148:149],v230 offset:57344
s_waitcnt lgkmcnt(7)
mm v[0:3],a[128:131],a[112:115],v[0:3]
tr a[150:151],v230 offset:61440
bl a[64:67],v214,s[8:11],s48 offen offset:0 sc1
mm v[0:3],a[132:135],a[120:123],v[0:3]
tr a[152:153],v231 offset:49152
mm v[4:7],a[128:131],a[116:119],v[4:7]
tr a[154:155],v231 offset:53248
mm v[4:7],a[132:135],a[124:127],v[4:7]
tr a[156:157],v231 offset:57344
s_waitcnt lgkmcnt(7)
mm v[8:11],a[136:139],a[112:115],v[8:11]
tr a[158:159],v231 offset:61440
bl a[68:71],v215,s[8:11],s48 offen offset:0 sc1
mm v[8:11],a[140:143],a[120:123],v[8:11]
tr a[128:129],v232 offset:49152
mm v[12:15],a[136:139],a[116:119],v[12:15]
tr a[130:131],v232 offset:53248
mm v[12:15],a[140:143],a[124:127],v[12:15]
tr a[132:133],v232 offset:57344
s_waitcnt lgkmcnt(7)
mm v[16:19],a[144:147],a[112:115],v[16:19]
tr a[134:135],v232 offset:61440
bl a[72:75],v214,s[8:11],s48 offen offset:1024 sc1
mm v[16:19],a[148:151],a[120:123],v[16:19]
tr a[136:137],v233 offset:49152
mm v[20:23],a[144:147],a[116:119],v[20:23]
tr a[138:139],v233 offset:53248
mm v[20:23],a[148:151],a[124:127],v[20:23]
tr a[140:141],v233 offset:57344
s_waitcnt lgkmcnt(7)
mm v[24:27],a[152:155],a[112:115],v[24:27]
tr a[142:143],v233 offset:61440
bl a[76:79],v215,s[8:11],s48 offen offset:1024 sc1
mm v[24:27],a[156:159],a[120:123],v[24:27]
tr a[144:145],v234 offset:49152
s_add_u32 s48,s48,2048
mm v[28:31],a[152:155],a[116:119],v[28:31]
tr a[146:147],v234 offset:53248
s_add_u32 m0,s50,65536
mm v[28:31],a[156:159],a[124:127],v[28:31]
tr a[148:149],v234 offset:57344
s_waitcnt lgkmcnt(7)
mm v[32:35],a[128:131],a[112:115],v[32:35]
tr a[150:151],v234 offset:61440
bl v216,s[12:15],s49 offen offset:0 lds
mm v[32:35],a[132:135],a[120:123],v[32:35]
tr a[152:153],v235 offset:49152
s_waitcnt vmcnt(29)
mm v[36:39],a[128:131],a[116:119],v[36:39]
tr a[154:155],v235 offset:53248
s_barrier
mm v[36:39],a[132:135],a[124:127],v[36:39]
tr a[156:157],v235 offset:57344
s_waitcnt lgkmcnt(7)
mm v[40:43],a[136:139],a[112:115],v[40:43]
tr a[158:159],v235 offset:61440
bl v217,s[12:15],s49 offen offset:1024 lds
mm v[40:43],a[140:143],a[120:123],v[40:43]
tr a[128:129],v220 offset:0
mm v[44:47],a[136:139],a[116:119],v[44:47]
tr a[130:131],v220 offset:4096
mm v[44:47],a[140:143],a[124:127],v[44:47]
tr a[132:133],v220 offset:8192
s_waitcnt lgkmcnt(7)
mm v[48:51],a[144:147],a[112:115],v[48:51]
tr a[134:135],v220 offset:12288
bl v218,s[12:15],s49 offen offset:2048 lds
mm v[48:51],a[148:151],a[120:123],v[48:51]
tr a[136:137],v221 offset:0
mm v[52:55],a[144:147],a[116:119],v[52:55]
tr a[138:139],v221 offset:4096
mm v[52:55],a[148:151],a[124:127],v[52:55]
tr a[140:141],v221 offset:8192
s_waitcnt lgkmcnt(7)
mm v[56:59],a[152:155],a[112:115],v[56:59]
tr a[142:143],v221 offset:12288
mm v[56:59],a[156:159],a[120:123],v[56:59]
tr a[144:145],v222 offset:0
bl v219,s[12:15],s49 offen offset:3072 lds
mm v[60:63],a[152:155],a[116:119],v[60:63]
tr a[146:147],v222 offset:4096
s_add_u32 s49,s49,131072
mm v[60:63],a[156:159],a[124:127],v[60:63]
tr a[148:149],v222 offset:8192
s_waitcnt lgkmcnt(7)
mm v[0:3],a[128:131],a[0:3],v[0:3]
tr a[150:151],v222 offset:12288
mm v[0:3],a[132:135],a[8:11],v[0:3]
tr a[152:153],v223 offset:0
bl a[80:83],v214,s[8:11],s48 offen offset:0 sc1
mm v[4:7],a[128:131],a[4:7],v[4:7]
tr a[154:155],v223 offset:4096
mm v[4:7],a[132:135],a[12:15],v[4:7]
tr a[156:157],v223 offset:8192
s_waitcnt lgkmcnt(7)
mm v[8:11],a[136:139],a[0:3],v[8:11]
tr a[158:159],v223 offset:12288
mm v[8:11],a[140:143],a[8:11],v[8:11]
tr a[128:129],v224 offset:0
bl a[84:87],v215,s[8:11],s48 offen offset:0 sc1
mm v[12:15],a[136:139],a[4:7],v[12:15]
tr a[130:131],v224 offset:4096
mm v[12:15],a[140:143],a[12:15],v[12:15]
tr a[132:133],v224 offset:8192
s_waitcnt lgkmcnt(7)
mm v[16:19],a[144:147],a[0:3],v[16:19]
tr a[134:135],v224 offset:12288
mm v[16:19],a[148:151],a[8:11],v[16:19]
tr a[136:137],v225 offset:0
mm v[20:23],a[144:147],a[4:7],v[20:23]
tr a[138:139],v225 offset:4096
bl a[88:91],v214,s[8:11],s48 offen offset:1024 sc1
mm v[20:23],a[148:151],a[12:15],v[20:23]
tr a[140:141],v225 offset:8192
s_waitcnt lgkmcnt(7)
mm v[24:27],a[152:155],a[0:3],v[24:27]
tr a[142:143],v225 offset:12288
mm v[24:27],a[156:159],a[8:11],v[24:27]
tr a[144:145],v226 offset:0
mm v[28:31],a[152:155],a[4:7],v[28:31]
tr a[146:147],v226 offset:4096
bl a[92:95],v215,s[8:11],s48 offen offset:1024 sc1
mm v[28:31],a[156:159],a[12:15],v[28:31]
tr a[148:149],v226 offset:8192
s_waitcnt lgkmcnt(7)
mm v[32:35],a[128:131],a[0:3],v[32:35]
tr a[150:151],v226 offset:12288
s_add_u32 s48,s48,2048
mm v[32:35],a[132:135],a[8:11],v[32:35]
tr a[152:153],v227 offset:0
s_waitcnt vmcnt(28)
mm v[36:39],a[128:131],a[4:7],v[36:39]
tr a[154:155],v227 offset:4096
s_barrier
mm v[36:39],a[132:135],a[12:15],v[36:39]
s_add_u32 m0,s50,81920
s_waitcnt lgkmcnt(6)
mm v[40:43],a[136:139],a[0:3],v[40:43]
tr a[156:157],v227 offset:8192
bl v216,s[12:15],s49 offen offset:0 lds
mm v[40:43],a[140:143],a[8:11],v[40:43]
tr a[158:159],v227 offset:12288
mm v[44:47],a[136:139],a[4:7],v[44:47]
tr a[128:129],v220 offset:16384
tr a[130:131],v220 offset:20480
mm v[44:47],a[140:143],a[12:15],v[44:47]
bl v217,s[12:15],s49 offen offset:1024 lds
s_waitcnt lgkmcnt(6)
mm v[48:51],a[144:147],a[0:3],v[48:51]
tr a[132:133],v220 offset:24576
tr a[134:135],v220 offset:28672
mm v[48:51],a[148:151],a[8:11],v[48:51]
tr a[136:137],v221 offset:16384
mm v[52:55],a[144:147],a[4:7],v[52:55]
tr a[138:139],v221 offset:20480
mm v[52:55],a[148:151],a[12:15],v[52:55]
tr a[140:141],v221 offset:24576
s_waitcnt lgkmcnt(7)
mm v[56:59],a[152:155],a[0:3],v[56:59]
tr a[142:143],v221 offset:28672
bl v218,s[12:15],s49 offen offset:2048 lds
mm v[56:59],a[156:159],a[8:11],v[56:59]
tr a[144:145],v222 offset:16384
mm v[60:63],a[152:155],a[4:7],v[60:63]
tr a[146:147],v222 offset:20480
mm v[60:63],a[156:159],a[12:15],v[60:63]
tr a[148:149],v222 offset:24576
s_waitcnt lgkmcnt(7)
mm v[0:3],a[128:131],a[16:19],v[0:3]
tr a[150:151],v222 offset:28672
bl v219,s[12:15],s49 offen offset:3072 lds
mm v[0:3],a[132:135],a[24:27],v[0:3]
tr a[152:153],v223 offset:16384
s_add_u32 s49,s49,131072
mm v[4:7],a[128:131],a[20:23],v[4:7]
tr a[154:155],v223 offset:20480
mm v[4:7],a[132:135],a[28:31],v[4:7]
tr a[156:157],v223 offset:24576
s_waitcnt lgkmcnt(7)
mm v[8:11],a[136:139],a[16:19],v[8:11]
tr a[158:159],v223 offset:28672
bl a[96:99],v214,s[8:11],s48 offen offset:0 sc1
mm v[8:11],a[140:143],a[24:27],v[8:11]
tr a[128:129],v224 offset:16384
mm v[12:15],a[136:139],a[20:23],v[12:15]
tr a[130:131],v224 offset:20480
mm v[12:15],a[140:143],a[28:31],v[12:15]
tr a[132:133],v224 offset:24576
s_waitcnt lgkmcnt(7)
mm v[16:19],a[144:147],a[16:19],v[16:19]
tr a[134:135],v224 offset:28672
bl a[100:103],v215,s[8:11],s48 offen offset:0 sc1
mm v[16:19],a[148:151],a[24:27],v[16:19]
tr a[136:137],v225 offset:16384
mm v[20:23],a[144:147],a[20:23],v[20:23]
tr a[138:139],v225 offset:20480
mm v[20:23],a[148:151],a[28:31],v[20:23]
tr a[140:141],v225 offset:24576
s_waitcnt lgkmcnt(7)
mm v[24:27],a[152:155],a[16:19],v[24:27]
tr a[142:143],v225 offset:28672
bl a[104:107],v214,s[8:11],s48 offen offset:1024 sc1
mm v[24:27],a[156:159],a[24:27],v[24:27]
tr a[144:145],v226 offset:16384
mm v[28:31],a[152:155],a[20:23],v[28:31]
tr a[146:147],v226 offset:20480
mm v[28:31],a[156:159],a[28:31],v[28:31]
tr a[148:149],v226 offset:24576
s_waitcnt lgkmcnt(7)
mm v[32:35],a[128:131],a[16:19],v[32:35]
tr a[150:151],v226 offset:28672
bl a[108:111],v215,s[8:11],s48 offen offset:1024 sc1
mm v[32:35],a[132:135],a[24:27],v[32:35]
tr a[152:153],v227 offset:16384
s_waitcnt vmcnt(28)
mm v[36:39],a[128:131],a[20:23],v[36:39]
tr a[154:155],v227 offset:20480
s_barrier
mm v[36:39],a[132:135],a[28:31],v[36:39]
tr a[156:157],v227 offset:24576
s_waitcnt lgkmcnt(7)
mm v[40:43],a[136:139],a[16:19],v[40:43]
tr a[158:159],v227 offset:28672
s_add_u32 s48,s48,2048
mm v[40:43],a[140:143],a[24:27],v[40:43]
tr a[128:129],v220 offset:32768
s_add_u32 m0,s50,98304
mm v[44:47],a[136:139],a[20:23],v[44:47]
tr a[130:131],v220 offset:36864
bl v216,s[12:15],s49 offen offset:0 lds
mm v[44:47],a[140:143],a[28:31],v[44:47]
tr a[132:133],v220 offset:40960
s_waitcnt lgkmcnt(7)
mm v[48:51],a[144:147],a[16:19],v[48:51]
tr a[134:135],v220 offset:45056
mm v[48:51],a[148:151],a[24:27],v[48:51]
tr a[136:137],v221 offset:32768
bl v217,s[12:15],s49 offen offset:1024 lds
mm v[52:55],a[144:147],a[20:23],v[52:55]
tr a[138:139],v221 offset:36864
mm v[52:55],a[148:151],a[28:31],v[52:55]
tr a[140:141],v221 offset:40960
s_waitcnt lgkmcnt(7)
mm v[56:59],a[152:155],a[16:19],v[56:59]
tr a[142:143],v221 offset:45056
mm v[56:59],a[156:159],a[24:27],v[56:59]
tr a[144:145],v222 offset:32768
bl v218,s[12:15],s49 offen offset:2048 lds
mm v[60:63],a[152:155],a[20:23],v[60:63]
tr a[146:147],v222 offset:36864
mm v[60:63],a[156:159],a[28:31],v[60:63]
tr a[148:149],v222 offset:40960
s_waitcnt lgkmcnt(7)
mm v[0:3],a[128:131],a[32:35],v[0:3]
tr a[150:151],v222 offset:45056
mm v[0:3],a[132:135],a[40:43],v[0:3]
tr a[152:153],v223 offset:32768
bl v219,s[12:15],s49 offen offset:3072 lds
mm v[4:7],a[128:131],a[36:39],v[4:7]
tr a[154:155],v223 offset:36864
s_add_u32 s49,s49,131072
mm v[4:7],a[132:135],a[44:47],v[4:7]
tr a[156:157],v223 offset:40960
s_waitcnt lgkmcnt(7)
mm v[8:11],a[136:139],a[32:35],v[8:11]
tr a[158:159],v223 offset:45056
mm v[8:11],a[140:143],a[40:43],v[8:11]
tr a[128:129],v224 offset:32768
mm v[12:15],a[136:139],a[36:39],v[12:15]
tr a[130:131],v224 offset:36864
bl a[112:115],v214,s[8:11],s48 offen offset:0 sc1
mm v[12:15],a[140:143],a[44:47],v[12:15]
tr a[132:133],v224 offset:40960
s_waitcnt lgkmcnt(7)
mm v[16:19],a[144:147],a[32:35],v[16:19]
tr a[134:135],v224 offset:45056
mm v[16:19],a[148:151],a[40:43],v[16:19]
tr a[136:137],v225 offset:32768
mm v[20:23],a[144:147],a[36:39],v[20:23]
tr a[138:139],v225 offset:36864
bl a[116:119],v215,s[8:11],s48 offen offset:0 sc1
mm v[20:23],a[148:151],a[44:47],v[20:23]
tr a[140:141],v225 offset:40960
s_waitcnt lgkmcnt(7)
mm v[24:27],a[152:155],a[32:35],v[24:27]
tr a[142:143],v225 offset:45056
mm v[24:27],a[156:159],a[40:43],v[24:27]
tr a[144:145],v226 offset:32768
mm v[28:31],a[152:155],a[36:39],v[28:31]
tr a[146:147],v226 offset:36864
bl a[120:123],v214,s[8:11],s48 offen offset:1024 sc1
mm v[28:31],a[156:159],a[44:47],v[28:31]
tr a[148:149],v226 offset:40960
s_waitcnt lgkmcnt(7)
mm v[32:35],a[128:131],a[32:35],v[32:35]
tr a[150:151],v226 offset:45056
mm v[32:35],a[132:135],a[40:43],v[32:35]
tr a[152:153],v227 offset:32768
s_waitcnt vmcnt(27)
mm v[36:39],a[128:131],a[36:39],v[36:39]
tr a[154:155],v227 offset:36864
s_barrier
mm v[36:39],a[132:135],a[44:47],v[36:39]
bl a[124:127],v215,s[8:11],s48 offen offset:1024 sc1
s_waitcnt lgkmcnt(6)
mm v[40:43],a[136:139],a[32:35],v[40:43]
tr a[156:157],v227 offset:40960
tr a[158:159],v227 offset:45056
mm v[40:43],a[140:143],a[40:43],v[40:43]
tr a[128:129],v220 offset:49152
s_add_u32 s48,s48,2048
mm v[44:47],a[136:139],a[36:39],v[44:47]
tr a[130:131],v220 offset:53248
s_add_u32 m0,s50,114688
mm v[44:47],a[140:143],a[44:47],v[44:47]
tr a[132:133],v220 offset:57344
s_waitcnt lgkmcnt(7)
mm v[48:51],a[144:147],a[32:35],v[48:51]
tr a[134:135],v220 offset:61440
bl v216,s[12:15],s49 offen offset:0 lds
mm v[48:51],a[148:151],a[40:43],v[48:51]
tr a[136:137],v221 offset:49152
mm v[52:55],a[144:147],a[36:39],v[52:55]
tr a[138:139],v221 offset:53248
mm v[52:55],a[148:151],a[44:47],v[52:55]
tr a[140:141],v221 offset:57344
s_waitcnt lgkmcnt(7)
mm v[56:59],a[152:155],a[32:35],v[56:59]
tr a[142:143],v221 offset:61440
bl v217,s[12:15],s49 offen offset:1024 lds
mm v[56:59],a[156:159],a[40:43],v[56:59]
tr a[144:145],v222 offset:49152
mm v[60:63],a[152:155],a[36:39],v[60:63]
tr a[146:147],v222 offset:53248
mm v[60:63],a[156:159],a[44:47],v[60:63]
tr a[148:149],v222 offset:57344
s_waitcnt lgkmcnt(7)
mm v[0:3],a[128:131],a[48:51],v[0:3]
tr a[150:151],v222 offset:61440
bl v218,s[12:15],s49 offen offset:2048 lds
mm v[0:3],a[132:135],a[56:59],v[0:3]
tr a[152:153],v223 offset:49152
mm v[4:7],a[128:131],a[52:55],v[4:7]
tr a[154:155],v223 offset:53248
mm v[4:7],a[132:135],a[60:63],v[4:7]
tr a[156:157],v223 offset:57344
s_waitcnt lgkmcnt(7)
mm v[8:11],a[136:139],a[48:51],v[8:11]
tr a[158:159],v223 offset:61440
bl v219,s[12:15],s49 offen offset:3072 lds
mm v[8:11],a[140:143],a[56:59],v[8:11]
tr a[128:129],v224 offset:49152
s_add_u32 s49,s49,131072
mm v[12:15],a[136:139],a[52:55],v[12:15]
tr a[130:131],v224 offset:53248
mm v[12:15],a[140:143],a[60:63],v[12:15]
tr a[132:133],v224 offset:57344
s_waitcnt lgkmcnt(7)
mm v[16:19],a[144:147],a[48:51],v[16:19]
tr a[134:135],v224 offset:61440
bl a[0:3],v214,s[8:11],s48 offen offset:0 sc1
mm v[16:19],a[148:151],a[56:59],v[16:19]
tr a[136:137],v225 offset:49152
mm v[20:23],a[144:147],a[52:55],v[20:23]
tr a[138:139],v225 offset:53248
mm v[20:23],a[148:151],a[60:63],v[20:23]
tr a[140:141],v225 offset:57344
s_waitcnt lgkmcnt(7)
mm v[24:27],a[152:155],a[48:51],v[24:27]
tr a[142:143],v225 offset:61440
bl a[4:7],v215,s[8:11],s48 offen offset:0 sc1
mm v[24:27],a[156:159],a[56:59],v[24:27]
tr a[144:145],v226 offset:49152
mm v[28:31],a[152:155],a[52:55],v[28:31]
tr a[146:147],v226 offset:53248
mm v[28:31],a[156:159],a[60:63],v[28:31]
tr a[148:149],v226 offset:57344
s_waitcnt lgkmcnt(7)
mm v[32:35],a[128:131],a[48:51],v[32:35]
tr a[150:151],v226 offset:61440
mm v[32:35],a[132:135],a[56:59],v[32:35]
tr a[152:153],v227 offset:49152
s_waitcnt vmcnt(26)
mm v[36:39],a[128:131],a[52:55],v[36:39]
tr a[154:155],v227 offset:53248
s_barrier
mm v[36:39],a[132:135],a[60:63],v[36:39]
bl a[8:11],v214,s[8:11],s48 offen offset:1024 sc1
s_waitcnt lgkmcnt(6)
mm v[40:43],a[136:139],a[48:51],v[40:43]
tr a[156:157],v227 offset:57344
tr a[158:159],v227 offset:61440
mm v[40:43],a[140:143],a[56:59],v[40:43]
tr a[128:129],v228 offset:0
bl a[12:15],v215,s[8:11],s48 offen offset:1024 sc1
mm v[44:47],a[136:139],a[52:55],v[44:47]
tr a[130:131],v228 offset:4096
s_add_u32 s48,s48,2048
mm v[44:47],a[140:143],a[60:63],v[44:47]
tr a[132:133],v228 offset:8192
s_waitcnt lgkmcnt(7)
mm v[48:51],a[144:147],a[48:51],v[48:51]
tr a[134:135],v228 offset:12288
s_add_u32 m0,s50,0
mm v[48:51],a[148:151],a[56:59],v[48:51]
tr a[136:137],v229 offset:0
bl v216,s[12:15],s49 offen offset:0 lds
mm v[52:55],a[144:147],a[52:55],v[52:55]
tr a[138:139],v229 offset:4096
mm v[52:55],a[148:151],a[60:63],v[52:55]
tr a[140:141],v229 offset:8192
s_waitcnt lgkmcnt(7)
mm v[56:59],a[152:155],a[48:51],v[56:59]
tr a[142:143],v229 offset:12288
mm v[56:59],a[156:159],a[56:59],v[56:59]
tr a[144:145],v230 offset:0
bl v217,s[12:15],s49 offen offset:1024 lds
mm v[60:63],a[152:155],a[52:55],v[60:63]
tr a[146:147],v230 offset:4096
mm v[60:63],a[156:159],a[60:63],v[60:63]
tr a[148:149],v230 offset:8192
s_waitcnt lgkmcnt(7)
mm v[0:3],a[128:131],a[64:67],v[0:3]
tr a[150:151],v230 offset:12288
mm v[0:3],a[132:135],a[72:75],v[0:3]
tr a[152:153],v231 offset:0
mm v[4:7],a[128:131],a[68:71],v[4:7]
tr a[154:155],v231 offset:4096
bl v218,s[12:15],s49 offen offset:2048 lds
mm v[4:7],a[132:135],a[76:79],v[4:7]
tr a[156:157],v231 offset:8192
s_waitcnt lgkmcnt(7)
mm v[8:11],a[136:139],a[64:67],v[8:11]
tr a[158:159],v231 offset:12288
mm v[8:11],a[140:143],a[72:75],v[8:11]
tr a[128:129],v232 offset:0
mm v[12:15],a[136:139],a[68:71],v[12:15]
tr a[130:131],v232 offset:4096
bl v219,s[12:15],s49 offen offset:3072 lds
mm v[12:15],a[140:143],a[76:79],v[12:15]
tr a[132:133],v232 offset:8192
s_waitcnt lgkmcnt(7)
mm v[16:19],a[144:147],a[64:67],v[16:19]
tr a[134:135],v232 offset:12288
s_add_u32 s49,s49,131072
mm v[16:19],a[148:151],a[72:75],v[16:19]
tr a[136:137],v233 offset:0
mm v[20:23],a[144:147],a[68:71],v[20:23]
tr a[138:139],v233 offset:4096
bl a[16:19],v214,s[8:11],s48 offen offset:0 sc1
mm v[20:23],a[148:151],a[76:79],v[20:23]
tr a[140:141],v233 offset:8192
s_waitcnt lgkmcnt(7)
mm v[24:27],a[152:155],a[64:67],v[24:27]
tr a[142:143],v233 offset:12288
mm v[24:27],a[156:159],a[72:75],v[24:27]
tr a[144:145],v234 offset:0
mm v[28:31],a[152:155],a[68:71],v[28:31]
tr a[146:147],v234 offset:4096
mm v[28:31],a[156:159],a[76:79],v[28:31]
tr a[148:149],v234 offset:8192
s_waitcnt lgkmcnt(7)
mm v[32:35],a[128:131],a[64:67],v[32:35]
tr a[150:151],v234 offset:12288
bl a[20:23],v215,s[8:11],s48 offen offset:0 sc1
mm v[32:35],a[132:135],a[72:75],v[32:35]
tr a[152:153],v235 offset:0
s_waitcnt vmcnt(26)
mm v[36:39],a[128:131],a[68:71],v[36:39]
tr a[154:155],v235 offset:4096
s_barrier
mm v[36:39],a[132:135],a[76:79],v[36:39]
tr a[156:157],v235 offset:8192
s_waitcnt lgkmcnt(7)
mm v[40:43],a[136:139],a[64:67],v[40:43]
tr a[158:159],v235 offset:12288
bl a[24:27],v214,s[8:11],s48 offen offset:1024 sc1
mm v[40:43],a[140:143],a[72:75],v[40:43]
tr a[128:129],v228 offset:16384
mm v[44:47],a[136:139],a[68:71],v[44:47]
tr a[130:131],v228 offset:20480
mm v[44:47],a[140:143],a[76:79],v[44:47]
tr a[132:133],v228 offset:24576
s_waitcnt lgkmcnt(7)
mm v[48:51],a[144:147],a[64:67],v[48:51]
tr a[134:135],v228 offset:28672
bl a[28:31],v215,s[8:11],s48 offen offset:1024 sc1
mm v[48:51],a[148:151],a[72:75],v[48:51]
tr a[136:137],v229 offset:16384
s_add_u32 s48,s48,2048
mm v[52:55],a[144:147],a[68:71],v[52:55]
tr a[138:139],v229 offset:20480
s_add_u32 m0,s50,16384
mm v[52:55],a[148:151],a[76:79],v[52:55]
tr a[140:141],v229 offset:24576
s_waitcnt lgkmcnt(7)
mm v[56:59],a[152:155],a[64:67],v[56:59]
tr a[142:143],v229 offset:28672
bl v216,s[12:15],s49 offen offset:0 lds
mm v[56:59],a[156:159],a[72:75],v[56:59]
tr a[144:145],v230 offset:16384
mm v[60:63],a[152:155],a[68:71],v[60:63]
tr a[146:147],v230 offset:20480
mm v[60:63],a[156:159],a[76:79],v[60:63]
tr a[148:149],v230 offset:24576
s_waitcnt lgkmcnt(7)
mm v[0:3],a[128:131],a[80:83],v[0:3]
tr a[150:151],v230 offset:28672
bl v217,s[12:15],s49 offen offset:1024 lds
mm v[0:3],a[132:135],a[88:91],v[0:3]
tr a[152:153],v231 offset:16384
mm v[4:7],a[128:131],a[84:87],v[4:7]
tr a[154:155],v231 offset:20480
mm v[4:7],a[132:135],a[92:95],v[4:7]
tr a[156:157],v231 offset:24576
s_waitcnt lgkmcnt(7)
mm v[8:11],a[136:139],a[80:83],v[8:11]
tr a[158:159],v231 offset:28672
bl v218,s[12:15],s49 offen offset:2048 lds
mm v[8:11],a[140:143],a[88:91],v[8:11]
tr a[128:129],v232 offset:16384
mm v[12:15],a[136:139],a[84:87],v[12:15]
tr a[130:131],v232 offset:20480
mm v[12:15],a[140:143],a[92:95],v[12:15]
tr a[132:133],v232 offset:24576
s_waitcnt lgkmcnt(7)
mm v[16:19],a[144:147],a[80:83],v[16:19]
tr a[134:135],v232 offset:28672
bl v219,s[12:15],s49 offen offset:3072 lds
mm v[16:19],a[148:151],a[88:91],v[16:19]
tr a[136:137],v233 offset:16384
s_add_u32 s49,s49,131072
mm v[20:23],a[144:147],a[84:87],v[20:23]
tr a[138:139],v233 offset:20480
mm v[20:23],a[148:151],a[92:95],v[20:23]
tr a[140:141],v233 offset:24576
s_waitcnt lgkmcnt(7)
mm v[24:27],a[152:155],a[80:83],v[24:27]
tr a[142:143],v233 offset:28672
mm v[24:27],a[156:159],a[88:91],v[24:27]
tr a[144:145],v234 offset:16384
bl a[32:35],v214,s[8:11],s48 offen offset:0 sc1
mm v[28:31],a[152:155],a[84:87],v[28:31]
tr a[146:147],v234 offset:20480
mm v[28:31],a[156:159],a[92:95],v[28:31]
tr a[148:149],v234 offset:24576
s_waitcnt lgkmcnt(7)
mm v[32:35],a[128:131],a[80:83],v[32:35]
tr a[150:151],v234 offset:28672
mm v[32:35],a[132:135],a[88:91],v[32:35]
tr a[152:153],v235 offset:16384
s_waitcnt vmcnt(25)
mm v[36:39],a[128:131],a[84:87],v[36:39]
tr a[154:155],v235 offset:20480
s_barrier
mm v[36:39],a[132:135],a[92:95],v[36:39]
bl a[36:39],v215,s[8:11],s48 offen offset:0 sc1
s_waitcnt lgkmcnt(6)
mm v[40:43],a[136:139],a[80:83],v[40:43]
tr a[156:157],v235 offset:24576
tr a[158:159],v235 offset:28672
mm v[40:43],a[140:143],a[88:91],v[40:43]
tr a[128:129],v228 offset:32768
bl a[40:43],v214,s[8:11],s48 offen offset:1024 sc1
mm v[44:47],a[136:139],a[84:87],v[44:47]
tr a[130:131],v228 offset:36864
mm v[44:47],a[140:143],a[92:95],v[44:47]
tr a[132:133],v228 offset:40960
s_waitcnt lgkmcnt(7)
mm v[48:51],a[144:147],a[80:83],v[48:51]
tr a[134:135],v228 offset:45056
mm v[48:51],a[148:151],a[88:91],v[48:51]
tr a[136:137],v229 offset:32768
bl a[44:47],v215,s[8:11],s48 offen offset:1024 sc1
mm v[52:55],a[144:147],a[84:87],v[52:55]
tr a[138:139],v229 offset:36864
s_add_u32 s48,s48,2048
mm v[52:55],a[148:151],a[92:95],v[52:55]
tr a[140:141],v229 offset:40960
s_waitcnt lgkmcnt(7)
mm v[56:59],a[152:155],a[80:83],v[56:59]
tr a[142:143],v229 offset:45056
s_add_u32 m0,s50,32768
mm v[56:59],a[156:159],a[88:91],v[56:59]
tr a[144:145],v230 offset:32768
mm v[60:63],a[152:155],a[84:87],v[60:63]
tr a[146:147],v230 offset:36864
bl v216,s[12:15],s49 offen offset:0 lds
mm v[60:63],a[156:159],a[92:95],v[60:63]
tr a[148:149],v230 offset:40960
s_waitcnt lgkmcnt(7)
mm v[0:3],a[128:131],a[96:99],v[0:3]
tr a[150:151],v230 offset:45056
mm v[0:3],a[132:135],a[104:107],v[0:3]
tr a[152:153],v231 offset:32768
mm v[4:7],a[128:131],a[100:103],v[4:7]
tr a[154:155],v231 offset:36864
bl v217,s[12:15],s49 offen offset:1024 lds
mm v[4:7],a[132:135],a[108:111],v[4:7]
tr a[156:157],v231 offset:40960
s_waitcnt lgkmcnt(7)
mm v[8:11],a[136:139],a[96:99],v[8:11]
tr a[158:159],v231 offset:45056
mm v[8:11],a[140:143],a[104:107],v[8:11]
tr a[128:129],v232 offset:32768
mm v[12:15],a[136:139],a[100:103],v[12:15]
tr a[130:131],v232 offset:36864
bl v218,s[12:15],s49 offen offset:2048 lds
mm v[12:15],a[140:143],a[108:111],v[12:15]
tr a[132:133],v232 offset:40960
s_waitcnt lgkmcnt(7)
mm v[16:19],a[144:147],a[96:99],v[16:19]
tr a[134:135],v232 offset:45056
mm v[16:19],a[148:151],a[104:107],v[16:19]
tr a[136:137],v233 offset:32768
mm v[20:23],a[144:147],a[100:103],v[20:23]
tr a[138:139],v233 offset:36864
mm v[20:23],a[148:151],a[108:111],v[20:23]
tr a[140:141],v233 offset:40960
s_waitcnt lgkmcnt(7)
mm v[24:27],a[152:155],a[96:99],v[24:27]
tr a[142:143],v233 offset:45056
bl v219,s[12:15],s49 offen offset:3072 lds
mm v[24:27],a[156:159],a[104:107],v[24:27]
tr a[144:145],v234 offset:32768
s_add_u32 s49,s49,131072
mm v[28:31],a[152:155],a[100:103],v[28:31]
tr a[146:147],v234 offset:36864
mm v[28:31],a[156:159],a[108:111],v[28:31]
tr a[148:149],v234 offset:40960
s_waitcnt lgkmcnt(7)
mm v[32:35],a[128:131],a[96:99],v[32:35]
tr a[150:151],v234 offset:45056
bl a[48:51],v214,s[8:11],s48 offen offset:0 sc1
mm v[32:35],a[132:135],a[104:107],v[32:35]
tr a[152:153],v235 offset:32768
s_waitcnt vmcnt(25)
mm v[36:39],a[128:131],a[100:103],v[36:39]
tr a[154:155],v235 offset:36864
s_barrier
mm v[36:39],a[132:135],a[108:111],v[36:39]
tr a[156:157],v235 offset:40960
s_waitcnt lgkmcnt(7)
mm v[40:43],a[136:139],a[96:99],v[40:43]
tr a[158:159],v235 offset:45056
bl a[52:55],v215,s[8:11],s48 offen offset:0 sc1
mm v[40:43],a[140:143],a[104:107],v[40:43]
tr a[128:129],v228 offset:49152
mm v[44:47],a[136:139],a[100:103],v[44:47]
tr a[130:131],v228 offset:53248
mm v[44:47],a[140:143],a[108:111],v[44:47]
tr a[132:133],v228 offset:57344
s_waitcnt lgkmcnt(7)
mm v[48:51],a[144:147],a[96:99],v[48:51]
tr a[134:135],v228 offset:61440
bl a[56:59],v214,s[8:11],s48 offen offset:1024 sc1
mm v[48:51],a[148:151],a[104:107],v[48:51]
tr a[136:137],v229 offset:49152
mm v[52:55],a[144:147],a[100:103],v[52:55]
tr a[138:139],v229 offset:53248
mm v[52:55],a[148:151],a[108:111],v[52:55]
tr a[140:141],v229 offset:57344
s_waitcnt lgkmcnt(7)
mm v[56:59],a[152:155],a[96:99],v[56:59]
tr a[142:143],v229 offset:61440
bl a[60:63],v215,s[8:11],s48 offen offset:1024 sc1
mm v[56:59],a[156:159],a[104:107],v[56:59]
tr a[144:145],v230 offset:49152
s_add_u32 s48,s48,2048
mm v[60:63],a[152:155],a[100:103],v[60:63]
tr a[146:147],v230 offset:53248
s_add_u32 m0,s50,49152
mm v[60:63],a[156:159],a[108:111],v[60:63]
tr a[148:149],v230 offset:57344
s_waitcnt lgkmcnt(7)
mm v[0:3],a[128:131],a[112:115],v[0:3]
tr a[150:151],v230 offset:61440
bl v216,s[12:15],s49 offen offset:0 lds
mm v[0:3],a[132:135],a[120:123],v[0:3]
tr a[152:153],v231 offset:49152
mm v[4:7],a[128:131],a[116:119],v[4:7]
tr a[154:155],v231 offset:53248
mm v[4:7],a[132:135],a[124:127],v[4:7]
tr a[156:157],v231 offset:57344
s_waitcnt lgkmcnt(7)
mm v[8:11],a[136:139],a[112:115],v[8:11]
tr a[158:159],v231 offset:61440
bl v217,s[12:15],s49 offen offset:1024 lds
mm v[8:11],a[140:143],a[120:123],v[8:11]
tr a[128:129],v232 offset:49152
mm v[12:15],a[136:139],a[116:119],v[12:15]
tr a[130:131],v232 offset:53248
mm v[12:15],a[140:143],a[124:127],v[12:15]
tr a[132:133],v232 offset:57344
s_waitcnt lgkmcnt(7)
mm v[16:19],a[144:147],a[112:115],v[16:19]
tr a[134:135],v232 offset:61440
mm v[16:19],a[148:151],a[120:123],v[16:19]
tr a[136:137],v233 offset:49152
bl v218,s[12:15],s49 offen offset:2048 lds
mm v[20:23],a[144:147],a[116:119],v[20:23]
tr a[138:139],v233 offset:53248
mm v[20:23],a[148:151],a[124:127],v[20:23]
tr a[140:141],v233 offset:57344
s_waitcnt lgkmcnt(7)
mm v[24:27],a[152:155],a[112:115],v[24:27]
tr a[142:143],v233 offset:61440
mm v[24:27],a[156:159],a[120:123],v[24:27]
tr a[144:145],v234 offset:49152
bl v219,s[12:15],s49 offen offset:3072 lds
mm v[28:31],a[152:155],a[116:119],v[28:31]
tr a[146:147],v234 offset:53248
s_add_u32 s49,s49,131072
mm v[28:31],a[156:159],a[124:127],v[28:31]
tr a[148:149],v234 offset:57344
s_waitcnt lgkmcnt(7)
mm v[32:35],a[128:131],a[112:115],v[32:35]
tr a[150:151],v234 offset:61440
mm v[32:35],a[132:135],a[120:123],v[32:35]
tr a[152:153],v235 offset:49152
s_waitcnt vmcnt(24)
mm v[36:39],a[128:131],a[116:119],v[36:39]
tr a[154:155],v235 offset:53248
s_barrier
mm v[36:39],a[132:135],a[124:127],v[36:39]
bl a[64:67],v214,s[8:11],s48 offen offset:0 sc1
s_waitcnt lgkmcnt(6)
mm v[40:43],a[136:139],a[112:115],v[40:43]
tr a[156:157],v235 offset:57344
tr a[158:159],v235 offset:61440
mm v[40:43],a[140:143],a[120:123],v[40:43]
tr a[128:129],v220 offset:0
mm v[44:47],a[136:139],a[116:119],v[44:47]
tr a[130:131],v220 offset:4096
bl a[68:71],v215,s[8:11],s48 offen offset:0 sc1
mm v[44:47],a[140:143],a[124:127],v[44:47]
tr a[132:133],v220 offset:8192
s_waitcnt lgkmcnt(7)
mm v[48:51],a[144:147],a[112:115],v[48:51]
tr a[134:135],v220 offset:12288
mm v[48:51],a[148:151],a[120:123],v[48:51]
tr a[136:137],v221 offset:0
mm v[52:55],a[144:147],a[116:119],v[52:55]
tr a[138:139],v221 offset:4096
bl a[72:75],v214,s[8:11],s48 offen offset:1024 sc1
mm v[52:55],a[148:151],a[124:127],v[52:55]
tr a[140:141],v221 offset:8192
s_waitcnt lgkmcnt(7)
mm v[56:59],a[152:155],a[112:115],v[56:59]
tr a[142:143],v221 offset:12288
mm v[56:59],a[156:159],a[120:123],v[56:59]
tr a[144:145],v222 offset:0
mm v[60:63],a[152:155],a[116:119],v[60:63]
tr a[146:147],v222 offset:4096
bl a[76:79],v215,s[8:11],s48 offen offset:1024 sc1
mm v[60:63],a[156:159],a[124:127],v[60:63]
tr a[148:149],v222 offset:8192
s_waitcnt lgkmcnt(7)
mm v[0:3],a[128:131],a[0:3],v[0:3]
tr a[150:151],v222 offset:12288
s_add_u32 s48,s48,2048
mm v[0:3],a[132:135],a[8:11],v[0:3]
tr a[152:153],v223 offset:0
s_add_u32 m0,s50,65536
mm v[4:7],a[128:131],a[4:7],v[4:7]
tr a[154:155],v223 offset:4096
bl v216,s[12:15],s49 offen offset:0 lds
mm v[4:7],a[132:135],a[12:15],v[4:7]
tr a[156:157],v223 offset:8192
s_waitcnt lgkmcnt(7)
mm v[8:11],a[136:139],a[0:3],v[8:11]
tr a[158:159],v223 offset:12288
mm v[8:11],a[140:143],a[8:11],v[8:11]
tr a[128:129],v224 offset:0
mm v[12:15],a[136:139],a[4:7],v[12:15]
tr a[130:131],v224 offset:4096
mm v[12:15],a[140:143],a[12:15],v[12:15]
tr a[132:133],v224 offset:8192
s_waitcnt lgkmcnt(7)
mm v[16:19],a[144:147],a[0:3],v[16:19]
tr a[134:135],v224 offset:12288
bl v217,s[12:15],s49 offen offset:1024 lds
mm v[16:19],a[148:151],a[8:11],v[16:19]
tr a[136:137],v225 offset:0
mm v[20:23],a[144:147],a[4:7],v[20:23]
tr a[138:139],v225 offset:4096
mm v[20:23],a[148:151],a[12:15],v[20:23]
tr a[140:141],v225 offset:8192
s_waitcnt lgkmcnt(7)
mm v[24:27],a[152:155],a[0:3],v[24:27]
tr a[142:143],v225 offset:12288
bl v218,s[12:15],s49 offen offset:2048 lds
mm v[24:27],a[156:159],a[8:11],v[24:27]
tr a[144:145],v226 offset:0
mm v[28:31],a[152:155],a[4:7],v[28:31]
tr a[146:147],v226 offset:4096
mm v[28:31],a[156:159],a[12:15],v[28:31]
tr a[148:149],v226 offset:8192
s_waitcnt lgkmcnt(7)
mm v[32:35],a[128:131],a[0:3],v[32:35]
tr a[150:151],v226 offset:12288
bl v219,s[12:15],s49 offen offset:3072 lds
mm v[32:35],a[132:135],a[8:11],v[32:35]
tr a[152:153],v227 offset:0
s_waitcnt vmcnt(24)
mm v[36:39],a[128:131],a[4:7],v[36:39]
tr a[154:155],v227 offset:4096
s_barrier
mm v[36:39],a[132:135],a[12:15],v[36:39]
tr a[156:157],v227 offset:8192
s_waitcnt lgkmcnt(7)
mm v[40:43],a[136:139],a[0:3],v[40:43]
tr a[158:159],v227 offset:12288
s_add_u32 s49,s49,131072
mm v[40:43],a[140:143],a[8:11],v[40:43]
tr a[128:129],v220 offset:16384
buffer_load_dword v210,v209,s[8:11],s61 offen sc1
mm v[44:47],a[136:139],a[4:7],v[44:47]
tr a[130:131],v220 offset:20480
mm v[44:47],a[140:143],a[12:15],v[44:47]
tr a[132:133],v220 offset:24576
s_waitcnt lgkmcnt(7)
mm v[48:51],a[144:147],a[0:3],v[48:51]
tr a[134:135],v220 offset:28672
bl a[80:83],v214,s[8:11],s48 offen offset:0 sc1
mm v[48:51],a[148:151],a[8:11],v[48:51]
tr a[136:137],v221 offset:16384
mm v[52:55],a[144:147],a[4:7],v[52:55]
tr a[138:139],v221 offset:20480
mm v[52:55],a[148:151],a[12:15],v[52:55]
tr a[140:141],v221 offset:24576
s_waitcnt lgkmcnt(7)
mm v[56:59],a[152:155],a[0:3],v[56:59]
tr a[142:143],v221 offset:28672
bl a[84:87],v215,s[8:11],s48 offen offset:0 sc1
mm v[56:59],a[156:159],a[8:11],v[56:59]
tr a[144:145],v222 offset:16384
mm v[60:63],a[152:155],a[4:7],v[60:63]
tr a[146:147],v222 offset:20480
mm v[60:63],a[156:159],a[12:15],v[60:63]
tr a[148:149],v222 offset:24576
s_waitcnt lgkmcnt(7)
mm v[0:3],a[128:131],a[16:19],v[0:3]
tr a[150:151],v222 offset:28672
bl a[88:91],v214,s[8:11],s48 offen offset:1024 sc1
mm v[0:3],a[132:135],a[24:27],v[0:3]
tr a[152:153],v223 offset:16384
mm v[4:7],a[128:131],a[20:23],v[4:7]
tr a[154:155],v223 offset:20480
mm v[4:7],a[132:135],a[28:31],v[4:7]
tr a[156:157],v223 offset:24576
s_waitcnt lgkmcnt(7)
mm v[8:11],a[136:139],a[16:19],v[8:11]
tr a[158:159],v223 offset:28672
mm v[8:11],a[140:143],a[24:27],v[8:11]
tr a[128:129],v224 offset:16384
bl a[92:95],v215,s[8:11],s48 offen offset:1024 sc1
mm v[12:15],a[136:139],a[20:23],v[12:15]
tr a[130:131],v224 offset:20480
s_add_u32 s48,s48,2048
mm v[12:15],a[140:143],a[28:31],v[12:15]
tr a[132:133],v224 offset:24576
s_waitcnt lgkmcnt(7)
mm v[16:19],a[144:147],a[16:19],v[16:19]
tr a[134:135],v224 offset:28672
s_add_u32 m0,s50,81920
mm v[16:19],a[148:151],a[24:27],v[16:19]
tr a[136:137],v225 offset:16384
bl v216,s[12:15],s49 offen offset:0 lds
mm v[20:23],a[144:147],a[20:23],v[20:23]
tr a[138:139],v225 offset:20480
mm v[20:23],a[148:151],a[28:31],v[20:23]
tr a[140:141],v225 offset:24576
s_waitcnt lgkmcnt(7)
mm v[24:27],a[152:155],a[16:19],v[24:27]
tr a[142:143],v225 offset:28672
mm v[24:27],a[156:159],a[24:27],v[24:27]
tr a[144:145],v226 offset:16384
bl v217,s[12:15],s49 offen offset:1024 lds
mm v[28:31],a[152:155],a[20:23],v[28:31]
tr a[146:147],v226 offset:20480
mm v[28:31],a[156:159],a[28:31],v[28:31]
tr a[148:149],v226 offset:24576
s_waitcnt lgkmcnt(7)
mm v[32:35],a[128:131],a[16:19],v[32:35]
tr a[150:151],v226 offset:28672
mm v[32:35],a[132:135],a[24:27],v[32:35]
tr a[152:153],v227 offset:16384
s_waitcnt vmcnt(23)
mm v[36:39],a[128:131],a[20:23],v[36:39]
tr a[154:155],v227 offset:20480
s_barrier
mm v[36:39],a[132:135],a[28:31],v[36:39]
bl v218,s[12:15],s49 offen offset:2048 lds
s_waitcnt lgkmcnt(6)
mm v[40:43],a[136:139],a[16:19],v[40:43]
tr a[156:157],v227 offset:24576
tr a[158:159],v227 offset:28672
mm v[40:43],a[140:143],a[24:27],v[40:43]
tr a[128:129],v220 offset:32768
mm v[44:47],a[136:139],a[20:23],v[44:47]
tr a[130:131],v220 offset:36864
bl v219,s[12:15],s49 offen offset:3072 lds
mm v[44:47],a[140:143],a[28:31],v[44:47]
tr a[132:133],v220 offset:40960
s_waitcnt lgkmcnt(7)
mm v[48:51],a[144:147],a[16:19],v[48:51]
tr a[134:135],v220 offset:45056
s_add_u32 s49,s49,131072
mm v[48:51],a[148:151],a[24:27],v[48:51]
tr a[136:137],v221 offset:32768
mm v[52:55],a[144:147],a[20:23],v[52:55]
tr a[138:139],v221 offset:36864
bl a[96:99],v214,s[8:11],s48 offen offset:0 sc1
mm v[52:55],a[148:151],a[28:31],v[52:55]
tr a[140:141],v221 offset:40960
s_waitcnt lgkmcnt(7)
mm v[56:59],a[152:155],a[16:19],v[56:59]
tr a[142:143],v221 offset:45056
mm v[56:59],a[156:159],a[24:27],v[56:59]
tr a[144:145],v222 offset:32768
mm v[60:63],a[152:155],a[20:23],v[60:63]
tr a[146:147],v222 offset:36864
mm v[60:63],a[156:159],a[28:31],v[60:63]
tr a[148:149],v222 offset:40960
s_waitcnt lgkmcnt(7)
mm v[0:3],a[128:131],a[32:35],v[0:3]
tr a[150:151],v222 offset:45056
bl a[100:103],v215,s[8:11],s48 offen offset:0 sc1
mm v[0:3],a[132:135],a[40:43],v[0:3]
tr a[152:153],v223 offset:32768
mm v[4:7],a[128:131],a[36:39],v[4:7]
tr a[154:155],v223 offset:36864
mm v[4:7],a[132:135],a[44:47],v[4:7]
tr a[156:157],v223 offset:40960
s_waitcnt lgkmcnt(7)
mm v[8:11],a[136:139],a[32:35],v[8:11]
tr a[158:159],v223 offset:45056
bl a[104:107],v214,s[8:11],s48 offen offset:1024 sc1
mm v[8:11],a[140:143],a[40:43],v[8:11]
tr a[128:129],v224 offset:32768
mm v[12:15],a[136:139],a[36:39],v[12:15]
tr a[130:131],v224 offset:36864
mm v[12:15],a[140:143],a[44:47],v[12:15]
tr a[132:133],v224 offset:40960
s_waitcnt lgkmcnt(7)
mm v[16:19],a[144:147],a[32:35],v[16:19]
tr a[134:135],v224 offset:45056
bl a[108:111],v215,s[8:11],s48 offen offset:1024 sc1
mm v[16:19],a[148:151],a[40:43],v[16:19]
tr a[136:137],v225 offset:32768
s_add_u32 s48,s48,2048
mm v[20:23],a[144:147],a[36:39],v[20:23]
tr a[138:139],v225 offset:36864
s_add_u32 m0,s50,98304
mm v[20:23],a[148:151],a[44:47],v[20:23]
tr a[140:141],v225 offset:40960
s_waitcnt lgkmcnt(7)
mm v[24:27],a[152:155],a[32:35],v[24:27]
tr a[142:143],v225 offset:45056
bl v216,s[12:15],s49 offen offset:0 lds
mm v[24:27],a[156:159],a[40:43],v[24:27]
tr a[144:145],v226 offset:32768
mm v[28:31],a[152:155],a[36:39],v[28:31]
tr a[146:147],v226 offset:36864
mm v[28:31],a[156:159],a[44:47],v[28:31]
tr a[148:149],v226 offset:40960
s_waitcnt lgkmcnt(7)
mm v[32:35],a[128:131],a[32:35],v[32:35]
tr a[150:151],v226 offset:45056
bl v217,s[12:15],s49 offen offset:1024 lds
mm v[32:35],a[132:135],a[40:43],v[32:35]
tr a[152:153],v227 offset:32768
s_waitcnt vmcnt(23)
mm v[36:39],a[128:131],a[36:39],v[36:39]
tr a[154:155],v227 offset:36864
s_barrier
mm v[36:39],a[132:135],a[44:47],v[36:39]
tr a[156:157],v227 offset:40960
s_waitcnt lgkmcnt(7)
mm v[40:43],a[136:139],a[32:35],v[40:43]
tr a[158:159],v227 offset:45056
bl v218,s[12:15],s49 offen offset:2048 lds
mm v[40:43],a[140:143],a[40:43],v[40:43]
tr a[128:129],v220 offset:49152
mm v[44:47],a[136:139],a[36:39],v[44:47]
tr a[130:131],v220 offset:53248
mm v[44:47],a[140:143],a[44:47],v[44:47]
tr a[132:133],v220 offset:57344
s_waitcnt lgkmcnt(7)
mm v[48:51],a[144:147],a[32:35],v[48:51]
tr a[134:135],v220 offset:61440
bl v219,s[12:15],s49 offen offset:3072 lds
mm v[48:51],a[148:151],a[40:43],v[48:51]
tr a[136:137],v221 offset:49152
s_add_u32 s49,s49,131072
mm v[52:55],a[144:147],a[36:39],v[52:55]
tr a[138:139],v221 offset:53248
mm v[52:55],a[148:151],a[44:47],v[52:55]
tr a[140:141],v221 offset:57344
s_waitcnt lgkmcnt(7)
mm v[56:59],a[152:155],a[32:35],v[56:59]
tr a[142:143],v221 offset:61440
mm v[56:59],a[156:159],a[40:43],v[56:59]
tr a[144:145],v222 offset:49152
bl a[112:115],v214,s[8:11],s48 offen offset:0 sc1
mm v[60:63],a[152:155],a[36:39],v[60:63]
tr a[146:147],v222 offset:53248
mm v[60:63],a[156:159],a[44:47],v[60:63]
tr a[148:149],v222 offset:57344
s_waitcnt lgkmcnt(7)
mm v[0:3],a[128:131],a[48:51],v[0:3]
tr a[150:151],v222 offset:61440
mm v[0:3],a[132:135],a[56:59],v[0:3]
tr a[152:153],v223 offset:49152
bl a[116:119],v215,s[8:11],s48 offen offset:0 sc1
mm v[4:7],a[128:131],a[52:55],v[4:7]
tr a[154:155],v223 offset:53248
mm v[4:7],a[132:135],a[60:63],v[4:7]
tr a[156:157],v223 offset:57344
s_waitcnt lgkmcnt(7)
mm v[8:11],a[136:139],a[48:51],v[8:11]
tr a[158:159],v223 offset:61440
mm v[8:11],a[140:143],a[56:59],v[8:11]
tr a[128:129],v224 offset:49152
bl a[120:123],v214,s[8:11],s48 offen offset:1024 sc1
mm v[12:15],a[136:139],a[52:55],v[12:15]
tr a[130:131],v224 offset:53248
mm v[12:15],a[140:143],a[60:63],v[12:15]
tr a[132:133],v224 offset:57344
s_waitcnt lgkmcnt(7)
mm v[16:19],a[144:147],a[48:51],v[16:19]
tr a[134:135],v224 offset:61440
mm v[16:19],a[148:151],a[56:59],v[16:19]
tr a[136:137],v225 offset:49152
bl a[124:127],v215,s[8:11],s48 offen offset:1024 sc1
mm v[20:23],a[144:147],a[52:55],v[20:23]
tr a[138:139],v225 offset:53248
s_add_u32 s48,s48,2048
mm v[20:23],a[148:151],a[60:63],v[20:23]
tr a[140:141],v225 offset:57344
s_waitcnt lgkmcnt(7)
mm v[24:27],a[152:155],a[48:51],v[24:27]
tr a[142:143],v225 offset:61440
s_add_u32 m0,s50,114688
mm v[24:27],a[156:159],a[56:59],v[24:27]
tr a[144:145],v226 offset:49152
mm v[28:31],a[152:155],a[52:55],v[28:31]
tr a[146:147],v226 offset:53248
bl v216,s[12:15],s49 offen offset:0 lds
mm v[28:31],a[156:159],a[60:63],v[28:31]
tr a[148:149],v226 offset:57344
s_waitcnt lgkmcnt(7)
mm v[32:35],a[128:131],a[48:51],v[32:35]
tr a[150:151],v226 offset:61440
mm v[32:35],a[132:135],a[56:59],v[32:35]
tr a[152:153],v227 offset:49152
s_waitcnt vmcnt(22)
mm v[36:39],a[128:131],a[52:55],v[36:39]
tr a[154:155],v227 offset:53248
s_barrier
mm v[36:39],a[132:135],a[60:63],v[36:39]
bl v217,s[12:15],s49 offen offset:1024 lds
s_waitcnt lgkmcnt(6)
mm v[40:43],a[136:139],a[48:51],v[40:43]
tr a[156:157],v227 offset:57344
tr a[158:159],v227 offset:61440
mm v[40:43],a[140:143],a[56:59],v[40:43]
tr a[128:129],v228 offset:0
mm v[44:47],a[136:139],a[52:55],v[44:47]
tr a[130:131],v228 offset:4096
bl v218,s[12:15],s49 offen offset:2048 lds
mm v[44:47],a[140:143],a[60:63],v[44:47]
tr a[132:133],v228 offset:8192
s_waitcnt lgkmcnt(7)
mm v[48:51],a[144:147],a[48:51],v[48:51]
tr a[134:135],v228 offset:12288
mm v[48:51],a[148:151],a[56:59],v[48:51]
tr a[136:137],v229 offset:0
mm v[52:55],a[144:147],a[52:55],v[52:55]
tr a[138:139],v229 offset:4096
mm v[52:55],a[148:151],a[60:63],v[52:55]
tr a[140:141],v229 offset:8192
s_waitcnt lgkmcnt(7)
mm v[56:59],a[152:155],a[48:51],v[56:59]
tr a[142:143],v229 offset:12288
bl v219,s[12:15],s49 offen offset:3072 lds
mm v[56:59],a[156:159],a[56:59],v[56:59]
tr a[144:145],v230 offset:0
s_add_u32 s49,s49,131072
mm v[60:63],a[152:155],a[52:55],v[60:63]
tr a[146:147],v230 offset:4096
mm v[60:63],a[156:159],a[60:63],v[60:63]
tr a[148:149],v230 offset:8192
s_waitcnt lgkmcnt(7)
mm v[0:3],a[128:131],a[64:67],v[0:3]
tr a[150:151],v230 offset:12288
bl a[0:3],v214,s[8:11],s48 offen offset:0 sc1
mm v[0:3],a[132:135],a[72:75],v[0:3]
tr a[152:153],v231 offset:0
mm v[4:7],a[128:131],a[68:71],v[4:7]
tr a[154:155],v231 offset:4096
mm v[4:7],a[132:135],a[76:79],v[4:7]
tr a[156:157],v231 offset:8192
s_waitcnt lgkmcnt(7)
mm v[8:11],a[136:139],a[64:67],v[8:11]
tr a[158:159],v231 offset:12288
bl a[4:7],v215,s[8:11],s48 offen offset:0 sc1
mm v[8:11],a[140:143],a[72:75],v[8:11]
tr a[128:129],v232 offset:0
mm v[12:15],a[136:139],a[68:71],v[12:15]
tr a[130:131],v232 offset:4096
mm v[12:15],a[140:143],a[76:79],v[12:15]
tr a[132:133],v232 offset:8192
s_waitcnt lgkmcnt(7)
mm v[16:19],a[144:147],a[64:67],v[16:19]
tr a[134:135],v232 offset:12288
bl a[8:11],v214,s[8:11],s48 offen offset:1024 sc1
mm v[16:19],a[148:151],a[72:75],v[16:19]
tr a[136:137],v233 offset:0
mm v[20:23],a[144:147],a[68:71],v[20:23]
tr a[138:139],v233 offset:4096
mm v[20:23],a[148:151],a[76:79],v[20:23]
tr a[140:141],v233 offset:8192
s_waitcnt lgkmcnt(7)
mm v[24:27],a[152:155],a[64:67],v[24:27]
tr a[142:143],v233 offset:12288
bl a[12:15],v215,s[8:11],s48 offen offset:1024 sc1
mm v[24:27],a[156:159],a[72:75],v[24:27]
tr a[144:145],v234 offset:0
s_add_u32 s48,s48,2048
mm v[28:31],a[152:155],a[68:71],v[28:31]
tr a[146:147],v234 offset:4096
s_add_u32 m0,s50,0
mm v[28:31],a[156:159],a[76:79],v[28:31]
tr a[148:149],v234 offset:8192
s_waitcnt lgkmcnt(7)
mm v[32:35],a[128:131],a[64:67],v[32:35]
tr a[150:151],v234 offset:12288
bl v216,s[12:15],s49 offen offset:0 lds
mm v[32:35],a[132:135],a[72:75],v[32:35]
tr a[152:153],v235 offset:0
s_waitcnt vmcnt(21)
mm v[36:39],a[128:131],a[68:71],v[36:39]
tr a[154:155],v235 offset:4096
s_barrier
mm v[36:39],a[132:135],a[76:79],v[36:39]
tr a[156:157],v235 offset:8192
s_waitcnt lgkmcnt(7)
mm v[40:43],a[136:139],a[64:67],v[40:43]
tr a[158:159],v235 offset:12288
bl v217,s[12:15],s49 offen offset:1024 lds
mm v[40:43],a[140:143],a[72:75],v[40:43]
tr a[128:129],v228 offset:16384
mm v[44:47],a[136:139],a[68:71],v[44:47]
tr a[130:131],v228 offset:20480
mm v[44:47],a[140:143],a[76:79],v[44:47]
tr a[132:133],v228 offset:24576
s_waitcnt lgkmcnt(7)
mm v[48:51],a[144:147],a[64:67],v[48:51]
tr a[134:135],v228 offset:28672
mm v[48:51],a[148:151],a[72:75],v[48:51]
tr a[136:137],v229 offset:16384
bl v218,s[12:15],s49 offen offset:2048 lds
mm v[52:55],a[144:147],a[68:71],v[52:55]
tr a[138:139],v229 offset:20480
mm v[52:55],a[148:151],a[76:79],v[52:55]
tr a[140:141],v229 offset:24576
s_waitcnt lgkmcnt(7)
mm v[56:59],a[152:155],a[64:67],v[56:59]
tr a[142:143],v229 offset:28672
mm v[56:59],a[156:159],a[72:75],v[56:59]
tr a[144:145],v230 offset:16384
bl v219,s[12:15],s49 offen offset:3072 lds
mm v[60:63],a[152:155],a[68:71],v[60:63]
tr a[146:147],v230 offset:20480
s_add_u32 s49,s49,131072
mm v[60:63],a[156:159],a[76:79],v[60:63]
tr a[148:149],v230 offset:24576
s_waitcnt lgkmcnt(7)
mm v[0:3],a[128:131],a[80:83],v[0:3]
tr a[150:151],v230 offset:28672
mm v[0:3],a[132:135],a[88:91],v[0:3]
tr a[152:153],v231 offset:16384
bl a[16:19],v214,s[8:11],s48 offen offset:0 sc1
mm v[4:7],a[128:131],a[84:87],v[4:7]
tr a[154:155],v231 offset:20480
mm v[4:7],a[132:135],a[92:95],v[4:7]
tr a[156:157],v231 offset:24576
s_waitcnt lgkmcnt(7)
mm v[8:11],a[136:139],a[80:83],v[8:11]
tr a[158:159],v231 offset:28672
mm v[8:11],a[140:143],a[88:91],v[8:11]
tr a[128:129],v232 offset:16384
bl a[20:23],v215,s[8:11],s48 offen offset:0 sc1
mm v[12:15],a[136:139],a[84:87],v[12:15]
tr a[130:131],v232 offset:20480
mm v[12:15],a[140:143],a[92:95],v[12:15]
tr a[132:133],v232 offset:24576
s_waitcnt lgkmcnt(7)
mm v[16:19],a[144:147],a[80:83],v[16:19]
tr a[134:135],v232 offset:28672
mm v[16:19],a[148:151],a[88:91],v[16:19]
tr a[136:137],v233 offset:16384
mm v[20:23],a[144:147],a[84:87],v[20:23]
tr a[138:139],v233 offset:20480
bl a[24:27],v214,s[8:11],s48 offen offset:1024 sc1
mm v[20:23],a[148:151],a[92:95],v[20:23]
tr a[140:141],v233 offset:24576
s_waitcnt lgkmcnt(7)
mm v[24:27],a[152:155],a[80:83],v[24:27]
tr a[142:143],v233 offset:28672
mm v[24:27],a[156:159],a[88:91],v[24:27]
tr a[144:145],v234 offset:16384
mm v[28:31],a[152:155],a[84:87],v[28:31]
tr a[146:147],v234 offset:20480
bl a[28:31],v215,s[8:11],s48 offen offset:1024 sc1
mm v[28:31],a[156:159],a[92:95],v[28:31]
tr a[148:149],v234 offset:24576
s_waitcnt lgkmcnt(7)
mm v[32:35],a[128:131],a[80:83],v[32:35]
tr a[150:151],v234 offset:28672
s_add_u32 s48,s48,2048
mm v[32:35],a[132:135],a[88:91],v[32:35]
tr a[152:153],v235 offset:16384
s_waitcnt vmcnt(20)
mm v[36:39],a[128:131],a[84:87],v[36:39]
tr a[154:155],v235 offset:20480
s_barrier
mm v[36:39],a[132:135],a[92:95],v[36:39]
s_add_u32 m0,s50,16384
s_waitcnt lgkmcnt(6)
mm v[40:43],a[136:139],a[80:83],v[40:43]
tr a[156:157],v235 offset:24576
bl v216,s[12:15],s49 offen offset:0 lds
mm v[40:43],a[140:143],a[88:91],v[40:43]
tr a[158:159],v235 offset:28672
mm v[44:47],a[136:139],a[84:87],v[44:47]
tr a[128:129],v228 offset:32768
tr a[130:131],v228 offset:36864
mm v[44:47],a[140:143],a[92:95],v[44:47]
tr a[132:133],v228 offset:40960
s_waitcnt lgkmcnt(7)
mm v[48:51],a[144:147],a[80:83],v[48:51]
tr a[134:135],v228 offset:45056
bl v217,s[12:15],s49 offen offset:1024 lds
mm v[48:51],a[148:151],a[88:91],v[48:51]
tr a[136:137],v229 offset:32768
mm v[52:55],a[144:147],a[84:87],v[52:55]
tr a[138:139],v229 offset:36864
mm v[52:55],a[148:151],a[92:95],v[52:55]
tr a[140:141],v229 offset:40960
s_waitcnt lgkmcnt(7)
mm v[56:59],a[152:155],a[80:83],v[56:59]
tr a[142:143],v229 offset:45056
bl v218,s[12:15],s49 offen offset:2048 lds
mm v[56:59],a[156:159],a[88:91],v[56:59]
tr a[144:145],v230 offset:32768
mm v[60:63],a[152:155],a[84:87],v[60:63]
tr a[146:147],v230 offset:36864
mm v[60:63],a[156:159],a[92:95],v[60:63]
tr a[148:149],v230 offset:40960
s_waitcnt lgkmcnt(7)
mm v[0:3],a[128:131],a[96:99],v[0:3]
tr a[150:151],v230 offset:45056
bl v219,s[12:15],s49 offen offset:3072 lds
mm v[0:3],a[132:135],a[104:107],v[0:3]
tr a[152:153],v231 offset:32768
s_add_u32 s49,s49,131072
mm v[4:7],a[128:131],a[100:103],v[4:7]
tr a[154:155],v231 offset:36864
mm v[4:7],a[132:135],a[108:111],v[4:7]
tr a[156:157],v231 offset:40960
s_waitcnt lgkmcnt(7)
mm v[8:11],a[136:139],a[96:99],v[8:11]
tr a[158:159],v231 offset:45056
bl a[32:35],v214,s[8:11],s48 offen offset:0 sc1
mm v[8:11],a[140:143],a[104:107],v[8:11]
tr a[128:129],v232 offset:32768
mm v[12:15],a[136:139],a[100:103],v[12:15]
tr a[130:131],v232 offset:36864
mm v[12:15],a[140:143],a[108:111],v[12:15]
tr a[132:133],v232 offset:40960
s_waitcnt lgkmcnt(7)
mm v[16:19],a[144:147],a[96:99],v[16:19]
tr a[134:135],v232 offset:45056
bl a[36:39],v215,s[8:11],s48 offen offset:0 sc1
mm v[16:19],a[148:151],a[104:107],v[16:19]
tr a[136:137],v233 offset:32768
mm v[20:23],a[144:147],a[100:103],v[20:23]
tr a[138:139],v233 offset:36864
mm v[20:23],a[148:151],a[108:111],v[20:23]
tr a[140:141],v233 offset:40960
s_waitcnt lgkmcnt(7)
mm v[24:27],a[152:155],a[96:99],v[24:27]
tr a[142:143],v233 offset:45056
bl a[40:43],v214,s[8:11],s48 offen offset:1024 sc1
mm v[24:27],a[156:159],a[104:107],v[24:27]
tr a[144:145],v234 offset:32768
mm v[28:31],a[152:155],a[100:103],v[28:31]
tr a[146:147],v234 offset:36864
mm v[28:31],a[156:159],a[108:111],v[28:31]
tr a[148:149],v234 offset:40960
s_waitcnt lgkmcnt(7)
mm v[32:35],a[128:131],a[96:99],v[32:35]
tr a[150:151],v234 offset:45056
bl a[44:47],v215,s[8:11],s48 offen offset:1024 sc1
mm v[32:35],a[132:135],a[104:107],v[32:35]
tr a[152:153],v235 offset:32768
s_waitcnt vmcnt(20)
mm v[36:39],a[128:131],a[100:103],v[36:39]
tr a[154:155],v235 offset:36864
s_barrier
mm v[36:39],a[132:135],a[108:111],v[36:39]
tr a[156:157],v235 offset:40960
s_waitcnt lgkmcnt(7)
mm v[40:43],a[136:139],a[96:99],v[40:43]
tr a[158:159],v235 offset:45056
s_add_u32 s48,s48,2048
mm v[40:43],a[140:143],a[104:107],v[40:43]
tr a[128:129],v228 offset:49152
s_add_u32 m0,s50,32768
mm v[44:47],a[136:139],a[100:103],v[44:47]
tr a[130:131],v228 offset:53248
bl v216,s[12:15],s49 offen offset:0 lds
mm v[44:47],a[140:143],a[108:111],v[44:47]
tr a[132:133],v228 offset:57344
s_waitcnt lgkmcnt(7)
mm v[48:51],a[144:147],a[96:99],v[48:51]
tr a[134:135],v228 offset:61440
mm v[48:51],a[148:151],a[104:107],v[48:51]
tr a[136:137],v229 offset:49152
bl v217,s[12:15],s49 offen offset:1024 lds
mm v[52:55],a[144:147],a[100:103],v[52:55]
tr a[138:139],v229 offset:53248
mm v[52:55],a[148:151],a[108:111],v[52:55]
tr a[140:141],v229 offset:57344
s_waitcnt lgkmcnt(7)
mm v[56:59],a[152:155],a[96:99],v[56:59]
tr a[142:143],v229 offset:61440
mm v[56:59],a[156:159],a[104:107],v[56:59]
tr a[144:145],v230 offset:49152
bl v218,s[12:15],s49 offen offset:2048 lds
mm v[60:63],a[152:155],a[100:103],v[60:63]
tr a[146:147],v230 offset:53248
mm v[60:63],a[156:159],a[108:111],v[60:63]
tr a[148:149],v230 offset:57344
s_waitcnt lgkmcnt(7)
mm v[0:3],a[128:131],a[112:115],v[0:3]
tr a[150:151],v230 offset:61440
mm v[0:3],a[132:135],a[120:123],v[0:3]
tr a[152:153],v231 offset:49152
mm v[4:7],a[128:131],a[116:119],v[4:7]
tr a[154:155],v231 offset:53248
bl v219,s[12:15],s49 offen offset:3072 lds
mm v[4:7],a[132:135],a[124:127],v[4:7]
tr a[156:157],v231 offset:57344
s_waitcnt lgkmcnt(7)
mm v[8:11],a[136:139],a[112:115],v[8:11]
tr a[158:159],v231 offset:61440
s_add_u32 s49,s49,131072
mm v[8:11],a[140:143],a[120:123],v[8:11]
tr a[128:129],v232 offset:49152
mm v[12:15],a[136:139],a[116:119],v[12:15]
tr a[130:131],v232 offset:53248
bl a[48:51],v214,s[8:11],s48 offen offset:0 sc1
mm v[12:15],a[140:143],a[124:127],v[12:15]
tr a[132:133],v232 offset:57344
s_waitcnt lgkmcnt(7)
mm v[16:19],a[144:147],a[112:115],v[16:19]
tr a[134:135],v232 offset:61440
mm v[16:19],a[148:151],a[120:123],v[16:19]
tr a[136:137],v233 offset:49152
mm v[20:23],a[144:147],a[116:119],v[20:23]
tr a[138:139],v233 offset:53248
bl a[52:55],v215,s[8:11],s48 offen offset:0 sc1
mm v[20:23],a[148:151],a[124:127],v[20:23]
tr a[140:141],v233 offset:57344
s_waitcnt lgkmcnt(7)
mm v[24:27],a[152:155],a[112:115],v[24:27]
tr a[142:143],v233 offset:61440
mm v[24:27],a[156:159],a[120:123],v[24:27]
tr a[144:145],v234 offset:49152
mm v[28:31],a[152:155],a[116:119],v[28:31]
tr a[146:147],v234 offset:53248
bl a[56:59],v214,s[8:11],s48 offen offset:1024 sc1
mm v[28:31],a[156:159],a[124:127],v[28:31]
tr a[148:149],v234 offset:57344
s_waitcnt lgkmcnt(7)
mm v[32:35],a[128:131],a[112:115],v[32:35]
tr a[150:151],v234 offset:61440
mm v[32:35],a[132:135],a[120:123],v[32:35]
tr a[152:153],v235 offset:49152
s_waitcnt vmcnt(19)
mm v[36:39],a[128:131],a[116:119],v[36:39]
tr a[154:155],v235 offset:53248
s_barrier
mm v[36:39],a[132:135],a[124:127],v[36:39]
tr a[156:157],v235 offset:57344
s_waitcnt lgkmcnt(7)
mm v[40:43],a[136:139],a[112:115],v[40:43]
tr a[158:159],v235 offset:61440
bl a[60:63],v215,s[8:11],s48 offen offset:1024 sc1
mm v[40:43],a[140:143],a[120:123],v[40:43]
tr a[128:129],v220 offset:0
s_add_u32 s48,s48,2048
mm v[44:47],a[136:139],a[116:119],v[44:47]
tr a[130:131],v220 offset:4096
s_add_u32 m0,s50,49152
mm v[44:47],a[140:143],a[124:127],v[44:47]
tr a[132:133],v220 offset:8192
s_waitcnt lgkmcnt(7)
mm v[48:51],a[144:147],a[112:115],v[48:51]
tr a[134:135],v220 offset:12288
bl v216,s[12:15],s49 offen offset:0 lds
mm v[48:51],a[148:151],a[120:123],v[48:51]
tr a[136:137],v221 offset:0
mm v[52:55],a[144:147],a[116:119],v[52:55]
tr a[138:139],v221 offset:4096
mm v[52:55],a[148:151],a[124:127],v[52:55]
tr a[140:141],v221 offset:8192
s_waitcnt lgkmcnt(7)
mm v[56:59],a[152:155],a[112:115],v[56:59]
tr a[142:143],v221 offset:12288
bl v217,s[12:15],s49 offen offset:1024 lds
mm v[56:59],a[156:159],a[120:123],v[56:59]
tr a[144:145],v222 offset:0
mm v[60:63],a[152:155],a[116:119],v[60:63]
tr a[146:147],v222 offset:4096
mm v[60:63],a[156:159],a[124:127],v[60:63]
tr a[148:149],v222 offset:8192
v_cmp_gt_u32 vcc,16,v210
s_nop 0
s_cbranch_vccnz tail_allspin
tail_allok:
s_waitcnt lgkmcnt(7)
mm v[0:3],a[128:131],a[0:3],v[0:3]
tr a[150:151],v222 offset:12288
bl v218,s[12:15],s49 offen offset:2048 lds
mm v[0:3],a[132:135],a[8:11],v[0:3]
tr a[152:153],v223 offset:0
mm v[4:7],a[128:131],a[4:7],v[4:7]
tr a[154:155],v223 offset:4096
mm v[4:7],a[132:135],a[12:15],v[4:7]
tr a[156:157],v223 offset:8192
s_waitcnt lgkmcnt(7)
mm v[8:11],a[136:139],a[0:3],v[8:11]
tr a[158:159],v223 offset:12288
bl v219,s[12:15],s49 offen offset:3072 lds
mm v[8:11],a[140:143],a[8:11],v[8:11]
tr a[128:129],v224 offset:0
s_add_u32 s49,s49,131072
mm v[12:15],a[136:139],a[4:7],v[12:15]
tr a[130:131],v224 offset:4096
mm v[12:15],a[140:143],a[12:15],v[12:15]
tr a[132:133],v224 offset:8192
s_waitcnt lgkmcnt(7)
mm v[16:19],a[144:147],a[0:3],v[16:19]
tr a[134:135],v224 offset:12288
bl a[64:67],v214,s[8:11],s48 offen offset:0 sc1
mm v[16:19],a[148:151],a[8:11],v[16:19]
tr a[136:137],v225 offset:0
mm v[20:23],a[144:147],a[4:7],v[20:23]
tr a[138:139],v225 offset:4096
mm v[20:23],a[148:151],a[12:15],v[20:23]
tr a[140:141],v225 offset:8192
s_waitcnt lgkmcnt(7)
mm v[24:27],a[152:155],a[0:3],v[24:27]
tr a[142:143],v225 offset:12288
bl a[68:71],v215,s[8:11],s48 offen offset:0 sc1
mm v[24:27],a[156:159],a[8:11],v[24:27]
tr a[144:145],v226 offset:0
mm v[28:31],a[152:155],a[4:7],v[28:31]
tr a[146:147],v226 offset:4096
mm v[28:31],a[156:159],a[12:15],v[28:31]
tr a[148:149],v226 offset:8192
s_waitcnt lgkmcnt(7)
mm v[32:35],a[128:131],a[0:3],v[32:35]
tr a[150:151],v226 offset:12288
mm v[32:35],a[132:135],a[8:11],v[32:35]
tr a[152:153],v227 offset:0
s_waitcnt vmcnt(18)
mm v[36:39],a[128:131],a[4:7],v[36:39]
tr a[154:155],v227 offset:4096
s_barrier
mm v[36:39],a[132:135],a[12:15],v[36:39]
bl a[72:75],v214,s[8:11],s48 offen offset:1024 sc1
s_waitcnt lgkmcnt(6)
mm v[40:43],a[136:139],a[0:3],v[40:43]
tr a[156:157],v227 offset:8192
tr a[158:159],v227 offset:12288
mm v[40:43],a[140:143],a[8:11],v[40:43]
tr a[128:129],v220 offset:16384
bl a[76:79],v215,s[8:11],s48 offen offset:1024 sc1
mm v[44:47],a[136:139],a[4:7],v[44:47]
tr a[130:131],v220 offset:20480
s_add_u32 s48,s48,2048
mm v[44:47],a[140:143],a[12:15],v[44:47]
tr a[132:133],v220 offset:24576
s_waitcnt lgkmcnt(7)
mm v[48:51],a[144:147],a[0:3],v[48:51]
tr a[134:135],v220 offset:28672
s_add_u32 m0,s50,65536
mm v[48:51],a[148:151],a[8:11],v[48:51]
tr a[136:137],v221 offset:16384
bl v216,s[12:15],s49 offen offset:0 lds
mm v[52:55],a[144:147],a[4:7],v[52:55]
tr a[138:139],v221 offset:20480
mm v[52:55],a[148:151],a[12:15],v[52:55]
tr a[140:141],v221 offset:24576
s_waitcnt lgkmcnt(7)
mm v[56:59],a[152:155],a[0:3],v[56:59]
tr a[142:143],v221 offset:28672
mm v[56:59],a[156:159],a[8:11],v[56:59]
tr a[144:145],v222 offset:16384
mm v[60:63],a[152:155],a[4:7],v[60:63]
tr a[146:147],v222 offset:20480
bl v217,s[12:15],s49 offen offset:1024 lds
mm v[60:63],a[156:159],a[12:15],v[60:63]
tr a[148:149],v222 offset:24576
s_waitcnt lgkmcnt(7)
mm v[0:3],a[128:131],a[16:19],v[0:3]
tr a[150:151],v222 offset:28672
mm v[0:3],a[132:135],a[24:27],v[0:3]
tr a[152:153],v223 offset:16384
mm v[4:7],a[128:131],a[20:23],v[4:7]
tr a[154:155],v223 offset:20480
bl v218,s[12:15],s49 offen offset:2048 lds
mm v[4:7],a[132:135],a[28:31],v[4:7]
tr a[156:157],v223 offset:24576
s_waitcnt lgkmcnt(7)
mm v[8:11],a[136:139],a[16:19],v[8:11]
tr a[158:159],v223 offset:28672
mm v[8:11],a[140:143],a[24:27],v[8:11]
tr a[128:129],v224 offset:16384
mm v[12:15],a[136:139],a[20:23],v[12:15]
tr a[130:131],v224 offset:20480
bl v219,s[12:15],s49 offen offset:3072 lds
mm v[12:15],a[140:143],a[28:31],v[12:15]
tr a[132:133],v224 offset:24576
s_waitcnt lgkmcnt(7)
mm v[16:19],a[144:147],a[16:19],v[16:19]
tr a[134:135],v224 offset:28672
s_add_u32 s49,s49,131072
mm v[16:19],a[148:151],a[24:27],v[16:19]
tr a[136:137],v225 offset:16384
mm v[20:23],a[144:147],a[20:23],v[20:23]
tr a[138:139],v225 offset:20480
mm v[20:23],a[148:151],a[28:31],v[20:23]
tr a[140:141],v225 offset:24576
s_waitcnt lgkmcnt(7)
mm v[24:27],a[152:155],a[16:19],v[24:27]
tr a[142:143],v225 offset:28672
bl a[80:83],v214,s[8:11],s48 offen offset:0 sc1
mm v[24:27],a[156:159],a[24:27],v[24:27]
tr a[144:145],v226 offset:16384
mm v[28:31],a[152:155],a[20:23],v[28:31]
tr a[146:147],v226 offset:20480
mm v[28:31],a[156:159],a[28:31],v[28:31]
tr a[148:149],v226 offset:24576
s_waitcnt lgkmcnt(7)
mm v[32:35],a[128:131],a[16:19],v[32:35]
tr a[150:151],v226 offset:28672
bl a[84:87],v215,s[8:11],s48 offen offset:0 sc1
mm v[32:35],a[132:135],a[24:27],v[32:35]
tr a[152:153],v227 offset:16384
s_waitcnt vmcnt(18)
mm v[36:39],a[128:131],a[20:23],v[36:39]
tr a[154:155],v227 offset:20480
s_barrier
mm v[36:39],a[132:135],a[28:31],v[36:39]
tr a[156:157],v227 offset:24576
s_waitcnt lgkmcnt(7)
mm v[40:43],a[136:139],a[16:19],v[40:43]
tr a[158:159],v227 offset:28672
bl a[88:91],v214,s[8:11],s48 offen offset:1024 sc1
mm v[40:43],a[140:143],a[24:27],v[40:43]
tr a[128:129],v220 offset:32768
mm v[44:47],a[136:139],a[20:23],v[44:47]
tr a[130:131],v220 offset:36864
mm v[44:47],a[140:143],a[28:31],v[44:47]
tr a[132:133],v220 offset:40960
s_waitcnt lgkmcnt(7)
mm v[48:51],a[144:147],a[16:19],v[48:51]
tr a[134:135],v220 offset:45056
bl a[92:95],v215,s[8:11],s48 offen offset:1024 sc1
mm v[48:51],a[148:151],a[24:27],v[48:51]
tr a[136:137],v221 offset:32768
s_add_u32 s48,s48,2048
mm v[52:55],a[144:147],a[20:23],v[52:55]
tr a[138:139],v221 offset:36864
s_add_u32 m0,s50,81920
mm v[52:55],a[148:151],a[28:31],v[52:55]
tr a[140:141],v221 offset:40960
s_waitcnt lgkmcnt(7)
mm v[56:59],a[152:155],a[16:19],v[56:59]
tr a[142:143],v221 offset:45056
bl v216,s[12:15],s49 offen offset:0 lds
mm v[56:59],a[156:159],a[24:27],v[56:59]
tr a[144:145],v222 offset:32768
mm v[60:63],a[152:155],a[20:23],v[60:63]
tr a[146:147],v222 offset:36864
mm v[60:63],a[156:159],a[28:31],v[60:63]
tr a[148:149],v222 offset:40960
s_waitcnt lgkmcnt(7)
mm v[0:3],a[128:131],a[32:35],v[0:3]
tr a[150:151],v222 offset:45056
bl v217,s[12:15],s49 offen offset:1024 lds
mm v[0:3],a[132:135],a[40:43],v[0:3]
tr a[152:153],v223 offset:32768
mm v[4:7],a[128:131],a[36:39],v[4:7]
tr a[154:155],v223 offset:36864
mm v[4:7],a[132:135],a[44:47],v[4:7]
tr a[156:157],v223 offset:40960
s_waitcnt lgkmcnt(7)
mm v[8:11],a[136:139],a[32:35],v[8:11]
tr a[158:159],v223 offset:45056
bl v218,s[12:15],s49 offen offset:2048 lds
mm v[8:11],a[140:143],a[40:43],v[8:11]
tr a[128:129],v224 offset:32768
mm v[12:15],a[136:139],a[36:39],v[12:15]
tr a[130:131],v224 offset:36864
mm v[12:15],a[140:143],a[44:47],v[12:15]
tr a[132:133],v224 offset:40960
s_waitcnt lgkmcnt(7)
mm v[16:19],a[144:147],a[32:35],v[16:19]
tr a[134:135],v224 offset:45056
mm v[16:19],a[148:151],a[40:43],v[16:19]
tr a[136:137],v225 offset:32768
bl v219,s[12:15],s49 offen offset:3072 lds
mm v[20:23],a[144:147],a[36:39],v[20:23]
tr a[138:139],v225 offset:36864
s_add_u32 s49,s49,131072
mm v[20:23],a[148:151],a[44:47],v[20:23]
tr a[140:141],v225 offset:40960
s_waitcnt lgkmcnt(7)
mm v[24:27],a[152:155],a[32:35],v[24:27]
tr a[142:143],v225 offset:45056
mm v[24:27],a[156:159],a[40:43],v[24:27]
tr a[144:145],v226 offset:32768
bl a[96:99],v214,s[8:11],s48 offen offset:0 sc1
mm v[28:31],a[152:155],a[36:39],v[28:31]
tr a[146:147],v226 offset:36864
mm v[28:31],a[156:159],a[44:47],v[28:31]
tr a[148:149],v226 offset:40960
s_waitcnt lgkmcnt(7)
mm v[32:35],a[128:131],a[32:35],v[32:35]
tr a[150:151],v226 offset:45056
mm v[32:35],a[132:135],a[40:43],v[32:35]
tr a[152:153],v227 offset:32768
s_waitcnt vmcnt(17)
mm v[36:39],a[128:131],a[36:39],v[36:39]
tr a[154:155],v227 offset:36864
s_barrier
mm v[36:39],a[132:135],a[44:47],v[36:39]
bl a[100:103],v215,s[8:11],s48 offen offset:0 sc1
s_waitcnt lgkmcnt(6)
mm v[40:43],a[136:139],a[32:35],v[40:43]
tr a[156:157],v227 offset:40960
tr a[158:159],v227 offset:45056
mm v[40:43],a[140:143],a[40:43],v[40:43]
tr a[128:129],v220 offset:49152
bl a[104:107],v214,s[8:11],s48 offen offset:1024 sc1
mm v[44:47],a[136:139],a[36:39],v[44:47]
tr a[130:131],v220 offset:53248
mm v[44:47],a[140:143],a[44:47],v[44:47]
tr a[132:133],v220 offset:57344
s_waitcnt lgkmcnt(7)
mm v[48:51],a[144:147],a[32:35],v[48:51]
tr a[134:135],v220 offset:61440
mm v[48:51],a[148:151],a[40:43],v[48:51]
tr a[136:137],v221 offset:49152
mm v[52:55],a[144:147],a[36:39],v[52:55]
tr a[138:139],v221 offset:53248
bl a[108:111],v215,s[8:11],s48 offen offset:1024 sc1
mm v[52:55],a[148:151],a[44:47],v[52:55]
tr a[140:141],v221 offset:57344
s_waitcnt lgkmcnt(7)
mm v[56:59],a[152:155],a[32:35],v[56:59]
tr a[142:143],v221 offset:61440
s_add_u32 s48,s48,2048
mm v[56:59],a[156:159],a[40:43],v[56:59]
tr a[144:145],v222 offset:49152
s_add_u32 m0,s50,98304
mm v[60:63],a[152:155],a[36:39],v[60:63]
tr a[146:147],v222 offset:53248
bl v216,s[12:15],s49 offen offset:0 lds
mm v[60:63],a[156:159],a[44:47],v[60:63]
tr a[148:149],v222 offset:57344
s_waitcnt lgkmcnt(7)
mm v[0:3],a[128:131],a[48:51],v[0:3]
tr a[150:151],v222 offset:61440
mm v[0:3],a[132:135],a[56:59],v[0:3]
tr a[152:153],v223 offset:49152
mm v[4:7],a[128:131],a[52:55],v[4:7]
tr a[154:155],v223 offset:53248
bl v217,s[12:15],s49 offen offset:1024 lds
mm v[4:7],a[132:135],a[60:63],v[4:7]
tr a[156:157],v223 offset:57344
s_waitcnt lgkmcnt(7)
mm v[8:11],a[136:139],a[48:51],v[8:11]
tr a[158:159],v223 offset:61440
mm v[8:11],a[140:143],a[56:59],v[8:11]
tr a[128:129],v224 offset:49152
mm v[12:15],a[136:139],a[52:55],v[12:15]
tr a[130:131],v224 offset:53248
mm v[12:15],a[140:143],a[60:63],v[12:15]
tr a[132:133],v224 offset:57344
s_waitcnt lgkmcnt(7)
mm v[16:19],a[144:147],a[48:51],v[16:19]
tr a[134:135],v224 offset:61440
bl v218,s[12:15],s49 offen offset:2048 lds
mm v[16:19],a[148:151],a[56:59],v[16:19]
tr a[136:137],v225 offset:49152
mm v[20:23],a[144:147],a[52:55],v[20:23]
tr a[138:139],v225 offset:53248
mm v[20:23],a[148:151],a[60:63],v[20:23]
tr a[140:141],v225 offset:57344
s_waitcnt lgkmcnt(7)
mm v[24:27],a[152:155],a[48:51],v[24:27]
tr a[142:143],v225 offset:61440
bl v219,s[12:15],s49 offen offset:3072 lds
mm v[24:27],a[156:159],a[56:59],v[24:27]
tr a[144:145],v226 offset:49152
s_add_u32 s49,s49,131072
mm v[28:31],a[152:155],a[52:55],v[28:31]
tr a[146:147],v226 offset:53248
mm v[28:31],a[156:159],a[60:63],v[28:31]
tr a[148:149],v226 offset:57344
s_waitcnt lgkmcnt(7)
mm v[32:35],a[128:131],a[48:51],v[32:35]
tr a[150:151],v226 offset:61440
bl a[112:115],v214,s[8:11],s48 offen offset:0 sc1
mm v[32:35],a[132:135],a[56:59],v[32:35]
tr a[152:153],v227 offset:49152
s_waitcnt vmcnt(17)
mm v[36:39],a[128:131],a[52:55],v[36:39]
tr a[154:155],v227 offset:53248
s_barrier
mm v[36:39],a[132:135],a[60:63],v[36:39]
tr a[156:157],v227 offset:57344
s_waitcnt lgkmcnt(7)
mm v[40:43],a[136:139],a[48:51],v[40:43]
tr a[158:159],v227 offset:61440
bl a[116:119],v215,s[8:11],s48 offen offset:0 sc1
mm v[40:43],a[140:143],a[56:59],v[40:43]
tr a[128:129],v228 offset:0
mm v[44:47],a[136:139],a[52:55],v[44:47]
tr a[130:131],v228 offset:4096
mm v[44:47],a[140:143],a[60:63],v[44:47]
tr a[132:133],v228 offset:8192
s_waitcnt lgkmcnt(7)
mm v[48:51],a[144:147],a[48:51],v[48:51]
tr a[134:135],v228 offset:12288
bl a[120:123],v214,s[8:11],s48 offen offset:1024 sc1
mm v[48:51],a[148:151],a[56:59],v[48:51]
tr a[136:137],v229 offset:0
mm v[52:55],a[144:147],a[52:55],v[52:55]
tr a[138:139],v229 offset:4096
mm v[52:55],a[148:151],a[60:63],v[52:55]
tr a[140:141],v229 offset:8192
s_waitcnt lgkmcnt(7)
mm v[56:59],a[152:155],a[48:51],v[56:59]
tr a[142:143],v229 offset:12288
bl a[124:127],v215,s[8:11],s48 offen offset:1024 sc1
mm v[56:59],a[156:159],a[56:59],v[56:59]
tr a[144:145],v230 offset:0
s_add_u32 s48,s48,2048
mm v[60:63],a[152:155],a[52:55],v[60:63]
tr a[146:147],v230 offset:4096
s_add_u32 m0,s50,114688
mm v[60:63],a[156:159],a[60:63],v[60:63]
tr a[148:149],v230 offset:8192
s_waitcnt lgkmcnt(7)
mm v[0:3],a[128:131],a[64:67],v[0:3]
tr a[150:151],v230 offset:12288
bl v216,s[12:15],s49 offen offset:0 lds
mm v[0:3],a[132:135],a[72:75],v[0:3]
tr a[152:153],v231 offset:0
mm v[4:7],a[128:131],a[68:71],v[4:7]
tr a[154:155],v231 offset:4096
mm v[4:7],a[132:135],a[76:79],v[4:7]
tr a[156:157],v231 offset:8192
s_waitcnt lgkmcnt(7)
mm v[8:11],a[136:139],a[64:67],v[8:11]
tr a[158:159],v231 offset:12288
mm v[8:11],a[140:143],a[72:75],v[8:11]
tr a[128:129],v232 offset:0
bl v217,s[12:15],s49 offen offset:1024 lds
mm v[12:15],a[136:139],a[68:71],v[12:15]
tr a[130:131],v232 offset:4096
mm v[12:15],a[140:143],a[76:79],v[12:15]
tr a[132:133],v232 offset:8192
s_waitcnt lgkmcnt(7)
mm v[16:19],a[144:147],a[64:67],v[16:19]
tr a[134:135],v232 offset:12288
mm v[16:19],a[148:151],a[72:75],v[16:19]
tr a[136:137],v233 offset:0
bl v218,s[12:15],s49 offen offset:2048 lds
mm v[20:23],a[144:147],a[68:71],v[20:23]
tr a[138:139],v233 offset:4096
mm v[20:23],a[148:151],a[76:79],v[20:23]
tr a[140:141],v233 offset:8192
s_waitcnt lgkmcnt(7)
mm v[24:27],a[152:155],a[64:67],v[24:27]
tr a[142:143],v233 offset:12288
mm v[24:27],a[156:159],a[72:75],v[24:27]
tr a[144:145],v234 offset:0
bl v219,s[12:15],s49 offen offset:3072 lds
mm v[28:31],a[152:155],a[68:71],v[28:31]
tr a[146:147],v234 offset:4096
s_add_u32 s49,s49,131072
mm v[28:31],a[156:159],a[76:79],v[28:31]
tr a[148:149],v234 offset:8192
s_waitcnt lgkmcnt(7)
mm v[32:35],a[128:131],a[64:67],v[32:35]
tr a[150:151],v234 offset:12288
s_add_u32 m0,s51,0
mm v[32:35],a[132:135],a[72:75],v[32:35]
tr a[152:153],v235 offset:0
s_waitcnt vmcnt(16)
mm v[36:39],a[128:131],a[68:71],v[36:39]
tr a[154:155],v235 offset:4096
s_barrier
mm v[36:39],a[132:135],a[76:79],v[36:39]
bl v238,s[16:19],s54 offen offset:0 lds
s_waitcnt lgkmcnt(6)
mm v[40:43],a[136:139],a[64:67],v[40:43]
tr a[156:157],v235 offset:8192
tr a[158:159],v235 offset:12288
mm v[40:43],a[140:143],a[72:75],v[40:43]
tr a[128:129],v228 offset:16384
mm v[44:47],a[136:139],a[68:71],v[44:47]
tr a[130:131],v228 offset:20480
bl v239,s[16:19],s54 offen offset:1024 lds
mm v[44:47],a[140:143],a[76:79],v[44:47]
tr a[132:133],v228 offset:24576
s_waitcnt lgkmcnt(7)
mm v[48:51],a[144:147],a[64:67],v[48:51]
tr a[134:135],v228 offset:28672
mm v[48:51],a[148:151],a[72:75],v[48:51]
tr a[136:137],v229 offset:16384
mm v[52:55],a[144:147],a[68:71],v[52:55]
tr a[138:139],v229 offset:20480
bl v240,s[16:19],s54 offen offset:2048 lds
mm v[52:55],a[148:151],a[76:79],v[52:55]
tr a[140:141],v229 offset:24576
s_waitcnt lgkmcnt(7)
mm v[56:59],a[152:155],a[64:67],v[56:59]
tr a[142:143],v229 offset:28672
mm v[56:59],a[156:159],a[72:75],v[56:59]
tr a[144:145],v230 offset:16384
mm v[60:63],a[152:155],a[68:71],v[60:63]
tr a[146:147],v230 offset:20480
bl v241,s[16:19],s54 offen offset:3072 lds
mm v[60:63],a[156:159],a[76:79],v[60:63]
tr a[148:149],v230 offset:24576
s_waitcnt lgkmcnt(7)
mm v[0:3],a[128:131],a[80:83],v[0:3]
tr a[150:151],v230 offset:28672
s_add_u32 m0,s51,4096
mm v[0:3],a[132:135],a[88:91],v[0:3]
tr a[152:153],v231 offset:16384
mm v[4:7],a[128:131],a[84:87],v[4:7]
tr a[154:155],v231 offset:20480
mm v[4:7],a[132:135],a[92:95],v[4:7]
tr a[156:157],v231 offset:24576
s_waitcnt lgkmcnt(7)
mm v[8:11],a[136:139],a[80:83],v[8:11]
tr a[158:159],v231 offset:28672
bl v242,s[16:19],s54 offen offset:0 lds
mm v[8:11],a[140:143],a[88:91],v[8:11]
tr a[128:129],v232 offset:16384
mm v[12:15],a[136:139],a[84:87],v[12:15]
tr a[130:131],v232 offset:20480
mm v[12:15],a[140:143],a[92:95],v[12:15]
tr a[132:133],v232 offset:24576
s_waitcnt lgkmcnt(7)
mm v[16:19],a[144:147],a[80:83],v[16:19]
tr a[134:135],v232 offset:28672
bl v243,s[16:19],s54 offen offset:1024 lds
mm v[16:19],a[148:151],a[88:91],v[16:19]
tr a[136:137],v233 offset:16384
mm v[20:23],a[144:147],a[84:87],v[20:23]
tr a[138:139],v233 offset:20480
mm v[20:23],a[148:151],a[92:95],v[20:23]
tr a[140:141],v233 offset:24576
s_waitcnt lgkmcnt(7)
mm v[24:27],a[152:155],a[80:83],v[24:27]
tr a[142:143],v233 offset:28672
bl v244,s[16:19],s54 offen offset:2048 lds
mm v[24:27],a[156:159],a[88:91],v[24:27]
tr a[144:145],v234 offset:16384
s_add_u32 s54,s54,458752
mm v[28:31],a[152:155],a[84:87],v[28:31]
tr a[146:147],v234 offset:20480
s_add_u32 m0,s51,28672
mm v[28:31],a[156:159],a[92:95],v[28:31]
tr a[148:149],v234 offset:24576
s_waitcnt lgkmcnt(7)
mm v[32:35],a[128:131],a[80:83],v[32:35]
tr a[150:151],v234 offset:28672
bl v238,s[16:19],s54 offen offset:0 lds
mm v[32:35],a[132:135],a[88:91],v[32:35]
tr a[152:153],v235 offset:16384
s_waitcnt vmcnt(16)
mm v[36:39],a[128:131],a[84:87],v[36:39]
tr a[154:155],v235 offset:20480
s_barrier
mm v[36:39],a[132:135],a[92:95],v[36:39]
tr a[156:157],v235 offset:24576
s_waitcnt lgkmcnt(7)
mm v[40:43],a[136:139],a[80:83],v[40:43]
tr a[158:159],v235 offset:28672
bl v239,s[16:19],s54 offen offset:1024 lds
mm v[40:43],a[140:143],a[88:91],v[40:43]
tr a[128:129],v228 offset:32768
mm v[44:47],a[136:139],a[84:87],v[44:47]
tr a[130:131],v228 offset:36864
mm v[44:47],a[140:143],a[92:95],v[44:47]
tr a[132:133],v228 offset:40960
s_waitcnt lgkmcnt(7)
mm v[48:51],a[144:147],a[80:83],v[48:51]
tr a[134:135],v228 offset:45056
bl v240,s[16:19],s54 offen offset:2048 lds
mm v[48:51],a[148:151],a[88:91],v[48:51]
tr a[136:137],v229 offset:32768
mm v[52:55],a[144:147],a[84:87],v[52:55]
tr a[138:139],v229 offset:36864
mm v[52:55],a[148:151],a[92:95],v[52:55]
tr a[140:141],v229 offset:40960
s_waitcnt lgkmcnt(7)
mm v[56:59],a[152:155],a[80:83],v[56:59]
tr a[142:143],v229 offset:45056
bl v241,s[16:19],s54 offen offset:3072 lds
mm v[56:59],a[156:159],a[88:91],v[56:59]
tr a[144:145],v230 offset:32768
s_add_u32 m0,s51,32768
mm v[60:63],a[152:155],a[84:87],v[60:63]
tr a[146:147],v230 offset:36864
mm v[60:63],a[156:159],a[92:95],v[60:63]
tr a[148:149],v230 offset:40960
s_waitcnt lgkmcnt(7)
mm v[0:3],a[128:131],a[96:99],v[0:3]
tr a[150:151],v230 offset:45056
mm v[0:3],a[132:135],a[104:107],v[0:3]
tr a[152:153],v231 offset:32768
bl v242,s[16:19],s54 offen offset:0 lds
mm v[4:7],a[128:131],a[100:103],v[4:7]
tr a[154:155],v231 offset:36864
mm v[4:7],a[132:135],a[108:111],v[4:7]
tr a[156:157],v231 offset:40960
s_waitcnt lgkmcnt(7)
mm v[8:11],a[136:139],a[96:99],v[8:11]
tr a[158:159],v231 offset:45056
mm v[8:11],a[140:143],a[104:107],v[8:11]
tr a[128:129],v232 offset:32768
bl v243,s[16:19],s54 offen offset:1024 lds
mm v[12:15],a[136:139],a[100:103],v[12:15]
tr a[130:131],v232 offset:36864
mm v[12:15],a[140:143],a[108:111],v[12:15]
tr a[132:133],v232 offset:40960
s_waitcnt lgkmcnt(7)
mm v[16:19],a[144:147],a[96:99],v[16:19]
tr a[134:135],v232 offset:45056
mm v[16:19],a[148:151],a[104:107],v[16:19]
tr a[136:137],v233 offset:32768
bl v244,s[16:19],s54 offen offset:2048 lds
mm v[20:23],a[144:147],a[100:103],v[20:23]
tr a[138:139],v233 offset:36864
s_add_u32 s54,s54,458752
mm v[20:23],a[148:151],a[108:111],v[20:23]
tr a[140:141],v233 offset:40960
s_waitcnt lgkmcnt(7)
mm v[24:27],a[152:155],a[96:99],v[24:27]
tr a[142:143],v233 offset:45056
mm v[24:27],a[156:159],a[104:107],v[24:27]
tr a[144:145],v234 offset:32768
mm v[28:31],a[152:155],a[100:103],v[28:31]
tr a[146:147],v234 offset:36864
mm v[28:31],a[156:159],a[108:111],v[28:31]
tr a[148:149],v234 offset:40960
s_waitcnt lgkmcnt(7)
mm v[32:35],a[128:131],a[96:99],v[32:35]
tr a[150:151],v234 offset:45056
mm v[32:35],a[132:135],a[104:107],v[32:35]
tr a[152:153],v235 offset:32768
s_waitcnt vmcnt(14)
mm v[36:39],a[128:131],a[100:103],v[36:39]
tr a[154:155],v235 offset:36864
s_barrier
mm v[36:39],a[132:135],a[108:111],v[36:39]
tr a[156:157],v235 offset:40960
s_waitcnt lgkmcnt(7)
mm v[40:43],a[136:139],a[96:99],v[40:43]
tr a[158:159],v235 offset:45056
mm v[40:43],a[140:143],a[104:107],v[40:43]
tr a[128:129],v228 offset:49152
mm v[44:47],a[136:139],a[100:103],v[44:47]
tr a[130:131],v228 offset:53248
mm v[44:47],a[140:143],a[108:111],v[44:47]
tr a[132:133],v228 offset:57344
s_waitcnt lgkmcnt(7)
mm v[48:51],a[144:147],a[96:99],v[48:51]
tr a[134:135],v228 offset:61440
mm v[48:51],a[148:151],a[104:107],v[48:51]
tr a[136:137],v229 offset:49152
mm v[52:55],a[144:147],a[100:103],v[52:55]
tr a[138:139],v229 offset:53248
mm v[52:55],a[148:151],a[108:111],v[52:55]
tr a[140:141],v229 offset:57344
s_waitcnt lgkmcnt(7)
mm v[56:59],a[152:155],a[96:99],v[56:59]
tr a[142:143],v229 offset:61440
mm v[56:59],a[156:159],a[104:107],v[56:59]
tr a[144:145],v230 offset:49152
mm v[60:63],a[152:155],a[100:103],v[60:63]
tr a[146:147],v230 offset:53248
mm v[60:63],a[156:159],a[108:111],v[60:63]
tr a[148:149],v230 offset:57344
s_waitcnt lgkmcnt(7)
mm v[0:3],a[128:131],a[112:115],v[0:3]
tr a[150:151],v230 offset:61440
mm v[0:3],a[132:135],a[120:123],v[0:3]
tr a[152:153],v231 offset:49152
mm v[4:7],a[128:131],a[116:119],v[4:7]
tr a[154:155],v231 offset:53248
mm v[4:7],a[132:135],a[124:127],v[4:7]
tr a[156:157],v231 offset:57344
s_waitcnt lgkmcnt(7)
mm v[8:11],a[136:139],a[112:115],v[8:11]
tr a[158:159],v231 offset:61440
mm v[8:11],a[140:143],a[120:123],v[8:11]
tr a[128:129],v232 offset:49152
mm v[12:15],a[136:139],a[116:119],v[12:15]
tr a[130:131],v232 offset:53248
mm v[12:15],a[140:143],a[124:127],v[12:15]
tr a[132:133],v232 offset:57344
s_waitcnt lgkmcnt(7)
mm v[16:19],a[144:147],a[112:115],v[16:19]
tr a[134:135],v232 offset:61440
mm v[16:19],a[148:151],a[120:123],v[16:19]
tr a[136:137],v233 offset:49152
mm v[20:23],a[144:147],a[116:119],v[20:23]
tr a[138:139],v233 offset:53248
mm v[20:23],a[148:151],a[124:127],v[20:23]
tr a[140:141],v233 offset:57344
s_waitcnt lgkmcnt(7)
mm v[24:27],a[152:155],a[112:115],v[24:27]
tr a[142:143],v233 offset:61440
mm v[24:27],a[156:159],a[120:123],v[24:27]
tr a[144:145],v234 offset:49152
mm v[28:31],a[152:155],a[116:119],v[28:31]
tr a[146:147],v234 offset:53248
mm v[28:31],a[156:159],a[124:127],v[28:31]
tr a[148:149],v234 offset:57344
s_waitcnt lgkmcnt(7)
mm v[32:35],a[128:131],a[112:115],v[32:35]
tr a[150:151],v234 offset:61440
mm v[32:35],a[132:135],a[120:123],v[32:35]
tr a[152:153],v235 offset:49152
mm v[36:39],a[128:131],a[116:119],v[36:39]
tr a[154:155],v235 offset:53248
mm v[36:39],a[132:135],a[124:127],v[36:39]
tr a[156:157],v235 offset:57344
s_waitcnt lgkmcnt(7)
mm v[40:43],a[136:139],a[112:115],v[40:43]
tr a[158:159],v235 offset:61440
mm v[40:43],a[140:143],a[120:123],v[40:43]
mm v[44:47],a[136:139],a[116:119],v[44:47]
mm v[44:47],a[140:143],a[124:127],v[44:47]
s_waitcnt lgkmcnt(4)
mm v[48:51],a[144:147],a[112:115],v[48:51]
mm v[48:51],a[148:151],a[120:123],v[48:51]
mm v[52:55],a[144:147],a[116:119],v[52:55]
mm v[52:55],a[148:151],a[124:127],v[52:55]
s_waitcnt lgkmcnt(0)
mm v[56:59],a[152:155],a[112:115],v[56:59]
mm v[56:59],a[156:159],a[120:123],v[56:59]
mm v[60:63],a[152:155],a[116:119],v[60:63]
mm v[60:63],a[156:159],a[124:127],v[60:63]
tail_Aepi:
s_add_u32 s27,s56,52428800
cv v0,v0,v1
cv v1,v2,v3
cv v2,v8,v9
cv v3,v10,v11
buffer_store_dwordx4 v[0:3],v254,s[8:11],s27 offen offset:0 sc1
cv v16,v16,v17
cv v17,v18,v19
cv v18,v24,v25
cv v19,v26,v27
buffer_store_dwordx4 v[16:19],v254,s[8:11],s27 offen offset:1024 sc1
cv v32,v32,v33
cv v33,v34,v35
cv v34,v40,v41
cv v35,v42,v43
buffer_store_dwordx4 v[32:35],v254,s[8:11],s27 offen offset:2048 sc1
cv v48,v48,v49
cv v49,v50,v51
cv v50,v56,v57
cv v51,v58,v59
buffer_store_dwordx4 v[48:51],v254,s[8:11],s27 offen offset:3072 sc1
s_add_u32 s27,s27,32768
cv v4,v4,v5
cv v5,v6,v7
cv v6,v12,v13
cv v7,v14,v15
buffer_store_dwordx4 v[4:7],v254,s[8:11],s27 offen offset:0 sc1
cv v20,v20,v21
cv v21,v22,v23
cv v22,v28,v29
cv v23,v30,v31
buffer_store_dwordx4 v[20:23],v254,s[8:11],s27 offen offset:1024 sc1
cv v36,v36,v37
cv v37,v38,v39
cv v38,v44,v45
cv v39,v46,v47
buffer_store_dwordx4 v[36:39],v254,s[8:11],s27 offen offset:2048 sc1
cv v52,v52,v53
cv v53,v54,v55
cv v54,v60,v61
cv v55,v62,v63
buffer_store_dwordx4 v[52:55],v254,s[8:11],s27 offen offset:3072 sc1
v_permlane16_swap_b32 v184,v186
v_permlane16_swap_b32 v185,v187
v_permlane16_swap_b32 v188,v190
v_permlane16_swap_b32 v189,v191
v_permlane16_swap_b32 v192,v194
v_permlane16_swap_b32 v193,v195
v_permlane16_swap_b32 v196,v198
v_permlane16_swap_b32 v197,v199
s_waitcnt vmcnt(0)
v_mov_b32 v204,0
v_mov_b32 v205,1
s_barrier
s_cmp_lg_u32 s20,0
s_cbranch_scc1 tail_gb1_a
s_mov_b64 exec,1
buffer_atomic_add v205,v204,s[8:11],s57 offen offset:0 sc1
s_mov_b64 exec,-1
tail_gb1_a:
s_mov_b32 s24,8192
bl v[120:123],v253,s[8:11],s24 offen offset:0 sc1
bl v[124:127],v253,s[8:11],s24 offen offset:64 sc1
bl v[128:131],v253,s[8:11],s24 offen offset:256 sc1
bl v[132:135],v253,s[8:11],s24 offen offset:320 sc1
bl v[136:139],v253,s[8:11],s24 offen offset:512 sc1
bl v[140:143],v253,s[8:11],s24 offen offset:576 sc1
bl v[144:147],v253,s[8:11],s24 offen offset:768 sc1
bl v[148:151],v253,s[8:11],s24 offen offset:832 sc1
s_mov_b32 s24,16384
bl v[152:155],v253,s[8:11],s24 offen offset:0 sc1
bl v[156:159],v253,s[8:11],s24 offen offset:64 sc1
bl v[160:163],v253,s[8:11],s24 offen offset:256 sc1
bl v[164:167],v253,s[8:11],s24 offen offset:320 sc1
bl v[168:171],v253,s[8:11],s24 offen offset:512 sc1
bl v[172:175],v253,s[8:11],s24 offen offset:576 sc1
bl v[176:179],v253,s[8:11],s24 offen offset:768 sc1
bl v[180:183],v253,s[8:11],s24 offen offset:832 sc1
s_mov_b32 s24,12288
bl v[88:91],v253,s[8:11],s24 offen offset:0 sc1
bl v[92:95],v253,s[8:11],s24 offen offset:64 sc1
bl v[96:99],v253,s[8:11],s24 offen offset:256 sc1
bl v[100:103],v253,s[8:11],s24 offen offset:320 sc1
bl v[104:107],v253,s[8:11],s24 offen offset:512 sc1
bl v[108:111],v253,s[8:11],s24 offen offset:576 sc1
bl v[112:115],v253,s[8:11],s24 offen offset:768 sc1
bl v[116:119],v253,s[8:11],s24 offen offset:832 sc1
s_cmp_lg_u32 s20,0
s_cbranch_scc1 tail_gb1_w
s_mov_b64 exec,1
s_mov_b32 s59,0x40000
tail_gb1_p:
buffer_load_dword v206,v204,s[8:11],s57 offen offset:0 sc1
s_waitcnt vmcnt(0)
v_readfirstlane_b32 s60,v206
s_sub_u32 s59,s59,1
s_cmp_eq_u32 s59,0
s_cbranch_scc1 tail_gb1_g
s_cmp_lt_u32 s60,16
s_cbranch_scc1 tail_gb1_p
tail_gb1_g:
s_mov_b64 exec,-1
tail_gb1_w:
s_barrier
s_add_u32 s24,s53,52428800
bl v[32:35],v251,s[8:11],s24 offen offset:0 sc1
bl v[36:39],v251,s[8:11],s24 offen offset:2048 sc1
s_add_u32 s24,s24,4096
bl v[40:43],v251,s[8:11],s24 offen offset:0 sc1
bl v[44:47],v251,s[8:11],s24 offen offset:2048 sc1
s_add_u32 s24,s24,4190208
bl v[48:51],v251,s[8:11],s24 offen offset:0 sc1
bl v[52:55],v251,s[8:11],s24 offen offset:2048 sc1
s_add_u32 s24,s24,4096
bl v[56:59],v251,s[8:11],s24 offen offset:0 sc1
bl v[60:63],v251,s[8:11],s24 offen offset:2048 sc1
s_waitcnt vmcnt(23)
v_add_f32 v152,1.0,v152
v_add_f32 v153,1.0,v153
v_add_f32 v154,1.0,v154
v_add_f32 v155,1.0,v155
s_waitcnt vmcnt(22)
v_add_f32 v156,1.0,v156
v_add_f32 v157,1.0,v157
v_add_f32 v158,1.0,v158
v_add_f32 v159,1.0,v159
s_waitcnt vmcnt(21)
v_add_f32 v160,1.0,v160
v_add_f32 v161,1.0,v161
v_add_f32 v162,1.0,v162
v_add_f32 v163,1.0,v163
s_waitcnt vmcnt(20)
v_add_f32 v164,1.0,v164
v_add_f32 v165,1.0,v165
v_add_f32 v166,1.0,v166
v_add_f32 v167,1.0,v167
s_waitcnt vmcnt(19)
v_add_f32 v168,1.0,v168
v_add_f32 v169,1.0,v169
v_add_f32 v170,1.0,v170
v_add_f32 v171,1.0,v171
s_waitcnt vmcnt(18)
v_add_f32 v172,1.0,v172
v_add_f32 v173,1.0,v173
v_add_f32 v174,1.0,v174
v_add_f32 v175,1.0,v175
s_waitcnt vmcnt(17)
v_add_f32 v176,1.0,v176
v_add_f32 v177,1.0,v177
v_add_f32 v178,1.0,v178
v_add_f32 v179,1.0,v179
s_waitcnt vmcnt(16)
v_add_f32 v180,1.0,v180
v_add_f32 v181,1.0,v181
v_add_f32 v182,1.0,v182
v_add_f32 v183,1.0,v183
cv v200,v152,v153
v_lshlrev_b32 v152,16,v200
v_and_b32 v153,0xffff0000,v200
cv v200,v154,v155
v_lshlrev_b32 v154,16,v200
v_and_b32 v155,0xffff0000,v200
cv v200,v156,v157
v_lshlrev_b32 v156,16,v200
v_and_b32 v157,0xffff0000,v200
cv v200,v158,v159
v_lshlrev_b32 v158,16,v200
v_and_b32 v159,0xffff0000,v200
cv v200,v160,v161
v_lshlrev_b32 v160,16,v200
v_and_b32 v161,0xffff0000,v200
cv v200,v162,v163
v_lshlrev_b32 v162,16,v200
v_and_b32 v163,0xffff0000,v200
cv v200,v164,v165
v_lshlrev_b32 v164,16,v200
v_and_b32 v165,0xffff0000,v200
cv v200,v166,v167
v_lshlrev_b32 v166,16,v200
v_and_b32 v167,0xffff0000,v200
cv v200,v168,v169
v_lshlrev_b32 v168,16,v200
v_and_b32 v169,0xffff0000,v200
cv v200,v170,v171
v_lshlrev_b32 v170,16,v200
v_and_b32 v171,0xffff0000,v200
cv v200,v172,v173
v_lshlrev_b32 v172,16,v200
v_and_b32 v173,0xffff0000,v200
cv v200,v174,v175
v_lshlrev_b32 v174,16,v200
v_and_b32 v175,0xffff0000,v200
cv v200,v176,v177
v_lshlrev_b32 v176,16,v200
v_and_b32 v177,0xffff0000,v200
cv v200,v178,v179
v_lshlrev_b32 v178,16,v200
v_and_b32 v179,0xffff0000,v200
cv v200,v180,v181
v_lshlrev_b32 v180,16,v200
v_and_b32 v181,0xffff0000,v200
cv v200,v182,v183
v_lshlrev_b32 v182,16,v200
v_and_b32 v183,0xffff0000,v200
v_and_b32 v207,7,v255
v_lshlrev_b32 v207,5,v207
v_add_u32 v207,143360,v207
s_lshl_b32 s24,s20,3
v_add_u32 v206,s24,v207
s_waitcnt vmcnt(7)
v_and_b32 v1,0xffff0000,v32
v_lshlrev_b32 v0,16,v32
v_and_b32 v3,0xffff0000,v33
v_lshlrev_b32 v2,16,v33
v_and_b32 v5,0xffff0000,v34
v_lshlrev_b32 v4,16,v34
v_and_b32 v7,0xffff0000,v35
v_lshlrev_b32 v6,16,v35
s_waitcnt vmcnt(6)
v_and_b32 v9,0xffff0000,v36
v_lshlrev_b32 v8,16,v36
v_and_b32 v11,0xffff0000,v37
v_lshlrev_b32 v10,16,v37
v_and_b32 v13,0xffff0000,v38
v_lshlrev_b32 v12,16,v38
v_and_b32 v15,0xffff0000,v39
v_lshlrev_b32 v14,16,v39
s_waitcnt vmcnt(5)
v_and_b32 v17,0xffff0000,v40
v_lshlrev_b32 v16,16,v40
v_and_b32 v19,0xffff0000,v41
v_lshlrev_b32 v18,16,v41
v_and_b32 v21,0xffff0000,v42
v_lshlrev_b32 v20,16,v42
v_and_b32 v23,0xffff0000,v43
v_lshlrev_b32 v22,16,v43
s_waitcnt vmcnt(4)
v_and_b32 v25,0xffff0000,v44
v_lshlrev_b32 v24,16,v44
v_and_b32 v27,0xffff0000,v45
v_lshlrev_b32 v26,16,v45
v_and_b32 v29,0xffff0000,v46
v_lshlrev_b32 v28,16,v46
v_and_b32 v31,0xffff0000,v47
v_lshlrev_b32 v30,16,v47
s_waitcnt vmcnt(3)
v_and_b32 v33,0xffff0000,v48
v_lshlrev_b32 v32,16,v48
v_and_b32 v35,0xffff0000,v49
v_lshlrev_b32 v34,16,v49
v_and_b32 v37,0xffff0000,v50
v_lshlrev_b32 v36,16,v50
v_and_b32 v39,0xffff0000,v51
v_lshlrev_b32 v38,16,v51
s_waitcnt vmcnt(2)
v_and_b32 v41,0xffff0000,v52
v_lshlrev_b32 v40,16,v52
v_and_b32 v43,0xffff0000,v53
v_lshlrev_b32 v42,16,v53
v_and_b32 v45,0xffff0000,v54
v_lshlrev_b32 v44,16,v54
v_and_b32 v47,0xffff0000,v55
v_lshlrev_b32 v46,16,v55
s_waitcnt vmcnt(1)
v_and_b32 v65,0xffff0000,v56
v_lshlrev_b32 v64,16,v56
v_and_b32 v67,0xffff0000,v57
v_lshlrev_b32 v66,16,v57
v_and_b32 v69,0xffff0000,v58
v_lshlrev_b32 v68,16,v58
v_and_b32 v71,0xffff0000,v59
v_lshlrev_b32 v70,16,v59
s_waitcnt vmcnt(0)
v_and_b32 v73,0xffff0000,v60
v_lshlrev_b32 v72,16,v60
v_and_b32 v75,0xffff0000,v61
v_lshlrev_b32 v74,16,v61
v_and_b32 v77,0xffff0000,v62
v_lshlrev_b32 v76,16,v62
v_and_b32 v79,0xffff0000,v63
v_lshlrev_b32 v78,16,v63
v_pk_add_f32 v[0:1],v[0:1],v[32:33]
v_pk_add_f32 v[2:3],v[2:3],v[34:35]
v_pk_add_f32 v[4:5],v[4:5],v[36:37]
v_pk_add_f32 v[6:7],v[6:7],v[38:39]
v_pk_add_f32 v[8:9],v[8:9],v[40:41]
v_pk_add_f32 v[10:11],v[10:11],v[42:43]
v_pk_add_f32 v[12:13],v[12:13],v[44:45]
v_pk_add_f32 v[14:15],v[14:15],v[46:47]
v_pk_add_f32 v[16:17],v[16:17],v[64:65]
v_pk_add_f32 v[18:19],v[18:19],v[66:67]
v_pk_add_f32 v[20:21],v[20:21],v[68:69]
v_pk_add_f32 v[22:23],v[22:23],v[70:71]
v_pk_add_f32 v[24:25],v[24:25],v[72:73]
v_pk_add_f32 v[26:27],v[26:27],v[74:75]
v_pk_add_f32 v[28:29],v[28:29],v[76:77]
v_pk_add_f32 v[30:31],v[30:31],v[78:79]
s_add_u32 m0,s51,57344
v_and_b32 v33,0xffff0000,v184
v_lshlrev_b32 v32,16,v184
v_and_b32 v35,0xffff0000,v185
v_lshlrev_b32 v34,16,v185
v_and_b32 v37,0xffff0000,v186
v_lshlrev_b32 v36,16,v186
v_and_b32 v39,0xffff0000,v187
v_lshlrev_b32 v38,16,v187
v_and_b32 v41,0xffff0000,v188
v_lshlrev_b32 v40,16,v188
v_and_b32 v43,0xffff0000,v189
v_lshlrev_b32 v42,16,v189
v_and_b32 v45,0xffff0000,v190
v_lshlrev_b32 v44,16,v190
v_and_b32 v47,0xffff0000,v191
v_lshlrev_b32 v46,16,v191
v_and_b32 v49,0xffff0000,v192
v_lshlrev_b32 v48,16,v192
v_and_b32 v51,0xffff0000,v193
bl v238,s[16:19],s54 offen offset:0 lds
v_lshlrev_b32 v50,16,v193
v_and_b32 v53,0xffff0000,v194
v_lshlrev_b32 v52,16,v194
v_and_b32 v55,0xffff0000,v195
v_lshlrev_b32 v54,16,v195
v_and_b32 v57,0xffff0000,v196
v_lshlrev_b32 v56,16,v196
v_and_b32 v59,0xffff0000,v197
v_lshlrev_b32 v58,16,v197
v_and_b32 v61,0xffff0000,v198
v_lshlrev_b32 v60,16,v198
v_and_b32 v63,0xffff0000,v199
v_lshlrev_b32 v62,16,v199
v_pk_fma_f32 v[0:1],v[0:1],v[120:121],v[32:33]
v_pk_fma_f32 v[2:3],v[2:3],v[122:123],v[34:35]
v_pk_fma_f32 v[4:5],v[4:5],v[124:125],v[36:37]
v_pk_fma_f32 v[6:7],v[6:7],v[126:127],v[38:39]
v_pk_fma_f32 v[8:9],v[8:9],v[128:129],v[40:41]
bl v239,s[16:19],s54 offen offset:1024 lds
v_pk_fma_f32 v[10:11],v[10:11],v[130:131],v[42:43]
v_pk_fma_f32 v[12:13],v[12:13],v[132:133],v[44:45]
v_pk_fma_f32 v[14:15],v[14:15],v[134:135],v[46:47]
v_pk_fma_f32 v[16:17],v[16:17],v[136:137],v[48:49]
v_pk_fma_f32 v[18:19],v[18:19],v[138:139],v[50:51]
v_pk_fma_f32 v[20:21],v[20:21],v[140:141],v[52:53]
v_pk_fma_f32 v[22:23],v[22:23],v[142:143],v[54:55]
v_pk_fma_f32 v[24:25],v[24:25],v[144:145],v[56:57]
v_pk_fma_f32 v[26:27],v[26:27],v[146:147],v[58:59]
v_pk_fma_f32 v[28:29],v[28:29],v[148:149],v[60:61]
v_pk_fma_f32 v[30:31],v[30:31],v[150:151],v[62:63]
cv v184,v0,v1
cv v185,v2,v3
cv v186,v4,v5
cv v187,v6,v7
cv v188,v8,v9
cv v189,v10,v11
cv v190,v12,v13
bl v240,s[16:19],s54 offen offset:2048 lds
cv v191,v14,v15
cv v192,v16,v17
cv v193,v18,v19
cv v194,v20,v21
cv v195,v22,v23
cv v196,v24,v25
cv v197,v26,v27
cv v198,v28,v29
cv v199,v30,v31
v_and_b32 v1,0xffff0000,v184
v_lshlrev_b32 v0,16,v184
v_and_b32 v3,0xffff0000,v185
v_lshlrev_b32 v2,16,v185
v_and_b32 v5,0xffff0000,v186
v_lshlrev_b32 v4,16,v186
v_and_b32 v7,0xffff0000,v187
v_lshlrev_b32 v6,16,v187
v_and_b32 v9,0xffff0000,v188
v_lshlrev_b32 v8,16,v188
bl v241,s[16:19],s54 offen offset:3072 lds
v_and_b32 v11,0xffff0000,v189
v_lshlrev_b32 v10,16,v189
v_and_b32 v13,0xffff0000,v190
v_lshlrev_b32 v12,16,v190
v_and_b32 v15,0xffff0000,v191
v_lshlrev_b32 v14,16,v191
v_and_b32 v17,0xffff0000,v192
v_lshlrev_b32 v16,16,v192
v_and_b32 v19,0xffff0000,v193
v_lshlrev_b32 v18,16,v193
v_and_b32 v21,0xffff0000,v194
v_lshlrev_b32 v20,16,v194
v_and_b32 v23,0xffff0000,v195
v_lshlrev_b32 v22,16,v195
v_and_b32 v25,0xffff0000,v196
v_lshlrev_b32 v24,16,v196
v_and_b32 v27,0xffff0000,v197
v_lshlrev_b32 v26,16,v197
s_add_u32 m0,s51,61440
v_and_b32 v29,0xffff0000,v198
v_lshlrev_b32 v28,16,v198
v_and_b32 v31,0xffff0000,v199
v_lshlrev_b32 v30,16,v199
v_pk_add_f32 v[200:201],v[0:1],v[2:3]
v_pk_add_f32 v[202:203],v[4:5],v[6:7]
v_pk_add_f32 v[200:201],v[200:201],v[8:9]
v_pk_add_f32 v[202:203],v[202:203],v[10:11]
v_pk_add_f32 v[200:201],v[200:201],v[12:13]
v_pk_add_f32 v[202:203],v[202:203],v[14:15]
v_pk_add_f32 v[200:201],v[200:201],v[16:17]
v_pk_add_f32 v[202:203],v[202:203],v[18:19]
v_pk_add_f32 v[200:201],v[200:201],v[20:21]
v_pk_add_f32 v[202:203],v[202:203],v[22:23]
v_pk_add_f32 v[200:201],v[200:201],v[24:25]
v_pk_add_f32 v[202:203],v[202:203],v[26:27]
v_pk_add_f32 v[200:201],v[200:201],v[28:29]
v_pk_add_f32 v[202:203],v[202:203],v[30:31]
bl v242,s[16:19],s54 offen offset:0 lds
v_pk_add_f32 v[200:201],v[200:201],v[202:203]
v_add_f32 v200,v200,v201
s_nop 1
v_add_f32_dpp v200,v200,v200 row_ror:8 row_mask:0xf bank_mask:0xf
v_mov_b32 v201,v200
s_nop 1
v_permlane16_swap_b32 v201,v200
v_add_f32 v200,v200,v201
v_mov_b32 v201,v200
s_nop 1
v_permlane32_swap_b32 v201,v200
v_add_f32 v200,v200,v201
v_mul_f32 v200,0x3b800000,v200
v_pk_add_f32 v[32:33],v[0:1],v[200:201] op_sel_hi:[1,0] neg_lo:[0,1] neg_hi:[0,1]
v_pk_add_f32 v[34:35],v[2:3],v[200:201] op_sel_hi:[1,0] neg_lo:[0,1] neg_hi:[0,1]
v_pk_add_f32 v[36:37],v[4:5],v[200:201] op_sel_hi:[1,0] neg_lo:[0,1] neg_hi:[0,1]
v_pk_add_f32 v[38:39],v[6:7],v[200:201] op_sel_hi:[1,0] neg_lo:[0,1] neg_hi:[0,1]
v_pk_add_f32 v[40:41],v[8:9],v[200:201] op_sel_hi:[1,0] neg_lo:[0,1] neg_hi:[0,1]
v_pk_add_f32 v[42:43],v[10:11],v[200:201] op_sel_hi:[1,0] neg_lo:[0,1] neg_hi:[0,1]
v_pk_add_f32 v[44:45],v[12:13],v[200:201] op_sel_hi:[1,0] neg_lo:[0,1] neg_hi:[0,1]
v_pk_add_f32 v[46:47],v[14:15],v[200:201] op_sel_hi:[1,0] neg_lo:[0,1] neg_hi:[0,1]
v_pk_add_f32 v[48:49],v[16:17],v[200:201] op_sel_hi:[1,0] neg_lo:[0,1] neg_hi:[0,1]
bl v243,s[16:19],s54 offen offset:1024 lds
v_pk_add_f32 v[50:51],v[18:19],v[200:201] op_sel_hi:[1,0] neg_lo:[0,1] neg_hi:[0,1]
v_pk_add_f32 v[52:53],v[20:21],v[200:201] op_sel_hi:[1,0] neg_lo:[0,1] neg_hi:[0,1]
v_pk_add_f32 v[54:55],v[22:23],v[200:201] op_sel_hi:[1,0] neg_lo:[0,1] neg_hi:[0,1]
v_pk_add_f32 v[56:57],v[24:25],v[200:201] op_sel_hi:[1,0] neg_lo:[0,1] neg_hi:[0,1]
v_pk_add_f32 v[58:59],v[26:27],v[200:201] op_sel_hi:[1,0] neg_lo:[0,1] neg_hi:[0,1]
v_pk_add_f32 v[60:61],v[28:29],v[200:201] op_sel_hi:[1,0] neg_lo:[0,1] neg_hi:[0,1]
v_pk_add_f32 v[62:63],v[30:31],v[200:201] op_sel_hi:[1,0] neg_lo:[0,1] neg_hi:[0,1]
v_pk_mul_f32 v[202:203],v[32:33],v[32:33]
v_pk_fma_f32 v[202:203],v[34:35],v[34:35],v[202:203]
v_pk_fma_f32 v[202:203],v[36:37],v[36:37],v[202:203]
v_pk_fma_f32 v[202:203],v[38:39],v[38:39],v[202:203]
v_pk_fma_f32 v[202:203],v[40:41],v[40:41],v[202:203]
v_pk_fma_f32 v[202:203],v[42:43],v[42:43],v[202:203]
v_pk_fma_f32 v[202:203],v[44:45],v[44:45],v[202:203]
v_pk_fma_f32 v[202:203],v[46:47],v[46:47],v[202:203]
v_pk_fma_f32 v[202:203],v[48:49],v[48:49],v[202:203]
v_pk_fma_f32 v[202:203],v[50:51],v[50:51],v[202:203]
v_pk_fma_f32 v[202:203],v[52:53],v[52:53],v[202:203]
bl v244,s[16:19],s54 offen offset:2048 lds
v_pk_fma_f32 v[202:203],v[54:55],v[54:55],v[202:203]
v_pk_fma_f32 v[202:203],v[56:57],v[56:57],v[202:203]
v_pk_fma_f32 v[202:203],v[58:59],v[58:59],v[202:203]
v_pk_fma_f32 v[202:203],v[60:61],v[60:61],v[202:203]
v_pk_fma_f32 v[202:203],v[62:63],v[62:63],v[202:203]
v_add_f32 v201,v202,v203
s_nop 1
v_add_f32_dpp v201,v201,v201 row_ror:8 row_mask:0xf bank_mask:0xf
v_mov_b32 v202,v201
s_nop 1
v_permlane16_swap_b32 v202,v201
v_add_f32 v201,v201,v202
v_mov_b32 v202,v201
s_nop 1
v_permlane32_swap_b32 v202,v201
v_add_f32 v201,v201,v202
ds_write_b64 v206,v[200:201] offset:0
s_waitcnt lgkmcnt(0)
s_barrier
ds_read_b128 v[32:35],v207 offset:0
ds_read_b128 v[36:39],v207 offset:16
s_add_u32 s54,s54,458752
s_waitcnt lgkmcnt(1)
v_add_f32 v200,v32,v34
v_add_f32 v201,v33,v35
s_waitcnt lgkmcnt(0)
v_add_f32 v200,v200,v36
v_add_f32 v201,v201,v37
v_add_f32 v200,v200,v38
v_add_f32 v201,v201,v39
v_mul_f32 v200,0x3e800000,v200
v_sub_f32 v32,v32,v200
v_sub_f32 v34,v34,v200
v_sub_f32 v36,v36,v200
v_sub_f32 v38,v38,v200
v_mul_f32 v202,v32,v32
v_fmac_f32 v202,v34,v34
v_fmac_f32 v202,v36,v36
v_fmac_f32 v202,v38,v38
v_mul_f32 v201,0x3a800000,v201
v_fmac_f32 v201,0x3e800000,v202
cv v200,v200,v200
s_add_u32 m0,s51,86016
v_lshlrev_b32 v200,16,v200
cv v201,v201,v201
v_lshlrev_b32 v201,16,v201
v_add_f32 v201,0x3727c5ac,v201
cv v201,v201,v201
v_lshlrev_b32 v201,16,v201
v_sqrt_f32 v201,v201
s_nop 0
cv v201,v201,v201
v_lshlrev_b32 v201,16,v201
v_rcp_f32 v202,v201
v_pk_add_f32 v[0:1],v[0:1],v[200:201] op_sel_hi:[1,0] neg_lo:[0,1] neg_hi:[0,1]
v_pk_add_f32 v[2:3],v[2:3],v[200:201] op_sel_hi:[1,0] neg_lo:[0,1] neg_hi:[0,1]
v_pk_add_f32 v[4:5],v[4:5],v[200:201] op_sel_hi:[1,0] neg_lo:[0,1] neg_hi:[0,1]
v_pk_add_f32 v[6:7],v[6:7],v[200:201] op_sel_hi:[1,0] neg_lo:[0,1] neg_hi:[0,1]
v_pk_add_f32 v[8:9],v[8:9],v[200:201] op_sel_hi:[1,0] neg_lo:[0,1] neg_hi:[0,1]
v_pk_add_f32 v[10:11],v[10:11],v[200:201] op_sel_hi:[1,0] neg_lo:[0,1] neg_hi:[0,1]
v_pk_add_f32 v[12:13],v[12:13],v[200:201] op_sel_hi:[1,0] neg_lo:[0,1] neg_hi:[0,1]
v_pk_add_f32 v[14:15],v[14:15],v[200:201] op_sel_hi:[1,0] neg_lo:[0,1] neg_hi:[0,1]
v_pk_add_f32 v[16:17],v[16:17],v[200:201] op_sel_hi:[1,0] neg_lo:[0,1] neg_hi:[0,1]
bl v238,s[16:19],s54 offen offset:0 lds
v_pk_add_f32 v[18:19],v[18:19],v[200:201] op_sel_hi:[1,0] neg_lo:[0,1] neg_hi:[0,1]
v_pk_add_f32 v[20:21],v[20:21],v[200:201] op_sel_hi:[1,0] neg_lo:[0,1] neg_hi:[0,1]
v_pk_add_f32 v[22:23],v[22:23],v[200:201] op_sel_hi:[1,0] neg_lo:[0,1] neg_hi:[0,1]
v_pk_add_f32 v[24:25],v[24:25],v[200:201] op_sel_hi:[1,0] neg_lo:[0,1] neg_hi:[0,1]
v_pk_add_f32 v[26:27],v[26:27],v[200:201] op_sel_hi:[1,0] neg_lo:[0,1] neg_hi:[0,1]
v_pk_add_f32 v[28:29],v[28:29],v[200:201] op_sel_hi:[1,0] neg_lo:[0,1] neg_hi:[0,1]
v_pk_add_f32 v[30:31],v[30:31],v[200:201] op_sel_hi:[1,0] neg_lo:[0,1] neg_hi:[0,1]
v_pk_mul_f32 v[0:1],v[0:1],v[202:203] op_sel_hi:[1,0]
v_pk_mul_f32 v[2:3],v[2:3],v[202:203] op_sel_hi:[1,0]
v_pk_mul_f32 v[4:5],v[4:5],v[202:203] op_sel_hi:[1,0]
v_pk_mul_f32 v[6:7],v[6:7],v[202:203] op_sel_hi:[1,0]
v_pk_mul_f32 v[8:9],v[8:9],v[202:203] op_sel_hi:[1,0]
v_pk_mul_f32 v[10:11],v[10:11],v[202:203] op_sel_hi:[1,0]
v_pk_mul_f32 v[12:13],v[12:13],v[202:203] op_sel_hi:[1,0]
v_pk_mul_f32 v[14:15],v[14:15],v[202:203] op_sel_hi:[1,0]
v_pk_mul_f32 v[16:17],v[16:17],v[202:203] op_sel_hi:[1,0]
v_pk_mul_f32 v[18:19],v[18:19],v[202:203] op_sel_hi:[1,0]
v_pk_mul_f32 v[20:21],v[20:21],v[202:203] op_sel_hi:[1,0]
bl v239,s[16:19],s54 offen offset:1024 lds
v_pk_mul_f32 v[22:23],v[22:23],v[202:203] op_sel_hi:[1,0]
v_pk_mul_f32 v[24:25],v[24:25],v[202:203] op_sel_hi:[1,0]
v_pk_mul_f32 v[26:27],v[26:27],v[202:203] op_sel_hi:[1,0]
v_pk_mul_f32 v[28:29],v[28:29],v[202:203] op_sel_hi:[1,0]
v_pk_mul_f32 v[30:31],v[30:31],v[202:203] op_sel_hi:[1,0]
v_pk_fma_f32 v[0:1],v[0:1],v[152:153],v[88:89]
v_pk_fma_f32 v[2:3],v[2:3],v[154:155],v[90:91]
v_pk_fma_f32 v[4:5],v[4:5],v[156:157],v[92:93]
v_pk_fma_f32 v[6:7],v[6:7],v[158:159],v[94:95]
v_pk_fma_f32 v[8:9],v[8:9],v[160:161],v[96:97]
v_pk_fma_f32 v[10:11],v[10:11],v[162:163],v[98:99]
v_pk_fma_f32 v[12:13],v[12:13],v[164:165],v[100:101]
v_pk_fma_f32 v[14:15],v[14:15],v[166:167],v[102:103]
v_pk_fma_f32 v[16:17],v[16:17],v[168:169],v[104:105]
v_pk_fma_f32 v[18:19],v[18:19],v[170:171],v[106:107]
v_pk_fma_f32 v[20:21],v[20:21],v[172:173],v[108:109]
v_pk_fma_f32 v[22:23],v[22:23],v[174:175],v[110:111]
v_pk_fma_f32 v[24:25],v[24:25],v[176:177],v[112:113]
bl v240,s[16:19],s54 offen offset:2048 lds
v_pk_fma_f32 v[26:27],v[26:27],v[178:179],v[114:115]
v_pk_fma_f32 v[28:29],v[28:29],v[180:181],v[116:117]
v_pk_fma_f32 v[30:31],v[30:31],v[182:183],v[118:119]
v_pk_add_f32 v[200:201],v[0:1],v[2:3]
v_pk_add_f32 v[202:203],v[4:5],v[6:7]
v_pk_add_f32 v[200:201],v[200:201],v[8:9]
v_pk_add_f32 v[202:203],v[202:203],v[10:11]
v_pk_add_f32 v[200:201],v[200:201],v[12:13]
v_pk_add_f32 v[202:203],v[202:203],v[14:15]
v_pk_add_f32 v[200:201],v[200:201],v[16:17]
v_pk_add_f32 v[202:203],v[202:203],v[18:19]
v_pk_add_f32 v[200:201],v[200:201],v[20:21]
v_pk_add_f32 v[202:203],v[202:203],v[22:23]
v_pk_add_f32 v[200:201],v[200:201],v[24:25]
v_pk_add_f32 v[202:203],v[202:203],v[26:27]
v_pk_add_f32 v[200:201],v[200:201],v[28:29]
v_pk_add_f32 v[202:203],v[202:203],v[30:31]
v_pk_add_f32 v[200:201],v[200:201],v[202:203]
v_add_f32 v200,v200,v201
bl v241,s[16:19],s54 offen offset:3072 lds
s_nop 0
v_add_f32_dpp v200,v200,v200 row_ror:8 row_mask:0xf bank_mask:0xf
v_mov_b32 v201,v200
s_nop 1
v_permlane16_swap_b32 v201,v200
v_add_f32 v200,v200,v201
v_mov_b32 v201,v200
s_nop 1
v_permlane32_swap_b32 v201,v200
v_add_f32 v200,v200,v201
v_mul_f32 v200,0x3b800000,v200
v_pk_add_f32 v[32:33],v[0:1],v[200:201] op_sel_hi:[1,0] neg_lo:[0,1] neg_hi:[0,1]
v_pk_add_f32 v[34:35],v[2:3],v[200:201] op_sel_hi:[1,0] neg_lo:[0,1] neg_hi:[0,1]
v_pk_add_f32 v[36:37],v[4:5],v[200:201] op_sel_hi:[1,0] neg_lo:[0,1] neg_hi:[0,1]
v_pk_add_f32 v[38:39],v[6:7],v[200:201] op_sel_hi:[1,0] neg_lo:[0,1] neg_hi:[0,1]
v_pk_add_f32 v[40:41],v[8:9],v[200:201] op_sel_hi:[1,0] neg_lo:[0,1] neg_hi:[0,1]
v_pk_add_f32 v[42:43],v[10:11],v[200:201] op_sel_hi:[1,0] neg_lo:[0,1] neg_hi:[0,1]
v_pk_add_f32 v[44:45],v[12:13],v[200:201] op_sel_hi:[1,0] neg_lo:[0,1] neg_hi:[0,1]
v_pk_add_f32 v[46:47],v[14:15],v[200:201] op_sel_hi:[1,0] neg_lo:[0,1] neg_hi:[0,1]
v_pk_add_f32 v[48:49],v[16:17],v[200:201] op_sel_hi:[1,0] neg_lo:[0,1] neg_hi:[0,1]
v_pk_add_f32 v[50:51],v[18:19],v[200:201] op_sel_hi:[1,0] neg_lo:[0,1] neg_hi:[0,1]
s_add_u32 m0,s51,90112
v_pk_add_f32 v[52:53],v[20:21],v[200:201] op_sel_hi:[1,0] neg_lo:[0,1] neg_hi:[0,1]
v_pk_add_f32 v[54:55],v[22:23],v[200:201] op_sel_hi:[1,0] neg_lo:[0,1] neg_hi:[0,1]
v_pk_add_f32 v[56:57],v[24:25],v[200:201] op_sel_hi:[1,0] neg_lo:[0,1] neg_hi:[0,1]
v_pk_add_f32 v[58:59],v[26:27],v[200:201] op_sel_hi:[1,0] neg_lo:[0,1] neg_hi:[0,1]
v_pk_add_f32 v[60:61],v[28:29],v[200:201] op_sel_hi:[1,0] neg_lo:[0,1] neg_hi:[0,1]
v_pk_add_f32 v[62:63],v[30:31],v[200:201] op_sel_hi:[1,0] neg_lo:[0,1] neg_hi:[0,1]
v_pk_mul_f32 v[202:203],v[32:33],v[32:33]
v_pk_fma_f32 v[202:203],v[34:35],v[34:35],v[202:203]
v_pk_fma_f32 v[202:203],v[36:37],v[36:37],v[202:203]
v_pk_fma_f32 v[202:203],v[38:39],v[38:39],v[202:203]
v_pk_fma_f32 v[202:203],v[40:41],v[40:41],v[202:203]
v_pk_fma_f32 v[202:203],v[42:43],v[42:43],v[202:203]
v_pk_fma_f32 v[202:203],v[44:45],v[44:45],v[202:203]
v_pk_fma_f32 v[202:203],v[46:47],v[46:47],v[202:203]
v_pk_fma_f32 v[202:203],v[48:49],v[48:49],v[202:203]
v_pk_fma_f32 v[202:203],v[50:51],v[50:51],v[202:203]
v_pk_fma_f32 v[202:203],v[52:53],v[52:53],v[202:203]
v_pk_fma_f32 v[202:203],v[54:55],v[54:55],v[202:203]
bl v242,s[16:19],s54 offen offset:0 lds
v_pk_fma_f32 v[202:203],v[56:57],v[56:57],v[202:203]
v_pk_fma_f32 v[202:203],v[58:59],v[58:59],v[202:203]
v_pk_fma_f32 v[202:203],v[60:61],v[60:61],v[202:203]
v_pk_fma_f32 v[202:203],v[62:63],v[62:63],v[202:203]
v_add_f32 v201,v202,v203
s_nop 1
v_add_f32_dpp v201,v201,v201 row_ror:8 row_mask:0xf bank_mask:0xf
v_mov_b32 v202,v201
s_nop 1
v_permlane16_swap_b32 v202,v201
v_add_f32 v201,v201,v202
v_mov_b32 v202,v201
s_nop 1
v_permlane32_swap_b32 v202,v201
v_add_f32 v201,v201,v202
ds_write_b64 v206,v[200:201] offset:256
s_waitcnt lgkmcnt(0)
s_barrier
ds_read_b128 v[32:35],v207 offset:256
ds_read_b128 v[36:39],v207 offset:272
s_waitcnt lgkmcnt(1)
v_add_f32 v200,v32,v34
v_add_f32 v201,v33,v35
bl v243,s[16:19],s54 offen offset:1024 lds
s_waitcnt lgkmcnt(0)
v_add_f32 v200,v200,v36
v_add_f32 v201,v201,v37
v_add_f32 v200,v200,v38
v_add_f32 v201,v201,v39
v_mul_f32 v200,0x3e800000,v200
v_sub_f32 v32,v32,v200
v_sub_f32 v34,v34,v200
v_sub_f32 v36,v36,v200
v_sub_f32 v38,v38,v200
v_mul_f32 v202,v32,v32
v_fmac_f32 v202,v34,v34
v_fmac_f32 v202,v36,v36
v_fmac_f32 v202,v38,v38
v_mul_f32 v201,0x3a800000,v201
v_fmac_f32 v201,0x3e800000,v202
cv v200,v200,v200
v_lshlrev_b32 v200,16,v200
cv v201,v201,v201
bl v244,s[16:19],s54 offen offset:2048 lds
v_lshlrev_b32 v201,16,v201
v_add_f32 v201,0x3727c5ac,v201
cv v201,v201,v201
v_lshlrev_b32 v201,16,v201
v_sqrt_f32 v201,v201
s_nop 0
cv v201,v201,v201
v_lshlrev_b32 v201,16,v201
v_rcp_f32 v202,v201
v_pk_add_f32 v[0:1],v[0:1],v[200:201] op_sel_hi:[1,0] neg_lo:[0,1] neg_hi:[0,1]
v_pk_add_f32 v[2:3],v[2:3],v[200:201] op_sel_hi:[1,0] neg_lo:[0,1] neg_hi:[0,1]
v_pk_add_f32 v[4:5],v[4:5],v[200:201] op_sel_hi:[1,0] neg_lo:[0,1] neg_hi:[0,1]
v_pk_add_f32 v[6:7],v[6:7],v[200:201] op_sel_hi:[1,0] neg_lo:[0,1] neg_hi:[0,1]
v_pk_add_f32 v[8:9],v[8:9],v[200:201] op_sel_hi:[1,0] neg_lo:[0,1] neg_hi:[0,1]
v_pk_add_f32 v[10:11],v[10:11],v[200:201] op_sel_hi:[1,0] neg_lo:[0,1] neg_hi:[0,1]
v_pk_add_f32 v[12:13],v[12:13],v[200:201] op_sel_hi:[1,0] neg_lo:[0,1] neg_hi:[0,1]
v_pk_add_f32 v[14:15],v[14:15],v[200:201] op_sel_hi:[1,0] neg_lo:[0,1] neg_hi:[0,1]
v_pk_add_f32 v[16:17],v[16:17],v[200:201] op_sel_hi:[1,0] neg_lo:[0,1] neg_hi:[0,1]
v_pk_add_f32 v[18:19],v[18:19],v[200:201] op_sel_hi:[1,0] neg_lo:[0,1] neg_hi:[0,1]
s_add_u32 s54,s54,458752
v_pk_add_f32 v[20:21],v[20:21],v[200:201] op_sel_hi:[1,0] neg_lo:[0,1] neg_hi:[0,1]
v_pk_add_f32 v[22:23],v[22:23],v[200:201] op_sel_hi:[1,0] neg_lo:[0,1] neg_hi:[0,1]
v_pk_add_f32 v[24:25],v[24:25],v[200:201] op_sel_hi:[1,0] neg_lo:[0,1] neg_hi:[0,1]
v_pk_add_f32 v[26:27],v[26:27],v[200:201] op_sel_hi:[1,0] neg_lo:[0,1] neg_hi:[0,1]
v_pk_add_f32 v[28:29],v[28:29],v[200:201] op_sel_hi:[1,0] neg_lo:[0,1] neg_hi:[0,1]
v_pk_add_f32 v[30:31],v[30:31],v[200:201] op_sel_hi:[1,0] neg_lo:[0,1] neg_hi:[0,1]
v_pk_mul_f32 v[0:1],v[0:1],v[202:203] op_sel_hi:[1,0]
v_pk_mul_f32 v[2:3],v[2:3],v[202:203] op_sel_hi:[1,0]
v_pk_mul_f32 v[4:5],v[4:5],v[202:203] op_sel_hi:[1,0]
v_pk_mul_f32 v[6:7],v[6:7],v[202:203] op_sel_hi:[1,0]
v_pk_mul_f32 v[8:9],v[8:9],v[202:203] op_sel_hi:[1,0]
v_pk_mul_f32 v[10:11],v[10:11],v[202:203] op_sel_hi:[1,0]
v_pk_mul_f32 v[12:13],v[12:13],v[202:203] op_sel_hi:[1,0]
v_pk_mul_f32 v[14:15],v[14:15],v[202:203] op_sel_hi:[1,0]
v_pk_mul_f32 v[16:17],v[16:17],v[202:203] op_sel_hi:[1,0]
v_pk_mul_f32 v[18:19],v[18:19],v[202:203] op_sel_hi:[1,0]
v_pk_mul_f32 v[20:21],v[20:21],v[202:203] op_sel_hi:[1,0]
v_pk_mul_f32 v[22:23],v[22:23],v[202:203] op_sel_hi:[1,0]
v_pk_mul_f32 v[24:25],v[24:25],v[202:203] op_sel_hi:[1,0]
v_pk_mul_f32 v[26:27],v[26:27],v[202:203] op_sel_hi:[1,0]
v_pk_mul_f32 v[28:29],v[28:29],v[202:203] op_sel_hi:[1,0]
v_pk_mul_f32 v[30:31],v[30:31],v[202:203] op_sel_hi:[1,0]
cv v32,v0,v1
cv v33,v2,v3
cv v34,v4,v5
cv v35,v6,v7
cv v36,v8,v9
cv v37,v10,v11
cv v38,v12,v13
cv v39,v14,v15
cv v40,v16,v17
cv v41,v18,v19
cv v42,v20,v21
cv v43,v22,v23
cv v44,v24,v25
cv v45,v26,v27
cv v46,v28,v29
cv v47,v30,v31
s_add_u32 s24,s53,48234496
buffer_store_dwordx4 v[32:35],v251,s[8:11],s24 offen offset:0 sc1
buffer_store_dwordx4 v[36:39],v251,s[8:11],s24 offen offset:2048 sc1
s_add_u32 s24,s24,4096
buffer_store_dwordx4 v[40:43],v251,s[8:11],s24 offen offset:0 sc1
buffer_store_dwordx4 v[44:47],v251,s[8:11],s24 offen offset:2048 sc1
s_lshl_b32 s48,s21,18
s_add_u32 s48,s48,48234496
ar v64,a168
ar v65,a169
ar v66,a170
ar v67,a171
ar v68,a172
ar v69,a173
ar v70,a174
ar v71,a175
ar v72,a176
ar v73,a177
ar v74,a178
ar v75,a179
ar v76,a180
ar v77,a181
ar v78,a182
ar v79,a183
ar v80,a184
ar v81,a185
ar v82,a186
ar v83,a187
ar v84,a188
ar v85,a189
ar v86,a190
ar v87,a191
ar v88,a192
ar v89,a193
ar v90,a194
ar v91,a195
v_and_b32 v121,0xffff0000,v64
v_lshlrev_b32 v120,16,v64
v_and_b32 v123,0xffff0000,v65
v_lshlrev_b32 v122,16,v65
v_and_b32 v125,0xffff0000,v66
v_lshlrev_b32 v124,16,v66
v_and_b32 v127,0xffff0000,v67
v_lshlrev_b32 v126,16,v67
v_and_b32 v129,0xffff0000,v68
v_lshlrev_b32 v128,16,v68
v_and_b32 v131,0xffff0000,v69
v_lshlrev_b32 v130,16,v69
v_and_b32 v133,0xffff0000,v70
v_lshlrev_b32 v132,16,v70
v_and_b32 v135,0xffff0000,v71
v_lshlrev_b32 v134,16,v71
v_and_b32 v137,0xffff0000,v72
v_lshlrev_b32 v136,16,v72
v_and_b32 v139,0xffff0000,v73
v_lshlrev_b32 v138,16,v73
v_and_b32 v141,0xffff0000,v74
v_lshlrev_b32 v140,16,v74
v_and_b32 v143,0xffff0000,v75
v_lshlrev_b32 v142,16,v75
v_and_b32 v145,0xffff0000,v76
v_lshlrev_b32 v144,16,v76
v_and_b32 v147,0xffff0000,v77
v_lshlrev_b32 v146,16,v77
v_and_b32 v149,0xffff0000,v78
v_lshlrev_b32 v148,16,v78
v_and_b32 v151,0xffff0000,v79
v_lshlrev_b32 v150,16,v79
v_and_b32 v153,0xffff0000,v80
v_lshlrev_b32 v152,16,v80
v_and_b32 v155,0xffff0000,v81
v_lshlrev_b32 v154,16,v81
v_and_b32 v157,0xffff0000,v82
v_lshlrev_b32 v156,16,v82
v_and_b32 v159,0xffff0000,v83
v_lshlrev_b32 v158,16,v83
v_and_b32 v161,0xffff0000,v84
v_lshlrev_b32 v160,16,v84
v_and_b32 v163,0xffff0000,v85
v_lshlrev_b32 v162,16,v85
v_and_b32 v165,0xffff0000,v86
v_lshlrev_b32 v164,16,v86
v_and_b32 v167,0xffff0000,v87
v_lshlrev_b32 v166,16,v87
v_and_b32 v169,0xffff0000,v88
v_lshlrev_b32 v168,16,v88
v_and_b32 v171,0xffff0000,v89
v_lshlrev_b32 v170,16,v89
v_and_b32 v173,0xffff0000,v90
v_lshlrev_b32 v172,16,v90
v_and_b32 v175,0xffff0000,v91
v_lshlrev_b32 v174,16,v91
s_lshl_b32 s24,s21,3
s_lshl_b32 s25,s20,1
s_add_u32 s24,s24,s25
s_mul_i32 s24,s24,112
s_mul_i32 s25,s22,7
s_add_u32 s24,s24,s25
s_lshl_b32 s27,s24,10
s_add_u32 s27,s27,33554432
s_waitcnt vmcnt(0)
v_mov_b32 v204,0
v_mov_b32 v205,1
s_barrier
s_cmp_lg_u32 s20,0
s_cbranch_scc1 tail_gb2_a
s_mov_b64 exec,1
buffer_atomic_add v205,v204,s[8:11],s57 offen offset:512 sc1
s_mov_b64 exec,-1
tail_gb2_a:
s_cmp_lg_u32 s20,0
s_cbranch_scc1 tail_gb2_w
s_mov_b64 exec,1
s_mov_b32 s59,0x40000
tail_gb2_p:
buffer_load_dword v206,v204,s[8:11],s57 offen offset:512 sc1
s_waitcnt vmcnt(0)
v_readfirstlane_b32 s60,v206
s_sub_u32 s59,s59,1
s_cmp_eq_u32 s59,0
s_cbranch_scc1 tail_gb2_g
s_cmp_lt_u32 s60,16
s_cbranch_scc1 tail_gb2_p
tail_gb2_g:
s_mov_b64 exec,-1
tail_gb2_w:
s_barrier
bl a[0:3],v236,s[8:11],s48 offen offset:0 sc1
bl a[4:7],v237,s[8:11],s48 offen offset:0 sc1
bl a[8:11],v236,s[8:11],s48 offen offset:1024 sc1
bl a[12:15],v237,s[8:11],s48 offen offset:1024 sc1
s_add_u32 s48,s48,2048
bl a[16:19],v236,s[8:11],s48 offen offset:0 sc1
bl a[20:23],v237,s[8:11],s48 offen offset:0 sc1
bl a[24:27],v236,s[8:11],s48 offen offset:1024 sc1
bl a[28:31],v237,s[8:11],s48 offen offset:1024 sc1
s_add_u32 s48,s48,2048
s_waitcnt vmcnt(4)
s_barrier
tr a[128:129],v245 offset:0
tr a[130:131],v245 offset:7168
tr a[132:133],v245 offset:14336
tr a[134:135],v245 offset:21504
tr a[136:137],v246 offset:0
tr a[138:139],v246 offset:7168
tr a[140:141],v246 offset:14336
tr a[142:143],v246 offset:21504
tr a[144:145],v245 offset:64
tr a[146:147],v245 offset:7232
tr a[148:149],v245 offset:14400
tr a[150:151],v245 offset:21568
s_waitcnt lgkmcnt(8)
mm v[0:3],a[128:131],a[0:3],v[120:123]
tr a[152:153],v246 offset:64
bl a[32:35],v236,s[8:11],s48 offen offset:0 sc1
mm v[0:3],a[132:135],a[8:11],v[0:3]
tr a[154:155],v246 offset:7232
mm v[4:7],a[128:131],a[4:7],v[120:123]
tr a[156:157],v246 offset:14400
mm v[4:7],a[132:135],a[12:15],v[4:7]
tr a[158:159],v246 offset:21568
s_waitcnt lgkmcnt(8)
mm v[8:11],a[136:139],a[0:3],v[124:127]
tr a[160:161],v245 offset:128
mm v[8:11],a[140:143],a[8:11],v[8:11]
tr a[162:163],v245 offset:7296
bl a[36:39],v237,s[8:11],s48 offen offset:0 sc1
mm v[12:15],a[136:139],a[4:7],v[124:127]
tr a[164:165],v245 offset:14464
mm v[12:15],a[140:143],a[12:15],v[12:15]
tr a[166:167],v245 offset:21632
s_waitcnt lgkmcnt(8)
mm v[16:19],a[144:147],a[0:3],v[128:131]
tr a[128:129],v246 offset:128
mm v[16:19],a[148:151],a[8:11],v[16:19]
tr a[130:131],v246 offset:7296
mm v[20:23],a[144:147],a[4:7],v[128:131]
tr a[132:133],v246 offset:14464
bl a[40:43],v236,s[8:11],s48 offen offset:1024 sc1
mm v[20:23],a[148:151],a[12:15],v[20:23]
tr a[134:135],v246 offset:21632
s_waitcnt lgkmcnt(8)
mm v[24:27],a[152:155],a[0:3],v[132:135]
tr a[136:137],v245 offset:192
mm v[24:27],a[156:159],a[8:11],v[24:27]
tr a[138:139],v245 offset:7360
mm v[28:31],a[152:155],a[4:7],v[132:135]
tr a[140:141],v245 offset:14528
mm v[28:31],a[156:159],a[12:15],v[28:31]
tr a[142:143],v245 offset:21696
s_waitcnt lgkmcnt(8)
mm v[32:35],a[160:163],a[0:3],v[136:139]
tr a[144:145],v246 offset:192
bl a[44:47],v237,s[8:11],s48 offen offset:1024 sc1
mm v[32:35],a[164:167],a[8:11],v[32:35]
tr a[146:147],v246 offset:7360
s_add_u32 s48,s48,2048
mm v[36:39],a[160:163],a[4:7],v[136:139]
tr a[148:149],v246 offset:14528
mm v[36:39],a[164:167],a[12:15],v[36:39]
tr a[150:151],v246 offset:21696
s_waitcnt lgkmcnt(8)
mm v[40:43],a[128:131],a[0:3],v[140:143]
tr a[152:153],v245 offset:256
bl a[48:51],v236,s[8:11],s48 offen offset:0 sc1
mm v[40:43],a[132:135],a[8:11],v[40:43]
tr a[154:155],v245 offset:7424
mm v[44:47],a[128:131],a[4:7],v[140:143]
tr a[156:157],v245 offset:14592
mm v[44:47],a[132:135],a[12:15],v[44:47]
tr a[158:159],v245 offset:21760
s_waitcnt lgkmcnt(8)
mm v[48:51],a[136:139],a[0:3],v[144:147]
tr a[160:161],v246 offset:256
mm v[48:51],a[140:143],a[8:11],v[48:51]
tr a[162:163],v246 offset:7424
bl a[52:55],v237,s[8:11],s48 offen offset:0 sc1
mm v[52:55],a[136:139],a[4:7],v[144:147]
tr a[164:165],v246 offset:14592
mm v[52:55],a[140:143],a[12:15],v[52:55]
tr a[166:167],v246 offset:21760
s_waitcnt lgkmcnt(8)
mm v[56:59],a[144:147],a[0:3],v[148:151]
tr a[128:129],v245 offset:320
mm v[56:59],a[148:151],a[8:11],v[56:59]
tr a[130:131],v245 offset:7488
mm v[60:63],a[144:147],a[4:7],v[148:151]
tr a[132:133],v245 offset:14656
bl a[56:59],v236,s[8:11],s48 offen offset:1024 sc1
mm v[60:63],a[148:151],a[12:15],v[60:63]
tr a[134:135],v245 offset:21824
s_waitcnt lgkmcnt(8)
mm v[64:67],a[152:155],a[0:3],v[152:155]
tr a[136:137],v246 offset:320
mm v[64:67],a[156:159],a[8:11],v[64:67]
tr a[138:139],v246 offset:7488
mm v[68:71],a[152:155],a[4:7],v[152:155]
tr a[140:141],v246 offset:14656
mm v[68:71],a[156:159],a[12:15],v[68:71]
tr a[142:143],v246 offset:21824
s_waitcnt lgkmcnt(8)
mm v[72:75],a[160:163],a[0:3],v[156:159]
tr a[144:145],v245 offset:384
bl a[60:63],v237,s[8:11],s48 offen offset:1024 sc1
mm v[72:75],a[164:167],a[8:11],v[72:75]
tr a[146:147],v245 offset:7552
s_add_u32 s48,s48,2048
mm v[76:79],a[160:163],a[4:7],v[156:159]
tr a[148:149],v245 offset:14720
mm v[76:79],a[164:167],a[12:15],v[76:79]
tr a[150:151],v245 offset:21888
s_waitcnt lgkmcnt(8)
mm v[80:83],a[128:131],a[0:3],v[160:163]
tr a[152:153],v246 offset:384
mm v[80:83],a[132:135],a[8:11],v[80:83]
tr a[154:155],v246 offset:7552
s_waitcnt vmcnt(8)
mm v[84:87],a[128:131],a[4:7],v[160:163]
tr a[156:157],v246 offset:14720
s_barrier
mm v[84:87],a[132:135],a[12:15],v[84:87]
s_add_u32 m0,s51,114688
s_waitcnt lgkmcnt(7)
mm v[88:91],a[136:139],a[0:3],v[164:167]
tr a[158:159],v246 offset:21888
bl v238,s[16:19],s54 offen offset:0 lds
mm v[88:91],a[140:143],a[8:11],v[88:91]
tr a[160:161],v245 offset:28672
mm v[92:95],a[136:139],a[4:7],v[164:167]
tr a[162:163],v245 offset:35840
mm v[92:95],a[140:143],a[12:15],v[92:95]
tr a[164:165],v245 offset:43008
s_waitcnt lgkmcnt(7)
mm v[96:99],a[144:147],a[0:3],v[168:171]
tr a[166:167],v245 offset:50176
bl v239,s[16:19],s54 offen offset:1024 lds
mm v[96:99],a[148:151],a[8:11],v[96:99]
tr a[128:129],v246 offset:28672
mm v[100:103],a[144:147],a[4:7],v[168:171]
tr a[130:131],v246 offset:35840
mm v[100:103],a[148:151],a[12:15],v[100:103]
tr a[132:133],v246 offset:43008
s_waitcnt lgkmcnt(7)
mm v[104:107],a[152:155],a[0:3],v[172:175]
tr a[134:135],v246 offset:50176
mm v[104:107],a[156:159],a[8:11],v[104:107]
tr a[136:137],v245 offset:28736
bl v240,s[16:19],s54 offen offset:2048 lds
mm v[108:111],a[152:155],a[4:7],v[172:175]
tr a[138:139],v245 offset:35904
mm v[108:111],a[156:159],a[12:15],v[108:111]
tr a[140:141],v245 offset:43072
s_waitcnt lgkmcnt(7)
mm v[0:3],a[160:163],a[16:19],v[0:3]
tr a[142:143],v245 offset:50240
mm v[0:3],a[164:167],a[24:27],v[0:3]
tr a[144:145],v246 offset:28736
mm v[4:7],a[160:163],a[20:23],v[4:7]
tr a[146:147],v246 offset:35904
bl v241,s[16:19],s54 offen offset:3072 lds
mm v[4:7],a[164:167],a[28:31],v[4:7]
tr a[148:149],v246 offset:43072
s_waitcnt lgkmcnt(7)
mm v[8:11],a[128:131],a[16:19],v[8:11]
tr a[150:151],v246 offset:50240
s_add_u32 m0,s51,118784
mm v[8:11],a[132:135],a[24:27],v[8:11]
tr a[152:153],v245 offset:28800
mm v[12:15],a[128:131],a[20:23],v[12:15]
tr a[154:155],v245 offset:35968
mm v[12:15],a[132:135],a[28:31],v[12:15]
tr a[156:157],v245 offset:43136
s_waitcnt lgkmcnt(7)
mm v[16:19],a[136:139],a[16:19],v[16:19]
tr a[158:159],v245 offset:50304
bl v242,s[16:19],s54 offen offset:0 lds
mm v[16:19],a[140:143],a[24:27],v[16:19]
tr a[160:161],v246 offset:28800
mm v[20:23],a[136:139],a[20:23],v[20:23]
tr a[162:163],v246 offset:35968
mm v[20:23],a[140:143],a[28:31],v[20:23]
tr a[164:165],v246 offset:43136
s_waitcnt lgkmcnt(7)
mm v[24:27],a[144:147],a[16:19],v[24:27]
tr a[166:167],v246 offset:50304
bl v243,s[16:19],s54 offen offset:1024 lds
mm v[24:27],a[148:151],a[24:27],v[24:27]
tr a[128:129],v245 offset:28864
mm v[28:31],a[144:147],a[20:23],v[28:31]
tr a[130:131],v245 offset:36032
mm v[28:31],a[148:151],a[28:31],v[28:31]
tr a[132:133],v245 offset:43200
s_waitcnt lgkmcnt(7)
mm v[32:35],a[152:155],a[16:19],v[32:35]
tr a[134:135],v245 offset:50368
bl v244,s[16:19],s54 offen offset:2048 lds
mm v[32:35],a[156:159],a[24:27],v[32:35]
tr a[136:137],v246 offset:28864
s_add_u32 s54,s54,458752
mm v[36:39],a[152:155],a[20:23],v[36:39]
tr a[138:139],v246 offset:36032
mm v[36:39],a[156:159],a[28:31],v[36:39]
tr a[140:141],v246 offset:43200
s_waitcnt lgkmcnt(7)
mm v[40:43],a[160:163],a[16:19],v[40:43]
tr a[142:143],v246 offset:50368
mm v[40:43],a[164:167],a[24:27],v[40:43]
tr a[144:145],v245 offset:28928
bl a[64:67],v236,s[8:11],s48 offen offset:0 sc1
mm v[44:47],a[160:163],a[20:23],v[44:47]
tr a[146:147],v245 offset:36096
mm v[44:47],a[164:167],a[28:31],v[44:47]
tr a[148:149],v245 offset:43264
s_waitcnt lgkmcnt(7)
mm v[48:51],a[128:131],a[16:19],v[48:51]
tr a[150:151],v245 offset:50432
mm v[48:51],a[132:135],a[24:27],v[48:51]
tr a[152:153],v246 offset:28928
mm v[52:55],a[128:131],a[20:23],v[52:55]
tr a[154:155],v246 offset:36096
bl a[68:71],v237,s[8:11],s48 offen offset:0 sc1
mm v[52:55],a[132:135],a[28:31],v[52:55]
tr a[156:157],v246 offset:43264
s_waitcnt lgkmcnt(7)
mm v[56:59],a[136:139],a[16:19],v[56:59]
tr a[158:159],v246 offset:50432
mm v[56:59],a[140:143],a[24:27],v[56:59]
tr a[160:161],v245 offset:28992
mm v[60:63],a[136:139],a[20:23],v[60:63]
tr a[162:163],v245 offset:36160
mm v[60:63],a[140:143],a[28:31],v[60:63]
tr a[164:165],v245 offset:43328
s_waitcnt lgkmcnt(7)
mm v[64:67],a[144:147],a[16:19],v[64:67]
tr a[166:167],v245 offset:50496
bl a[72:75],v236,s[8:11],s48 offen offset:1024 sc1
mm v[64:67],a[148:151],a[24:27],v[64:67]
tr a[128:129],v246 offset:28992
mm v[68:71],a[144:147],a[20:23],v[68:71]
tr a[130:131],v246 offset:36160
mm v[68:71],a[148:151],a[28:31],v[68:71]
tr a[132:133],v246 offset:43328
s_waitcnt lgkmcnt(7)
mm v[72:75],a[152:155],a[16:19],v[72:75]
tr a[134:135],v246 offset:50496
bl a[76:79],v237,s[8:11],s48 offen offset:1024 sc1
mm v[72:75],a[156:159],a[24:27],v[72:75]
tr a[136:137],v245 offset:29056
s_add_u32 s48,s48,2048
mm v[76:79],a[152:155],a[20:23],v[76:79]
tr a[138:139],v245 offset:36224
mm v[76:79],a[156:159],a[28:31],v[76:79]
tr a[140:141],v245 offset:43392
s_waitcnt lgkmcnt(7)
mm v[80:83],a[160:163],a[16:19],v[80:83]
tr a[142:143],v245 offset:50560
mm v[80:83],a[164:167],a[24:27],v[80:83]
tr a[144:145],v246 offset:29056
s_waitcnt vmcnt(15)
mm v[84:87],a[160:163],a[20:23],v[84:87]
tr a[146:147],v246 offset:36224
s_barrier
mm v[84:87],a[164:167],a[28:31],v[84:87]
s_add_u32 m0,s51,0
s_waitcnt lgkmcnt(6)
mm v[88:91],a[128:131],a[16:19],v[88:91]
tr a[148:149],v246 offset:43392
tr a[150:151],v246 offset:50560
mm v[88:91],a[132:135],a[24:27],v[88:91]
tr a[152:153],v247 offset:0
bl v238,s[16:19],s54 offen offset:0 lds
mm v[92:95],a[128:131],a[20:23],v[92:95]
tr a[154:155],v247 offset:7168
mm v[92:95],a[132:135],a[28:31],v[92:95]
tr a[156:157],v247 offset:14336
s_waitcnt lgkmcnt(7)
mm v[96:99],a[136:139],a[16:19],v[96:99]
tr a[158:159],v247 offset:21504
bl v239,s[16:19],s54 offen offset:1024 lds
mm v[96:99],a[140:143],a[24:27],v[96:99]
tr a[160:161],v248 offset:0
mm v[100:103],a[136:139],a[20:23],v[100:103]
tr a[162:163],v248 offset:7168
mm v[100:103],a[140:143],a[28:31],v[100:103]
tr a[164:165],v248 offset:14336
s_waitcnt lgkmcnt(7)
mm v[104:107],a[144:147],a[16:19],v[104:107]
tr a[166:167],v248 offset:21504
mm v[104:107],a[148:151],a[24:27],v[104:107]
tr a[128:129],v247 offset:64
bl v240,s[16:19],s54 offen offset:2048 lds
mm v[108:111],a[144:147],a[20:23],v[108:111]
tr a[130:131],v247 offset:7232
mm v[108:111],a[148:151],a[28:31],v[108:111]
tr a[132:133],v247 offset:14400
s_waitcnt lgkmcnt(7)
mm v[0:3],a[152:155],a[32:35],v[0:3]
tr a[134:135],v247 offset:21568
mm v[0:3],a[156:159],a[40:43],v[0:3]
tr a[136:137],v248 offset:64
mm v[4:7],a[152:155],a[36:39],v[4:7]
tr a[138:139],v248 offset:7232
bl v241,s[16:19],s54 offen offset:3072 lds
mm v[4:7],a[156:159],a[44:47],v[4:7]
tr a[140:141],v248 offset:14400
s_waitcnt lgkmcnt(7)
mm v[8:11],a[160:163],a[32:35],v[8:11]
tr a[142:143],v248 offset:21568
s_add_u32 m0,s51,4096
mm v[8:11],a[164:167],a[40:43],v[8:11]
tr a[144:145],v247 offset:128
mm v[12:15],a[160:163],a[36:39],v[12:15]
tr a[146:147],v247 offset:7296
mm v[12:15],a[164:167],a[44:47],v[12:15]
tr a[148:149],v247 offset:14464
s_waitcnt lgkmcnt(7)
mm v[16:19],a[128:131],a[32:35],v[16:19]
tr a[150:151],v247 offset:21632
bl v242,s[16:19],s54 offen offset:0 lds
mm v[16:19],a[132:135],a[40:43],v[16:19]
tr a[152:153],v248 offset:128
mm v[20:23],a[128:131],a[36:39],v[20:23]
tr a[154:155],v248 offset:7296
mm v[20:23],a[132:135],a[44:47],v[20:23]
tr a[156:157],v248 offset:14464
s_waitcnt lgkmcnt(7)
mm v[24:27],a[136:139],a[32:35],v[24:27]
tr a[158:159],v248 offset:21632
bl v243,s[16:19],s54 offen offset:1024 lds
mm v[24:27],a[140:143],a[40:43],v[24:27]
tr a[160:161],v247 offset:192
mm v[28:31],a[136:139],a[36:39],v[28:31]
tr a[162:163],v247 offset:7360
mm v[28:31],a[140:143],a[44:47],v[28:31]
tr a[164:165],v247 offset:14528
s_waitcnt lgkmcnt(7)
mm v[32:35],a[144:147],a[32:35],v[32:35]
tr a[166:167],v247 offset:21696
bl v244,s[16:19],s54 offen offset:2048 lds
mm v[32:35],a[148:151],a[40:43],v[32:35]
tr a[128:129],v248 offset:192
s_add_u32 s54,s54,458752
mm v[36:39],a[144:147],a[36:39],v[36:39]
tr a[130:131],v248 offset:7360
mm v[36:39],a[148:151],a[44:47],v[36:39]
tr a[132:133],v248 offset:14528
s_waitcnt lgkmcnt(7)
mm v[40:43],a[152:155],a[32:35],v[40:43]
tr a[134:135],v248 offset:21696
mm v[40:43],a[156:159],a[40:43],v[40:43]
tr a[136:137],v247 offset:256
bl a[0:3],v236,s[8:11],s48 offen offset:0 sc1
mm v[44:47],a[152:155],a[36:39],v[44:47]
tr a[138:139],v247 offset:7424
mm v[44:47],a[156:159],a[44:47],v[44:47]
tr a[140:141],v247 offset:14592
s_waitcnt lgkmcnt(7)
mm v[48:51],a[160:163],a[32:35],v[48:51]
tr a[142:143],v247 offset:21760
mm v[48:51],a[164:167],a[40:43],v[48:51]
tr a[144:145],v248 offset:256
mm v[52:55],a[160:163],a[36:39],v[52:55]
tr a[146:147],v248 offset:7424
bl a[4:7],v237,s[8:11],s48 offen offset:0 sc1
mm v[52:55],a[164:167],a[44:47],v[52:55]
tr a[148:149],v248 offset:14592
s_waitcnt lgkmcnt(7)
mm v[56:59],a[128:131],a[32:35],v[56:59]
tr a[150:151],v248 offset:21760
mm v[56:59],a[132:135],a[40:43],v[56:59]
tr a[152:153],v247 offset:320
mm v[60:63],a[128:131],a[36:39],v[60:63]
tr a[154:155],v247 offset:7488
mm v[60:63],a[132:135],a[44:47],v[60:63]
tr a[156:157],v247 offset:14656
s_waitcnt lgkmcnt(7)
mm v[64:67],a[136:139],a[32:35],v[64:67]
tr a[158:159],v247 offset:21824
bl a[8:11],v236,s[8:11],s48 offen offset:1024 sc1
mm v[64:67],a[140:143],a[40:43],v[64:67]
tr a[160:161],v248 offset:320
mm v[68:71],a[136:139],a[36:39],v[68:71]
tr a[162:163],v248 offset:7488
mm v[68:71],a[140:143],a[44:47],v[68:71]
tr a[164:165],v248 offset:14656
s_waitcnt lgkmcnt(7)
mm v[72:75],a[144:147],a[32:35],v[72:75]
tr a[166:167],v248 offset:21824
bl a[12:15],v237,s[8:11],s48 offen offset:1024 sc1
mm v[72:75],a[148:151],a[40:43],v[72:75]
tr a[128:129],v247 offset:384
s_add_u32 s48,s48,2048
mm v[76:79],a[144:147],a[36:39],v[76:79]
tr a[130:131],v247 offset:7552
mm v[76:79],a[148:151],a[44:47],v[76:79]
tr a[132:133],v247 offset:14720
s_waitcnt lgkmcnt(7)
mm v[80:83],a[152:155],a[32:35],v[80:83]
tr a[134:135],v247 offset:21888
mm v[80:83],a[156:159],a[40:43],v[80:83]
tr a[136:137],v248 offset:384
s_waitcnt vmcnt(22)
mm v[84:87],a[152:155],a[36:39],v[84:87]
tr a[138:139],v248 offset:7552
s_barrier
mm v[84:87],a[156:159],a[44:47],v[84:87]
s_add_u32 m0,s51,28672
s_waitcnt lgkmcnt(6)
mm v[88:91],a[160:163],a[32:35],v[88:91]
tr a[140:141],v248 offset:14720
tr a[142:143],v248 offset:21888
mm v[88:91],a[164:167],a[40:43],v[88:91]
tr a[144:145],v247 offset:28672
bl v238,s[16:19],s54 offen offset:0 lds
mm v[92:95],a[160:163],a[36:39],v[92:95]
tr a[146:147],v247 offset:35840
mm v[92:95],a[164:167],a[44:47],v[92:95]
tr a[148:149],v247 offset:43008
s_waitcnt lgkmcnt(7)
mm v[96:99],a[128:131],a[32:35],v[96:99]
tr a[150:151],v247 offset:50176
bl v239,s[16:19],s54 offen offset:1024 lds
mm v[96:99],a[132:135],a[40:43],v[96:99]
tr a[152:153],v248 offset:28672
mm v[100:103],a[128:131],a[36:39],v[100:103]
tr a[154:155],v248 offset:35840
mm v[100:103],a[132:135],a[44:47],v[100:103]
tr a[156:157],v248 offset:43008
s_waitcnt lgkmcnt(7)
mm v[104:107],a[136:139],a[32:35],v[104:107]
tr a[158:159],v248 offset:50176
mm v[104:107],a[140:143],a[40:43],v[104:107]
tr a[160:161],v247 offset:28736
bl v240,s[16:19],s54 offen offset:2048 lds
mm v[108:111],a[136:139],a[36:39],v[108:111]
tr a[162:163],v247 offset:35904
mm v[108:111],a[140:143],a[44:47],v[108:111]
tr a[164:165],v247 offset:43072
s_waitcnt lgkmcnt(7)
mm v[0:3],a[144:147],a[48:51],v[0:3]
tr a[166:167],v247 offset:50240
mm v[0:3],a[148:151],a[56:59],v[0:3]
tr a[128:129],v248 offset:28736
mm v[4:7],a[144:147],a[52:55],v[4:7]
tr a[130:131],v248 offset:35904
bl v241,s[16:19],s54 offen offset:3072 lds
mm v[4:7],a[148:151],a[60:63],v[4:7]
tr a[132:133],v248 offset:43072
s_waitcnt lgkmcnt(7)
mm v[8:11],a[152:155],a[48:51],v[8:11]
tr a[134:135],v248 offset:50240
s_add_u32 m0,s51,32768
mm v[8:11],a[156:159],a[56:59],v[8:11]
tr a[136:137],v247 offset:28800
mm v[12:15],a[152:155],a[52:55],v[12:15]
tr a[138:139],v247 offset:35968
mm v[12:15],a[156:159],a[60:63],v[12:15]
tr a[140:141],v247 offset:43136
s_waitcnt lgkmcnt(7)
mm v[16:19],a[160:163],a[48:51],v[16:19]
tr a[142:143],v247 offset:50304
bl v242,s[16:19],s54 offen offset:0 lds
mm v[16:19],a[164:167],a[56:59],v[16:19]
tr a[144:145],v248 offset:28800
mm v[20:23],a[160:163],a[52:55],v[20:23]
tr a[146:147],v248 offset:35968
mm v[20:23],a[164:167],a[60:63],v[20:23]
tr a[148:149],v248 offset:43136
s_waitcnt lgkmcnt(7)
mm v[24:27],a[128:131],a[48:51],v[24:27]
tr a[150:151],v248 offset:50304
bl v243,s[16:19],s54 offen offset:1024 lds
mm v[24:27],a[132:135],a[56:59],v[24:27]
tr a[152:153],v247 offset:28864
mm v[28:31],a[128:131],a[52:55],v[28:31]
tr a[154:155],v247 offset:36032
mm v[28:31],a[132:135],a[60:63],v[28:31]
tr a[156:157],v247 offset:43200
s_waitcnt lgkmcnt(7)
mm v[32:35],a[136:139],a[48:51],v[32:35]
tr a[158:159],v247 offset:50368
bl v244,s[16:19],s54 offen offset:2048 lds
mm v[32:35],a[140:143],a[56:59],v[32:35]
tr a[160:161],v248 offset:28864
s_add_u32 s54,s54,458752
mm v[36:39],a[136:139],a[52:55],v[36:39]
tr a[162:163],v248 offset:36032
mm v[36:39],a[140:143],a[60:63],v[36:39]
tr a[164:165],v248 offset:43200
s_waitcnt lgkmcnt(7)
mm v[40:43],a[144:147],a[48:51],v[40:43]
tr a[166:167],v248 offset:50368
mm v[40:43],a[148:151],a[56:59],v[40:43]
tr a[128:129],v247 offset:28928
bl a[16:19],v236,s[8:11],s48 offen offset:0 sc1
mm v[44:47],a[144:147],a[52:55],v[44:47]
tr a[130:131],v247 offset:36096
mm v[44:47],a[148:151],a[60:63],v[44:47]
tr a[132:133],v247 offset:43264
s_waitcnt lgkmcnt(7)
mm v[48:51],a[152:155],a[48:51],v[48:51]
tr a[134:135],v247 offset:50432
mm v[48:51],a[156:159],a[56:59],v[48:51]
tr a[136:137],v248 offset:28928
mm v[52:55],a[152:155],a[52:55],v[52:55]
tr a[138:139],v248 offset:36096
bl a[20:23],v237,s[8:11],s48 offen offset:0 sc1
mm v[52:55],a[156:159],a[60:63],v[52:55]
tr a[140:141],v248 offset:43264
s_waitcnt lgkmcnt(7)
mm v[56:59],a[160:163],a[48:51],v[56:59]
tr a[142:143],v248 offset:50432
mm v[56:59],a[164:167],a[56:59],v[56:59]
tr a[144:145],v247 offset:28992
mm v[60:63],a[160:163],a[52:55],v[60:63]
tr a[146:147],v247 offset:36160
mm v[60:63],a[164:167],a[60:63],v[60:63]
tr a[148:149],v247 offset:43328
s_waitcnt lgkmcnt(7)
mm v[64:67],a[128:131],a[48:51],v[64:67]
tr a[150:151],v247 offset:50496
bl a[24:27],v236,s[8:11],s48 offen offset:1024 sc1
mm v[64:67],a[132:135],a[56:59],v[64:67]
tr a[152:153],v248 offset:28992
mm v[68:71],a[128:131],a[52:55],v[68:71]
tr a[154:155],v248 offset:36160
mm v[68:71],a[132:135],a[60:63],v[68:71]
tr a[156:157],v248 offset:43328
s_waitcnt lgkmcnt(7)
mm v[72:75],a[136:139],a[48:51],v[72:75]
tr a[158:159],v248 offset:50496
bl a[28:31],v237,s[8:11],s48 offen offset:1024 sc1
mm v[72:75],a[140:143],a[56:59],v[72:75]
tr a[160:161],v247 offset:29056
s_add_u32 s48,s48,2048
mm v[76:79],a[136:139],a[52:55],v[76:79]
tr a[162:163],v247 offset:36224
mm v[76:79],a[140:143],a[60:63],v[76:79]
tr a[164:165],v247 offset:43392
s_waitcnt lgkmcnt(7)
mm v[80:83],a[144:147],a[48:51],v[80:83]
tr a[166:167],v247 offset:50560
mm v[80:83],a[148:151],a[56:59],v[80:83]
tr a[128:129],v248 offset:29056
s_waitcnt vmcnt(22)
mm v[84:87],a[144:147],a[52:55],v[84:87]
tr a[130:131],v248 offset:36224
s_barrier
mm v[84:87],a[148:151],a[60:63],v[84:87]
s_add_u32 m0,s51,57344
s_waitcnt lgkmcnt(6)
mm v[88:91],a[152:155],a[48:51],v[88:91]
tr a[132:133],v248 offset:43392
tr a[134:135],v248 offset:50560
mm v[88:91],a[156:159],a[56:59],v[88:91]
tr a[136:137],v249 offset:0
bl v238,s[16:19],s54 offen offset:0 lds
mm v[92:95],a[152:155],a[52:55],v[92:95]
tr a[138:139],v249 offset:7168
mm v[92:95],a[156:159],a[60:63],v[92:95]
tr a[140:141],v249 offset:14336
s_waitcnt lgkmcnt(7)
mm v[96:99],a[160:163],a[48:51],v[96:99]
tr a[142:143],v249 offset:21504
bl v239,s[16:19],s54 offen offset:1024 lds
mm v[96:99],a[164:167],a[56:59],v[96:99]
tr a[144:145],v250 offset:0
mm v[100:103],a[160:163],a[52:55],v[100:103]
tr a[146:147],v250 offset:7168
mm v[100:103],a[164:167],a[60:63],v[100:103]
tr a[148:149],v250 offset:14336
s_waitcnt lgkmcnt(7)
mm v[104:107],a[128:131],a[48:51],v[104:107]
tr a[150:151],v250 offset:21504
mm v[104:107],a[132:135],a[56:59],v[104:107]
tr a[152:153],v249 offset:64
bl v240,s[16:19],s54 offen offset:2048 lds
mm v[108:111],a[128:131],a[52:55],v[108:111]
tr a[154:155],v249 offset:7232
mm v[108:111],a[132:135],a[60:63],v[108:111]
tr a[156:157],v249 offset:14400
s_waitcnt lgkmcnt(7)
mm v[0:3],a[136:139],a[64:67],v[0:3]
tr a[158:159],v249 offset:21568
mm v[0:3],a[140:143],a[72:75],v[0:3]
tr a[160:161],v250 offset:64
mm v[4:7],a[136:139],a[68:71],v[4:7]
tr a[162:163],v250 offset:7232
bl v241,s[16:19],s54 offen offset:3072 lds
mm v[4:7],a[140:143],a[76:79],v[4:7]
tr a[164:165],v250 offset:14400
s_waitcnt lgkmcnt(7)
mm v[8:11],a[144:147],a[64:67],v[8:11]
tr a[166:167],v250 offset:21568
s_add_u32 m0,s51,61440
mm v[8:11],a[148:151],a[72:75],v[8:11]
tr a[128:129],v249 offset:128
mm v[12:15],a[144:147],a[68:71],v[12:15]
tr a[130:131],v249 offset:7296
mm v[12:15],a[148:151],a[76:79],v[12:15]
tr a[132:133],v249 offset:14464
s_waitcnt lgkmcnt(7)
mm v[16:19],a[152:155],a[64:67],v[16:19]
tr a[134:135],v249 offset:21632
bl v242,s[16:19],s54 offen offset:0 lds
mm v[16:19],a[156:159],a[72:75],v[16:19]
tr a[136:137],v250 offset:128
mm v[20:23],a[152:155],a[68:71],v[20:23]
tr a[138:139],v250 offset:7296
mm v[20:23],a[156:159],a[76:79],v[20:23]
tr a[140:141],v250 offset:14464
s_waitcnt lgkmcnt(7)
mm v[24:27],a[160:163],a[64:67],v[24:27]
tr a[142:143],v250 offset:21632
bl v243,s[16:19],s54 offen offset:1024 lds
mm v[24:27],a[164:167],a[72:75],v[24:27]
tr a[144:145],v249 offset:192
mm v[28:31],a[160:163],a[68:71],v[28:31]
tr a[146:147],v249 offset:7360
mm v[28:31],a[164:167],a[76:79],v[28:31]
tr a[148:149],v249 offset:14528
s_waitcnt lgkmcnt(7)
mm v[32:35],a[128:131],a[64:67],v[32:35]
tr a[150:151],v249 offset:21696
bl v244,s[16:19],s54 offen offset:2048 lds
mm v[32:35],a[132:135],a[72:75],v[32:35]
tr a[152:153],v250 offset:192
s_add_u32 s54,s54,458752
mm v[36:39],a[128:131],a[68:71],v[36:39]
tr a[154:155],v250 offset:7360
mm v[36:39],a[132:135],a[76:79],v[36:39]
tr a[156:157],v250 offset:14528
s_waitcnt lgkmcnt(7)
mm v[40:43],a[136:139],a[64:67],v[40:43]
tr a[158:159],v250 offset:21696
mm v[40:43],a[140:143],a[72:75],v[40:43]
tr a[160:161],v249 offset:256
bl a[32:35],v236,s[8:11],s48 offen offset:0 sc1
mm v[44:47],a[136:139],a[68:71],v[44:47]
tr a[162:163],v249 offset:7424
mm v[44:47],a[140:143],a[76:79],v[44:47]
tr a[164:165],v249 offset:14592
s_waitcnt lgkmcnt(7)
mm v[48:51],a[144:147],a[64:67],v[48:51]
tr a[166:167],v249 offset:21760
mm v[48:51],a[148:151],a[72:75],v[48:51]
tr a[128:129],v250 offset:256
mm v[52:55],a[144:147],a[68:71],v[52:55]
tr a[130:131],v250 offset:7424
bl a[36:39],v237,s[8:11],s48 offen offset:0 sc1
mm v[52:55],a[148:151],a[76:79],v[52:55]
tr a[132:133],v250 offset:14592
s_waitcnt lgkmcnt(7)
mm v[56:59],a[152:155],a[64:67],v[56:59]
tr a[134:135],v250 offset:21760
mm v[56:59],a[156:159],a[72:75],v[56:59]
tr a[136:137],v249 offset:320
mm v[60:63],a[152:155],a[68:71],v[60:63]
tr a[138:139],v249 offset:7488
mm v[60:63],a[156:159],a[76:79],v[60:63]
tr a[140:141],v249 offset:14656
s_waitcnt lgkmcnt(7)
mm v[64:67],a[160:163],a[64:67],v[64:67]
tr a[142:143],v249 offset:21824
bl a[40:43],v236,s[8:11],s48 offen offset:1024 sc1
mm v[64:67],a[164:167],a[72:75],v[64:67]
tr a[144:145],v250 offset:320
mm v[68:71],a[160:163],a[68:71],v[68:71]
tr a[146:147],v250 offset:7488
mm v[68:71],a[164:167],a[76:79],v[68:71]
tr a[148:149],v250 offset:14656
s_waitcnt lgkmcnt(7)
mm v[72:75],a[128:131],a[64:67],v[72:75]
tr a[150:151],v250 offset:21824
bl a[44:47],v237,s[8:11],s48 offen offset:1024 sc1
mm v[72:75],a[132:135],a[72:75],v[72:75]
tr a[152:153],v249 offset:384
s_add_u32 s48,s48,2048
mm v[76:79],a[128:131],a[68:71],v[76:79]
tr a[154:155],v249 offset:7552
mm v[76:79],a[132:135],a[76:79],v[76:79]
tr a[156:157],v249 offset:14720
s_waitcnt lgkmcnt(7)
mm v[80:83],a[136:139],a[64:67],v[80:83]
tr a[158:159],v249 offset:21888
mm v[80:83],a[140:143],a[72:75],v[80:83]
tr a[160:161],v250 offset:384
s_waitcnt vmcnt(22)
mm v[84:87],a[136:139],a[68:71],v[84:87]
tr a[162:163],v250 offset:7552
s_barrier
mm v[84:87],a[140:143],a[76:79],v[84:87]
s_add_u32 m0,s51,86016
s_waitcnt lgkmcnt(6)
mm v[88:91],a[144:147],a[64:67],v[88:91]
tr a[164:165],v250 offset:14720
tr a[166:167],v250 offset:21888
mm v[88:91],a[148:151],a[72:75],v[88:91]
tr a[128:129],v245 offset:0
bl v238,s[16:19],s54 offen offset:0 lds
mm v[92:95],a[144:147],a[68:71],v[92:95]
tr a[130:131],v245 offset:7168
mm v[92:95],a[148:151],a[76:79],v[92:95]
tr a[132:133],v245 offset:14336
s_waitcnt lgkmcnt(7)
mm v[96:99],a[152:155],a[64:67],v[96:99]
tr a[134:135],v245 offset:21504
mm v[96:99],a[156:159],a[72:75],v[96:99]
tr a[136:137],v246 offset:0
mm v[100:103],a[152:155],a[68:71],v[100:103]
tr a[138:139],v246 offset:7168
bl v239,s[16:19],s54 offen offset:1024 lds
mm v[100:103],a[156:159],a[76:79],v[100:103]
tr a[140:141],v246 offset:14336
s_waitcnt lgkmcnt(7)
mm v[104:107],a[160:163],a[64:67],v[104:107]
tr a[142:143],v246 offset:21504
mm v[104:107],a[164:167],a[72:75],v[104:107]
tr a[144:145],v245 offset:64
mm v[108:111],a[160:163],a[68:71],v[108:111]
tr a[146:147],v245 offset:7232
mm v[108:111],a[164:167],a[76:79],v[108:111]
tr a[148:149],v245 offset:14400
tr a[150:151],v245 offset:21568
s_waitcnt lgkmcnt(8)
mm v[0:3],a[128:131],a[0:3],v[0:3]
tr a[152:153],v246 offset:64
bl v240,s[16:19],s54 offen offset:2048 lds
mm v[0:3],a[132:135],a[8:11],v[0:3]
tr a[154:155],v246 offset:7232
mm v[4:7],a[128:131],a[4:7],v[4:7]
tr a[156:157],v246 offset:14400
mm v[4:7],a[132:135],a[12:15],v[4:7]
tr a[158:159],v246 offset:21568
s_waitcnt lgkmcnt(8)
mm v[8:11],a[136:139],a[0:3],v[8:11]
tr a[160:161],v245 offset:128
mm v[8:11],a[140:143],a[8:11],v[8:11]
tr a[162:163],v245 offset:7296
bl v241,s[16:19],s54 offen offset:3072 lds
mm v[12:15],a[136:139],a[4:7],v[12:15]
tr a[164:165],v245 offset:14464
s_add_u32 m0,s51,90112
mm v[12:15],a[140:143],a[12:15],v[12:15]
tr a[166:167],v245 offset:21632
s_waitcnt lgkmcnt(8)
mm v[16:19],a[144:147],a[0:3],v[16:19]
tr a[128:129],v246 offset:128
mm v[16:19],a[148:151],a[8:11],v[16:19]
tr a[130:131],v246 offset:7296
mm v[20:23],a[144:147],a[4:7],v[20:23]
tr a[132:133],v246 offset:14464
bl v242,s[16:19],s54 offen offset:0 lds
mm v[20:23],a[148:151],a[12:15],v[20:23]
tr a[134:135],v246 offset:21632
s_waitcnt lgkmcnt(8)
mm v[24:27],a[152:155],a[0:3],v[24:27]
tr a[136:137],v245 offset:192
mm v[24:27],a[156:159],a[8:11],v[24:27]
tr a[138:139],v245 offset:7360
mm v[28:31],a[152:155],a[4:7],v[28:31]
tr a[140:141],v245 offset:14528
mm v[28:31],a[156:159],a[12:15],v[28:31]
bl v243,s[16:19],s54 offen offset:1024 lds
s_waitcnt lgkmcnt(7)
mm v[32:35],a[160:163],a[0:3],v[32:35]
tr a[142:143],v245 offset:21696
mm v[32:35],a[164:167],a[8:11],v[32:35]
tr a[144:145],v246 offset:192
mm v[36:39],a[160:163],a[4:7],v[36:39]
tr a[146:147],v246 offset:7360
mm v[36:39],a[164:167],a[12:15],v[36:39]
tr a[148:149],v246 offset:14528
s_waitcnt lgkmcnt(7)
mm v[40:43],a[128:131],a[0:3],v[40:43]
tr a[150:151],v246 offset:21696
bl v244,s[16:19],s54 offen offset:2048 lds
mm v[40:43],a[132:135],a[8:11],v[40:43]
tr a[152:153],v245 offset:256
s_add_u32 s54,s54,458752
mm v[44:47],a[128:131],a[4:7],v[44:47]
tr a[154:155],v245 offset:7424
mm v[44:47],a[132:135],a[12:15],v[44:47]
tr a[156:157],v245 offset:14592
s_waitcnt lgkmcnt(7)
mm v[48:51],a[136:139],a[0:3],v[48:51]
tr a[158:159],v245 offset:21760
mm v[48:51],a[140:143],a[8:11],v[48:51]
tr a[160:161],v246 offset:256
bl a[48:51],v236,s[8:11],s48 offen offset:0 sc1
mm v[52:55],a[136:139],a[4:7],v[52:55]
tr a[162:163],v246 offset:7424
mm v[52:55],a[140:143],a[12:15],v[52:55]
tr a[164:165],v246 offset:14592
s_waitcnt lgkmcnt(7)
mm v[56:59],a[144:147],a[0:3],v[56:59]
tr a[166:167],v246 offset:21760
mm v[56:59],a[148:151],a[8:11],v[56:59]
tr a[128:129],v245 offset:320
mm v[60:63],a[144:147],a[4:7],v[60:63]
tr a[130:131],v245 offset:7488
bl a[52:55],v237,s[8:11],s48 offen offset:0 sc1
mm v[60:63],a[148:151],a[12:15],v[60:63]
tr a[132:133],v245 offset:14656
s_waitcnt lgkmcnt(7)
mm v[64:67],a[152:155],a[0:3],v[64:67]
tr a[134:135],v245 offset:21824
mm v[64:67],a[156:159],a[8:11],v[64:67]
tr a[136:137],v246 offset:320
mm v[68:71],a[152:155],a[4:7],v[68:71]
tr a[138:139],v246 offset:7488
mm v[68:71],a[156:159],a[12:15],v[68:71]
bl a[56:59],v236,s[8:11],s48 offen offset:1024 sc1
s_waitcnt lgkmcnt(6)
mm v[72:75],a[160:163],a[0:3],v[72:75]
tr a[140:141],v246 offset:14656
tr a[142:143],v246 offset:21824
mm v[72:75],a[164:167],a[8:11],v[72:75]
tr a[144:145],v245 offset:384
mm v[76:79],a[160:163],a[4:7],v[76:79]
tr a[146:147],v245 offset:7552
mm v[76:79],a[164:167],a[12:15],v[76:79]
tr a[148:149],v245 offset:14720
s_waitcnt lgkmcnt(7)
mm v[80:83],a[128:131],a[0:3],v[80:83]
tr a[150:151],v245 offset:21888
bl a[60:63],v237,s[8:11],s48 offen offset:1024 sc1
mm v[80:83],a[132:135],a[8:11],v[80:83]
tr a[152:153],v246 offset:384
s_waitcnt vmcnt(22)
mm v[84:87],a[128:131],a[4:7],v[84:87]
tr a[154:155],v246 offset:7552
s_barrier
mm v[84:87],a[132:135],a[12:15],v[84:87]
tr a[156:157],v246 offset:14720
s_waitcnt lgkmcnt(7)
mm v[88:91],a[136:139],a[0:3],v[88:91]
tr a[158:159],v246 offset:21888
s_add_u32 s48,s48,2048
mm v[88:91],a[140:143],a[8:11],v[88:91]
tr a[160:161],v245 offset:28672
s_add_u32 m0,s51,114688
mm v[92:95],a[136:139],a[4:7],v[92:95]
tr a[162:163],v245 offset:35840
bl v238,s[16:19],s54 offen offset:0 lds
mm v[92:95],a[140:143],a[12:15],v[92:95]
tr a[164:165],v245 offset:43008
s_waitcnt lgkmcnt(7)
mm v[96:99],a[144:147],a[0:3],v[96:99]
tr a[166:167],v245 offset:50176
bl v239,s[16:19],s54 offen offset:1024 lds
mm v[96:99],a[148:151],a[8:11],v[96:99]
tr a[128:129],v246 offset:28672
mm v[100:103],a[144:147],a[4:7],v[100:103]
tr a[130:131],v246 offset:35840
mm v[100:103],a[148:151],a[12:15],v[100:103]
tr a[132:133],v246 offset:43008
s_waitcnt lgkmcnt(7)
mm v[104:107],a[152:155],a[0:3],v[104:107]
tr a[134:135],v246 offset:50176
mm v[104:107],a[156:159],a[8:11],v[104:107]
tr a[136:137],v245 offset:28736
bl v240,s[16:19],s54 offen offset:2048 lds
mm v[108:111],a[152:155],a[4:7],v[108:111]
tr a[138:139],v245 offset:35904
mm v[108:111],a[156:159],a[12:15],v[108:111]
tr a[140:141],v245 offset:43072
s_waitcnt lgkmcnt(7)
mm v[0:3],a[160:163],a[16:19],v[0:3]
tr a[142:143],v245 offset:50240
mm v[0:3],a[164:167],a[24:27],v[0:3]
tr a[144:145],v246 offset:28736
mm v[4:7],a[160:163],a[20:23],v[4:7]
tr a[146:147],v246 offset:35904
bl v241,s[16:19],s54 offen offset:3072 lds
mm v[4:7],a[164:167],a[28:31],v[4:7]
tr a[148:149],v246 offset:43072
s_waitcnt lgkmcnt(7)
mm v[8:11],a[128:131],a[16:19],v[8:11]
tr a[150:151],v246 offset:50240
s_add_u32 m0,s51,118784
mm v[8:11],a[132:135],a[24:27],v[8:11]
tr a[152:153],v245 offset:28800
mm v[12:15],a[128:131],a[20:23],v[12:15]
tr a[154:155],v245 offset:35968
mm v[12:15],a[132:135],a[28:31],v[12:15]
tr a[156:157],v245 offset:43136
s_waitcnt lgkmcnt(7)
mm v[16:19],a[136:139],a[16:19],v[16:19]
tr a[158:159],v245 offset:50304
bl v242,s[16:19],s54 offen offset:0 lds
mm v[16:19],a[140:143],a[24:27],v[16:19]
tr a[160:161],v246 offset:28800
mm v[20:23],a[136:139],a[20:23],v[20:23]
tr a[162:163],v246 offset:35968
mm v[20:23],a[140:143],a[28:31],v[20:23]
tr a[164:165],v246 offset:43136
s_waitcnt lgkmcnt(7)
mm v[24:27],a[144:147],a[16:19],v[24:27]
tr a[166:167],v246 offset:50304
bl v243,s[16:19],s54 offen offset:1024 lds
mm v[24:27],a[148:151],a[24:27],v[24:27]
tr a[128:129],v245 offset:28864
mm v[28:31],a[144:147],a[20:23],v[28:31]
tr a[130:131],v245 offset:36032
mm v[28:31],a[148:151],a[28:31],v[28:31]
tr a[132:133],v245 offset:43200
s_waitcnt lgkmcnt(7)
mm v[32:35],a[152:155],a[16:19],v[32:35]
tr a[134:135],v245 offset:50368
bl v244,s[16:19],s54 offen offset:2048 lds
mm v[32:35],a[156:159],a[24:27],v[32:35]
tr a[136:137],v246 offset:28864
s_add_u32 s54,s54,458752
mm v[36:39],a[152:155],a[20:23],v[36:39]
tr a[138:139],v246 offset:36032
mm v[36:39],a[156:159],a[28:31],v[36:39]
tr a[140:141],v246 offset:43200
s_waitcnt lgkmcnt(7)
mm v[40:43],a[160:163],a[16:19],v[40:43]
tr a[142:143],v246 offset:50368
mm v[40:43],a[164:167],a[24:27],v[40:43]
tr a[144:145],v245 offset:28928
bl a[64:67],v236,s[8:11],s48 offen offset:0 sc1
mm v[44:47],a[160:163],a[20:23],v[44:47]
tr a[146:147],v245 offset:36096
mm v[44:47],a[164:167],a[28:31],v[44:47]
tr a[148:149],v245 offset:43264
s_waitcnt lgkmcnt(7)
mm v[48:51],a[128:131],a[16:19],v[48:51]
tr a[150:151],v245 offset:50432
mm v[48:51],a[132:135],a[24:27],v[48:51]
tr a[152:153],v246 offset:28928
mm v[52:55],a[128:131],a[20:23],v[52:55]
tr a[154:155],v246 offset:36096
bl a[68:71],v237,s[8:11],s48 offen offset:0 sc1
mm v[52:55],a[132:135],a[28:31],v[52:55]
tr a[156:157],v246 offset:43264
s_waitcnt lgkmcnt(7)
mm v[56:59],a[136:139],a[16:19],v[56:59]
tr a[158:159],v246 offset:50432
mm v[56:59],a[140:143],a[24:27],v[56:59]
tr a[160:161],v245 offset:28992
mm v[60:63],a[136:139],a[20:23],v[60:63]
tr a[162:163],v245 offset:36160
mm v[60:63],a[140:143],a[28:31],v[60:63]
tr a[164:165],v245 offset:43328
s_waitcnt lgkmcnt(7)
mm v[64:67],a[144:147],a[16:19],v[64:67]
tr a[166:167],v245 offset:50496
bl a[72:75],v236,s[8:11],s48 offen offset:1024 sc1
mm v[64:67],a[148:151],a[24:27],v[64:67]
tr a[128:129],v246 offset:28992
mm v[68:71],a[144:147],a[20:23],v[68:71]
tr a[130:131],v246 offset:36160
mm v[68:71],a[148:151],a[28:31],v[68:71]
tr a[132:133],v246 offset:43328
s_waitcnt lgkmcnt(7)
mm v[72:75],a[152:155],a[16:19],v[72:75]
tr a[134:135],v246 offset:50496
bl a[76:79],v237,s[8:11],s48 offen offset:1024 sc1
mm v[72:75],a[156:159],a[24:27],v[72:75]
tr a[136:137],v245 offset:29056
s_add_u32 s48,s48,2048
mm v[76:79],a[152:155],a[20:23],v[76:79]
tr a[138:139],v245 offset:36224
mm v[76:79],a[156:159],a[28:31],v[76:79]
tr a[140:141],v245 offset:43392
s_waitcnt lgkmcnt(7)
mm v[80:83],a[160:163],a[16:19],v[80:83]
tr a[142:143],v245 offset:50560
mm v[80:83],a[164:167],a[24:27],v[80:83]
tr a[144:145],v246 offset:29056
s_waitcnt vmcnt(22)
mm v[84:87],a[160:163],a[20:23],v[84:87]
tr a[146:147],v246 offset:36224
s_barrier
mm v[84:87],a[164:167],a[28:31],v[84:87]
s_add_u32 m0,s51,0
s_waitcnt lgkmcnt(6)
mm v[88:91],a[128:131],a[16:19],v[88:91]
tr a[148:149],v246 offset:43392
tr a[150:151],v246 offset:50560
mm v[88:91],a[132:135],a[24:27],v[88:91]
tr a[152:153],v247 offset:0
bl v238,s[16:19],s54 offen offset:0 lds
mm v[92:95],a[128:131],a[20:23],v[92:95]
tr a[154:155],v247 offset:7168
mm v[92:95],a[132:135],a[28:31],v[92:95]
tr a[156:157],v247 offset:14336
s_waitcnt lgkmcnt(7)
mm v[96:99],a[136:139],a[16:19],v[96:99]
tr a[158:159],v247 offset:21504
bl v239,s[16:19],s54 offen offset:1024 lds
mm v[96:99],a[140:143],a[24:27],v[96:99]
tr a[160:161],v248 offset:0
mm v[100:103],a[136:139],a[20:23],v[100:103]
tr a[162:163],v248 offset:7168
mm v[100:103],a[140:143],a[28:31],v[100:103]
tr a[164:165],v248 offset:14336
s_waitcnt lgkmcnt(7)
mm v[104:107],a[144:147],a[16:19],v[104:107]
tr a[166:167],v248 offset:21504
mm v[104:107],a[148:151],a[24:27],v[104:107]
tr a[128:129],v247 offset:64
bl v240,s[16:19],s54 offen offset:2048 lds
mm v[108:111],a[144:147],a[20:23],v[108:111]
tr a[130:131],v247 offset:7232
mm v[108:111],a[148:151],a[28:31],v[108:111]
tr a[132:133],v247 offset:14400
s_waitcnt lgkmcnt(7)
mm v[0:3],a[152:155],a[32:35],v[0:3]
tr a[134:135],v247 offset:21568
mm v[0:3],a[156:159],a[40:43],v[0:3]
tr a[136:137],v248 offset:64
mm v[4:7],a[152:155],a[36:39],v[4:7]
tr a[138:139],v248 offset:7232
bl v241,s[16:19],s54 offen offset:3072 lds
mm v[4:7],a[156:159],a[44:47],v[4:7]
tr a[140:141],v248 offset:14400
s_waitcnt lgkmcnt(7)
mm v[8:11],a[160:163],a[32:35],v[8:11]
tr a[142:143],v248 offset:21568
s_add_u32 m0,s51,4096
mm v[8:11],a[164:167],a[40:43],v[8:11]
tr a[144:145],v247 offset:128
mm v[12:15],a[160:163],a[36:39],v[12:15]
tr a[146:147],v247 offset:7296
mm v[12:15],a[164:167],a[44:47],v[12:15]
tr a[148:149],v247 offset:14464
s_waitcnt lgkmcnt(7)
mm v[16:19],a[128:131],a[32:35],v[16:19]
tr a[150:151],v247 offset:21632
bl v242,s[16:19],s54 offen offset:0 lds
mm v[16:19],a[132:135],a[40:43],v[16:19]
tr a[152:153],v248 offset:128
mm v[20:23],a[128:131],a[36:39],v[20:23]
tr a[154:155],v248 offset:7296
mm v[20:23],a[132:135],a[44:47],v[20:23]
tr a[156:157],v248 offset:14464
s_waitcnt lgkmcnt(7)
mm v[24:27],a[136:139],a[32:35],v[24:27]
tr a[158:159],v248 offset:21632
bl v243,s[16:19],s54 offen offset:1024 lds
mm v[24:27],a[140:143],a[40:43],v[24:27]
tr a[160:161],v247 offset:192
mm v[28:31],a[136:139],a[36:39],v[28:31]
tr a[162:163],v247 offset:7360
mm v[28:31],a[140:143],a[44:47],v[28:31]
tr a[164:165],v247 offset:14528
s_waitcnt lgkmcnt(7)
mm v[32:35],a[144:147],a[32:35],v[32:35]
tr a[166:167],v247 offset:21696
bl v244,s[16:19],s54 offen offset:2048 lds
mm v[32:35],a[148:151],a[40:43],v[32:35]
tr a[128:129],v248 offset:192
s_add_u32 s54,s54,458752
mm v[36:39],a[144:147],a[36:39],v[36:39]
tr a[130:131],v248 offset:7360
mm v[36:39],a[148:151],a[44:47],v[36:39]
tr a[132:133],v248 offset:14528
s_waitcnt lgkmcnt(7)
mm v[40:43],a[152:155],a[32:35],v[40:43]
tr a[134:135],v248 offset:21696
mm v[40:43],a[156:159],a[40:43],v[40:43]
tr a[136:137],v247 offset:256
bl a[0:3],v236,s[8:11],s48 offen offset:0 sc1
mm v[44:47],a[152:155],a[36:39],v[44:47]
tr a[138:139],v247 offset:7424
mm v[44:47],a[156:159],a[44:47],v[44:47]
tr a[140:141],v247 offset:14592
s_waitcnt lgkmcnt(7)
mm v[48:51],a[160:163],a[32:35],v[48:51]
tr a[142:143],v247 offset:21760
mm v[48:51],a[164:167],a[40:43],v[48:51]
tr a[144:145],v248 offset:256
mm v[52:55],a[160:163],a[36:39],v[52:55]
tr a[146:147],v248 offset:7424
bl a[4:7],v237,s[8:11],s48 offen offset:0 sc1
mm v[52:55],a[164:167],a[44:47],v[52:55]
tr a[148:149],v248 offset:14592
s_waitcnt lgkmcnt(7)
mm v[56:59],a[128:131],a[32:35],v[56:59]
tr a[150:151],v248 offset:21760
mm v[56:59],a[132:135],a[40:43],v[56:59]
tr a[152:153],v247 offset:320
mm v[60:63],a[128:131],a[36:39],v[60:63]
tr a[154:155],v247 offset:7488
mm v[60:63],a[132:135],a[44:47],v[60:63]
tr a[156:157],v247 offset:14656
s_waitcnt lgkmcnt(7)
mm v[64:67],a[136:139],a[32:35],v[64:67]
tr a[158:159],v247 offset:21824
bl a[8:11],v236,s[8:11],s48 offen offset:1024 sc1
mm v[64:67],a[140:143],a[40:43],v[64:67]
tr a[160:161],v248 offset:320
mm v[68:71],a[136:139],a[36:39],v[68:71]
tr a[162:163],v248 offset:7488
mm v[68:71],a[140:143],a[44:47],v[68:71]
tr a[164:165],v248 offset:14656
s_waitcnt lgkmcnt(7)
mm v[72:75],a[144:147],a[32:35],v[72:75]
tr a[166:167],v248 offset:21824
bl a[12:15],v237,s[8:11],s48 offen offset:1024 sc1
mm v[72:75],a[148:151],a[40:43],v[72:75]
tr a[128:129],v247 offset:384
s_add_u32 s48,s48,2048
mm v[76:79],a[144:147],a[36:39],v[76:79]
tr a[130:131],v247 offset:7552
mm v[76:79],a[148:151],a[44:47],v[76:79]
tr a[132:133],v247 offset:14720
s_waitcnt lgkmcnt(7)
mm v[80:83],a[152:155],a[32:35],v[80:83]
tr a[134:135],v247 offset:21888
mm v[80:83],a[156:159],a[40:43],v[80:83]
tr a[136:137],v248 offset:384
s_waitcnt vmcnt(22)
mm v[84:87],a[152:155],a[36:39],v[84:87]
tr a[138:139],v248 offset:7552
s_barrier
mm v[84:87],a[156:159],a[44:47],v[84:87]
s_add_u32 m0,s51,28672
s_waitcnt lgkmcnt(6)
mm v[88:91],a[160:163],a[32:35],v[88:91]
tr a[140:141],v248 offset:14720
tr a[142:143],v248 offset:21888
mm v[88:91],a[164:167],a[40:43],v[88:91]
tr a[144:145],v247 offset:28672
bl v238,s[16:19],s54 offen offset:0 lds
mm v[92:95],a[160:163],a[36:39],v[92:95]
tr a[146:147],v247 offset:35840
mm v[92:95],a[164:167],a[44:47],v[92:95]
tr a[148:149],v247 offset:43008
s_waitcnt lgkmcnt(7)
mm v[96:99],a[128:131],a[32:35],v[96:99]
tr a[150:151],v247 offset:50176
bl v239,s[16:19],s54 offen offset:1024 lds
mm v[96:99],a[132:135],a[40:43],v[96:99]
tr a[152:153],v248 offset:28672
mm v[100:103],a[128:131],a[36:39],v[100:103]
tr a[154:155],v248 offset:35840
mm v[100:103],a[132:135],a[44:47],v[100:103]
tr a[156:157],v248 offset:43008
s_waitcnt lgkmcnt(7)
mm v[104:107],a[136:139],a[32:35],v[104:107]
tr a[158:159],v248 offset:50176
mm v[104:107],a[140:143],a[40:43],v[104:107]
tr a[160:161],v247 offset:28736
bl v240,s[16:19],s54 offen offset:2048 lds
mm v[108:111],a[136:139],a[36:39],v[108:111]
tr a[162:163],v247 offset:35904
mm v[108:111],a[140:143],a[44:47],v[108:111]
tr a[164:165],v247 offset:43072
s_waitcnt lgkmcnt(7)
mm v[0:3],a[144:147],a[48:51],v[0:3]
tr a[166:167],v247 offset:50240
mm v[0:3],a[148:151],a[56:59],v[0:3]
tr a[128:129],v248 offset:28736
mm v[4:7],a[144:147],a[52:55],v[4:7]
tr a[130:131],v248 offset:35904
bl v241,s[16:19],s54 offen offset:3072 lds
mm v[4:7],a[148:151],a[60:63],v[4:7]
tr a[132:133],v248 offset:43072
s_waitcnt lgkmcnt(7)
mm v[8:11],a[152:155],a[48:51],v[8:11]
tr a[134:135],v248 offset:50240
s_add_u32 m0,s51,32768
mm v[8:11],a[156:159],a[56:59],v[8:11]
tr a[136:137],v247 offset:28800
mm v[12:15],a[152:155],a[52:55],v[12:15]
tr a[138:139],v247 offset:35968
mm v[12:15],a[156:159],a[60:63],v[12:15]
tr a[140:141],v247 offset:43136
s_waitcnt lgkmcnt(7)
mm v[16:19],a[160:163],a[48:51],v[16:19]
tr a[142:143],v247 offset:50304
bl v242,s[16:19],s54 offen offset:0 lds
mm v[16:19],a[164:167],a[56:59],v[16:19]
tr a[144:145],v248 offset:28800
mm v[20:23],a[160:163],a[52:55],v[20:23]
tr a[146:147],v248 offset:35968
mm v[20:23],a[164:167],a[60:63],v[20:23]
tr a[148:149],v248 offset:43136
s_waitcnt lgkmcnt(7)
mm v[24:27],a[128:131],a[48:51],v[24:27]
tr a[150:151],v248 offset:50304
bl v243,s[16:19],s54 offen offset:1024 lds
mm v[24:27],a[132:135],a[56:59],v[24:27]
tr a[152:153],v247 offset:28864
mm v[28:31],a[128:131],a[52:55],v[28:31]
tr a[154:155],v247 offset:36032
mm v[28:31],a[132:135],a[60:63],v[28:31]
tr a[156:157],v247 offset:43200
s_waitcnt lgkmcnt(7)
mm v[32:35],a[136:139],a[48:51],v[32:35]
tr a[158:159],v247 offset:50368
bl v244,s[16:19],s54 offen offset:2048 lds
mm v[32:35],a[140:143],a[56:59],v[32:35]
tr a[160:161],v248 offset:28864
s_add_u32 s54,s54,458752
mm v[36:39],a[136:139],a[52:55],v[36:39]
tr a[162:163],v248 offset:36032
mm v[36:39],a[140:143],a[60:63],v[36:39]
tr a[164:165],v248 offset:43200
s_waitcnt lgkmcnt(7)
mm v[40:43],a[144:147],a[48:51],v[40:43]
tr a[166:167],v248 offset:50368
mm v[40:43],a[148:151],a[56:59],v[40:43]
tr a[128:129],v247 offset:28928
bl a[16:19],v236,s[8:11],s48 offen offset:0 sc1
mm v[44:47],a[144:147],a[52:55],v[44:47]
tr a[130:131],v247 offset:36096
mm v[44:47],a[148:151],a[60:63],v[44:47]
tr a[132:133],v247 offset:43264
s_waitcnt lgkmcnt(7)
mm v[48:51],a[152:155],a[48:51],v[48:51]
tr a[134:135],v247 offset:50432
mm v[48:51],a[156:159],a[56:59],v[48:51]
tr a[136:137],v248 offset:28928
mm v[52:55],a[152:155],a[52:55],v[52:55]
tr a[138:139],v248 offset:36096
bl a[20:23],v237,s[8:11],s48 offen offset:0 sc1
mm v[52:55],a[156:159],a[60:63],v[52:55]
tr a[140:141],v248 offset:43264
s_waitcnt lgkmcnt(7)
mm v[56:59],a[160:163],a[48:51],v[56:59]
tr a[142:143],v248 offset:50432
mm v[56:59],a[164:167],a[56:59],v[56:59]
tr a[144:145],v247 offset:28992
mm v[60:63],a[160:163],a[52:55],v[60:63]
tr a[146:147],v247 offset:36160
mm v[60:63],a[164:167],a[60:63],v[60:63]
tr a[148:149],v247 offset:43328
s_waitcnt lgkmcnt(7)
mm v[64:67],a[128:131],a[48:51],v[64:67]
tr a[150:151],v247 offset:50496
bl a[24:27],v236,s[8:11],s48 offen offset:1024 sc1
mm v[64:67],a[132:135],a[56:59],v[64:67]
tr a[152:153],v248 offset:28992
mm v[68:71],a[128:131],a[52:55],v[68:71]
tr a[154:155],v248 offset:36160
mm v[68:71],a[132:135],a[60:63],v[68:71]
tr a[156:157],v248 offset:43328
s_waitcnt lgkmcnt(7)
mm v[72:75],a[136:139],a[48:51],v[72:75]
tr a[158:159],v248 offset:50496
bl a[28:31],v237,s[8:11],s48 offen offset:1024 sc1
mm v[72:75],a[140:143],a[56:59],v[72:75]
tr a[160:161],v247 offset:29056
s_add_u32 s48,s48,2048
mm v[76:79],a[136:139],a[52:55],v[76:79]
tr a[162:163],v247 offset:36224
mm v[76:79],a[140:143],a[60:63],v[76:79]
tr a[164:165],v247 offset:43392
s_waitcnt lgkmcnt(7)
mm v[80:83],a[144:147],a[48:51],v[80:83]
tr a[166:167],v247 offset:50560
mm v[80:83],a[148:151],a[56:59],v[80:83]
tr a[128:129],v248 offset:29056
s_waitcnt vmcnt(22)
mm v[84:87],a[144:147],a[52:55],v[84:87]
tr a[130:131],v248 offset:36224
s_barrier
mm v[84:87],a[148:151],a[60:63],v[84:87]
s_add_u32 m0,s51,57344
s_waitcnt lgkmcnt(6)
mm v[88:91],a[152:155],a[48:51],v[88:91]
tr a[132:133],v248 offset:43392
tr a[134:135],v248 offset:50560
mm v[88:91],a[156:159],a[56:59],v[88:91]
tr a[136:137],v249 offset:0
bl v238,s[16:19],s54 offen offset:0 lds
mm v[92:95],a[152:155],a[52:55],v[92:95]
tr a[138:139],v249 offset:7168
mm v[92:95],a[156:159],a[60:63],v[92:95]
tr a[140:141],v249 offset:14336
s_waitcnt lgkmcnt(7)
mm v[96:99],a[160:163],a[48:51],v[96:99]
tr a[142:143],v249 offset:21504
bl v239,s[16:19],s54 offen offset:1024 lds
mm v[96:99],a[164:167],a[56:59],v[96:99]
tr a[144:145],v250 offset:0
mm v[100:103],a[160:163],a[52:55],v[100:103]
tr a[146:147],v250 offset:7168
mm v[100:103],a[164:167],a[60:63],v[100:103]
tr a[148:149],v250 offset:14336
s_waitcnt lgkmcnt(7)
mm v[104:107],a[128:131],a[48:51],v[104:107]
tr a[150:151],v250 offset:21504
mm v[104:107],a[132:135],a[56:59],v[104:107]
tr a[152:153],v249 offset:64
bl v240,s[16:19],s54 offen offset:2048 lds
mm v[108:111],a[128:131],a[52:55],v[108:111]
tr a[154:155],v249 offset:7232
mm v[108:111],a[132:135],a[60:63],v[108:111]
tr a[156:157],v249 offset:14400
s_waitcnt lgkmcnt(7)
mm v[0:3],a[136:139],a[64:67],v[0:3]
tr a[158:159],v249 offset:21568
mm v[0:3],a[140:143],a[72:75],v[0:3]
tr a[160:161],v250 offset:64
mm v[4:7],a[136:139],a[68:71],v[4:7]
tr a[162:163],v250 offset:7232
bl v241,s[16:19],s54 offen offset:3072 lds
mm v[4:7],a[140:143],a[76:79],v[4:7]
tr a[164:165],v250 offset:14400
s_waitcnt lgkmcnt(7)
mm v[8:11],a[144:147],a[64:67],v[8:11]
tr a[166:167],v250 offset:21568
s_add_u32 m0,s51,61440
mm v[8:11],a[148:151],a[72:75],v[8:11]
tr a[128:129],v249 offset:128
mm v[12:15],a[144:147],a[68:71],v[12:15]
tr a[130:131],v249 offset:7296
mm v[12:15],a[148:151],a[76:79],v[12:15]
tr a[132:133],v249 offset:14464
s_waitcnt lgkmcnt(7)
mm v[16:19],a[152:155],a[64:67],v[16:19]
tr a[134:135],v249 offset:21632
bl v242,s[16:19],s54 offen offset:0 lds
mm v[16:19],a[156:159],a[72:75],v[16:19]
tr a[136:137],v250 offset:128
mm v[20:23],a[152:155],a[68:71],v[20:23]
tr a[138:139],v250 offset:7296
mm v[20:23],a[156:159],a[76:79],v[20:23]
tr a[140:141],v250 offset:14464
s_waitcnt lgkmcnt(7)
mm v[24:27],a[160:163],a[64:67],v[24:27]
tr a[142:143],v250 offset:21632
bl v243,s[16:19],s54 offen offset:1024 lds
mm v[24:27],a[164:167],a[72:75],v[24:27]
tr a[144:145],v249 offset:192
mm v[28:31],a[160:163],a[68:71],v[28:31]
tr a[146:147],v249 offset:7360
mm v[28:31],a[164:167],a[76:79],v[28:31]
tr a[148:149],v249 offset:14528
s_waitcnt lgkmcnt(7)
mm v[32:35],a[128:131],a[64:67],v[32:35]
tr a[150:151],v249 offset:21696
bl v244,s[16:19],s54 offen offset:2048 lds
mm v[32:35],a[132:135],a[72:75],v[32:35]
tr a[152:153],v250 offset:192
s_add_u32 s54,s54,458752
mm v[36:39],a[128:131],a[68:71],v[36:39]
tr a[154:155],v250 offset:7360
mm v[36:39],a[132:135],a[76:79],v[36:39]
tr a[156:157],v250 offset:14528
s_waitcnt lgkmcnt(7)
mm v[40:43],a[136:139],a[64:67],v[40:43]
tr a[158:159],v250 offset:21696
mm v[40:43],a[140:143],a[72:75],v[40:43]
tr a[160:161],v249 offset:256
bl a[32:35],v236,s[8:11],s48 offen offset:0 sc1
mm v[44:47],a[136:139],a[68:71],v[44:47]
tr a[162:163],v249 offset:7424
mm v[44:47],a[140:143],a[76:79],v[44:47]
tr a[164:165],v249 offset:14592
s_waitcnt lgkmcnt(7)
mm v[48:51],a[144:147],a[64:67],v[48:51]
tr a[166:167],v249 offset:21760
mm v[48:51],a[148:151],a[72:75],v[48:51]
tr a[128:129],v250 offset:256
mm v[52:55],a[144:147],a[68:71],v[52:55]
tr a[130:131],v250 offset:7424
bl a[36:39],v237,s[8:11],s48 offen offset:0 sc1
mm v[52:55],a[148:151],a[76:79],v[52:55]
tr a[132:133],v250 offset:14592
s_waitcnt lgkmcnt(7)
mm v[56:59],a[152:155],a[64:67],v[56:59]
tr a[134:135],v250 offset:21760
mm v[56:59],a[156:159],a[72:75],v[56:59]
tr a[136:137],v249 offset:320
mm v[60:63],a[152:155],a[68:71],v[60:63]
tr a[138:139],v249 offset:7488
mm v[60:63],a[156:159],a[76:79],v[60:63]
tr a[140:141],v249 offset:14656
s_waitcnt lgkmcnt(7)
mm v[64:67],a[160:163],a[64:67],v[64:67]
tr a[142:143],v249 offset:21824
bl a[40:43],v236,s[8:11],s48 offen offset:1024 sc1
mm v[64:67],a[164:167],a[72:75],v[64:67]
tr a[144:145],v250 offset:320
mm v[68:71],a[160:163],a[68:71],v[68:71]
tr a[146:147],v250 offset:7488
mm v[68:71],a[164:167],a[76:79],v[68:71]
tr a[148:149],v250 offset:14656
s_waitcnt lgkmcnt(7)
mm v[72:75],a[128:131],a[64:67],v[72:75]
tr a[150:151],v250 offset:21824
bl a[44:47],v237,s[8:11],s48 offen offset:1024 sc1
mm v[72:75],a[132:135],a[72:75],v[72:75]
tr a[152:153],v249 offset:384
s_add_u32 s48,s48,2048
mm v[76:79],a[128:131],a[68:71],v[76:79]
tr a[154:155],v249 offset:7552
mm v[76:79],a[132:135],a[76:79],v[76:79]
tr a[156:157],v249 offset:14720
s_waitcnt lgkmcnt(7)
mm v[80:83],a[136:139],a[64:67],v[80:83]
tr a[158:159],v249 offset:21888
mm v[80:83],a[140:143],a[72:75],v[80:83]
tr a[160:161],v250 offset:384
s_waitcnt vmcnt(22)
mm v[84:87],a[136:139],a[68:71],v[84:87]
tr a[162:163],v250 offset:7552
s_barrier
mm v[84:87],a[140:143],a[76:79],v[84:87]
s_add_u32 m0,s51,86016
s_waitcnt lgkmcnt(6)
mm v[88:91],a[144:147],a[64:67],v[88:91]
tr a[164:165],v250 offset:14720
tr a[166:167],v250 offset:21888
mm v[88:91],a[148:151],a[72:75],v[88:91]
tr a[128:129],v245 offset:0
bl v238,s[16:19],s54 offen offset:0 lds
mm v[92:95],a[144:147],a[68:71],v[92:95]
tr a[130:131],v245 offset:7168
mm v[92:95],a[148:151],a[76:79],v[92:95]
tr a[132:133],v245 offset:14336
s_waitcnt lgkmcnt(7)
mm v[96:99],a[152:155],a[64:67],v[96:99]
tr a[134:135],v245 offset:21504
mm v[96:99],a[156:159],a[72:75],v[96:99]
tr a[136:137],v246 offset:0
mm v[100:103],a[152:155],a[68:71],v[100:103]
tr a[138:139],v246 offset:7168
bl v239,s[16:19],s54 offen offset:1024 lds
mm v[100:103],a[156:159],a[76:79],v[100:103]
tr a[140:141],v246 offset:14336
s_waitcnt lgkmcnt(7)
mm v[104:107],a[160:163],a[64:67],v[104:107]
tr a[142:143],v246 offset:21504
mm v[104:107],a[164:167],a[72:75],v[104:107]
tr a[144:145],v245 offset:64
mm v[108:111],a[160:163],a[68:71],v[108:111]
tr a[146:147],v245 offset:7232
mm v[108:111],a[164:167],a[76:79],v[108:111]
tr a[148:149],v245 offset:14400
tr a[150:151],v245 offset:21568
s_waitcnt lgkmcnt(8)
mm v[0:3],a[128:131],a[0:3],v[0:3]
tr a[152:153],v246 offset:64
bl v240,s[16:19],s54 offen offset:2048 lds
mm v[0:3],a[132:135],a[8:11],v[0:3]
tr a[154:155],v246 offset:7232
mm v[4:7],a[128:131],a[4:7],v[4:7]
tr a[156:157],v246 offset:14400
mm v[4:7],a[132:135],a[12:15],v[4:7]
tr a[158:159],v246 offset:21568
s_waitcnt lgkmcnt(8)
mm v[8:11],a[136:139],a[0:3],v[8:11]
tr a[160:161],v245 offset:128
mm v[8:11],a[140:143],a[8:11],v[8:11]
tr a[162:163],v245 offset:7296
bl v241,s[16:19],s54 offen offset:3072 lds
mm v[12:15],a[136:139],a[4:7],v[12:15]
tr a[164:165],v245 offset:14464
s_add_u32 m0,s51,90112
mm v[12:15],a[140:143],a[12:15],v[12:15]
tr a[166:167],v245 offset:21632
s_waitcnt lgkmcnt(8)
mm v[16:19],a[144:147],a[0:3],v[16:19]
tr a[128:129],v246 offset:128
mm v[16:19],a[148:151],a[8:11],v[16:19]
tr a[130:131],v246 offset:7296
mm v[20:23],a[144:147],a[4:7],v[20:23]
tr a[132:133],v246 offset:14464
bl v242,s[16:19],s54 offen offset:0 lds
mm v[20:23],a[148:151],a[12:15],v[20:23]
tr a[134:135],v246 offset:21632
s_waitcnt lgkmcnt(8)
mm v[24:27],a[152:155],a[0:3],v[24:27]
tr a[136:137],v245 offset:192
mm v[24:27],a[156:159],a[8:11],v[24:27]
tr a[138:139],v245 offset:7360
mm v[28:31],a[152:155],a[4:7],v[28:31]
tr a[140:141],v245 offset:14528
mm v[28:31],a[156:159],a[12:15],v[28:31]
bl v243,s[16:19],s54 offen offset:1024 lds
s_waitcnt lgkmcnt(7)
mm v[32:35],a[160:163],a[0:3],v[32:35]
tr a[142:143],v245 offset:21696
mm v[32:35],a[164:167],a[8:11],v[32:35]
tr a[144:145],v246 offset:192
mm v[36:39],a[160:163],a[4:7],v[36:39]
tr a[146:147],v246 offset:7360
mm v[36:39],a[164:167],a[12:15],v[36:39]
tr a[148:149],v246 offset:14528
s_waitcnt lgkmcnt(7)
mm v[40:43],a[128:131],a[0:3],v[40:43]
tr a[150:151],v246 offset:21696
bl v244,s[16:19],s54 offen offset:2048 lds
mm v[40:43],a[132:135],a[8:11],v[40:43]
tr a[152:153],v245 offset:256
s_add_u32 s54,s54,458752
mm v[44:47],a[128:131],a[4:7],v[44:47]
tr a[154:155],v245 offset:7424
mm v[44:47],a[132:135],a[12:15],v[44:47]
tr a[156:157],v245 offset:14592
s_waitcnt lgkmcnt(7)
mm v[48:51],a[136:139],a[0:3],v[48:51]
tr a[158:159],v245 offset:21760
mm v[48:51],a[140:143],a[8:11],v[48:51]
tr a[160:161],v246 offset:256
bl a[48:51],v236,s[8:11],s48 offen offset:0 sc1
mm v[52:55],a[136:139],a[4:7],v[52:55]
tr a[162:163],v246 offset:7424
mm v[52:55],a[140:143],a[12:15],v[52:55]
tr a[164:165],v246 offset:14592
s_waitcnt lgkmcnt(7)
mm v[56:59],a[144:147],a[0:3],v[56:59]
tr a[166:167],v246 offset:21760
mm v[56:59],a[148:151],a[8:11],v[56:59]
tr a[128:129],v245 offset:320
mm v[60:63],a[144:147],a[4:7],v[60:63]
tr a[130:131],v245 offset:7488
bl a[52:55],v237,s[8:11],s48 offen offset:0 sc1
mm v[60:63],a[148:151],a[12:15],v[60:63]
tr a[132:133],v245 offset:14656
s_waitcnt lgkmcnt(7)
mm v[64:67],a[152:155],a[0:3],v[64:67]
tr a[134:135],v245 offset:21824
mm v[64:67],a[156:159],a[8:11],v[64:67]
tr a[136:137],v246 offset:320
mm v[68:71],a[152:155],a[4:7],v[68:71]
tr a[138:139],v246 offset:7488
mm v[68:71],a[156:159],a[12:15],v[68:71]
bl a[56:59],v236,s[8:11],s48 offen offset:1024 sc1
s_waitcnt lgkmcnt(6)
mm v[72:75],a[160:163],a[0:3],v[72:75]
tr a[140:141],v246 offset:14656
tr a[142:143],v246 offset:21824
mm v[72:75],a[164:167],a[8:11],v[72:75]
tr a[144:145],v245 offset:384
mm v[76:79],a[160:163],a[4:7],v[76:79]
tr a[146:147],v245 offset:7552
mm v[76:79],a[164:167],a[12:15],v[76:79]
tr a[148:149],v245 offset:14720
s_waitcnt lgkmcnt(7)
mm v[80:83],a[128:131],a[0:3],v[80:83]
tr a[150:151],v245 offset:21888
bl a[60:63],v237,s[8:11],s48 offen offset:1024 sc1
mm v[80:83],a[132:135],a[8:11],v[80:83]
tr a[152:153],v246 offset:384
s_waitcnt vmcnt(22)
mm v[84:87],a[128:131],a[4:7],v[84:87]
tr a[154:155],v246 offset:7552
s_barrier
mm v[84:87],a[132:135],a[12:15],v[84:87]
tr a[156:157],v246 offset:14720
s_waitcnt lgkmcnt(7)
mm v[88:91],a[136:139],a[0:3],v[88:91]
tr a[158:159],v246 offset:21888
s_add_u32 s48,s48,2048
mm v[88:91],a[140:143],a[8:11],v[88:91]
tr a[160:161],v245 offset:28672
s_add_u32 m0,s51,114688
mm v[92:95],a[136:139],a[4:7],v[92:95]
tr a[162:163],v245 offset:35840
bl v238,s[16:19],s54 offen offset:0 lds
mm v[92:95],a[140:143],a[12:15],v[92:95]
tr a[164:165],v245 offset:43008
s_waitcnt lgkmcnt(7)
mm v[96:99],a[144:147],a[0:3],v[96:99]
tr a[166:167],v245 offset:50176
bl v239,s[16:19],s54 offen offset:1024 lds
mm v[96:99],a[148:151],a[8:11],v[96:99]
tr a[128:129],v246 offset:28672
mm v[100:103],a[144:147],a[4:7],v[100:103]
tr a[130:131],v246 offset:35840
mm v[100:103],a[148:151],a[12:15],v[100:103]
tr a[132:133],v246 offset:43008
s_waitcnt lgkmcnt(7)
mm v[104:107],a[152:155],a[0:3],v[104:107]
tr a[134:135],v246 offset:50176
mm v[104:107],a[156:159],a[8:11],v[104:107]
tr a[136:137],v245 offset:28736
bl v240,s[16:19],s54 offen offset:2048 lds
mm v[108:111],a[152:155],a[4:7],v[108:111]
tr a[138:139],v245 offset:35904
mm v[108:111],a[156:159],a[12:15],v[108:111]
tr a[140:141],v245 offset:43072
s_waitcnt lgkmcnt(7)
mm v[0:3],a[160:163],a[16:19],v[0:3]
tr a[142:143],v245 offset:50240
mm v[0:3],a[164:167],a[24:27],v[0:3]
tr a[144:145],v246 offset:28736
mm v[4:7],a[160:163],a[20:23],v[4:7]
tr a[146:147],v246 offset:35904
bl v241,s[16:19],s54 offen offset:3072 lds
mm v[4:7],a[164:167],a[28:31],v[4:7]
tr a[148:149],v246 offset:43072
s_waitcnt lgkmcnt(7)
mm v[8:11],a[128:131],a[16:19],v[8:11]
tr a[150:151],v246 offset:50240
s_add_u32 m0,s51,118784
mm v[8:11],a[132:135],a[24:27],v[8:11]
tr a[152:153],v245 offset:28800
mm v[12:15],a[128:131],a[20:23],v[12:15]
tr a[154:155],v245 offset:35968
mm v[12:15],a[132:135],a[28:31],v[12:15]
tr a[156:157],v245 offset:43136
s_waitcnt lgkmcnt(7)
mm v[16:19],a[136:139],a[16:19],v[16:19]
tr a[158:159],v245 offset:50304
bl v242,s[16:19],s54 offen offset:0 lds
mm v[16:19],a[140:143],a[24:27],v[16:19]
tr a[160:161],v246 offset:28800
mm v[20:23],a[136:139],a[20:23],v[20:23]
tr a[162:163],v246 offset:35968
mm v[20:23],a[140:143],a[28:31],v[20:23]
tr a[164:165],v246 offset:43136
s_waitcnt lgkmcnt(7)
mm v[24:27],a[144:147],a[16:19],v[24:27]
tr a[166:167],v246 offset:50304
bl v243,s[16:19],s54 offen offset:1024 lds
mm v[24:27],a[148:151],a[24:27],v[24:27]
tr a[128:129],v245 offset:28864
mm v[28:31],a[144:147],a[20:23],v[28:31]
tr a[130:131],v245 offset:36032
mm v[28:31],a[148:151],a[28:31],v[28:31]
tr a[132:133],v245 offset:43200
s_waitcnt lgkmcnt(7)
mm v[32:35],a[152:155],a[16:19],v[32:35]
tr a[134:135],v245 offset:50368
bl v244,s[16:19],s54 offen offset:2048 lds
mm v[32:35],a[156:159],a[24:27],v[32:35]
tr a[136:137],v246 offset:28864
s_add_u32 s54,s54,458752
mm v[36:39],a[152:155],a[20:23],v[36:39]
tr a[138:139],v246 offset:36032
mm v[36:39],a[156:159],a[28:31],v[36:39]
tr a[140:141],v246 offset:43200
s_waitcnt lgkmcnt(7)
mm v[40:43],a[160:163],a[16:19],v[40:43]
tr a[142:143],v246 offset:50368
mm v[40:43],a[164:167],a[24:27],v[40:43]
tr a[144:145],v245 offset:28928
bl a[64:67],v236,s[8:11],s48 offen offset:0 sc1
mm v[44:47],a[160:163],a[20:23],v[44:47]
tr a[146:147],v245 offset:36096
mm v[44:47],a[164:167],a[28:31],v[44:47]
tr a[148:149],v245 offset:43264
s_waitcnt lgkmcnt(7)
mm v[48:51],a[128:131],a[16:19],v[48:51]
tr a[150:151],v245 offset:50432
mm v[48:51],a[132:135],a[24:27],v[48:51]
tr a[152:153],v246 offset:28928
mm v[52:55],a[128:131],a[20:23],v[52:55]
tr a[154:155],v246 offset:36096
bl a[68:71],v237,s[8:11],s48 offen offset:0 sc1
mm v[52:55],a[132:135],a[28:31],v[52:55]
tr a[156:157],v246 offset:43264
s_waitcnt lgkmcnt(7)
mm v[56:59],a[136:139],a[16:19],v[56:59]
tr a[158:159],v246 offset:50432
mm v[56:59],a[140:143],a[24:27],v[56:59]
tr a[160:161],v245 offset:28992
mm v[60:63],a[136:139],a[20:23],v[60:63]
tr a[162:163],v245 offset:36160
mm v[60:63],a[140:143],a[28:31],v[60:63]
tr a[164:165],v245 offset:43328
s_waitcnt lgkmcnt(7)
mm v[64:67],a[144:147],a[16:19],v[64:67]
tr a[166:167],v245 offset:50496
bl a[72:75],v236,s[8:11],s48 offen offset:1024 sc1
mm v[64:67],a[148:151],a[24:27],v[64:67]
tr a[128:129],v246 offset:28992
mm v[68:71],a[144:147],a[20:23],v[68:71]
tr a[130:131],v246 offset:36160
mm v[68:71],a[148:151],a[28:31],v[68:71]
tr a[132:133],v246 offset:43328
s_waitcnt lgkmcnt(7)
mm v[72:75],a[152:155],a[16:19],v[72:75]
tr a[134:135],v246 offset:50496
bl a[76:79],v237,s[8:11],s48 offen offset:1024 sc1
mm v[72:75],a[156:159],a[24:27],v[72:75]
tr a[136:137],v245 offset:29056
s_add_u32 s48,s48,2048
mm v[76:79],a[152:155],a[20:23],v[76:79]
tr a[138:139],v245 offset:36224
mm v[76:79],a[156:159],a[28:31],v[76:79]
tr a[140:141],v245 offset:43392
s_waitcnt lgkmcnt(7)
mm v[80:83],a[160:163],a[16:19],v[80:83]
tr a[142:143],v245 offset:50560
mm v[80:83],a[164:167],a[24:27],v[80:83]
tr a[144:145],v246 offset:29056
s_waitcnt vmcnt(22)
mm v[84:87],a[160:163],a[20:23],v[84:87]
tr a[146:147],v246 offset:36224
s_barrier
mm v[84:87],a[164:167],a[28:31],v[84:87]
s_add_u32 m0,s51,0
s_waitcnt lgkmcnt(6)
mm v[88:91],a[128:131],a[16:19],v[88:91]
tr a[148:149],v246 offset:43392
tr a[150:151],v246 offset:50560
mm v[88:91],a[132:135],a[24:27],v[88:91]
tr a[152:153],v247 offset:0
bl v238,s[16:19],s54 offen offset:0 lds
mm v[92:95],a[128:131],a[20:23],v[92:95]
tr a[154:155],v247 offset:7168
mm v[92:95],a[132:135],a[28:31],v[92:95]
tr a[156:157],v247 offset:14336
s_waitcnt lgkmcnt(7)
mm v[96:99],a[136:139],a[16:19],v[96:99]
tr a[158:159],v247 offset:21504
bl v239,s[16:19],s54 offen offset:1024 lds
mm v[96:99],a[140:143],a[24:27],v[96:99]
tr a[160:161],v248 offset:0
mm v[100:103],a[136:139],a[20:23],v[100:103]
tr a[162:163],v248 offset:7168
mm v[100:103],a[140:143],a[28:31],v[100:103]
tr a[164:165],v248 offset:14336
s_waitcnt lgkmcnt(7)
mm v[104:107],a[144:147],a[16:19],v[104:107]
tr a[166:167],v248 offset:21504
mm v[104:107],a[148:151],a[24:27],v[104:107]
tr a[128:129],v247 offset:64
bl v240,s[16:19],s54 offen offset:2048 lds
mm v[108:111],a[144:147],a[20:23],v[108:111]
tr a[130:131],v247 offset:7232
mm v[108:111],a[148:151],a[28:31],v[108:111]
tr a[132:133],v247 offset:14400
s_waitcnt lgkmcnt(7)
mm v[0:3],a[152:155],a[32:35],v[0:3]
tr a[134:135],v247 offset:21568
mm v[0:3],a[156:159],a[40:43],v[0:3]
tr a[136:137],v248 offset:64
mm v[4:7],a[152:155],a[36:39],v[4:7]
tr a[138:139],v248 offset:7232
bl v241,s[16:19],s54 offen offset:3072 lds
mm v[4:7],a[156:159],a[44:47],v[4:7]
tr a[140:141],v248 offset:14400
s_waitcnt lgkmcnt(7)
mm v[8:11],a[160:163],a[32:35],v[8:11]
tr a[142:143],v248 offset:21568
s_add_u32 m0,s51,4096
mm v[8:11],a[164:167],a[40:43],v[8:11]
tr a[144:145],v247 offset:128
mm v[12:15],a[160:163],a[36:39],v[12:15]
tr a[146:147],v247 offset:7296
mm v[12:15],a[164:167],a[44:47],v[12:15]
tr a[148:149],v247 offset:14464
s_waitcnt lgkmcnt(7)
mm v[16:19],a[128:131],a[32:35],v[16:19]
tr a[150:151],v247 offset:21632
bl v242,s[16:19],s54 offen offset:0 lds
mm v[16:19],a[132:135],a[40:43],v[16:19]
tr a[152:153],v248 offset:128
mm v[20:23],a[128:131],a[36:39],v[20:23]
tr a[154:155],v248 offset:7296
mm v[20:23],a[132:135],a[44:47],v[20:23]
tr a[156:157],v248 offset:14464
s_waitcnt lgkmcnt(7)
mm v[24:27],a[136:139],a[32:35],v[24:27]
tr a[158:159],v248 offset:21632
bl v243,s[16:19],s54 offen offset:1024 lds
mm v[24:27],a[140:143],a[40:43],v[24:27]
tr a[160:161],v247 offset:192
mm v[28:31],a[136:139],a[36:39],v[28:31]
tr a[162:163],v247 offset:7360
mm v[28:31],a[140:143],a[44:47],v[28:31]
tr a[164:165],v247 offset:14528
s_waitcnt lgkmcnt(7)
mm v[32:35],a[144:147],a[32:35],v[32:35]
tr a[166:167],v247 offset:21696
bl v244,s[16:19],s54 offen offset:2048 lds
mm v[32:35],a[148:151],a[40:43],v[32:35]
tr a[128:129],v248 offset:192
s_add_u32 s54,s54,458752
mm v[36:39],a[144:147],a[36:39],v[36:39]
tr a[130:131],v248 offset:7360
mm v[36:39],a[148:151],a[44:47],v[36:39]
tr a[132:133],v248 offset:14528
s_waitcnt lgkmcnt(7)
mm v[40:43],a[152:155],a[32:35],v[40:43]
tr a[134:135],v248 offset:21696
mm v[40:43],a[156:159],a[40:43],v[40:43]
tr a[136:137],v247 offset:256
bl a[0:3],v236,s[8:11],s48 offen offset:0 sc1
mm v[44:47],a[152:155],a[36:39],v[44:47]
tr a[138:139],v247 offset:7424
mm v[44:47],a[156:159],a[44:47],v[44:47]
tr a[140:141],v247 offset:14592
s_waitcnt lgkmcnt(7)
mm v[48:51],a[160:163],a[32:35],v[48:51]
tr a[142:143],v247 offset:21760
mm v[48:51],a[164:167],a[40:43],v[48:51]
tr a[144:145],v248 offset:256
mm v[52:55],a[160:163],a[36:39],v[52:55]
tr a[146:147],v248 offset:7424
bl a[4:7],v237,s[8:11],s48 offen offset:0 sc1
mm v[52:55],a[164:167],a[44:47],v[52:55]
tr a[148:149],v248 offset:14592
s_waitcnt lgkmcnt(7)
mm v[56:59],a[128:131],a[32:35],v[56:59]
tr a[150:151],v248 offset:21760
mm v[56:59],a[132:135],a[40:43],v[56:59]
tr a[152:153],v247 offset:320
mm v[60:63],a[128:131],a[36:39],v[60:63]
tr a[154:155],v247 offset:7488
mm v[60:63],a[132:135],a[44:47],v[60:63]
tr a[156:157],v247 offset:14656
s_waitcnt lgkmcnt(7)
mm v[64:67],a[136:139],a[32:35],v[64:67]
tr a[158:159],v247 offset:21824
bl a[8:11],v236,s[8:11],s48 offen offset:1024 sc1
mm v[64:67],a[140:143],a[40:43],v[64:67]
tr a[160:161],v248 offset:320
mm v[68:71],a[136:139],a[36:39],v[68:71]
tr a[162:163],v248 offset:7488
mm v[68:71],a[140:143],a[44:47],v[68:71]
tr a[164:165],v248 offset:14656
s_waitcnt lgkmcnt(7)
mm v[72:75],a[144:147],a[32:35],v[72:75]
tr a[166:167],v248 offset:21824
bl a[12:15],v237,s[8:11],s48 offen offset:1024 sc1
mm v[72:75],a[148:151],a[40:43],v[72:75]
tr a[128:129],v247 offset:384
s_add_u32 s48,s48,2048
mm v[76:79],a[144:147],a[36:39],v[76:79]
tr a[130:131],v247 offset:7552
mm v[76:79],a[148:151],a[44:47],v[76:79]
tr a[132:133],v247 offset:14720
s_waitcnt lgkmcnt(7)
mm v[80:83],a[152:155],a[32:35],v[80:83]
tr a[134:135],v247 offset:21888
mm v[80:83],a[156:159],a[40:43],v[80:83]
tr a[136:137],v248 offset:384
s_waitcnt vmcnt(22)
mm v[84:87],a[152:155],a[36:39],v[84:87]
tr a[138:139],v248 offset:7552
s_barrier
mm v[84:87],a[156:159],a[44:47],v[84:87]
s_add_u32 s24,s53,5242880
s_waitcnt lgkmcnt(6)
mm v[88:91],a[160:163],a[32:35],v[88:91]
tr a[140:141],v248 offset:14720
tr a[142:143],v248 offset:21888
mm v[88:91],a[164:167],a[40:43],v[88:91]
tr a[144:145],v247 offset:28672
buffer_store_dwordx4 v[184:187],v251,s[8:11],s24 offen offset:0 sc1
mm v[92:95],a[160:163],a[36:39],v[92:95]
tr a[146:147],v247 offset:35840
mm v[92:95],a[164:167],a[44:47],v[92:95]
tr a[148:149],v247 offset:43008
s_waitcnt lgkmcnt(7)
mm v[96:99],a[128:131],a[32:35],v[96:99]
tr a[150:151],v247 offset:50176
mm v[96:99],a[132:135],a[40:43],v[96:99]
tr a[152:153],v248 offset:28672
mm v[100:103],a[128:131],a[36:39],v[100:103]
tr a[154:155],v248 offset:35840
buffer_store_dwordx4 v[188:191],v251,s[8:11],s24 offen offset:2048 sc1
mm v[100:103],a[132:135],a[44:47],v[100:103]
tr a[156:157],v248 offset:43008
s_waitcnt lgkmcnt(7)
mm v[104:107],a[136:139],a[32:35],v[104:107]
tr a[158:159],v248 offset:50176
s_add_u32 s24,s24,4096
mm v[104:107],a[140:143],a[40:43],v[104:107]
tr a[160:161],v247 offset:28736
mm v[108:111],a[136:139],a[36:39],v[108:111]
tr a[162:163],v247 offset:35904
mm v[108:111],a[140:143],a[44:47],v[108:111]
tr a[164:165],v247 offset:43072
s_waitcnt lgkmcnt(7)
mm v[0:3],a[144:147],a[48:51],v[0:3]
tr a[166:167],v247 offset:50240
mm v[0:3],a[148:151],a[56:59],v[0:3]
tr a[128:129],v248 offset:28736
buffer_store_dwordx4 v[192:195],v251,s[8:11],s24 offen offset:0 sc1
mm v[4:7],a[144:147],a[52:55],v[4:7]
tr a[130:131],v248 offset:35904
mm v[4:7],a[148:151],a[60:63],v[4:7]
tr a[132:133],v248 offset:43072
s_waitcnt lgkmcnt(7)
mm v[8:11],a[152:155],a[48:51],v[8:11]
tr a[134:135],v248 offset:50240
mm v[8:11],a[156:159],a[56:59],v[8:11]
tr a[136:137],v247 offset:28800
mm v[12:15],a[152:155],a[52:55],v[12:15]
tr a[138:139],v247 offset:35968
mm v[12:15],a[156:159],a[60:63],v[12:15]
tr a[140:141],v247 offset:43136
s_waitcnt lgkmcnt(7)
mm v[16:19],a[160:163],a[48:51],v[16:19]
tr a[142:143],v247 offset:50304
buffer_store_dwordx4 v[196:199],v251,s[8:11],s24 offen offset:2048 sc1
mm v[16:19],a[164:167],a[56:59],v[16:19]
tr a[144:145],v248 offset:28800
s_add_u32 m0,s50,32768
mm v[20:23],a[160:163],a[52:55],v[20:23]
tr a[146:147],v248 offset:35968
mm v[20:23],a[164:167],a[60:63],v[20:23]
tr a[148:149],v248 offset:43136
s_waitcnt lgkmcnt(7)
mm v[24:27],a[128:131],a[48:51],v[24:27]
tr a[150:151],v248 offset:50304
mm v[24:27],a[132:135],a[56:59],v[24:27]
tr a[152:153],v247 offset:28864
mm v[28:31],a[128:131],a[52:55],v[28:31]
tr a[154:155],v247 offset:36032
bl v216,s[28:31],s55 offen offset:0 lds
mm v[28:31],a[132:135],a[60:63],v[28:31]
tr a[156:157],v247 offset:43200
s_waitcnt lgkmcnt(7)
mm v[32:35],a[136:139],a[48:51],v[32:35]
tr a[158:159],v247 offset:50368
mm v[32:35],a[140:143],a[56:59],v[32:35]
tr a[160:161],v248 offset:28864
mm v[36:39],a[136:139],a[52:55],v[36:39]
tr a[162:163],v248 offset:36032
mm v[36:39],a[140:143],a[60:63],v[36:39]
tr a[164:165],v248 offset:43200
s_waitcnt lgkmcnt(7)
mm v[40:43],a[144:147],a[48:51],v[40:43]
tr a[166:167],v248 offset:50368
mm v[40:43],a[148:151],a[56:59],v[40:43]
tr a[128:129],v247 offset:28928
bl v217,s[28:31],s55 offen offset:1024 lds
mm v[44:47],a[144:147],a[52:55],v[44:47]
tr a[130:131],v247 offset:36096
mm v[44:47],a[148:151],a[60:63],v[44:47]
tr a[132:133],v247 offset:43264
s_waitcnt lgkmcnt(7)
mm v[48:51],a[152:155],a[48:51],v[48:51]
tr a[134:135],v247 offset:50432
mm v[48:51],a[156:159],a[56:59],v[48:51]
tr a[136:137],v248 offset:28928
mm v[52:55],a[152:155],a[52:55],v[52:55]
tr a[138:139],v248 offset:36096
mm v[52:55],a[156:159],a[60:63],v[52:55]
tr a[140:141],v248 offset:43264
s_waitcnt lgkmcnt(7)
mm v[56:59],a[160:163],a[48:51],v[56:59]
tr a[142:143],v248 offset:50432
bl v218,s[28:31],s55 offen offset:2048 lds
mm v[56:59],a[164:167],a[56:59],v[56:59]
tr a[144:145],v247 offset:28992
mm v[60:63],a[160:163],a[52:55],v[60:63]
tr a[146:147],v247 offset:36160
mm v[60:63],a[164:167],a[60:63],v[60:63]
tr a[148:149],v247 offset:43328
s_waitcnt lgkmcnt(7)
mm v[64:67],a[128:131],a[48:51],v[64:67]
tr a[150:151],v247 offset:50496
mm v[64:67],a[132:135],a[56:59],v[64:67]
tr a[152:153],v248 offset:28992
mm v[68:71],a[128:131],a[52:55],v[68:71]
tr a[154:155],v248 offset:36160
bl v219,s[28:31],s55 offen offset:3072 lds
mm v[68:71],a[132:135],a[60:63],v[68:71]
tr a[156:157],v248 offset:43328
s_waitcnt lgkmcnt(7)
mm v[72:75],a[136:139],a[48:51],v[72:75]
tr a[158:159],v248 offset:50496
s_add_u32 s55,s55,131072
mm v[72:75],a[140:143],a[56:59],v[72:75]
tr a[160:161],v247 offset:29056
mm v[76:79],a[136:139],a[52:55],v[76:79]
tr a[162:163],v247 offset:36224
mm v[76:79],a[140:143],a[60:63],v[76:79]
tr a[164:165],v247 offset:43392
s_waitcnt lgkmcnt(7)
mm v[80:83],a[144:147],a[48:51],v[80:83]
tr a[166:167],v247 offset:50560
mm v[80:83],a[148:151],a[56:59],v[80:83]
tr a[128:129],v248 offset:29056
s_waitcnt vmcnt(19)
mm v[84:87],a[144:147],a[52:55],v[84:87]
tr a[130:131],v248 offset:36224
s_barrier
mm v[84:87],a[148:151],a[60:63],v[84:87]
s_add_u32 m0,s50,49152
s_waitcnt lgkmcnt(6)
mm v[88:91],a[152:155],a[48:51],v[88:91]
tr a[132:133],v248 offset:43392
tr a[134:135],v248 offset:50560
mm v[88:91],a[156:159],a[56:59],v[88:91]
tr a[136:137],v249 offset:0
bl v216,s[28:31],s55 offen offset:0 lds
mm v[92:95],a[152:155],a[52:55],v[92:95]
tr a[138:139],v249 offset:7168
mm v[92:95],a[156:159],a[60:63],v[92:95]
tr a[140:141],v249 offset:14336
s_waitcnt lgkmcnt(7)
mm v[96:99],a[160:163],a[48:51],v[96:99]
tr a[142:143],v249 offset:21504
mm v[96:99],a[164:167],a[56:59],v[96:99]
tr a[144:145],v250 offset:0
mm v[100:103],a[160:163],a[52:55],v[100:103]
tr a[146:147],v250 offset:7168
bl v217,s[28:31],s55 offen offset:1024 lds
mm v[100:103],a[164:167],a[60:63],v[100:103]
tr a[148:149],v250 offset:14336
s_waitcnt lgkmcnt(7)
mm v[104:107],a[128:131],a[48:51],v[104:107]
tr a[150:151],v250 offset:21504
mm v[104:107],a[132:135],a[56:59],v[104:107]
tr a[152:153],v249 offset:64
mm v[108:111],a[128:131],a[52:55],v[108:111]
tr a[154:155],v249 offset:7232
mm v[108:111],a[132:135],a[60:63],v[108:111]
tr a[156:157],v249 offset:14400
s_waitcnt lgkmcnt(7)
mm v[0:3],a[136:139],a[64:67],v[0:3]
tr a[158:159],v249 offset:21568
mm v[0:3],a[140:143],a[72:75],v[0:3]
tr a[160:161],v250 offset:64
bl v218,s[28:31],s55 offen offset:2048 lds
mm v[4:7],a[136:139],a[68:71],v[4:7]
tr a[162:163],v250 offset:7232
mm v[4:7],a[140:143],a[76:79],v[4:7]
tr a[164:165],v250 offset:14400
s_waitcnt lgkmcnt(7)
mm v[8:11],a[144:147],a[64:67],v[8:11]
tr a[166:167],v250 offset:21568
mm v[8:11],a[148:151],a[72:75],v[8:11]
tr a[128:129],v249 offset:128
mm v[12:15],a[144:147],a[68:71],v[12:15]
tr a[130:131],v249 offset:7296
mm v[12:15],a[148:151],a[76:79],v[12:15]
tr a[132:133],v249 offset:14464
s_waitcnt lgkmcnt(7)
mm v[16:19],a[152:155],a[64:67],v[16:19]
tr a[134:135],v249 offset:21632
bl v219,s[28:31],s55 offen offset:3072 lds
mm v[16:19],a[156:159],a[72:75],v[16:19]
tr a[136:137],v250 offset:128
s_add_u32 s55,s55,131072
mm v[20:23],a[152:155],a[68:71],v[20:23]
tr a[138:139],v250 offset:7296
s_add_u32 m0,s50,65536
mm v[20:23],a[156:159],a[76:79],v[20:23]
tr a[140:141],v250 offset:14464
s_waitcnt lgkmcnt(7)
mm v[24:27],a[160:163],a[64:67],v[24:27]
tr a[142:143],v250 offset:21632
mm v[24:27],a[164:167],a[72:75],v[24:27]
tr a[144:145],v249 offset:192
mm v[28:31],a[160:163],a[68:71],v[28:31]
tr a[146:147],v249 offset:7360
bl v216,s[28:31],s55 offen offset:0 lds
mm v[28:31],a[164:167],a[76:79],v[28:31]
tr a[148:149],v249 offset:14528
s_waitcnt lgkmcnt(7)
mm v[32:35],a[128:131],a[64:67],v[32:35]
tr a[150:151],v249 offset:21696
mm v[32:35],a[132:135],a[72:75],v[32:35]
tr a[152:153],v250 offset:192
mm v[36:39],a[128:131],a[68:71],v[36:39]
tr a[154:155],v250 offset:7360
mm v[36:39],a[132:135],a[76:79],v[36:39]
tr a[156:157],v250 offset:14528
s_waitcnt lgkmcnt(7)
mm v[40:43],a[136:139],a[64:67],v[40:43]
tr a[158:159],v250 offset:21696
mm v[40:43],a[140:143],a[72:75],v[40:43]
tr a[160:161],v249 offset:256
bl v217,s[28:31],s55 offen offset:1024 lds
mm v[44:47],a[136:139],a[68:71],v[44:47]
tr a[162:163],v249 offset:7424
mm v[44:47],a[140:143],a[76:79],v[44:47]
tr a[164:165],v249 offset:14592
s_waitcnt lgkmcnt(7)
mm v[48:51],a[144:147],a[64:67],v[48:51]
tr a[166:167],v249 offset:21760
mm v[48:51],a[148:151],a[72:75],v[48:51]
tr a[128:129],v250 offset:256
mm v[52:55],a[144:147],a[68:71],v[52:55]
tr a[130:131],v250 offset:7424
mm v[52:55],a[148:151],a[76:79],v[52:55]
tr a[132:133],v250 offset:14592
s_waitcnt lgkmcnt(7)
mm v[56:59],a[152:155],a[64:67],v[56:59]
tr a[134:135],v250 offset:21760
bl v218,s[28:31],s55 offen offset:2048 lds
mm v[56:59],a[156:159],a[72:75],v[56:59]
tr a[136:137],v249 offset:320
mm v[60:63],a[152:155],a[68:71],v[60:63]
tr a[138:139],v249 offset:7488
mm v[60:63],a[156:159],a[76:79],v[60:63]
tr a[140:141],v249 offset:14656
s_waitcnt lgkmcnt(7)
mm v[64:67],a[160:163],a[64:67],v[64:67]
tr a[142:143],v249 offset:21824
mm v[64:67],a[164:167],a[72:75],v[64:67]
tr a[144:145],v250 offset:320
mm v[68:71],a[160:163],a[68:71],v[68:71]
tr a[146:147],v250 offset:7488
bl v219,s[28:31],s55 offen offset:3072 lds
mm v[68:71],a[164:167],a[76:79],v[68:71]
tr a[148:149],v250 offset:14656
s_waitcnt lgkmcnt(7)
mm v[72:75],a[128:131],a[64:67],v[72:75]
tr a[150:151],v250 offset:21824
s_add_u32 s55,s55,131072
mm v[72:75],a[132:135],a[72:75],v[72:75]
tr a[152:153],v249 offset:384
mm v[76:79],a[128:131],a[68:71],v[76:79]
tr a[154:155],v249 offset:7552
mm v[76:79],a[132:135],a[76:79],v[76:79]
tr a[156:157],v249 offset:14720
s_waitcnt lgkmcnt(7)
mm v[80:83],a[136:139],a[64:67],v[80:83]
tr a[158:159],v249 offset:21888
mm v[80:83],a[140:143],a[72:75],v[80:83]
tr a[160:161],v250 offset:384
s_waitcnt vmcnt(16)
mm v[84:87],a[136:139],a[68:71],v[84:87]
tr a[162:163],v250 offset:7552
s_barrier
mm v[84:87],a[140:143],a[76:79],v[84:87]
s_add_u32 m0,s50,81920
s_waitcnt lgkmcnt(6)
mm v[88:91],a[144:147],a[64:67],v[88:91]
tr a[164:165],v250 offset:14720
tr a[166:167],v250 offset:21888
mm v[88:91],a[148:151],a[72:75],v[88:91]
tr a[128:129],v245 offset:0
bl v216,s[28:31],s55 offen offset:0 lds
mm v[92:95],a[144:147],a[68:71],v[92:95]
tr a[130:131],v245 offset:7168
mm v[92:95],a[148:151],a[76:79],v[92:95]
tr a[132:133],v245 offset:14336
s_waitcnt lgkmcnt(7)
mm v[96:99],a[152:155],a[64:67],v[96:99]
tr a[134:135],v245 offset:21504
mm v[96:99],a[156:159],a[72:75],v[96:99]
tr a[136:137],v246 offset:0
mm v[100:103],a[152:155],a[68:71],v[100:103]
tr a[138:139],v246 offset:7168
bl v217,s[28:31],s55 offen offset:1024 lds
mm v[100:103],a[156:159],a[76:79],v[100:103]
tr a[140:141],v246 offset:14336
s_waitcnt lgkmcnt(7)
mm v[104:107],a[160:163],a[64:67],v[104:107]
tr a[142:143],v246 offset:21504
mm v[104:107],a[164:167],a[72:75],v[104:107]
tr a[144:145],v245 offset:64
mm v[108:111],a[160:163],a[68:71],v[108:111]
tr a[146:147],v245 offset:7232
mm v[108:111],a[164:167],a[76:79],v[108:111]
tr a[148:149],v245 offset:14400
s_waitcnt lgkmcnt(7)
mm v[0:3],a[128:131],a[0:3],v[0:3]
tr a[150:151],v245 offset:21568
mm v[0:3],a[132:135],a[8:11],v[0:3]
tr a[152:153],v246 offset:64
bl v218,s[28:31],s55 offen offset:2048 lds
mm v[4:7],a[128:131],a[4:7],v[4:7]
tr a[154:155],v246 offset:7232
mm v[4:7],a[132:135],a[12:15],v[4:7]
tr a[156:157],v246 offset:14400
s_waitcnt lgkmcnt(7)
mm v[8:11],a[136:139],a[0:3],v[8:11]
tr a[158:159],v246 offset:21568
mm v[8:11],a[140:143],a[8:11],v[8:11]
tr a[160:161],v245 offset:128
mm v[12:15],a[136:139],a[4:7],v[12:15]
tr a[162:163],v245 offset:7296
mm v[12:15],a[140:143],a[12:15],v[12:15]
tr a[164:165],v245 offset:14464
s_waitcnt lgkmcnt(7)
mm v[16:19],a[144:147],a[0:3],v[16:19]
tr a[166:167],v245 offset:21632
bl v219,s[28:31],s55 offen offset:3072 lds
mm v[16:19],a[148:151],a[8:11],v[16:19]
tr a[128:129],v246 offset:128
s_add_u32 s55,s55,131072
mm v[20:23],a[144:147],a[4:7],v[20:23]
tr a[130:131],v246 offset:7296
s_add_u32 m0,s50,98304
mm v[20:23],a[148:151],a[12:15],v[20:23]
tr a[132:133],v246 offset:14464
s_waitcnt lgkmcnt(7)
mm v[24:27],a[152:155],a[0:3],v[24:27]
tr a[134:135],v246 offset:21632
mm v[24:27],a[156:159],a[8:11],v[24:27]
tr a[136:137],v245 offset:192
mm v[28:31],a[152:155],a[4:7],v[28:31]
tr a[138:139],v245 offset:7360
bl v216,s[28:31],s55 offen offset:0 lds
mm v[28:31],a[156:159],a[12:15],v[28:31]
tr a[140:141],v245 offset:14528
s_waitcnt lgkmcnt(7)
mm v[32:35],a[160:163],a[0:3],v[32:35]
tr a[142:143],v245 offset:21696
mm v[32:35],a[164:167],a[8:11],v[32:35]
tr a[144:145],v246 offset:192
mm v[36:39],a[160:163],a[4:7],v[36:39]
tr a[146:147],v246 offset:7360
mm v[36:39],a[164:167],a[12:15],v[36:39]
tr a[148:149],v246 offset:14528
s_waitcnt lgkmcnt(7)
mm v[40:43],a[128:131],a[0:3],v[40:43]
tr a[150:151],v246 offset:21696
mm v[40:43],a[132:135],a[8:11],v[40:43]
tr a[152:153],v245 offset:256
bl v217,s[28:31],s55 offen offset:1024 lds
mm v[44:47],a[128:131],a[4:7],v[44:47]
tr a[154:155],v245 offset:7424
mm v[44:47],a[132:135],a[12:15],v[44:47]
tr a[156:157],v245 offset:14592
s_waitcnt lgkmcnt(7)
mm v[48:51],a[136:139],a[0:3],v[48:51]
tr a[158:159],v245 offset:21760
mm v[48:51],a[140:143],a[8:11],v[48:51]
tr a[160:161],v246 offset:256
mm v[52:55],a[136:139],a[4:7],v[52:55]
tr a[162:163],v246 offset:7424
mm v[52:55],a[140:143],a[12:15],v[52:55]
tr a[164:165],v246 offset:14592
s_waitcnt lgkmcnt(7)
mm v[56:59],a[144:147],a[0:3],v[56:59]
tr a[166:167],v246 offset:21760
bl v218,s[28:31],s55 offen offset:2048 lds
mm v[56:59],a[148:151],a[8:11],v[56:59]
tr a[128:129],v245 offset:320
mm v[60:63],a[144:147],a[4:7],v[60:63]
tr a[130:131],v245 offset:7488
mm v[60:63],a[148:151],a[12:15],v[60:63]
tr a[132:133],v245 offset:14656
s_waitcnt lgkmcnt(7)
mm v[64:67],a[152:155],a[0:3],v[64:67]
tr a[134:135],v245 offset:21824
mm v[64:67],a[156:159],a[8:11],v[64:67]
tr a[136:137],v246 offset:320
mm v[68:71],a[152:155],a[4:7],v[68:71]
tr a[138:139],v246 offset:7488
bl v219,s[28:31],s55 offen offset:3072 lds
mm v[68:71],a[156:159],a[12:15],v[68:71]
tr a[140:141],v246 offset:14656
s_waitcnt lgkmcnt(7)
mm v[72:75],a[160:163],a[0:3],v[72:75]
tr a[142:143],v246 offset:21824
s_add_u32 s55,s55,131072
mm v[72:75],a[164:167],a[8:11],v[72:75]
tr a[144:145],v245 offset:384
mm v[76:79],a[160:163],a[4:7],v[76:79]
tr a[146:147],v245 offset:7552
mm v[76:79],a[164:167],a[12:15],v[76:79]
tr a[148:149],v245 offset:14720
s_waitcnt lgkmcnt(7)
mm v[80:83],a[128:131],a[0:3],v[80:83]
tr a[150:151],v245 offset:21888
mm v[80:83],a[132:135],a[8:11],v[80:83]
tr a[152:153],v246 offset:384
mm v[84:87],a[128:131],a[4:7],v[84:87]
tr a[154:155],v246 offset:7552
s_barrier
mm v[84:87],a[132:135],a[12:15],v[84:87]
s_add_u32 m0,s50,114688
s_waitcnt lgkmcnt(6)
mm v[88:91],a[136:139],a[0:3],v[88:91]
tr a[156:157],v246 offset:14720
tr a[158:159],v246 offset:21888
mm v[88:91],a[140:143],a[8:11],v[88:91]
bl v216,s[28:31],s55 offen offset:0 lds
mm v[92:95],a[136:139],a[4:7],v[92:95]
mm v[92:95],a[140:143],a[12:15],v[92:95]
bl v217,s[28:31],s55 offen offset:1024 lds
s_waitcnt lgkmcnt(4)
mm v[96:99],a[144:147],a[0:3],v[96:99]
mm v[96:99],a[148:151],a[8:11],v[96:99]
mm v[100:103],a[144:147],a[4:7],v[100:103]
bl v218,s[28:31],s55 offen offset:2048 lds
mm v[100:103],a[148:151],a[12:15],v[100:103]
s_waitcnt lgkmcnt(0)
mm v[104:107],a[152:155],a[0:3],v[104:107]
mm v[104:107],a[156:159],a[8:11],v[104:107]
bl v219,s[28:31],s55 offen offset:3072 lds
s_add_u32 s55,s55,131072
mm v[108:111],a[152:155],a[4:7],v[108:111]
mm v[108:111],a[156:159],a[12:15],v[108:111]
tail_Cepi:
s_barrier
s_add_u32 m0,s50,0
s_mov_b32 s24,0xc0135761
s_mov_b32 s25,0xbdd2d3e8
v_mov_b32 v176,s24
v_mov_b32 v177,s24
v_mov_b32 v178,s25
v_mov_b32 v179,s25
v_mov_b32 v180,1.0
v_mov_b32 v181,1.0
v_pk_mul_f32 v[152:153],v[0:1],v[0:1]
v_pk_mul_f32 v[154:155],v[2:3],v[2:3]
v_pk_mul_f32 v[156:157],v[8:9],v[8:9]
v_pk_mul_f32 v[158:159],v[10:11],v[10:11]
v_pk_mul_f32 v[160:161],v[4:5],v[4:5]
v_pk_mul_f32 v[162:163],v[6:7],v[6:7]
v_pk_mul_f32 v[164:165],v[12:13],v[12:13]
v_pk_mul_f32 v[166:167],v[14:15],v[14:15]
v_pk_fma_f32 v[152:153],v[152:153],v[178:179],v[176:177]
v_pk_fma_f32 v[154:155],v[154:155],v[178:179],v[176:177]
v_pk_fma_f32 v[156:157],v[156:157],v[178:179],v[176:177]
v_pk_fma_f32 v[158:159],v[158:159],v[178:179],v[176:177]
v_pk_fma_f32 v[160:161],v[160:161],v[178:179],v[176:177]
v_pk_fma_f32 v[162:163],v[162:163],v[178:179],v[176:177]
v_pk_fma_f32 v[164:165],v[164:165],v[178:179],v[176:177]
v_pk_fma_f32 v[166:167],v[166:167],v[178:179],v[176:177]
v_pk_mul_f32 v[152:153],v[152:153],v[0:1]
v_pk_mul_f32 v[154:155],v[154:155],v[2:3]
v_pk_mul_f32 v[156:157],v[156:157],v[8:9]
v_pk_mul_f32 v[158:159],v[158:159],v[10:11]
v_pk_mul_f32 v[160:161],v[160:161],v[4:5]
v_pk_mul_f32 v[162:163],v[162:163],v[6:7]
v_pk_mul_f32 v[164:165],v[164:165],v[12:13]
v_pk_mul_f32 v[166:167],v[166:167],v[14:15]
v_exp_f32 v152,v152
v_exp_f32 v153,v153
v_exp_f32 v154,v154
v_exp_f32 v155,v155
v_exp_f32 v156,v156
v_exp_f32 v157,v157
bl v216,s[28:31],s55 offen offset:0 lds
v_exp_f32 v158,v158
v_exp_f32 v159,v159
v_exp_f32 v160,v160
v_exp_f32 v161,v161
v_exp_f32 v162,v162
v_exp_f32 v163,v163
v_exp_f32 v164,v164
v_exp_f32 v165,v165
v_exp_f32 v166,v166
v_exp_f32 v167,v167
v_pk_add_f32 v[152:153],v[152:153],v[180:181]
v_pk_add_f32 v[154:155],v[154:155],v[180:181]
v_pk_add_f32 v[156:157],v[156:157],v[180:181]
v_pk_add_f32 v[158:159],v[158:159],v[180:181]
v_pk_add_f32 v[160:161],v[160:161],v[180:181]
v_pk_add_f32 v[162:163],v[162:163],v[180:181]
v_pk_add_f32 v[164:165],v[164:165],v[180:181]
v_pk_add_f32 v[166:167],v[166:167],v[180:181]
v_rcp_f32 v152,v152
v_rcp_f32 v153,v153
v_rcp_f32 v154,v154
v_rcp_f32 v155,v155
v_rcp_f32 v156,v156
v_rcp_f32 v157,v157
v_rcp_f32 v158,v158
v_rcp_f32 v159,v159
v_rcp_f32 v160,v160
v_rcp_f32 v161,v161
v_rcp_f32 v162,v162
v_rcp_f32 v163,v163
v_rcp_f32 v164,v164
v_rcp_f32 v165,v165
v_rcp_f32 v166,v166
v_rcp_f32 v167,v167
v_pk_mul_f32 v[0:1],v[0:1],v[152:153]
v_pk_mul_f32 v[2:3],v[2:3],v[154:155]
v_pk_mul_f32 v[8:9],v[8:9],v[156:157]
bl v217,s[28:31],s55 offen offset:1024 lds
v_pk_mul_f32 v[10:11],v[10:11],v[158:159]
v_pk_mul_f32 v[4:5],v[4:5],v[160:161]
v_pk_mul_f32 v[6:7],v[6:7],v[162:163]
v_pk_mul_f32 v[12:13],v[12:13],v[164:165]
v_pk_mul_f32 v[14:15],v[14:15],v[166:167]
cv v0,v0,v1
cv v1,v2,v3
cv v2,v8,v9
cv v3,v10,v11
s_add_u32 s24,s27,0
buffer_store_dwordx4 v[0:3],v254,s[8:11],s24 offen sc1
cv v4,v4,v5
cv v5,v6,v7
cv v6,v12,v13
cv v7,v14,v15
s_add_u32 s24,s27,114688
buffer_store_dwordx4 v[4:7],v254,s[8:11],s24 offen sc1
v_pk_mul_f32 v[152:153],v[16:17],v[16:17]
v_pk_mul_f32 v[154:155],v[18:19],v[18:19]
v_pk_mul_f32 v[156:157],v[24:25],v[24:25]
v_pk_mul_f32 v[158:159],v[26:27],v[26:27]
v_pk_mul_f32 v[160:161],v[20:21],v[20:21]
v_pk_mul_f32 v[162:163],v[22:23],v[22:23]
v_pk_mul_f32 v[164:165],v[28:29],v[28:29]
v_pk_mul_f32 v[166:167],v[30:31],v[30:31]
v_pk_fma_f32 v[152:153],v[152:153],v[178:179],v[176:177]
v_pk_fma_f32 v[154:155],v[154:155],v[178:179],v[176:177]
v_pk_fma_f32 v[156:157],v[156:157],v[178:179],v[176:177]
v_pk_fma_f32 v[158:159],v[158:159],v[178:179],v[176:177]
v_pk_fma_f32 v[160:161],v[160:161],v[178:179],v[176:177]
v_pk_fma_f32 v[162:163],v[162:163],v[178:179],v[176:177]
v_pk_fma_f32 v[164:165],v[164:165],v[178:179],v[176:177]
v_pk_fma_f32 v[166:167],v[166:167],v[178:179],v[176:177]
v_pk_mul_f32 v[152:153],v[152:153],v[16:17]
v_pk_mul_f32 v[154:155],v[154:155],v[18:19]
v_pk_mul_f32 v[156:157],v[156:157],v[24:25]
v_pk_mul_f32 v[158:159],v[158:159],v[26:27]
bl v218,s[28:31],s55 offen offset:2048 lds
v_pk_mul_f32 v[160:161],v[160:161],v[20:21]
v_pk_mul_f32 v[162:163],v[162:163],v[22:23]
v_pk_mul_f32 v[164:165],v[164:165],v[28:29]
v_pk_mul_f32 v[166:167],v[166:167],v[30:31]
v_exp_f32 v152,v152
v_exp_f32 v153,v153
v_exp_f32 v154,v154
v_exp_f32 v155,v155
v_exp_f32 v156,v156
v_exp_f32 v157,v157
v_exp_f32 v158,v158
v_exp_f32 v159,v159
v_exp_f32 v160,v160
v_exp_f32 v161,v161
v_exp_f32 v162,v162
v_exp_f32 v163,v163
v_exp_f32 v164,v164
v_exp_f32 v165,v165
v_exp_f32 v166,v166
v_exp_f32 v167,v167
v_pk_add_f32 v[152:153],v[152:153],v[180:181]
v_pk_add_f32 v[154:155],v[154:155],v[180:181]
v_pk_add_f32 v[156:157],v[156:157],v[180:181]
v_pk_add_f32 v[158:159],v[158:159],v[180:181]
v_pk_add_f32 v[160:161],v[160:161],v[180:181]
v_pk_add_f32 v[162:163],v[162:163],v[180:181]
v_pk_add_f32 v[164:165],v[164:165],v[180:181]
v_pk_add_f32 v[166:167],v[166:167],v[180:181]
v_rcp_f32 v152,v152
v_rcp_f32 v153,v153
v_rcp_f32 v154,v154
v_rcp_f32 v155,v155
v_rcp_f32 v156,v156
v_rcp_f32 v157,v157
v_rcp_f32 v158,v158
v_rcp_f32 v159,v159
v_rcp_f32 v160,v160
bl v219,s[28:31],s55 offen offset:3072 lds
v_rcp_f32 v161,v161
v_rcp_f32 v162,v162
v_rcp_f32 v163,v163
v_rcp_f32 v164,v164
v_rcp_f32 v165,v165
v_rcp_f32 v166,v166
v_rcp_f32 v167,v167
v_pk_mul_f32 v[16:17],v[16:17],v[152:153]
v_pk_mul_f32 v[18:19],v[18:19],v[154:155]
v_pk_mul_f32 v[24:25],v[24:25],v[156:157]
v_pk_mul_f32 v[26:27],v[26:27],v[158:159]
v_pk_mul_f32 v[20:21],v[20:21],v[160:161]
v_pk_mul_f32 v[22:23],v[22:23],v[162:163]
v_pk_mul_f32 v[28:29],v[28:29],v[164:165]
v_pk_mul_f32 v[30:31],v[30:31],v[166:167]
cv v16,v16,v17
cv v17,v18,v19
cv v18,v24,v25
cv v19,v26,v27
s_add_u32 s24,s27,1024
buffer_store_dwordx4 v[16:19],v254,s[8:11],s24 offen sc1
cv v20,v20,v21
cv v21,v22,v23
cv v22,v28,v29
cv v23,v30,v31
s_add_u32 s24,s27,115712
buffer_store_dwordx4 v[20:23],v254,s[8:11],s24 offen sc1
v_pk_mul_f32 v[152:153],v[32:33],v[32:33]
v_pk_mul_f32 v[154:155],v[34:35],v[34:35]
v_pk_mul_f32 v[156:157],v[40:41],v[40:41]
v_pk_mul_f32 v[158:159],v[42:43],v[42:43]
v_pk_mul_f32 v[160:161],v[36:37],v[36:37]
v_pk_mul_f32 v[162:163],v[38:39],v[38:39]
v_pk_mul_f32 v[164:165],v[44:45],v[44:45]
v_pk_mul_f32 v[166:167],v[46:47],v[46:47]
v_pk_fma_f32 v[152:153],v[152:153],v[178:179],v[176:177]
v_pk_fma_f32 v[154:155],v[154:155],v[178:179],v[176:177]
s_add_u32 s55,s55,131072
v_pk_fma_f32 v[156:157],v[156:157],v[178:179],v[176:177]
v_pk_fma_f32 v[158:159],v[158:159],v[178:179],v[176:177]
v_pk_fma_f32 v[160:161],v[160:161],v[178:179],v[176:177]
v_pk_fma_f32 v[162:163],v[162:163],v[178:179],v[176:177]
v_pk_fma_f32 v[164:165],v[164:165],v[178:179],v[176:177]
v_pk_fma_f32 v[166:167],v[166:167],v[178:179],v[176:177]
v_pk_mul_f32 v[152:153],v[152:153],v[32:33]
v_pk_mul_f32 v[154:155],v[154:155],v[34:35]
v_pk_mul_f32 v[156:157],v[156:157],v[40:41]
v_pk_mul_f32 v[158:159],v[158:159],v[42:43]
v_pk_mul_f32 v[160:161],v[160:161],v[36:37]
v_pk_mul_f32 v[162:163],v[162:163],v[38:39]
v_pk_mul_f32 v[164:165],v[164:165],v[44:45]
v_pk_mul_f32 v[166:167],v[166:167],v[46:47]
v_exp_f32 v152,v152
v_exp_f32 v153,v153
v_exp_f32 v154,v154
v_exp_f32 v155,v155
v_exp_f32 v156,v156
v_exp_f32 v157,v157
v_exp_f32 v158,v158
v_exp_f32 v159,v159
v_exp_f32 v160,v160
v_exp_f32 v161,v161
v_exp_f32 v162,v162
v_exp_f32 v163,v163
v_exp_f32 v164,v164
v_exp_f32 v165,v165
v_exp_f32 v166,v166
v_exp_f32 v167,v167
v_pk_add_f32 v[152:153],v[152:153],v[180:181]
v_pk_add_f32 v[154:155],v[154:155],v[180:181]
v_pk_add_f32 v[156:157],v[156:157],v[180:181]
v_pk_add_f32 v[158:159],v[158:159],v[180:181]
v_pk_add_f32 v[160:161],v[160:161],v[180:181]
v_pk_add_f32 v[162:163],v[162:163],v[180:181]
v_pk_add_f32 v[164:165],v[164:165],v[180:181]
s_add_u32 m0,s50,16384
v_pk_add_f32 v[166:167],v[166:167],v[180:181]
v_rcp_f32 v152,v152
v_rcp_f32 v153,v153
v_rcp_f32 v154,v154
v_rcp_f32 v155,v155
v_rcp_f32 v156,v156
v_rcp_f32 v157,v157
v_rcp_f32 v158,v158
v_rcp_f32 v159,v159
v_rcp_f32 v160,v160
v_rcp_f32 v161,v161
v_rcp_f32 v162,v162
v_rcp_f32 v163,v163
v_rcp_f32 v164,v164
v_rcp_f32 v165,v165
v_rcp_f32 v166,v166
v_rcp_f32 v167,v167
v_pk_mul_f32 v[32:33],v[32:33],v[152:153]
v_pk_mul_f32 v[34:35],v[34:35],v[154:155]
v_pk_mul_f32 v[40:41],v[40:41],v[156:157]
v_pk_mul_f32 v[42:43],v[42:43],v[158:159]
v_pk_mul_f32 v[36:37],v[36:37],v[160:161]
v_pk_mul_f32 v[38:39],v[38:39],v[162:163]
v_pk_mul_f32 v[44:45],v[44:45],v[164:165]
v_pk_mul_f32 v[46:47],v[46:47],v[166:167]
cv v32,v32,v33
cv v33,v34,v35
cv v34,v40,v41
cv v35,v42,v43
s_add_u32 s24,s27,2048
buffer_store_dwordx4 v[32:35],v254,s[8:11],s24 offen sc1
cv v36,v36,v37
cv v37,v38,v39
cv v38,v44,v45
cv v39,v46,v47
s_add_u32 s24,s27,116736
buffer_store_dwordx4 v[36:39],v254,s[8:11],s24 offen sc1
v_pk_mul_f32 v[152:153],v[48:49],v[48:49]
bl v216,s[28:31],s55 offen offset:0 lds
v_pk_mul_f32 v[154:155],v[50:51],v[50:51]
v_pk_mul_f32 v[156:157],v[56:57],v[56:57]
v_pk_mul_f32 v[158:159],v[58:59],v[58:59]
v_pk_mul_f32 v[160:161],v[52:53],v[52:53]
v_pk_mul_f32 v[162:163],v[54:55],v[54:55]
v_pk_mul_f32 v[164:165],v[60:61],v[60:61]
v_pk_mul_f32 v[166:167],v[62:63],v[62:63]
v_pk_fma_f32 v[152:153],v[152:153],v[178:179],v[176:177]
v_pk_fma_f32 v[154:155],v[154:155],v[178:179],v[176:177]
v_pk_fma_f32 v[156:157],v[156:157],v[178:179],v[176:177]
v_pk_fma_f32 v[158:159],v[158:159],v[178:179],v[176:177]
v_pk_fma_f32 v[160:161],v[160:161],v[178:179],v[176:177]
v_pk_fma_f32 v[162:163],v[162:163],v[178:179],v[176:177]
v_pk_fma_f32 v[164:165],v[164:165],v[178:179],v[176:177]
v_pk_fma_f32 v[166:167],v[166:167],v[178:179],v[176:177]
v_pk_mul_f32 v[152:153],v[152:153],v[48:49]
v_pk_mul_f32 v[154:155],v[154:155],v[50:51]
v_pk_mul_f32 v[156:157],v[156:157],v[56:57]
v_pk_mul_f32 v[158:159],v[158:159],v[58:59]
v_pk_mul_f32 v[160:161],v[160:161],v[52:53]
v_pk_mul_f32 v[162:163],v[162:163],v[54:55]
v_pk_mul_f32 v[164:165],v[164:165],v[60:61]
v_pk_mul_f32 v[166:167],v[166:167],v[62:63]
v_exp_f32 v152,v152
v_exp_f32 v153,v153
v_exp_f32 v154,v154
v_exp_f32 v155,v155
v_exp_f32 v156,v156
v_exp_f32 v157,v157
v_exp_f32 v158,v158
v_exp_f32 v159,v159
v_exp_f32 v160,v160
v_exp_f32 v161,v161
v_exp_f32 v162,v162
v_exp_f32 v163,v163
v_exp_f32 v164,v164
v_exp_f32 v165,v165
bl v217,s[28:31],s55 offen offset:1024 lds
v_exp_f32 v166,v166
v_exp_f32 v167,v167
v_pk_add_f32 v[152:153],v[152:153],v[180:181]
v_pk_add_f32 v[154:155],v[154:155],v[180:181]
v_pk_add_f32 v[156:157],v[156:157],v[180:181]
v_pk_add_f32 v[158:159],v[158:159],v[180:181]
v_pk_add_f32 v[160:161],v[160:161],v[180:181]
v_pk_add_f32 v[162:163],v[162:163],v[180:181]
v_pk_add_f32 v[164:165],v[164:165],v[180:181]
v_pk_add_f32 v[166:167],v[166:167],v[180:181]
v_rcp_f32 v152,v152
v_rcp_f32 v153,v153
v_rcp_f32 v154,v154
v_rcp_f32 v155,v155
v_rcp_f32 v156,v156
v_rcp_f32 v157,v157
v_rcp_f32 v158,v158
v_rcp_f32 v159,v159
v_rcp_f32 v160,v160
v_rcp_f32 v161,v161
v_rcp_f32 v162,v162
v_rcp_f32 v163,v163
v_rcp_f32 v164,v164
v_rcp_f32 v165,v165
v_rcp_f32 v166,v166
v_rcp_f32 v167,v167
v_pk_mul_f32 v[48:49],v[48:49],v[152:153]
v_pk_mul_f32 v[50:51],v[50:51],v[154:155]
v_pk_mul_f32 v[56:57],v[56:57],v[156:157]
v_pk_mul_f32 v[58:59],v[58:59],v[158:159]
v_pk_mul_f32 v[52:53],v[52:53],v[160:161]
v_pk_mul_f32 v[54:55],v[54:55],v[162:163]
v_pk_mul_f32 v[60:61],v[60:61],v[164:165]
v_pk_mul_f32 v[62:63],v[62:63],v[166:167]
cv v48,v48,v49
cv v49,v50,v51
cv v50,v56,v57
bl v218,s[28:31],s55 offen offset:2048 lds
cv v51,v58,v59
s_add_u32 s24,s27,3072
buffer_store_dwordx4 v[48:51],v254,s[8:11],s24 offen sc1
cv v52,v52,v53
cv v53,v54,v55
cv v54,v60,v61
cv v55,v62,v63
s_add_u32 s24,s27,117760
buffer_store_dwordx4 v[52:55],v254,s[8:11],s24 offen sc1
v_pk_mul_f32 v[152:153],v[64:65],v[64:65]
v_pk_mul_f32 v[154:155],v[66:67],v[66:67]
v_pk_mul_f32 v[156:157],v[72:73],v[72:73]
v_pk_mul_f32 v[158:159],v[74:75],v[74:75]
v_pk_mul_f32 v[160:161],v[68:69],v[68:69]
v_pk_mul_f32 v[162:163],v[70:71],v[70:71]
v_pk_mul_f32 v[164:165],v[76:77],v[76:77]
v_pk_mul_f32 v[166:167],v[78:79],v[78:79]
v_pk_fma_f32 v[152:153],v[152:153],v[178:179],v[176:177]
v_pk_fma_f32 v[154:155],v[154:155],v[178:179],v[176:177]
v_pk_fma_f32 v[156:157],v[156:157],v[178:179],v[176:177]
v_pk_fma_f32 v[158:159],v[158:159],v[178:179],v[176:177]
v_pk_fma_f32 v[160:161],v[160:161],v[178:179],v[176:177]
v_pk_fma_f32 v[162:163],v[162:163],v[178:179],v[176:177]
v_pk_fma_f32 v[164:165],v[164:165],v[178:179],v[176:177]
v_pk_fma_f32 v[166:167],v[166:167],v[178:179],v[176:177]
v_pk_mul_f32 v[152:153],v[152:153],v[64:65]
v_pk_mul_f32 v[154:155],v[154:155],v[66:67]
v_pk_mul_f32 v[156:157],v[156:157],v[72:73]
v_pk_mul_f32 v[158:159],v[158:159],v[74:75]
v_pk_mul_f32 v[160:161],v[160:161],v[68:69]
v_pk_mul_f32 v[162:163],v[162:163],v[70:71]
v_pk_mul_f32 v[164:165],v[164:165],v[76:77]
v_pk_mul_f32 v[166:167],v[166:167],v[78:79]
v_exp_f32 v152,v152
v_exp_f32 v153,v153
v_exp_f32 v154,v154
v_exp_f32 v155,v155
bl v219,s[28:31],s55 offen offset:3072 lds
v_exp_f32 v156,v156
v_exp_f32 v157,v157
v_exp_f32 v158,v158
v_exp_f32 v159,v159
v_exp_f32 v160,v160
v_exp_f32 v161,v161
v_exp_f32 v162,v162
v_exp_f32 v163,v163
v_exp_f32 v164,v164
v_exp_f32 v165,v165
v_exp_f32 v166,v166
v_exp_f32 v167,v167
v_pk_add_f32 v[152:153],v[152:153],v[180:181]
v_pk_add_f32 v[154:155],v[154:155],v[180:181]
v_pk_add_f32 v[156:157],v[156:157],v[180:181]
v_pk_add_f32 v[158:159],v[158:159],v[180:181]
v_pk_add_f32 v[160:161],v[160:161],v[180:181]
v_pk_add_f32 v[162:163],v[162:163],v[180:181]
v_pk_add_f32 v[164:165],v[164:165],v[180:181]
v_pk_add_f32 v[166:167],v[166:167],v[180:181]
v_rcp_f32 v152,v152
v_rcp_f32 v153,v153
v_rcp_f32 v154,v154
v_rcp_f32 v155,v155
v_rcp_f32 v156,v156
v_rcp_f32 v157,v157
v_rcp_f32 v158,v158
v_rcp_f32 v159,v159
v_rcp_f32 v160,v160
v_rcp_f32 v161,v161
v_rcp_f32 v162,v162
v_rcp_f32 v163,v163
v_rcp_f32 v164,v164
v_rcp_f32 v165,v165
v_rcp_f32 v166,v166
v_rcp_f32 v167,v167
v_pk_mul_f32 v[64:65],v[64:65],v[152:153]
s_add_u32 s55,s55,131072
v_pk_mul_f32 v[66:67],v[66:67],v[154:155]
v_pk_mul_f32 v[72:73],v[72:73],v[156:157]
v_pk_mul_f32 v[74:75],v[74:75],v[158:159]
v_pk_mul_f32 v[68:69],v[68:69],v[160:161]
v_pk_mul_f32 v[70:71],v[70:71],v[162:163]
v_pk_mul_f32 v[76:77],v[76:77],v[164:165]
v_pk_mul_f32 v[78:79],v[78:79],v[166:167]
cv v64,v64,v65
cv v65,v66,v67
cv v66,v72,v73
cv v67,v74,v75
s_add_u32 s24,s27,4096
buffer_store_dwordx4 v[64:67],v254,s[8:11],s24 offen sc1
cv v68,v68,v69
cv v69,v70,v71
cv v70,v76,v77
cv v71,v78,v79
s_add_u32 s24,s27,118784
buffer_store_dwordx4 v[68:71],v254,s[8:11],s24 offen sc1
v_pk_mul_f32 v[152:153],v[80:81],v[80:81]
v_pk_mul_f32 v[154:155],v[82:83],v[82:83]
v_pk_mul_f32 v[156:157],v[88:89],v[88:89]
v_pk_mul_f32 v[158:159],v[90:91],v[90:91]
v_pk_mul_f32 v[160:161],v[84:85],v[84:85]
v_pk_mul_f32 v[162:163],v[86:87],v[86:87]
v_pk_mul_f32 v[164:165],v[92:93],v[92:93]
v_pk_mul_f32 v[166:167],v[94:95],v[94:95]
v_pk_fma_f32 v[152:153],v[152:153],v[178:179],v[176:177]
v_pk_fma_f32 v[154:155],v[154:155],v[178:179],v[176:177]
v_pk_fma_f32 v[156:157],v[156:157],v[178:179],v[176:177]
v_pk_fma_f32 v[158:159],v[158:159],v[178:179],v[176:177]
v_pk_fma_f32 v[160:161],v[160:161],v[178:179],v[176:177]
v_pk_fma_f32 v[162:163],v[162:163],v[178:179],v[176:177]
v_pk_fma_f32 v[164:165],v[164:165],v[178:179],v[176:177]
v_pk_fma_f32 v[166:167],v[166:167],v[178:179],v[176:177]
v_pk_mul_f32 v[152:153],v[152:153],v[80:81]
v_pk_mul_f32 v[154:155],v[154:155],v[82:83]
v_pk_mul_f32 v[156:157],v[156:157],v[88:89]
v_pk_mul_f32 v[158:159],v[158:159],v[90:91]
v_pk_mul_f32 v[160:161],v[160:161],v[84:85]
v_pk_mul_f32 v[162:163],v[162:163],v[86:87]
v_pk_mul_f32 v[164:165],v[164:165],v[92:93]
v_pk_mul_f32 v[166:167],v[166:167],v[94:95]
v_exp_f32 v152,v152
v_exp_f32 v153,v153
v_exp_f32 v154,v154
v_exp_f32 v155,v155
v_exp_f32 v156,v156
v_exp_f32 v157,v157
v_exp_f32 v158,v158
v_exp_f32 v159,v159
v_exp_f32 v160,v160
v_exp_f32 v161,v161
v_exp_f32 v162,v162
v_exp_f32 v163,v163
v_exp_f32 v164,v164
v_exp_f32 v165,v165
v_exp_f32 v166,v166
v_exp_f32 v167,v167
v_pk_add_f32 v[152:153],v[152:153],v[180:181]
v_pk_add_f32 v[154:155],v[154:155],v[180:181]
v_pk_add_f32 v[156:157],v[156:157],v[180:181]
v_pk_add_f32 v[158:159],v[158:159],v[180:181]
v_pk_add_f32 v[160:161],v[160:161],v[180:181]
v_pk_add_f32 v[162:163],v[162:163],v[180:181]
v_pk_add_f32 v[164:165],v[164:165],v[180:181]
v_pk_add_f32 v[166:167],v[166:167],v[180:181]
v_rcp_f32 v152,v152
v_rcp_f32 v153,v153
v_rcp_f32 v154,v154
v_rcp_f32 v155,v155
v_rcp_f32 v156,v156
v_rcp_f32 v157,v157
v_rcp_f32 v158,v158
v_rcp_f32 v159,v159
v_rcp_f32 v160,v160
v_rcp_f32 v161,v161
v_rcp_f32 v162,v162
v_rcp_f32 v163,v163
v_rcp_f32 v164,v164
v_rcp_f32 v165,v165
v_rcp_f32 v166,v166
v_rcp_f32 v167,v167
v_pk_mul_f32 v[80:81],v[80:81],v[152:153]
v_pk_mul_f32 v[82:83],v[82:83],v[154:155]
v_pk_mul_f32 v[88:89],v[88:89],v[156:157]
v_pk_mul_f32 v[90:91],v[90:91],v[158:159]
v_pk_mul_f32 v[84:85],v[84:85],v[160:161]
v_pk_mul_f32 v[86:87],v[86:87],v[162:163]
v_pk_mul_f32 v[92:93],v[92:93],v[164:165]
v_pk_mul_f32 v[94:95],v[94:95],v[166:167]
cv v80,v80,v81
cv v81,v82,v83
cv v82,v88,v89
cv v83,v90,v91
s_add_u32 s24,s27,5120
buffer_store_dwordx4 v[80:83],v254,s[8:11],s24 offen sc1
cv v84,v84,v85
cv v85,v86,v87
cv v86,v92,v93
cv v87,v94,v95
s_add_u32 s24,s27,119808
buffer_store_dwordx4 v[84:87],v254,s[8:11],s24 offen sc1
v_pk_mul_f32 v[152:153],v[96:97],v[96:97]
v_pk_mul_f32 v[154:155],v[98:99],v[98:99]
v_pk_mul_f32 v[156:157],v[104:105],v[104:105]
v_pk_mul_f32 v[158:159],v[106:107],v[106:107]
v_pk_mul_f32 v[160:161],v[100:101],v[100:101]
v_pk_mul_f32 v[162:163],v[102:103],v[102:103]
v_pk_mul_f32 v[164:165],v[108:109],v[108:109]
v_pk_mul_f32 v[166:167],v[110:111],v[110:111]
v_pk_fma_f32 v[152:153],v[152:153],v[178:179],v[176:177]
v_pk_fma_f32 v[154:155],v[154:155],v[178:179],v[176:177]
v_pk_fma_f32 v[156:157],v[156:157],v[178:179],v[176:177]
v_pk_fma_f32 v[158:159],v[158:159],v[178:179],v[176:177]
v_pk_fma_f32 v[160:161],v[160:161],v[178:179],v[176:177]
v_pk_fma_f32 v[162:163],v[162:163],v[178:179],v[176:177]
v_pk_fma_f32 v[164:165],v[164:165],v[178:179],v[176:177]
v_pk_fma_f32 v[166:167],v[166:167],v[178:179],v[176:177]
v_pk_mul_f32 v[152:153],v[152:153],v[96:97]
v_pk_mul_f32 v[154:155],v[154:155],v[98:99]
v_pk_mul_f32 v[156:157],v[156:157],v[104:105]
v_pk_mul_f32 v[158:159],v[158:159],v[106:107]
v_pk_mul_f32 v[160:161],v[160:161],v[100:101]
v_pk_mul_f32 v[162:163],v[162:163],v[102:103]
v_pk_mul_f32 v[164:165],v[164:165],v[108:109]
v_pk_mul_f32 v[166:167],v[166:167],v[110:111]
v_exp_f32 v152,v152
v_exp_f32 v153,v153
v_exp_f32 v154,v154
v_exp_f32 v155,v155
v_exp_f32 v156,v156
v_exp_f32 v157,v157
v_exp_f32 v158,v158
v_exp_f32 v159,v159
v_exp_f32 v160,v160
v_exp_f32 v161,v161
v_exp_f32 v162,v162
v_exp_f32 v163,v163
v_exp_f32 v164,v164
v_exp_f32 v165,v165
v_exp_f32 v166,v166
v_exp_f32 v167,v167
v_pk_add_f32 v[152:153],v[152:153],v[180:181]
v_pk_add_f32 v[154:155],v[154:155],v[180:181]
v_pk_add_f32 v[156:157],v[156:157],v[180:181]
v_pk_add_f32 v[158:159],v[158:159],v[180:181]
v_pk_add_f32 v[160:161],v[160:161],v[180:181]
v_pk_add_f32 v[162:163],v[162:163],v[180:181]
v_pk_add_f32 v[164:165],v[164:165],v[180:181]
v_pk_add_f32 v[166:167],v[166:167],v[180:181]
v_rcp_f32 v152,v152
v_rcp_f32 v153,v153
v_rcp_f32 v154,v154
v_rcp_f32 v155,v155
v_rcp_f32 v156,v156
v_rcp_f32 v157,v157
v_rcp_f32 v158,v158
v_rcp_f32 v159,v159
v_rcp_f32 v160,v160
v_rcp_f32 v161,v161
v_rcp_f32 v162,v162
v_rcp_f32 v163,v163
v_rcp_f32 v164,v164
v_rcp_f32 v165,v165
v_rcp_f32 v166,v166
v_rcp_f32 v167,v167
v_pk_mul_f32 v[96:97],v[96:97],v[152:153]
v_pk_mul_f32 v[98:99],v[98:99],v[154:155]
v_pk_mul_f32 v[104:105],v[104:105],v[156:157]
v_pk_mul_f32 v[106:107],v[106:107],v[158:159]
v_pk_mul_f32 v[100:101],v[100:101],v[160:161]
v_pk_mul_f32 v[102:103],v[102:103],v[162:163]
v_pk_mul_f32 v[108:109],v[108:109],v[164:165]
v_pk_mul_f32 v[110:111],v[110:111],v[166:167]
cv v96,v96,v97
cv v97,v98,v99
cv v98,v104,v105
cv v99,v106,v107
s_add_u32 s24,s27,6144
buffer_store_dwordx4 v[96:99],v254,s[8:11],s24 offen sc1
cv v100,v100,v101
cv v101,v102,v103
cv v102,v108,v109
cv v103,v110,v111
s_add_u32 s24,s27,120832
buffer_store_dwordx4 v[100:103],v254,s[8:11],s24 offen sc1
s_mul_i32 s48,s21,917504
s_mul_i32 s24,s26,57344
s_add_u32 s48,s48,s24
s_add_u32 s48,s48,33554432
s_lshl_b32 s24,s26,7
v_xor_b32 v220,s24,v220
v_xor_b32 v221,s24,v221
v_xor_b32 v222,s24,v222
v_xor_b32 v223,s24,v223
v_xor_b32 v224,s24,v224
v_xor_b32 v225,s24,v225
v_xor_b32 v226,s24,v226
v_xor_b32 v227,s24,v227
v_xor_b32 v228,s24,v228
v_xor_b32 v229,s24,v229
v_xor_b32 v230,s24,v230
v_xor_b32 v231,s24,v231
v_xor_b32 v232,s24,v232
v_xor_b32 v233,s24,v233
v_xor_b32 v234,s24,v234
v_xor_b32 v235,s24,v235
s_lshl_b32 s24,s23,7
s_lshl_b32 s25,s26,6
s_add_u32 s24,s24,s25
v_lshrrev_b32 v112,4,v255
v_lshl_add_u32 v112,v112,2,s24
v_lshlrev_b32 v113,1,v112
v_lshlrev_b32 v112,2,v112
v_lshrrev_b32 v115,4,v255
v_and_b32 v114,1,v115
v_lshlrev_b32 v114,4,v114
v_lshrrev_b32 v115,1,v115
v_lshl_add_u32 v114,v115,3,v114
v_add_u32 v114,s24,v114
s_lshl_b32 s25,s21,7
s_lshl_b32 s24,s20,5
s_add_u32 s25,s25,s24
v_and_b32 v115,15,v255
v_add_u32 v115,s25,v115
v_lshlrev_b32 v115,11,v115
v_lshl_add_u32 v114,v114,1,v115
s_mul_i32 s24,s26,4192256
s_sub_u32 s52,s56,s24
s_add_u32 s52,s52,5242880
s_add_u32 s53,s52,32768
s_lshl_b32 s24,s21,4
s_add_u32 s24,s24,s22
s_xor_b32 s25,s24,8
s_lshl_b32 s62,s24,8
s_add_u32 s62,s62,524352
s_lshl_b32 s63,s25,8
s_add_u32 s63,s63,524352
s_lshl_b32 s61,s20,12
s_add_u32 s61,s61,60817408
s_lshl_b32 s24,s24,14
s_lshl_b32 s25,s25,14
s_add_u32 s56,s61,s24
s_add_u32 s61,s61,s25
s_mov_b32 s27,20480
s_waitcnt vmcnt(0)
v_mov_b32 v204,0
v_mov_b32 v205,1
s_barrier
s_cmp_lg_u32 s20,0
s_cbranch_scc1 tail_gb3_a
s_mov_b64 exec,1
buffer_atomic_add v205,v204,s[8:11],s58 offen offset:0 sc1
buffer_atomic_add v205,v204,s[8:11],s57 offen offset:1536 sc1
s_mov_b64 exec,-1
tail_gb3_a:
s_cmp_lg_u32 s20,0
s_cbranch_scc1 tail_gb3_w
s_mov_b64 exec,1
s_mov_b32 s59,0x40000
tail_gb3_p:
buffer_load_dword v206,v204,s[8:11],s58 offen offset:0 sc1
s_waitcnt vmcnt(0)
v_readfirstlane_b32 s60,v206
s_sub_u32 s59,s59,1
s_cmp_eq_u32 s59,0
s_cbranch_scc1 tail_gb3_g
s_cmp_lt_u32 s60,8
s_cbranch_scc1 tail_gb3_p
tail_gb3_g:
s_mov_b64 exec,-1
tail_gb3_w:
s_barrier
bl a[0:3],v212,s[8:11],s48 offen offset:0 sc1
bl a[4:7],v213,s[8:11],s48 offen offset:0 sc1
bl a[8:11],v212,s[8:11],s48 offen offset:1024 sc1
bl a[12:15],v213,s[8:11],s48 offen offset:1024 sc1
s_add_u32 s48,s48,2048
bl a[16:19],v212,s[8:11],s48 offen offset:0 sc1
bl a[20:23],v213,s[8:11],s48 offen offset:0 sc1
bl a[24:27],v212,s[8:11],s48 offen offset:1024 sc1
bl a[28:31],v213,s[8:11],s48 offen offset:1024 sc1
s_add_u32 s48,s48,2048
bl a[32:35],v212,s[8:11],s48 offen offset:0 sc1
bl a[36:39],v213,s[8:11],s48 offen offset:0 sc1
bl a[40:43],v212,s[8:11],s48 offen offset:1024 sc1
bl a[44:47],v213,s[8:11],s48 offen offset:1024 sc1
s_add_u32 s48,s48,2048
s_waitcnt vmcnt(8)
s_barrier
tr a[128:129],v220 offset:32768
tr a[130:131],v220 offset:36864
tr a[132:133],v220 offset:40960
tr a[134:135],v220 offset:45056
tr a[136:137],v221 offset:32768
tr a[138:139],v221 offset:36864
tr a[140:141],v221 offset:40960
tr a[142:143],v221 offset:45056
tr a[144:145],v222 offset:32768
tr a[146:147],v222 offset:36864
tr a[148:149],v222 offset:40960
tr a[150:151],v222 offset:45056
s_waitcnt lgkmcnt(8)
mm v[0:3],a[128:131],a[0:3],0
tr a[152:153],v223 offset:32768
bl a[48:51],v212,s[8:11],s48 offen offset:0 sc1
mm v[0:3],a[132:135],a[8:11],v[0:3]
tr a[154:155],v223 offset:36864
mm v[4:7],a[128:131],a[4:7],0
tr a[156:157],v223 offset:40960
mm v[4:7],a[132:135],a[12:15],v[4:7]
tr a[158:159],v223 offset:45056
s_waitcnt lgkmcnt(8)
mm v[8:11],a[136:139],a[0:3],0
tr a[128:129],v224 offset:32768
bl a[52:55],v213,s[8:11],s48 offen offset:0 sc1
mm v[8:11],a[140:143],a[8:11],v[8:11]
tr a[130:131],v224 offset:36864
mm v[12:15],a[136:139],a[4:7],0
tr a[132:133],v224 offset:40960
mm v[12:15],a[140:143],a[12:15],v[12:15]
tr a[134:135],v224 offset:45056
s_waitcnt lgkmcnt(8)
mm v[16:19],a[144:147],a[0:3],0
tr a[136:137],v225 offset:32768
bl a[56:59],v212,s[8:11],s48 offen offset:1024 sc1
mm v[16:19],a[148:151],a[8:11],v[16:19]
tr a[138:139],v225 offset:36864
mm v[20:23],a[144:147],a[4:7],0
tr a[140:141],v225 offset:40960
mm v[20:23],a[148:151],a[12:15],v[20:23]
tr a[142:143],v225 offset:45056
s_waitcnt lgkmcnt(8)
mm v[24:27],a[152:155],a[0:3],0
tr a[144:145],v226 offset:32768
mm v[24:27],a[156:159],a[8:11],v[24:27]
tr a[146:147],v226 offset:36864
bl a[60:63],v213,s[8:11],s48 offen offset:1024 sc1
mm v[28:31],a[152:155],a[4:7],0
tr a[148:149],v226 offset:40960
s_add_u32 s48,s48,2048
mm v[28:31],a[156:159],a[12:15],v[28:31]
tr a[150:151],v226 offset:45056
s_waitcnt lgkmcnt(8)
mm v[32:35],a[128:131],a[0:3],0
tr a[152:153],v227 offset:32768
mm v[32:35],a[132:135],a[8:11],v[32:35]
tr a[154:155],v227 offset:36864
s_waitcnt vmcnt(8)
mm v[36:39],a[128:131],a[4:7],0
bl a[64:67],v212,s[8:11],s48 offen offset:0 sc1
s_barrier
mm v[36:39],a[132:135],a[12:15],v[36:39]
tr a[156:157],v227 offset:40960
s_waitcnt lgkmcnt(7)
mm v[40:43],a[136:139],a[0:3],0
tr a[158:159],v227 offset:45056
mm v[40:43],a[140:143],a[8:11],v[40:43]
tr a[128:129],v220 offset:49152
bl a[68:71],v213,s[8:11],s48 offen offset:0 sc1
mm v[44:47],a[136:139],a[4:7],0
tr a[130:131],v220 offset:53248
mm v[44:47],a[140:143],a[12:15],v[44:47]
tr a[132:133],v220 offset:57344
s_waitcnt lgkmcnt(7)
mm v[48:51],a[144:147],a[0:3],0
tr a[134:135],v220 offset:61440
mm v[48:51],a[148:151],a[8:11],v[48:51]
tr a[136:137],v221 offset:49152
mm v[52:55],a[144:147],a[4:7],0
tr a[138:139],v221 offset:53248
bl a[72:75],v212,s[8:11],s48 offen offset:1024 sc1
mm v[52:55],a[148:151],a[12:15],v[52:55]
tr a[140:141],v221 offset:57344
s_waitcnt lgkmcnt(7)
mm v[56:59],a[152:155],a[0:3],0
tr a[142:143],v221 offset:61440
mm v[56:59],a[156:159],a[8:11],v[56:59]
tr a[144:145],v222 offset:49152
mm v[60:63],a[152:155],a[4:7],0
tr a[146:147],v222 offset:53248
bl a[76:79],v213,s[8:11],s48 offen offset:1024 sc1
mm v[60:63],a[156:159],a[12:15],v[60:63]
tr a[148:149],v222 offset:57344
s_waitcnt lgkmcnt(7)
mm v[0:3],a[128:131],a[16:19],v[0:3]
tr a[150:151],v222 offset:61440
s_add_u32 s48,s48,2048
mm v[0:3],a[132:135],a[24:27],v[0:3]
tr a[152:153],v223 offset:49152
mm v[4:7],a[128:131],a[20:23],v[4:7]
tr a[154:155],v223 offset:53248
bl a[80:83],v212,s[8:11],s48 offen offset:0 sc1
mm v[4:7],a[132:135],a[28:31],v[4:7]
tr a[156:157],v223 offset:57344
s_waitcnt lgkmcnt(7)
mm v[8:11],a[136:139],a[16:19],v[8:11]
tr a[158:159],v223 offset:61440
mm v[8:11],a[140:143],a[24:27],v[8:11]
tr a[128:129],v224 offset:49152
mm v[12:15],a[136:139],a[20:23],v[12:15]
tr a[130:131],v224 offset:53248
mm v[12:15],a[140:143],a[28:31],v[12:15]
tr a[132:133],v224 offset:57344
s_waitcnt lgkmcnt(7)
mm v[16:19],a[144:147],a[16:19],v[16:19]
tr a[134:135],v224 offset:61440
bl a[84:87],v213,s[8:11],s48 offen offset:0 sc1
mm v[16:19],a[148:151],a[24:27],v[16:19]
tr a[136:137],v225 offset:49152
mm v[20:23],a[144:147],a[20:23],v[20:23]
tr a[138:139],v225 offset:53248
mm v[20:23],a[148:151],a[28:31],v[20:23]
tr a[140:141],v225 offset:57344
s_waitcnt lgkmcnt(7)
mm v[24:27],a[152:155],a[16:19],v[24:27]
tr a[142:143],v225 offset:61440
bl a[88:91],v212,s[8:11],s48 offen offset:1024 sc1
mm v[24:27],a[156:159],a[24:27],v[24:27]
tr a[144:145],v226 offset:49152
mm v[28:31],a[152:155],a[20:23],v[28:31]
tr a[146:147],v226 offset:53248
mm v[28:31],a[156:159],a[28:31],v[28:31]
tr a[148:149],v226 offset:57344
s_waitcnt lgkmcnt(7)
mm v[32:35],a[128:131],a[16:19],v[32:35]
tr a[150:151],v226 offset:61440
bl a[92:95],v213,s[8:11],s48 offen offset:1024 sc1
mm v[32:35],a[132:135],a[24:27],v[32:35]
tr a[152:153],v227 offset:49152
s_waitcnt vmcnt(12)
mm v[36:39],a[128:131],a[20:23],v[36:39]
tr a[154:155],v227 offset:53248
s_barrier
mm v[36:39],a[132:135],a[28:31],v[36:39]
tr a[156:157],v227 offset:57344
s_waitcnt lgkmcnt(7)
mm v[40:43],a[136:139],a[16:19],v[40:43]
tr a[158:159],v227 offset:61440
s_add_u32 s48,s48,2048
mm v[40:43],a[140:143],a[24:27],v[40:43]
tr a[128:129],v228 offset:0
bl a[96:99],v212,s[8:11],s48 offen offset:0 sc1
mm v[44:47],a[136:139],a[20:23],v[44:47]
tr a[130:131],v228 offset:4096
mm v[44:47],a[140:143],a[28:31],v[44:47]
tr a[132:133],v228 offset:8192
s_waitcnt lgkmcnt(7)
mm v[48:51],a[144:147],a[16:19],v[48:51]
tr a[134:135],v228 offset:12288
bl a[100:103],v213,s[8:11],s48 offen offset:0 sc1
mm v[48:51],a[148:151],a[24:27],v[48:51]
tr a[136:137],v229 offset:0
mm v[52:55],a[144:147],a[20:23],v[52:55]
tr a[138:139],v229 offset:4096
mm v[52:55],a[148:151],a[28:31],v[52:55]
tr a[140:141],v229 offset:8192
s_waitcnt lgkmcnt(7)
mm v[56:59],a[152:155],a[16:19],v[56:59]
tr a[142:143],v229 offset:12288
bl a[104:107],v212,s[8:11],s48 offen offset:1024 sc1
mm v[56:59],a[156:159],a[24:27],v[56:59]
tr a[144:145],v230 offset:0
mm v[60:63],a[152:155],a[20:23],v[60:63]
tr a[146:147],v230 offset:4096
mm v[60:63],a[156:159],a[28:31],v[60:63]
tr a[148:149],v230 offset:8192
s_waitcnt lgkmcnt(7)
mm v[0:3],a[128:131],a[32:35],v[0:3]
tr a[150:151],v230 offset:12288
mm v[0:3],a[132:135],a[40:43],v[0:3]
tr a[152:153],v231 offset:0
bl a[108:111],v213,s[8:11],s48 offen offset:1024 sc1
mm v[4:7],a[128:131],a[36:39],v[4:7]
tr a[154:155],v231 offset:4096
s_add_u32 s48,s48,2048
mm v[4:7],a[132:135],a[44:47],v[4:7]
tr a[156:157],v231 offset:8192
s_waitcnt lgkmcnt(7)
mm v[8:11],a[136:139],a[32:35],v[8:11]
tr a[158:159],v231 offset:12288
mm v[8:11],a[140:143],a[40:43],v[8:11]
tr a[128:129],v232 offset:0
bl a[112:115],v212,s[8:11],s48 offen offset:0 sc1
mm v[12:15],a[136:139],a[36:39],v[12:15]
tr a[130:131],v232 offset:4096
mm v[12:15],a[140:143],a[44:47],v[12:15]
tr a[132:133],v232 offset:8192
s_waitcnt lgkmcnt(7)
mm v[16:19],a[144:147],a[32:35],v[16:19]
tr a[134:135],v232 offset:12288
mm v[16:19],a[148:151],a[40:43],v[16:19]
tr a[136:137],v233 offset:0
bl a[116:119],v213,s[8:11],s48 offen offset:0 sc1
mm v[20:23],a[144:147],a[36:39],v[20:23]
tr a[138:139],v233 offset:4096
mm v[20:23],a[148:151],a[44:47],v[20:23]
tr a[140:141],v233 offset:8192
s_waitcnt lgkmcnt(7)
mm v[24:27],a[152:155],a[32:35],v[24:27]
tr a[142:143],v233 offset:12288
mm v[24:27],a[156:159],a[40:43],v[24:27]
tr a[144:145],v234 offset:0
mm v[28:31],a[152:155],a[36:39],v[28:31]
tr a[146:147],v234 offset:4096
bl a[120:123],v212,s[8:11],s48 offen offset:1024 sc1
mm v[28:31],a[156:159],a[44:47],v[28:31]
tr a[148:149],v234 offset:8192
s_waitcnt lgkmcnt(7)
mm v[32:35],a[128:131],a[32:35],v[32:35]
tr a[150:151],v234 offset:12288
mm v[32:35],a[132:135],a[40:43],v[32:35]
tr a[152:153],v235 offset:0
s_waitcnt vmcnt(15)
mm v[36:39],a[128:131],a[36:39],v[36:39]
tr a[154:155],v235 offset:4096
s_barrier
mm v[36:39],a[132:135],a[44:47],v[36:39]
bl a[124:127],v213,s[8:11],s48 offen offset:1024 sc1
s_waitcnt lgkmcnt(6)
mm v[40:43],a[136:139],a[32:35],v[40:43]
tr a[156:157],v235 offset:8192
tr a[158:159],v235 offset:12288
mm v[40:43],a[140:143],a[40:43],v[40:43]
tr a[128:129],v228 offset:16384
s_add_u32 s48,s48,2048
mm v[44:47],a[136:139],a[36:39],v[44:47]
tr a[130:131],v228 offset:20480
bl a[0:3],v212,s[8:11],s48 offen offset:0 sc1
mm v[44:47],a[140:143],a[44:47],v[44:47]
tr a[132:133],v228 offset:24576
s_waitcnt lgkmcnt(7)
mm v[48:51],a[144:147],a[32:35],v[48:51]
tr a[134:135],v228 offset:28672
mm v[48:51],a[148:151],a[40:43],v[48:51]
tr a[136:137],v229 offset:16384
mm v[52:55],a[144:147],a[36:39],v[52:55]
tr a[138:139],v229 offset:20480
mm v[52:55],a[148:151],a[44:47],v[52:55]
tr a[140:141],v229 offset:24576
s_waitcnt lgkmcnt(7)
mm v[56:59],a[152:155],a[32:35],v[56:59]
tr a[142:143],v229 offset:28672
bl a[4:7],v213,s[8:11],s48 offen offset:0 sc1
mm v[56:59],a[156:159],a[40:43],v[56:59]
tr a[144:145],v230 offset:16384
mm v[60:63],a[152:155],a[36:39],v[60:63]
tr a[146:147],v230 offset:20480
mm v[60:63],a[156:159],a[44:47],v[60:63]
tr a[148:149],v230 offset:24576
s_waitcnt lgkmcnt(7)
mm v[0:3],a[128:131],a[48:51],v[0:3]
tr a[150:151],v230 offset:28672
bl a[8:11],v212,s[8:11],s48 offen offset:1024 sc1
mm v[0:3],a[132:135],a[56:59],v[0:3]
tr a[152:153],v231 offset:16384
mm v[4:7],a[128:131],a[52:55],v[4:7]
tr a[154:155],v231 offset:20480
mm v[4:7],a[132:135],a[60:63],v[4:7]
tr a[156:157],v231 offset:24576
s_waitcnt lgkmcnt(7)
mm v[8:11],a[136:139],a[48:51],v[8:11]
tr a[158:159],v231 offset:28672
bl a[12:15],v213,s[8:11],s48 offen offset:1024 sc1
mm v[8:11],a[140:143],a[56:59],v[8:11]
tr a[128:129],v232 offset:16384
s_add_u32 s48,s48,2048
mm v[12:15],a[136:139],a[52:55],v[12:15]
tr a[130:131],v232 offset:20480
s_add_u32 m0,s50,32768
mm v[12:15],a[140:143],a[60:63],v[12:15]
tr a[132:133],v232 offset:24576
s_waitcnt lgkmcnt(7)
mm v[16:19],a[144:147],a[48:51],v[16:19]
tr a[134:135],v232 offset:28672
bl v216,s[28:31],s55 offen offset:0 lds
mm v[16:19],a[148:151],a[56:59],v[16:19]
tr a[136:137],v233 offset:16384
mm v[20:23],a[144:147],a[52:55],v[20:23]
tr a[138:139],v233 offset:20480
mm v[20:23],a[148:151],a[60:63],v[20:23]
tr a[140:141],v233 offset:24576
s_waitcnt lgkmcnt(7)
mm v[24:27],a[152:155],a[48:51],v[24:27]
tr a[142:143],v233 offset:28672
bl v217,s[28:31],s55 offen offset:1024 lds
mm v[24:27],a[156:159],a[56:59],v[24:27]
tr a[144:145],v234 offset:16384
mm v[28:31],a[152:155],a[52:55],v[28:31]
tr a[146:147],v234 offset:20480
mm v[28:31],a[156:159],a[60:63],v[28:31]
tr a[148:149],v234 offset:24576
s_waitcnt lgkmcnt(7)
mm v[32:35],a[128:131],a[48:51],v[32:35]
tr a[150:151],v234 offset:28672
bl v218,s[28:31],s55 offen offset:2048 lds
mm v[32:35],a[132:135],a[56:59],v[32:35]
tr a[152:153],v235 offset:16384
s_waitcnt vmcnt(19)
mm v[36:39],a[128:131],a[52:55],v[36:39]
tr a[154:155],v235 offset:20480
s_barrier
mm v[36:39],a[132:135],a[60:63],v[36:39]
tr a[156:157],v235 offset:24576
s_waitcnt lgkmcnt(7)
mm v[40:43],a[136:139],a[48:51],v[40:43]
tr a[158:159],v235 offset:28672
mm v[40:43],a[140:143],a[56:59],v[40:43]
tr a[128:129],v228 offset:32768
bl v219,s[28:31],s55 offen offset:3072 lds
mm v[44:47],a[136:139],a[52:55],v[44:47]
tr a[130:131],v228 offset:36864
s_add_u32 s55,s55,131072
mm v[44:47],a[140:143],a[60:63],v[44:47]
tr a[132:133],v228 offset:40960
s_waitcnt lgkmcnt(7)
mm v[48:51],a[144:147],a[48:51],v[48:51]
tr a[134:135],v228 offset:45056
mm v[48:51],a[148:151],a[56:59],v[48:51]
tr a[136:137],v229 offset:32768
bl a[16:19],v212,s[8:11],s48 offen offset:0 sc1
mm v[52:55],a[144:147],a[52:55],v[52:55]
tr a[138:139],v229 offset:36864
mm v[52:55],a[148:151],a[60:63],v[52:55]
tr a[140:141],v229 offset:40960
s_waitcnt lgkmcnt(7)
mm v[56:59],a[152:155],a[48:51],v[56:59]
tr a[142:143],v229 offset:45056
mm v[56:59],a[156:159],a[56:59],v[56:59]
tr a[144:145],v230 offset:32768
bl a[20:23],v213,s[8:11],s48 offen offset:0 sc1
mm v[60:63],a[152:155],a[52:55],v[60:63]
tr a[146:147],v230 offset:36864
mm v[60:63],a[156:159],a[60:63],v[60:63]
tr a[148:149],v230 offset:40960
s_waitcnt lgkmcnt(7)
mm v[0:3],a[128:131],a[64:67],v[0:3]
tr a[150:151],v230 offset:45056
mm v[0:3],a[132:135],a[72:75],v[0:3]
tr a[152:153],v231 offset:32768
mm v[4:7],a[128:131],a[68:71],v[4:7]
tr a[154:155],v231 offset:36864
bl a[24:27],v212,s[8:11],s48 offen offset:1024 sc1
mm v[4:7],a[132:135],a[76:79],v[4:7]
tr a[156:157],v231 offset:40960
s_waitcnt lgkmcnt(7)
mm v[8:11],a[136:139],a[64:67],v[8:11]
tr a[158:159],v231 offset:45056
mm v[8:11],a[140:143],a[72:75],v[8:11]
tr a[128:129],v232 offset:32768
mm v[12:15],a[136:139],a[68:71],v[12:15]
tr a[130:131],v232 offset:36864
bl a[28:31],v213,s[8:11],s48 offen offset:1024 sc1
mm v[12:15],a[140:143],a[76:79],v[12:15]
tr a[132:133],v232 offset:40960
s_waitcnt lgkmcnt(7)
mm v[16:19],a[144:147],a[64:67],v[16:19]
tr a[134:135],v232 offset:45056
s_add_u32 s48,s48,2048
mm v[16:19],a[148:151],a[72:75],v[16:19]
tr a[136:137],v233 offset:32768
s_add_u32 m0,s50,49152
mm v[20:23],a[144:147],a[68:71],v[20:23]
tr a[138:139],v233 offset:36864
bl v216,s[28:31],s55 offen offset:0 lds
mm v[20:23],a[148:151],a[76:79],v[20:23]
tr a[140:141],v233 offset:40960
s_waitcnt lgkmcnt(7)
mm v[24:27],a[152:155],a[64:67],v[24:27]
tr a[142:143],v233 offset:45056
mm v[24:27],a[156:159],a[72:75],v[24:27]
tr a[144:145],v234 offset:32768
mm v[28:31],a[152:155],a[68:71],v[28:31]
tr a[146:147],v234 offset:36864
mm v[28:31],a[156:159],a[76:79],v[28:31]
tr a[148:149],v234 offset:40960
s_waitcnt lgkmcnt(7)
mm v[32:35],a[128:131],a[64:67],v[32:35]
tr a[150:151],v234 offset:45056
bl v217,s[28:31],s55 offen offset:1024 lds
mm v[32:35],a[132:135],a[72:75],v[32:35]
tr a[152:153],v235 offset:32768
s_waitcnt vmcnt(22)
mm v[36:39],a[128:131],a[68:71],v[36:39]
tr a[154:155],v235 offset:36864
s_barrier
mm v[36:39],a[132:135],a[76:79],v[36:39]
tr a[156:157],v235 offset:40960
s_waitcnt lgkmcnt(7)
mm v[40:43],a[136:139],a[64:67],v[40:43]
tr a[158:159],v235 offset:45056
bl v218,s[28:31],s55 offen offset:2048 lds
mm v[40:43],a[140:143],a[72:75],v[40:43]
tr a[128:129],v228 offset:49152
mm v[44:47],a[136:139],a[68:71],v[44:47]
tr a[130:131],v228 offset:53248
mm v[44:47],a[140:143],a[76:79],v[44:47]
tr a[132:133],v228 offset:57344
s_waitcnt lgkmcnt(7)
mm v[48:51],a[144:147],a[64:67],v[48:51]
tr a[134:135],v228 offset:61440
bl v219,s[28:31],s55 offen offset:3072 lds
mm v[48:51],a[148:151],a[72:75],v[48:51]
tr a[136:137],v229 offset:49152
s_add_u32 s55,s55,131072
mm v[52:55],a[144:147],a[68:71],v[52:55]
tr a[138:139],v229 offset:53248
mm v[52:55],a[148:151],a[76:79],v[52:55]
tr a[140:141],v229 offset:57344
s_waitcnt lgkmcnt(7)
mm v[56:59],a[152:155],a[64:67],v[56:59]
tr a[142:143],v229 offset:61440
bl a[32:35],v212,s[8:11],s48 offen offset:0 sc1
mm v[56:59],a[156:159],a[72:75],v[56:59]
tr a[144:145],v230 offset:49152
mm v[60:63],a[152:155],a[68:71],v[60:63]
tr a[146:147],v230 offset:53248
mm v[60:63],a[156:159],a[76:79],v[60:63]
tr a[148:149],v230 offset:57344
s_waitcnt lgkmcnt(7)
mm v[0:3],a[128:131],a[80:83],v[0:3]
tr a[150:151],v230 offset:61440
bl a[36:39],v213,s[8:11],s48 offen offset:0 sc1
mm v[0:3],a[132:135],a[88:91],v[0:3]
tr a[152:153],v231 offset:49152
mm v[4:7],a[128:131],a[84:87],v[4:7]
tr a[154:155],v231 offset:53248
mm v[4:7],a[132:135],a[92:95],v[4:7]
tr a[156:157],v231 offset:57344
s_waitcnt lgkmcnt(7)
mm v[8:11],a[136:139],a[80:83],v[8:11]
tr a[158:159],v231 offset:61440
mm v[8:11],a[140:143],a[88:91],v[8:11]
tr a[128:129],v232 offset:49152
bl a[40:43],v212,s[8:11],s48 offen offset:1024 sc1
mm v[12:15],a[136:139],a[84:87],v[12:15]
tr a[130:131],v232 offset:53248
mm v[12:15],a[140:143],a[92:95],v[12:15]
tr a[132:133],v232 offset:57344
s_waitcnt lgkmcnt(7)
mm v[16:19],a[144:147],a[80:83],v[16:19]
tr a[134:135],v232 offset:61440
mm v[16:19],a[148:151],a[88:91],v[16:19]
tr a[136:137],v233 offset:49152
bl a[44:47],v213,s[8:11],s48 offen offset:1024 sc1
mm v[20:23],a[144:147],a[84:87],v[20:23]
tr a[138:139],v233 offset:53248
s_add_u32 s48,s48,2048
mm v[20:23],a[148:151],a[92:95],v[20:23]
tr a[140:141],v233 offset:57344
s_waitcnt lgkmcnt(7)
mm v[24:27],a[152:155],a[80:83],v[24:27]
tr a[142:143],v233 offset:61440
s_add_u32 m0,s50,65536
mm v[24:27],a[156:159],a[88:91],v[24:27]
tr a[144:145],v234 offset:49152
bl v216,s[28:31],s55 offen offset:0 lds
mm v[28:31],a[152:155],a[84:87],v[28:31]
tr a[146:147],v234 offset:53248
mm v[28:31],a[156:159],a[92:95],v[28:31]
tr a[148:149],v234 offset:57344
s_waitcnt lgkmcnt(7)
mm v[32:35],a[128:131],a[80:83],v[32:35]
tr a[150:151],v234 offset:61440
mm v[32:35],a[132:135],a[88:91],v[32:35]
tr a[152:153],v235 offset:49152
s_waitcnt vmcnt(25)
mm v[36:39],a[128:131],a[84:87],v[36:39]
tr a[154:155],v235 offset:53248
s_barrier
mm v[36:39],a[132:135],a[92:95],v[36:39]
bl v217,s[28:31],s55 offen offset:1024 lds
s_waitcnt lgkmcnt(6)
mm v[40:43],a[136:139],a[80:83],v[40:43]
tr a[156:157],v235 offset:57344
tr a[158:159],v235 offset:61440
mm v[40:43],a[140:143],a[88:91],v[40:43]
tr a[128:129],v220 offset:0
mm v[44:47],a[136:139],a[84:87],v[44:47]
tr a[130:131],v220 offset:4096
bl v218,s[28:31],s55 offen offset:2048 lds
mm v[44:47],a[140:143],a[92:95],v[44:47]
tr a[132:133],v220 offset:8192
s_waitcnt lgkmcnt(7)
mm v[48:51],a[144:147],a[80:83],v[48:51]
tr a[134:135],v220 offset:12288
mm v[48:51],a[148:151],a[88:91],v[48:51]
tr a[136:137],v221 offset:0
mm v[52:55],a[144:147],a[84:87],v[52:55]
tr a[138:139],v221 offset:4096
bl v219,s[28:31],s55 offen offset:3072 lds
mm v[52:55],a[148:151],a[92:95],v[52:55]
tr a[140:141],v221 offset:8192
s_waitcnt lgkmcnt(7)
mm v[56:59],a[152:155],a[80:83],v[56:59]
tr a[142:143],v221 offset:12288
s_add_u32 s55,s55,131072
mm v[56:59],a[156:159],a[88:91],v[56:59]
tr a[144:145],v222 offset:0
mm v[60:63],a[152:155],a[84:87],v[60:63]
tr a[146:147],v222 offset:4096
mm v[60:63],a[156:159],a[92:95],v[60:63]
tr a[148:149],v222 offset:8192
s_waitcnt lgkmcnt(7)
mm v[0:3],a[128:131],a[96:99],v[0:3]
tr a[150:151],v222 offset:12288
bl a[48:51],v212,s[8:11],s48 offen offset:0 sc1
mm v[0:3],a[132:135],a[104:107],v[0:3]
tr a[152:153],v223 offset:0
mm v[4:7],a[128:131],a[100:103],v[4:7]
tr a[154:155],v223 offset:4096
mm v[4:7],a[132:135],a[108:111],v[4:7]
tr a[156:157],v223 offset:8192
s_waitcnt lgkmcnt(7)
mm v[8:11],a[136:139],a[96:99],v[8:11]
tr a[158:159],v223 offset:12288
bl a[52:55],v213,s[8:11],s48 offen offset:0 sc1
mm v[8:11],a[140:143],a[104:107],v[8:11]
tr a[128:129],v224 offset:0
mm v[12:15],a[136:139],a[100:103],v[12:15]
tr a[130:131],v224 offset:4096
mm v[12:15],a[140:143],a[108:111],v[12:15]
tr a[132:133],v224 offset:8192
s_waitcnt lgkmcnt(7)
mm v[16:19],a[144:147],a[96:99],v[16:19]
tr a[134:135],v224 offset:12288
bl a[56:59],v212,s[8:11],s48 offen offset:1024 sc1
mm v[16:19],a[148:151],a[104:107],v[16:19]
tr a[136:137],v225 offset:0
mm v[20:23],a[144:147],a[100:103],v[20:23]
tr a[138:139],v225 offset:4096
mm v[20:23],a[148:151],a[108:111],v[20:23]
tr a[140:141],v225 offset:8192
s_waitcnt lgkmcnt(7)
mm v[24:27],a[152:155],a[96:99],v[24:27]
tr a[142:143],v225 offset:12288
bl a[60:63],v213,s[8:11],s48 offen offset:1024 sc1
mm v[24:27],a[156:159],a[104:107],v[24:27]
tr a[144:145],v226 offset:0
s_add_u32 s48,s48,2048
mm v[28:31],a[152:155],a[100:103],v[28:31]
tr a[146:147],v226 offset:4096
s_add_u32 m0,s50,81920
mm v[28:31],a[156:159],a[108:111],v[28:31]
tr a[148:149],v226 offset:8192
s_waitcnt lgkmcnt(7)
mm v[32:35],a[128:131],a[96:99],v[32:35]
tr a[150:151],v226 offset:12288
bl v216,s[28:31],s55 offen offset:0 lds
mm v[32:35],a[132:135],a[104:107],v[32:35]
tr a[152:153],v227 offset:0
s_waitcnt vmcnt(29)
mm v[36:39],a[128:131],a[100:103],v[36:39]
tr a[154:155],v227 offset:4096
s_barrier
mm v[36:39],a[132:135],a[108:111],v[36:39]
tr a[156:157],v227 offset:8192
s_waitcnt lgkmcnt(7)
mm v[40:43],a[136:139],a[96:99],v[40:43]
tr a[158:159],v227 offset:12288
bl v217,s[28:31],s55 offen offset:1024 lds
mm v[40:43],a[140:143],a[104:107],v[40:43]
tr a[128:129],v220 offset:16384
mm v[44:47],a[136:139],a[100:103],v[44:47]
tr a[130:131],v220 offset:20480
mm v[44:47],a[140:143],a[108:111],v[44:47]
tr a[132:133],v220 offset:24576
s_waitcnt lgkmcnt(7)
mm v[48:51],a[144:147],a[96:99],v[48:51]
tr a[134:135],v220 offset:28672
mm v[48:51],a[148:151],a[104:107],v[48:51]
tr a[136:137],v221 offset:16384
bl v218,s[28:31],s55 offen offset:2048 lds
mm v[52:55],a[144:147],a[100:103],v[52:55]
tr a[138:139],v221 offset:20480
mm v[52:55],a[148:151],a[108:111],v[52:55]
tr a[140:141],v221 offset:24576
s_waitcnt lgkmcnt(7)
mm v[56:59],a[152:155],a[96:99],v[56:59]
tr a[142:143],v221 offset:28672
mm v[56:59],a[156:159],a[104:107],v[56:59]
tr a[144:145],v222 offset:16384
bl v219,s[28:31],s55 offen offset:3072 lds
mm v[60:63],a[152:155],a[100:103],v[60:63]
tr a[146:147],v222 offset:20480
s_add_u32 s55,s55,131072
mm v[60:63],a[156:159],a[108:111],v[60:63]
tr a[148:149],v222 offset:24576
s_waitcnt lgkmcnt(7)
mm v[0:3],a[128:131],a[112:115],v[0:3]
tr a[150:151],v222 offset:28672
mm v[0:3],a[132:135],a[120:123],v[0:3]
tr a[152:153],v223 offset:16384
bl a[64:67],v212,s[8:11],s48 offen offset:0 sc1
mm v[4:7],a[128:131],a[116:119],v[4:7]
tr a[154:155],v223 offset:20480
mm v[4:7],a[132:135],a[124:127],v[4:7]
tr a[156:157],v223 offset:24576
s_waitcnt lgkmcnt(7)
mm v[8:11],a[136:139],a[112:115],v[8:11]
tr a[158:159],v223 offset:28672
mm v[8:11],a[140:143],a[120:123],v[8:11]
tr a[128:129],v224 offset:16384
mm v[12:15],a[136:139],a[116:119],v[12:15]
tr a[130:131],v224 offset:20480
bl a[68:71],v213,s[8:11],s48 offen offset:0 sc1
mm v[12:15],a[140:143],a[124:127],v[12:15]
tr a[132:133],v224 offset:24576
s_waitcnt lgkmcnt(7)
mm v[16:19],a[144:147],a[112:115],v[16:19]
tr a[134:135],v224 offset:28672
mm v[16:19],a[148:151],a[120:123],v[16:19]
tr a[136:137],v225 offset:16384
mm v[20:23],a[144:147],a[116:119],v[20:23]
tr a[138:139],v225 offset:20480
bl a[72:75],v212,s[8:11],s48 offen offset:1024 sc1
mm v[20:23],a[148:151],a[124:127],v[20:23]
tr a[140:141],v225 offset:24576
s_waitcnt lgkmcnt(7)
mm v[24:27],a[152:155],a[112:115],v[24:27]
tr a[142:143],v225 offset:28672
mm v[24:27],a[156:159],a[120:123],v[24:27]
tr a[144:145],v226 offset:16384
mm v[28:31],a[152:155],a[116:119],v[28:31]
tr a[146:147],v226 offset:20480
bl a[76:79],v213,s[8:11],s48 offen offset:1024 sc1
mm v[28:31],a[156:159],a[124:127],v[28:31]
tr a[148:149],v226 offset:24576
s_waitcnt lgkmcnt(7)
mm v[32:35],a[128:131],a[112:115],v[32:35]
tr a[150:151],v226 offset:28672
s_add_u32 s48,s48,2048
mm v[32:35],a[132:135],a[120:123],v[32:35]
tr a[152:153],v227 offset:16384
s_waitcnt vmcnt(28)
mm v[36:39],a[128:131],a[116:119],v[36:39]
tr a[154:155],v227 offset:20480
s_barrier
mm v[36:39],a[132:135],a[124:127],v[36:39]
s_add_u32 m0,s50,98304
s_waitcnt lgkmcnt(6)
mm v[40:43],a[136:139],a[112:115],v[40:43]
tr a[156:157],v227 offset:24576
tr a[158:159],v227 offset:28672
mm v[40:43],a[140:143],a[120:123],v[40:43]
tr a[128:129],v220 offset:32768
bl v216,s[28:31],s55 offen offset:0 lds
mm v[44:47],a[136:139],a[116:119],v[44:47]
tr a[130:131],v220 offset:36864
mm v[44:47],a[140:143],a[124:127],v[44:47]
tr a[132:133],v220 offset:40960
s_waitcnt lgkmcnt(7)
mm v[48:51],a[144:147],a[112:115],v[48:51]
tr a[134:135],v220 offset:45056
bl v217,s[28:31],s55 offen offset:1024 lds
mm v[48:51],a[148:151],a[120:123],v[48:51]
tr a[136:137],v221 offset:32768
mm v[52:55],a[144:147],a[116:119],v[52:55]
tr a[138:139],v221 offset:36864
mm v[52:55],a[148:151],a[124:127],v[52:55]
tr a[140:141],v221 offset:40960
s_waitcnt lgkmcnt(7)
mm v[56:59],a[152:155],a[112:115],v[56:59]
tr a[142:143],v221 offset:45056
bl v218,s[28:31],s55 offen offset:2048 lds
mm v[56:59],a[156:159],a[120:123],v[56:59]
tr a[144:145],v222 offset:32768
mm v[60:63],a[152:155],a[116:119],v[60:63]
tr a[146:147],v222 offset:36864
mm v[60:63],a[156:159],a[124:127],v[60:63]
tr a[148:149],v222 offset:40960
s_waitcnt lgkmcnt(7)
mm v[0:3],a[128:131],a[0:3],v[0:3]
tr a[150:151],v222 offset:45056
bl v219,s[28:31],s55 offen offset:3072 lds
mm v[0:3],a[132:135],a[8:11],v[0:3]
tr a[152:153],v223 offset:32768
s_add_u32 s55,s55,131072
mm v[4:7],a[128:131],a[4:7],v[4:7]
tr a[154:155],v223 offset:36864
mm v[4:7],a[132:135],a[12:15],v[4:7]
tr a[156:157],v223 offset:40960
s_waitcnt lgkmcnt(7)
mm v[8:11],a[136:139],a[0:3],v[8:11]
tr a[158:159],v223 offset:45056
bl a[80:83],v212,s[8:11],s48 offen offset:0 sc1
mm v[8:11],a[140:143],a[8:11],v[8:11]
tr a[128:129],v224 offset:32768
mm v[12:15],a[136:139],a[4:7],v[12:15]
tr a[130:131],v224 offset:36864
mm v[12:15],a[140:143],a[12:15],v[12:15]
tr a[132:133],v224 offset:40960
s_waitcnt lgkmcnt(7)
mm v[16:19],a[144:147],a[0:3],v[16:19]
tr a[134:135],v224 offset:45056
bl a[84:87],v213,s[8:11],s48 offen offset:0 sc1
mm v[16:19],a[148:151],a[8:11],v[16:19]
tr a[136:137],v225 offset:32768
mm v[20:23],a[144:147],a[4:7],v[20:23]
tr a[138:139],v225 offset:36864
mm v[20:23],a[148:151],a[12:15],v[20:23]
tr a[140:141],v225 offset:40960
s_waitcnt lgkmcnt(7)
mm v[24:27],a[152:155],a[0:3],v[24:27]
tr a[142:143],v225 offset:45056
mm v[24:27],a[156:159],a[8:11],v[24:27]
tr a[144:145],v226 offset:32768
bl a[88:91],v212,s[8:11],s48 offen offset:1024 sc1
mm v[28:31],a[152:155],a[4:7],v[28:31]
tr a[146:147],v226 offset:36864
mm v[28:31],a[156:159],a[12:15],v[28:31]
tr a[148:149],v226 offset:40960
s_waitcnt lgkmcnt(7)
mm v[32:35],a[128:131],a[0:3],v[32:35]
tr a[150:151],v226 offset:45056
mm v[32:35],a[132:135],a[8:11],v[32:35]
tr a[152:153],v227 offset:32768
s_waitcnt vmcnt(27)
mm v[36:39],a[128:131],a[4:7],v[36:39]
tr a[154:155],v227 offset:36864
s_barrier
mm v[36:39],a[132:135],a[12:15],v[36:39]
bl a[92:95],v213,s[8:11],s48 offen offset:1024 sc1
s_waitcnt lgkmcnt(6)
mm v[40:43],a[136:139],a[0:3],v[40:43]
tr a[156:157],v227 offset:40960
tr a[158:159],v227 offset:45056
mm v[40:43],a[140:143],a[8:11],v[40:43]
s_add_u32 s48,s48,2048
s_add_u32 m0,s50,114688
mm v[44:47],a[136:139],a[4:7],v[44:47]
tr a[128:129],v220 offset:49152
tr a[130:131],v220 offset:53248
mm v[44:47],a[140:143],a[12:15],v[44:47]
bl v216,s[28:31],s55 offen offset:0 lds
s_waitcnt lgkmcnt(6)
mm v[48:51],a[144:147],a[0:3],v[48:51]
tr a[132:133],v220 offset:57344
tr a[134:135],v220 offset:61440
mm v[48:51],a[148:151],a[8:11],v[48:51]
tr a[136:137],v221 offset:49152
mm v[52:55],a[144:147],a[4:7],v[52:55]
tr a[138:139],v221 offset:53248
bl v217,s[28:31],s55 offen offset:1024 lds
mm v[52:55],a[148:151],a[12:15],v[52:55]
tr a[140:141],v221 offset:57344
s_waitcnt lgkmcnt(7)
mm v[56:59],a[152:155],a[0:3],v[56:59]
tr a[142:143],v221 offset:61440
mm v[56:59],a[156:159],a[8:11],v[56:59]
tr a[144:145],v222 offset:49152
mm v[60:63],a[152:155],a[4:7],v[60:63]
tr a[146:147],v222 offset:53248
bl v218,s[28:31],s55 offen offset:2048 lds
mm v[60:63],a[156:159],a[12:15],v[60:63]
tr a[148:149],v222 offset:57344
s_waitcnt lgkmcnt(7)
mm v[0:3],a[128:131],a[16:19],v[0:3]
tr a[150:151],v222 offset:61440
mm v[0:3],a[132:135],a[24:27],v[0:3]
tr a[152:153],v223 offset:49152
mm v[4:7],a[128:131],a[20:23],v[4:7]
tr a[154:155],v223 offset:53248
bl v219,s[28:31],s55 offen offset:3072 lds
mm v[4:7],a[132:135],a[28:31],v[4:7]
tr a[156:157],v223 offset:57344
s_waitcnt lgkmcnt(7)
mm v[8:11],a[136:139],a[16:19],v[8:11]
tr a[158:159],v223 offset:61440
s_add_u32 s55,s55,131072
mm v[8:11],a[140:143],a[24:27],v[8:11]
tr a[128:129],v224 offset:49152
mm v[12:15],a[136:139],a[20:23],v[12:15]
tr a[130:131],v224 offset:53248
mm v[12:15],a[140:143],a[28:31],v[12:15]
tr a[132:133],v224 offset:57344
s_waitcnt lgkmcnt(7)
mm v[16:19],a[144:147],a[16:19],v[16:19]
tr a[134:135],v224 offset:61440
bl a[96:99],v212,s[8:11],s48 offen offset:0 sc1
mm v[16:19],a[148:151],a[24:27],v[16:19]
tr a[136:137],v225 offset:49152
mm v[20:23],a[144:147],a[20:23],v[20:23]
tr a[138:139],v225 offset:53248
mm v[20:23],a[148:151],a[28:31],v[20:23]
tr a[140:141],v225 offset:57344
s_waitcnt lgkmcnt(7)
mm v[24:27],a[152:155],a[16:19],v[24:27]
tr a[142:143],v225 offset:61440
bl a[100:103],v213,s[8:11],s48 offen offset:0 sc1
mm v[24:27],a[156:159],a[24:27],v[24:27]
tr a[144:145],v226 offset:49152
mm v[28:31],a[152:155],a[20:23],v[28:31]
tr a[146:147],v226 offset:53248
mm v[28:31],a[156:159],a[28:31],v[28:31]
tr a[148:149],v226 offset:57344
s_waitcnt lgkmcnt(7)
mm v[32:35],a[128:131],a[16:19],v[32:35]
tr a[150:151],v226 offset:61440
bl a[104:107],v212,s[8:11],s48 offen offset:1024 sc1
mm v[32:35],a[132:135],a[24:27],v[32:35]
tr a[152:153],v227 offset:49152
s_waitcnt vmcnt(27)
mm v[36:39],a[128:131],a[20:23],v[36:39]
tr a[154:155],v227 offset:53248
s_barrier
mm v[36:39],a[132:135],a[28:31],v[36:39]
tr a[156:157],v227 offset:57344
s_waitcnt lgkmcnt(7)
mm v[40:43],a[136:139],a[16:19],v[40:43]
tr a[158:159],v227 offset:61440
bl a[108:111],v213,s[8:11],s48 offen offset:1024 sc1
mm v[40:43],a[140:143],a[24:27],v[40:43]
tr a[128:129],v228 offset:0
s_add_u32 s48,s48,2048
mm v[44:47],a[136:139],a[20:23],v[44:47]
tr a[130:131],v228 offset:4096
s_add_u32 m0,s50,0
mm v[44:47],a[140:143],a[28:31],v[44:47]
tr a[132:133],v228 offset:8192
s_waitcnt lgkmcnt(7)
mm v[48:51],a[144:147],a[16:19],v[48:51]
tr a[134:135],v228 offset:12288
bl v216,s[28:31],s55 offen offset:0 lds
mm v[48:51],a[148:151],a[24:27],v[48:51]
tr a[136:137],v229 offset:0
mm v[52:55],a[144:147],a[20:23],v[52:55]
tr a[138:139],v229 offset:4096
mm v[52:55],a[148:151],a[28:31],v[52:55]
tr a[140:141],v229 offset:8192
s_waitcnt lgkmcnt(7)
mm v[56:59],a[152:155],a[16:19],v[56:59]
tr a[142:143],v229 offset:12288
mm v[56:59],a[156:159],a[24:27],v[56:59]
tr a[144:145],v230 offset:0
bl v217,s[28:31],s55 offen offset:1024 lds
mm v[60:63],a[152:155],a[20:23],v[60:63]
tr a[146:147],v230 offset:4096
mm v[60:63],a[156:159],a[28:31],v[60:63]
tr a[148:149],v230 offset:8192
s_waitcnt lgkmcnt(7)
mm v[0:3],a[128:131],a[32:35],v[0:3]
tr a[150:151],v230 offset:12288
mm v[0:3],a[132:135],a[40:43],v[0:3]
tr a[152:153],v231 offset:0
bl v218,s[28:31],s55 offen offset:2048 lds
mm v[4:7],a[128:131],a[36:39],v[4:7]
tr a[154:155],v231 offset:4096
mm v[4:7],a[132:135],a[44:47],v[4:7]
tr a[156:157],v231 offset:8192
s_waitcnt lgkmcnt(7)
mm v[8:11],a[136:139],a[32:35],v[8:11]
tr a[158:159],v231 offset:12288
mm v[8:11],a[140:143],a[40:43],v[8:11]
tr a[128:129],v232 offset:0
bl v219,s[28:31],s55 offen offset:3072 lds
mm v[12:15],a[136:139],a[36:39],v[12:15]
tr a[130:131],v232 offset:4096
s_add_u32 s55,s55,131072
mm v[12:15],a[140:143],a[44:47],v[12:15]
tr a[132:133],v232 offset:8192
s_waitcnt lgkmcnt(7)
mm v[16:19],a[144:147],a[32:35],v[16:19]
tr a[134:135],v232 offset:12288
mm v[16:19],a[148:151],a[40:43],v[16:19]
tr a[136:137],v233 offset:0
mm v[20:23],a[144:147],a[36:39],v[20:23]
tr a[138:139],v233 offset:4096
buffer_load_dword v210,v204,s[8:11],s57 offen offset:1536 sc1
mm v[20:23],a[148:151],a[44:47],v[20:23]
tr a[140:141],v233 offset:8192
s_waitcnt lgkmcnt(7)
mm v[24:27],a[152:155],a[32:35],v[24:27]
tr a[142:143],v233 offset:12288
mm v[24:27],a[156:159],a[40:43],v[24:27]
tr a[144:145],v234 offset:0
mm v[28:31],a[152:155],a[36:39],v[28:31]
tr a[146:147],v234 offset:4096
bl a[112:115],v212,s[8:11],s48 offen offset:0 sc1
mm v[28:31],a[156:159],a[44:47],v[28:31]
tr a[148:149],v234 offset:8192
s_waitcnt lgkmcnt(7)
mm v[32:35],a[128:131],a[32:35],v[32:35]
tr a[150:151],v234 offset:12288
mm v[32:35],a[132:135],a[40:43],v[32:35]
tr a[152:153],v235 offset:0
s_waitcnt vmcnt(26)
mm v[36:39],a[128:131],a[36:39],v[36:39]
tr a[154:155],v235 offset:4096
s_barrier
mm v[36:39],a[132:135],a[44:47],v[36:39]
bl a[116:119],v213,s[8:11],s48 offen offset:0 sc1
s_waitcnt lgkmcnt(6)
mm v[40:43],a[136:139],a[32:35],v[40:43]
tr a[156:157],v235 offset:8192
tr a[158:159],v235 offset:12288
mm v[40:43],a[140:143],a[40:43],v[40:43]
tr a[128:129],v228 offset:16384
mm v[44:47],a[136:139],a[36:39],v[44:47]
tr a[130:131],v228 offset:20480
mm v[44:47],a[140:143],a[44:47],v[44:47]
tr a[132:133],v228 offset:24576
s_waitcnt lgkmcnt(7)
mm v[48:51],a[144:147],a[32:35],v[48:51]
tr a[134:135],v228 offset:28672
bl a[120:123],v212,s[8:11],s48 offen offset:1024 sc1
mm v[48:51],a[148:151],a[40:43],v[48:51]
tr a[136:137],v229 offset:16384
mm v[52:55],a[144:147],a[36:39],v[52:55]
tr a[138:139],v229 offset:20480
mm v[52:55],a[148:151],a[44:47],v[52:55]
tr a[140:141],v229 offset:24576
s_waitcnt lgkmcnt(7)
mm v[56:59],a[152:155],a[32:35],v[56:59]
tr a[142:143],v229 offset:28672
bl a[124:127],v213,s[8:11],s48 offen offset:1024 sc1
mm v[56:59],a[156:159],a[40:43],v[56:59]
tr a[144:145],v230 offset:16384
s_add_u32 s48,s48,2048
mm v[60:63],a[152:155],a[36:39],v[60:63]
tr a[146:147],v230 offset:20480
s_add_u32 m0,s50,16384
mm v[60:63],a[156:159],a[44:47],v[60:63]
tr a[148:149],v230 offset:24576
s_waitcnt lgkmcnt(7)
mm v[0:3],a[128:131],a[48:51],v[0:3]
tr a[150:151],v230 offset:28672
bl v216,s[28:31],s55 offen offset:0 lds
mm v[0:3],a[132:135],a[56:59],v[0:3]
tr a[152:153],v231 offset:16384
mm v[4:7],a[128:131],a[52:55],v[4:7]
tr a[154:155],v231 offset:20480
mm v[4:7],a[132:135],a[60:63],v[4:7]
tr a[156:157],v231 offset:24576
s_waitcnt lgkmcnt(7)
mm v[8:11],a[136:139],a[48:51],v[8:11]
tr a[158:159],v231 offset:28672
bl v217,s[28:31],s55 offen offset:1024 lds
mm v[8:11],a[140:143],a[56:59],v[8:11]
tr a[128:129],v232 offset:16384
mm v[12:15],a[136:139],a[52:55],v[12:15]
tr a[130:131],v232 offset:20480
mm v[12:15],a[140:143],a[60:63],v[12:15]
tr a[132:133],v232 offset:24576
s_waitcnt lgkmcnt(7)
mm v[16:19],a[144:147],a[48:51],v[16:19]
tr a[134:135],v232 offset:28672
bl v218,s[28:31],s55 offen offset:2048 lds
mm v[16:19],a[148:151],a[56:59],v[16:19]
tr a[136:137],v233 offset:16384
mm v[20:23],a[144:147],a[52:55],v[20:23]
tr a[138:139],v233 offset:20480
mm v[20:23],a[148:151],a[60:63],v[20:23]
tr a[140:141],v233 offset:24576
s_waitcnt lgkmcnt(7)
mm v[24:27],a[152:155],a[48:51],v[24:27]
tr a[142:143],v233 offset:28672
bl v219,s[28:31],s55 offen offset:3072 lds
mm v[24:27],a[156:159],a[56:59],v[24:27]
tr a[144:145],v234 offset:16384
s_add_u32 s55,s55,131072
mm v[28:31],a[152:155],a[52:55],v[28:31]
tr a[146:147],v234 offset:20480
mm v[28:31],a[156:159],a[60:63],v[28:31]
tr a[148:149],v234 offset:24576
s_waitcnt lgkmcnt(7)
mm v[32:35],a[128:131],a[48:51],v[32:35]
tr a[150:151],v234 offset:28672
mm v[32:35],a[132:135],a[56:59],v[32:35]
tr a[152:153],v235 offset:16384
s_waitcnt vmcnt(25)
mm v[36:39],a[128:131],a[52:55],v[36:39]
tr a[154:155],v235 offset:20480
s_barrier
mm v[36:39],a[132:135],a[60:63],v[36:39]
bl a[0:3],v212,s[8:11],s48 offen offset:0 sc1
s_waitcnt lgkmcnt(6)
mm v[40:43],a[136:139],a[48:51],v[40:43]
tr a[156:157],v235 offset:24576
tr a[158:159],v235 offset:28672
mm v[40:43],a[140:143],a[56:59],v[40:43]
tr a[128:129],v228 offset:32768
bl a[4:7],v213,s[8:11],s48 offen offset:0 sc1
mm v[44:47],a[136:139],a[52:55],v[44:47]
tr a[130:131],v228 offset:36864
mm v[44:47],a[140:143],a[60:63],v[44:47]
tr a[132:133],v228 offset:40960
s_waitcnt lgkmcnt(7)
mm v[48:51],a[144:147],a[48:51],v[48:51]
tr a[134:135],v228 offset:45056
mm v[48:51],a[148:151],a[56:59],v[48:51]
tr a[136:137],v229 offset:32768
bl a[8:11],v212,s[8:11],s48 offen offset:1024 sc1
mm v[52:55],a[144:147],a[52:55],v[52:55]
tr a[138:139],v229 offset:36864
mm v[52:55],a[148:151],a[60:63],v[52:55]
tr a[140:141],v229 offset:40960
s_waitcnt lgkmcnt(7)
mm v[56:59],a[152:155],a[48:51],v[56:59]
tr a[142:143],v229 offset:45056
mm v[56:59],a[156:159],a[56:59],v[56:59]
tr a[144:145],v230 offset:32768
mm v[60:63],a[152:155],a[52:55],v[60:63]
tr a[146:147],v230 offset:36864
bl a[12:15],v213,s[8:11],s48 offen offset:1024 sc1
mm v[60:63],a[156:159],a[60:63],v[60:63]
tr a[148:149],v230 offset:40960
s_waitcnt lgkmcnt(7)
mm v[0:3],a[128:131],a[64:67],v[0:3]
tr a[150:151],v230 offset:45056
s_add_u32 s48,s48,2048
mm v[0:3],a[132:135],a[72:75],v[0:3]
tr a[152:153],v231 offset:32768
s_add_u32 m0,s50,32768
mm v[4:7],a[128:131],a[68:71],v[4:7]
tr a[154:155],v231 offset:36864
bl v216,s[28:31],s55 offen offset:0 lds
mm v[4:7],a[132:135],a[76:79],v[4:7]
tr a[156:157],v231 offset:40960
s_waitcnt lgkmcnt(7)
mm v[8:11],a[136:139],a[64:67],v[8:11]
tr a[158:159],v231 offset:45056
mm v[8:11],a[140:143],a[72:75],v[8:11]
tr a[128:129],v232 offset:32768
mm v[12:15],a[136:139],a[68:71],v[12:15]
tr a[130:131],v232 offset:36864
bl v217,s[28:31],s55 offen offset:1024 lds
mm v[12:15],a[140:143],a[76:79],v[12:15]
tr a[132:133],v232 offset:40960
s_waitcnt lgkmcnt(7)
mm v[16:19],a[144:147],a[64:67],v[16:19]
tr a[134:135],v232 offset:45056
mm v[16:19],a[148:151],a[72:75],v[16:19]
tr a[136:137],v233 offset:32768
mm v[20:23],a[144:147],a[68:71],v[20:23]
tr a[138:139],v233 offset:36864
mm v[20:23],a[148:151],a[76:79],v[20:23]
tr a[140:141],v233 offset:40960
s_waitcnt lgkmcnt(7)
mm v[24:27],a[152:155],a[64:67],v[24:27]
tr a[142:143],v233 offset:45056
bl v218,s[28:31],s55 offen offset:2048 lds
mm v[24:27],a[156:159],a[72:75],v[24:27]
tr a[144:145],v234 offset:32768
mm v[28:31],a[152:155],a[68:71],v[28:31]
tr a[146:147],v234 offset:36864
mm v[28:31],a[156:159],a[76:79],v[28:31]
tr a[148:149],v234 offset:40960
s_waitcnt lgkmcnt(7)
mm v[32:35],a[128:131],a[64:67],v[32:35]
tr a[150:151],v234 offset:45056
bl v219,s[28:31],s55 offen offset:3072 lds
mm v[32:35],a[132:135],a[72:75],v[32:35]
tr a[152:153],v235 offset:32768
s_waitcnt vmcnt(25)
mm v[36:39],a[128:131],a[68:71],v[36:39]
tr a[154:155],v235 offset:36864
s_barrier
mm v[36:39],a[132:135],a[76:79],v[36:39]
s_add_u32 s55,s55,131072
s_waitcnt lgkmcnt(6)
mm v[40:43],a[136:139],a[64:67],v[40:43]
tr a[156:157],v235 offset:40960
tr a[158:159],v235 offset:45056
mm v[40:43],a[140:143],a[72:75],v[40:43]
tr a[128:129],v228 offset:49152
bl a[16:19],v212,s[8:11],s48 offen offset:0 sc1
mm v[44:47],a[136:139],a[68:71],v[44:47]
tr a[130:131],v228 offset:53248
mm v[44:47],a[140:143],a[76:79],v[44:47]
tr a[132:133],v228 offset:57344
s_waitcnt lgkmcnt(7)
mm v[48:51],a[144:147],a[64:67],v[48:51]
tr a[134:135],v228 offset:61440
bl a[20:23],v213,s[8:11],s48 offen offset:0 sc1
mm v[48:51],a[148:151],a[72:75],v[48:51]
tr a[136:137],v229 offset:49152
mm v[52:55],a[144:147],a[68:71],v[52:55]
tr a[138:139],v229 offset:53248
mm v[52:55],a[148:151],a[76:79],v[52:55]
tr a[140:141],v229 offset:57344
s_waitcnt lgkmcnt(7)
mm v[56:59],a[152:155],a[64:67],v[56:59]
tr a[142:143],v229 offset:61440
bl a[24:27],v212,s[8:11],s48 offen offset:1024 sc1
mm v[56:59],a[156:159],a[72:75],v[56:59]
tr a[144:145],v230 offset:49152
mm v[60:63],a[152:155],a[68:71],v[60:63]
tr a[146:147],v230 offset:53248
mm v[60:63],a[156:159],a[76:79],v[60:63]
tr a[148:149],v230 offset:57344
s_waitcnt lgkmcnt(7)
mm v[0:3],a[128:131],a[80:83],v[0:3]
tr a[150:151],v230 offset:61440
bl a[28:31],v213,s[8:11],s48 offen offset:1024 sc1
mm v[0:3],a[132:135],a[88:91],v[0:3]
tr a[152:153],v231 offset:49152
s_add_u32 s48,s48,2048
mm v[4:7],a[128:131],a[84:87],v[4:7]
tr a[154:155],v231 offset:53248
s_add_u32 m0,s50,49152
mm v[4:7],a[132:135],a[92:95],v[4:7]
tr a[156:157],v231 offset:57344
s_waitcnt lgkmcnt(7)
mm v[8:11],a[136:139],a[80:83],v[8:11]
tr a[158:159],v231 offset:61440
mm v[8:11],a[140:143],a[88:91],v[8:11]
tr a[128:129],v232 offset:49152
bl v216,s[28:31],s55 offen offset:0 lds
mm v[12:15],a[136:139],a[84:87],v[12:15]
tr a[130:131],v232 offset:53248
mm v[12:15],a[140:143],a[92:95],v[12:15]
tr a[132:133],v232 offset:57344
s_waitcnt lgkmcnt(7)
mm v[16:19],a[144:147],a[80:83],v[16:19]
tr a[134:135],v232 offset:61440
mm v[16:19],a[148:151],a[88:91],v[16:19]
tr a[136:137],v233 offset:49152
bl v217,s[28:31],s55 offen offset:1024 lds
mm v[20:23],a[144:147],a[84:87],v[20:23]
tr a[138:139],v233 offset:53248
mm v[20:23],a[148:151],a[92:95],v[20:23]
tr a[140:141],v233 offset:57344
s_waitcnt lgkmcnt(7)
mm v[24:27],a[152:155],a[80:83],v[24:27]
tr a[142:143],v233 offset:61440
mm v[24:27],a[156:159],a[88:91],v[24:27]
tr a[144:145],v234 offset:49152
bl v218,s[28:31],s55 offen offset:2048 lds
mm v[28:31],a[152:155],a[84:87],v[28:31]
tr a[146:147],v234 offset:53248
mm v[28:31],a[156:159],a[92:95],v[28:31]
tr a[148:149],v234 offset:57344
s_waitcnt lgkmcnt(7)
mm v[32:35],a[128:131],a[80:83],v[32:35]
tr a[150:151],v234 offset:61440
mm v[32:35],a[132:135],a[88:91],v[32:35]
tr a[152:153],v235 offset:49152
s_waitcnt vmcnt(24)
mm v[36:39],a[128:131],a[84:87],v[36:39]
tr a[154:155],v235 offset:53248
s_barrier
mm v[36:39],a[132:135],a[92:95],v[36:39]
bl v219,s[28:31],s55 offen offset:3072 lds
s_waitcnt lgkmcnt(6)
mm v[40:43],a[136:139],a[80:83],v[40:43]
tr a[156:157],v235 offset:57344
tr a[158:159],v235 offset:61440
mm v[40:43],a[140:143],a[88:91],v[40:43]
tr a[128:129],v220 offset:0
s_add_u32 s55,s55,131072
mm v[44:47],a[136:139],a[84:87],v[44:47]
tr a[130:131],v220 offset:4096
bl a[32:35],v212,s[8:11],s48 offen offset:0 sc1
mm v[44:47],a[140:143],a[92:95],v[44:47]
tr a[132:133],v220 offset:8192
s_waitcnt lgkmcnt(7)
mm v[48:51],a[144:147],a[80:83],v[48:51]
tr a[134:135],v220 offset:12288
mm v[48:51],a[148:151],a[88:91],v[48:51]
tr a[136:137],v221 offset:0
mm v[52:55],a[144:147],a[84:87],v[52:55]
tr a[138:139],v221 offset:4096
bl a[36:39],v213,s[8:11],s48 offen offset:0 sc1
mm v[52:55],a[148:151],a[92:95],v[52:55]
tr a[140:141],v221 offset:8192
s_waitcnt lgkmcnt(7)
mm v[56:59],a[152:155],a[80:83],v[56:59]
tr a[142:143],v221 offset:12288
mm v[56:59],a[156:159],a[88:91],v[56:59]
tr a[144:145],v222 offset:0
mm v[60:63],a[152:155],a[84:87],v[60:63]
tr a[146:147],v222 offset:4096
mm v[60:63],a[156:159],a[92:95],v[60:63]
tr a[148:149],v222 offset:8192
s_waitcnt lgkmcnt(7)
mm v[0:3],a[128:131],a[96:99],v[0:3]
tr a[150:151],v222 offset:12288
bl a[40:43],v212,s[8:11],s48 offen offset:1024 sc1
mm v[0:3],a[132:135],a[104:107],v[0:3]
tr a[152:153],v223 offset:0
mm v[4:7],a[128:131],a[100:103],v[4:7]
tr a[154:155],v223 offset:4096
mm v[4:7],a[132:135],a[108:111],v[4:7]
tr a[156:157],v223 offset:8192
s_waitcnt lgkmcnt(7)
mm v[8:11],a[136:139],a[96:99],v[8:11]
tr a[158:159],v223 offset:12288
bl a[44:47],v213,s[8:11],s48 offen offset:1024 sc1
mm v[8:11],a[140:143],a[104:107],v[8:11]
tr a[128:129],v224 offset:0
s_add_u32 s48,s48,2048
mm v[12:15],a[136:139],a[100:103],v[12:15]
tr a[130:131],v224 offset:4096
s_add_u32 m0,s50,65536
mm v[12:15],a[140:143],a[108:111],v[12:15]
tr a[132:133],v224 offset:8192
s_waitcnt lgkmcnt(7)
mm v[16:19],a[144:147],a[96:99],v[16:19]
tr a[134:135],v224 offset:12288
bl v216,s[28:31],s55 offen offset:0 lds
mm v[16:19],a[148:151],a[104:107],v[16:19]
tr a[136:137],v225 offset:0
mm v[20:23],a[144:147],a[100:103],v[20:23]
tr a[138:139],v225 offset:4096
mm v[20:23],a[148:151],a[108:111],v[20:23]
tr a[140:141],v225 offset:8192
s_waitcnt lgkmcnt(7)
mm v[24:27],a[152:155],a[96:99],v[24:27]
tr a[142:143],v225 offset:12288
bl v217,s[28:31],s55 offen offset:1024 lds
mm v[24:27],a[156:159],a[104:107],v[24:27]
tr a[144:145],v226 offset:0
mm v[28:31],a[152:155],a[100:103],v[28:31]
tr a[146:147],v226 offset:4096
mm v[28:31],a[156:159],a[108:111],v[28:31]
tr a[148:149],v226 offset:8192
s_waitcnt lgkmcnt(7)
mm v[32:35],a[128:131],a[96:99],v[32:35]
tr a[150:151],v226 offset:12288
bl v218,s[28:31],s55 offen offset:2048 lds
mm v[32:35],a[132:135],a[104:107],v[32:35]
tr a[152:153],v227 offset:0
s_waitcnt vmcnt(23)
mm v[36:39],a[128:131],a[100:103],v[36:39]
tr a[154:155],v227 offset:4096
s_barrier
mm v[36:39],a[132:135],a[108:111],v[36:39]
tr a[156:157],v227 offset:8192
s_waitcnt lgkmcnt(7)
mm v[40:43],a[136:139],a[96:99],v[40:43]
tr a[158:159],v227 offset:12288
bl v219,s[28:31],s55 offen offset:3072 lds
mm v[40:43],a[140:143],a[104:107],v[40:43]
tr a[128:129],v220 offset:16384
s_add_u32 s55,s55,131072
mm v[44:47],a[136:139],a[100:103],v[44:47]
tr a[130:131],v220 offset:20480
mm v[44:47],a[140:143],a[108:111],v[44:47]
tr a[132:133],v220 offset:24576
s_waitcnt lgkmcnt(7)
mm v[48:51],a[144:147],a[96:99],v[48:51]
tr a[134:135],v220 offset:28672
mm v[48:51],a[148:151],a[104:107],v[48:51]
tr a[136:137],v221 offset:16384
bl a[48:51],v212,s[8:11],s48 offen offset:0 sc1
mm v[52:55],a[144:147],a[100:103],v[52:55]
tr a[138:139],v221 offset:20480
mm v[52:55],a[148:151],a[108:111],v[52:55]
tr a[140:141],v221 offset:24576
s_waitcnt lgkmcnt(7)
mm v[56:59],a[152:155],a[96:99],v[56:59]
tr a[142:143],v221 offset:28672
mm v[56:59],a[156:159],a[104:107],v[56:59]
tr a[144:145],v222 offset:16384
bl a[52:55],v213,s[8:11],s48 offen offset:0 sc1
mm v[60:63],a[152:155],a[100:103],v[60:63]
tr a[146:147],v222 offset:20480
mm v[60:63],a[156:159],a[108:111],v[60:63]
tr a[148:149],v222 offset:24576
s_waitcnt lgkmcnt(7)
mm v[0:3],a[128:131],a[112:115],v[0:3]
tr a[150:151],v222 offset:28672
mm v[0:3],a[132:135],a[120:123],v[0:3]
tr a[152:153],v223 offset:16384
mm v[4:7],a[128:131],a[116:119],v[4:7]
tr a[154:155],v223 offset:20480
bl a[56:59],v212,s[8:11],s48 offen offset:1024 sc1
mm v[4:7],a[132:135],a[124:127],v[4:7]
tr a[156:157],v223 offset:24576
s_waitcnt lgkmcnt(7)
mm v[8:11],a[136:139],a[112:115],v[8:11]
tr a[158:159],v223 offset:28672
mm v[8:11],a[140:143],a[120:123],v[8:11]
tr a[128:129],v224 offset:16384
mm v[12:15],a[136:139],a[116:119],v[12:15]
tr a[130:131],v224 offset:20480
bl a[60:63],v213,s[8:11],s48 offen offset:1024 sc1
mm v[12:15],a[140:143],a[124:127],v[12:15]
tr a[132:133],v224 offset:24576
s_waitcnt lgkmcnt(7)
mm v[16:19],a[144:147],a[112:115],v[16:19]
tr a[134:135],v224 offset:28672
s_add_u32 s48,s48,2048
mm v[16:19],a[148:151],a[120:123],v[16:19]
tr a[136:137],v225 offset:16384
s_add_u32 m0,s50,81920
mm v[20:23],a[144:147],a[116:119],v[20:23]
tr a[138:139],v225 offset:20480
bl v216,s[28:31],s55 offen offset:0 lds
mm v[20:23],a[148:151],a[124:127],v[20:23]
tr a[140:141],v225 offset:24576
s_waitcnt lgkmcnt(7)
mm v[24:27],a[152:155],a[112:115],v[24:27]
tr a[142:143],v225 offset:28672
mm v[24:27],a[156:159],a[120:123],v[24:27]
tr a[144:145],v226 offset:16384
mm v[28:31],a[152:155],a[116:119],v[28:31]
tr a[146:147],v226 offset:20480
mm v[28:31],a[156:159],a[124:127],v[28:31]
tr a[148:149],v226 offset:24576
s_waitcnt lgkmcnt(7)
mm v[32:35],a[128:131],a[112:115],v[32:35]
tr a[150:151],v226 offset:28672
bl v217,s[28:31],s55 offen offset:1024 lds
mm v[32:35],a[132:135],a[120:123],v[32:35]
tr a[152:153],v227 offset:16384
s_waitcnt vmcnt(22)
mm v[36:39],a[128:131],a[116:119],v[36:39]
tr a[154:155],v227 offset:20480
s_barrier
mm v[36:39],a[132:135],a[124:127],v[36:39]
tr a[156:157],v227 offset:24576
s_waitcnt lgkmcnt(7)
mm v[40:43],a[136:139],a[112:115],v[40:43]
tr a[158:159],v227 offset:28672
bl v218,s[28:31],s55 offen offset:2048 lds
mm v[40:43],a[140:143],a[120:123],v[40:43]
tr a[128:129],v220 offset:32768
mm v[44:47],a[136:139],a[116:119],v[44:47]
tr a[130:131],v220 offset:36864
mm v[44:47],a[140:143],a[124:127],v[44:47]
tr a[132:133],v220 offset:40960
s_waitcnt lgkmcnt(7)
mm v[48:51],a[144:147],a[112:115],v[48:51]
tr a[134:135],v220 offset:45056
bl v219,s[28:31],s55 offen offset:3072 lds
mm v[48:51],a[148:151],a[120:123],v[48:51]
tr a[136:137],v221 offset:32768
s_add_u32 s55,s55,131072
mm v[52:55],a[144:147],a[116:119],v[52:55]
tr a[138:139],v221 offset:36864
mm v[52:55],a[148:151],a[124:127],v[52:55]
tr a[140:141],v221 offset:40960
s_waitcnt lgkmcnt(7)
mm v[56:59],a[152:155],a[112:115],v[56:59]
tr a[142:143],v221 offset:45056
bl a[64:67],v212,s[8:11],s48 offen offset:0 sc1
mm v[56:59],a[156:159],a[120:123],v[56:59]
tr a[144:145],v222 offset:32768
mm v[60:63],a[152:155],a[116:119],v[60:63]
tr a[146:147],v222 offset:36864
mm v[60:63],a[156:159],a[124:127],v[60:63]
tr a[148:149],v222 offset:40960
s_waitcnt lgkmcnt(7)
mm v[0:3],a[128:131],a[0:3],v[0:3]
tr a[150:151],v222 offset:45056
bl a[68:71],v213,s[8:11],s48 offen offset:0 sc1
mm v[0:3],a[132:135],a[8:11],v[0:3]
tr a[152:153],v223 offset:32768
mm v[4:7],a[128:131],a[4:7],v[4:7]
tr a[154:155],v223 offset:36864
mm v[4:7],a[132:135],a[12:15],v[4:7]
tr a[156:157],v223 offset:40960
s_waitcnt lgkmcnt(7)
mm v[8:11],a[136:139],a[0:3],v[8:11]
tr a[158:159],v223 offset:45056
bl a[72:75],v212,s[8:11],s48 offen offset:1024 sc1
mm v[8:11],a[140:143],a[8:11],v[8:11]
tr a[128:129],v224 offset:32768
mm v[12:15],a[136:139],a[4:7],v[12:15]
tr a[130:131],v224 offset:36864
mm v[12:15],a[140:143],a[12:15],v[12:15]
tr a[132:133],v224 offset:40960
s_waitcnt lgkmcnt(7)
mm v[16:19],a[144:147],a[0:3],v[16:19]
tr a[134:135],v224 offset:45056
mm v[16:19],a[148:151],a[8:11],v[16:19]
tr a[136:137],v225 offset:32768
bl a[76:79],v213,s[8:11],s48 offen offset:1024 sc1
mm v[20:23],a[144:147],a[4:7],v[20:23]
tr a[138:139],v225 offset:36864
s_add_u32 s48,s48,2048
mm v[20:23],a[148:151],a[12:15],v[20:23]
tr a[140:141],v225 offset:40960
s_waitcnt lgkmcnt(7)
mm v[24:27],a[152:155],a[0:3],v[24:27]
tr a[142:143],v225 offset:45056
s_add_u32 m0,s50,98304
mm v[24:27],a[156:159],a[8:11],v[24:27]
tr a[144:145],v226 offset:32768
bl v216,s[28:31],s55 offen offset:0 lds
mm v[28:31],a[152:155],a[4:7],v[28:31]
tr a[146:147],v226 offset:36864
mm v[28:31],a[156:159],a[12:15],v[28:31]
tr a[148:149],v226 offset:40960
s_waitcnt lgkmcnt(7)
mm v[32:35],a[128:131],a[0:3],v[32:35]
tr a[150:151],v226 offset:45056
mm v[32:35],a[132:135],a[8:11],v[32:35]
tr a[152:153],v227 offset:32768
s_waitcnt vmcnt(21)
mm v[36:39],a[128:131],a[4:7],v[36:39]
tr a[154:155],v227 offset:36864
s_barrier
mm v[36:39],a[132:135],a[12:15],v[36:39]
bl v217,s[28:31],s55 offen offset:1024 lds
s_waitcnt lgkmcnt(6)
mm v[40:43],a[136:139],a[0:3],v[40:43]
tr a[156:157],v227 offset:40960
tr a[158:159],v227 offset:45056
mm v[40:43],a[140:143],a[8:11],v[40:43]
tr a[128:129],v220 offset:49152
mm v[44:47],a[136:139],a[4:7],v[44:47]
tr a[130:131],v220 offset:53248
bl v218,s[28:31],s55 offen offset:2048 lds
mm v[44:47],a[140:143],a[12:15],v[44:47]
tr a[132:133],v220 offset:57344
s_waitcnt lgkmcnt(7)
mm v[48:51],a[144:147],a[0:3],v[48:51]
tr a[134:135],v220 offset:61440
mm v[48:51],a[148:151],a[8:11],v[48:51]
tr a[136:137],v221 offset:49152
mm v[52:55],a[144:147],a[4:7],v[52:55]
tr a[138:139],v221 offset:53248
bl v219,s[28:31],s55 offen offset:3072 lds
mm v[52:55],a[148:151],a[12:15],v[52:55]
tr a[140:141],v221 offset:57344
s_waitcnt lgkmcnt(7)
mm v[56:59],a[152:155],a[0:3],v[56:59]
tr a[142:143],v221 offset:61440
s_add_u32 s55,s55,131072
mm v[56:59],a[156:159],a[8:11],v[56:59]
tr a[144:145],v222 offset:49152
mm v[60:63],a[152:155],a[4:7],v[60:63]
tr a[146:147],v222 offset:53248
bl a[80:83],v212,s[8:11],s48 offen offset:0 sc1
mm v[60:63],a[156:159],a[12:15],v[60:63]
tr a[148:149],v222 offset:57344
s_waitcnt lgkmcnt(7)
mm v[0:3],a[128:131],a[16:19],v[0:3]
tr a[150:151],v222 offset:61440
mm v[0:3],a[132:135],a[24:27],v[0:3]
tr a[152:153],v223 offset:49152
mm v[4:7],a[128:131],a[20:23],v[4:7]
tr a[154:155],v223 offset:53248
mm v[4:7],a[132:135],a[28:31],v[4:7]
tr a[156:157],v223 offset:57344
s_waitcnt lgkmcnt(7)
mm v[8:11],a[136:139],a[16:19],v[8:11]
tr a[158:159],v223 offset:61440
bl a[84:87],v213,s[8:11],s48 offen offset:0 sc1
mm v[8:11],a[140:143],a[24:27],v[8:11]
tr a[128:129],v224 offset:49152
mm v[12:15],a[136:139],a[20:23],v[12:15]
tr a[130:131],v224 offset:53248
mm v[12:15],a[140:143],a[28:31],v[12:15]
tr a[132:133],v224 offset:57344
s_waitcnt lgkmcnt(7)
mm v[16:19],a[144:147],a[16:19],v[16:19]
tr a[134:135],v224 offset:61440
bl a[88:91],v212,s[8:11],s48 offen offset:1024 sc1
mm v[16:19],a[148:151],a[24:27],v[16:19]
tr a[136:137],v225 offset:49152
mm v[20:23],a[144:147],a[20:23],v[20:23]
tr a[138:139],v225 offset:53248
mm v[20:23],a[148:151],a[28:31],v[20:23]
tr a[140:141],v225 offset:57344
s_waitcnt lgkmcnt(7)
mm v[24:27],a[152:155],a[16:19],v[24:27]
tr a[142:143],v225 offset:61440
bl a[92:95],v213,s[8:11],s48 offen offset:1024 sc1
mm v[24:27],a[156:159],a[24:27],v[24:27]
tr a[144:145],v226 offset:49152
s_add_u32 s48,s48,2048
mm v[28:31],a[152:155],a[20:23],v[28:31]
tr a[146:147],v226 offset:53248
s_add_u32 m0,s50,114688
mm v[28:31],a[156:159],a[28:31],v[28:31]
tr a[148:149],v226 offset:57344
s_waitcnt lgkmcnt(7)
mm v[32:35],a[128:131],a[16:19],v[32:35]
tr a[150:151],v226 offset:61440
bl v216,s[28:31],s55 offen offset:0 lds
mm v[32:35],a[132:135],a[24:27],v[32:35]
tr a[152:153],v227 offset:49152
s_waitcnt vmcnt(21)
mm v[36:39],a[128:131],a[20:23],v[36:39]
tr a[154:155],v227 offset:53248
s_barrier
mm v[36:39],a[132:135],a[28:31],v[36:39]
tr a[156:157],v227 offset:57344
s_waitcnt lgkmcnt(7)
mm v[40:43],a[136:139],a[16:19],v[40:43]
tr a[158:159],v227 offset:61440
bl v217,s[28:31],s55 offen offset:1024 lds
mm v[40:43],a[140:143],a[24:27],v[40:43]
tr a[128:129],v228 offset:0
mm v[44:47],a[136:139],a[20:23],v[44:47]
tr a[130:131],v228 offset:4096
mm v[44:47],a[140:143],a[28:31],v[44:47]
tr a[132:133],v228 offset:8192
s_waitcnt lgkmcnt(7)
mm v[48:51],a[144:147],a[16:19],v[48:51]
tr a[134:135],v228 offset:12288
bl v218,s[28:31],s55 offen offset:2048 lds
mm v[48:51],a[148:151],a[24:27],v[48:51]
tr a[136:137],v229 offset:0
mm v[52:55],a[144:147],a[20:23],v[52:55]
tr a[138:139],v229 offset:4096
mm v[52:55],a[148:151],a[28:31],v[52:55]
tr a[140:141],v229 offset:8192
s_waitcnt lgkmcnt(7)
mm v[56:59],a[152:155],a[16:19],v[56:59]
tr a[142:143],v229 offset:12288
mm v[56:59],a[156:159],a[24:27],v[56:59]
tr a[144:145],v230 offset:0
bl v219,s[28:31],s55 offen offset:3072 lds
mm v[60:63],a[152:155],a[20:23],v[60:63]
tr a[146:147],v230 offset:4096
s_add_u32 s55,s55,131072
mm v[60:63],a[156:159],a[28:31],v[60:63]
tr a[148:149],v230 offset:8192
s_waitcnt lgkmcnt(7)
mm v[0:3],a[128:131],a[32:35],v[0:3]
tr a[150:151],v230 offset:12288
mm v[0:3],a[132:135],a[40:43],v[0:3]
tr a[152:153],v231 offset:0
bl a[96:99],v212,s[8:11],s48 offen offset:0 sc1
mm v[4:7],a[128:131],a[36:39],v[4:7]
tr a[154:155],v231 offset:4096
mm v[4:7],a[132:135],a[44:47],v[4:7]
tr a[156:157],v231 offset:8192
s_waitcnt lgkmcnt(7)
mm v[8:11],a[136:139],a[32:35],v[8:11]
tr a[158:159],v231 offset:12288
mm v[8:11],a[140:143],a[40:43],v[8:11]
tr a[128:129],v232 offset:0
bl a[100:103],v213,s[8:11],s48 offen offset:0 sc1
mm v[12:15],a[136:139],a[36:39],v[12:15]
tr a[130:131],v232 offset:4096
mm v[12:15],a[140:143],a[44:47],v[12:15]
tr a[132:133],v232 offset:8192
s_waitcnt lgkmcnt(7)
mm v[16:19],a[144:147],a[32:35],v[16:19]
tr a[134:135],v232 offset:12288
mm v[16:19],a[148:151],a[40:43],v[16:19]
tr a[136:137],v233 offset:0
mm v[20:23],a[144:147],a[36:39],v[20:23]
tr a[138:139],v233 offset:4096
bl a[104:107],v212,s[8:11],s48 offen offset:1024 sc1
mm v[20:23],a[148:151],a[44:47],v[20:23]
tr a[140:141],v233 offset:8192
s_waitcnt lgkmcnt(7)
mm v[24:27],a[152:155],a[32:35],v[24:27]
tr a[142:143],v233 offset:12288
mm v[24:27],a[156:159],a[40:43],v[24:27]
tr a[144:145],v234 offset:0
mm v[28:31],a[152:155],a[36:39],v[28:31]
tr a[146:147],v234 offset:4096
bl a[108:111],v213,s[8:11],s48 offen offset:1024 sc1
mm v[28:31],a[156:159],a[44:47],v[28:31]
tr a[148:149],v234 offset:8192
s_waitcnt lgkmcnt(7)
mm v[32:35],a[128:131],a[32:35],v[32:35]
tr a[150:151],v234 offset:12288
s_add_u32 s48,s48,2048
mm v[32:35],a[132:135],a[40:43],v[32:35]
tr a[152:153],v235 offset:0
s_waitcnt vmcnt(20)
mm v[36:39],a[128:131],a[36:39],v[36:39]
tr a[154:155],v235 offset:4096
s_barrier
mm v[36:39],a[132:135],a[44:47],v[36:39]
s_add_u32 m0,s50,0
s_waitcnt lgkmcnt(6)
mm v[40:43],a[136:139],a[32:35],v[40:43]
tr a[156:157],v235 offset:8192
bl v216,s[28:31],s55 offen offset:0 lds
mm v[40:43],a[140:143],a[40:43],v[40:43]
tr a[158:159],v235 offset:12288
mm v[44:47],a[136:139],a[36:39],v[44:47]
tr a[128:129],v228 offset:16384
tr a[130:131],v228 offset:20480
mm v[44:47],a[140:143],a[44:47],v[44:47]
tr a[132:133],v228 offset:24576
s_waitcnt lgkmcnt(7)
mm v[48:51],a[144:147],a[32:35],v[48:51]
tr a[134:135],v228 offset:28672
bl v217,s[28:31],s55 offen offset:1024 lds
mm v[48:51],a[148:151],a[40:43],v[48:51]
tr a[136:137],v229 offset:16384
mm v[52:55],a[144:147],a[36:39],v[52:55]
tr a[138:139],v229 offset:20480
mm v[52:55],a[148:151],a[44:47],v[52:55]
tr a[140:141],v229 offset:24576
s_waitcnt lgkmcnt(7)
mm v[56:59],a[152:155],a[32:35],v[56:59]
tr a[142:143],v229 offset:28672
bl v218,s[28:31],s55 offen offset:2048 lds
mm v[56:59],a[156:159],a[40:43],v[56:59]
tr a[144:145],v230 offset:16384
mm v[60:63],a[152:155],a[36:39],v[60:63]
tr a[146:147],v230 offset:20480
mm v[60:63],a[156:159],a[44:47],v[60:63]
tr a[148:149],v230 offset:24576
v_cmp_gt_u32 vcc,16,v210
s_nop 0
s_cbranch_vccnz tail_xspin
tail_xok:
s_waitcnt lgkmcnt(7)
mm v[0:3],a[128:131],a[48:51],v[0:3]
tr a[150:151],v230 offset:28672
bl v219,s[28:31],s55 offen offset:3072 lds
mm v[0:3],a[132:135],a[56:59],v[0:3]
tr a[152:153],v231 offset:16384
s_add_u32 s55,s55,131072
mm v[4:7],a[128:131],a[52:55],v[4:7]
tr a[154:155],v231 offset:20480
mm v[4:7],a[132:135],a[60:63],v[4:7]
tr a[156:157],v231 offset:24576
s_waitcnt lgkmcnt(7)
mm v[8:11],a[136:139],a[48:51],v[8:11]
tr a[158:159],v231 offset:28672
bl a[112:115],v212,s[8:11],s48 offen offset:0 sc1
mm v[8:11],a[140:143],a[56:59],v[8:11]
tr a[128:129],v232 offset:16384
mm v[12:15],a[136:139],a[52:55],v[12:15]
tr a[130:131],v232 offset:20480
mm v[12:15],a[140:143],a[60:63],v[12:15]
tr a[132:133],v232 offset:24576
s_waitcnt lgkmcnt(7)
mm v[16:19],a[144:147],a[48:51],v[16:19]
tr a[134:135],v232 offset:28672
bl a[116:119],v213,s[8:11],s48 offen offset:0 sc1
mm v[16:19],a[148:151],a[56:59],v[16:19]
tr a[136:137],v233 offset:16384
mm v[20:23],a[144:147],a[52:55],v[20:23]
tr a[138:139],v233 offset:20480
mm v[20:23],a[148:151],a[60:63],v[20:23]
tr a[140:141],v233 offset:24576
s_waitcnt lgkmcnt(7)
mm v[24:27],a[152:155],a[48:51],v[24:27]
tr a[142:143],v233 offset:28672
bl a[120:123],v212,s[8:11],s48 offen offset:1024 sc1
mm v[24:27],a[156:159],a[56:59],v[24:27]
tr a[144:145],v234 offset:16384
mm v[28:31],a[152:155],a[52:55],v[28:31]
tr a[146:147],v234 offset:20480
mm v[28:31],a[156:159],a[60:63],v[28:31]
tr a[148:149],v234 offset:24576
s_waitcnt lgkmcnt(7)
mm v[32:35],a[128:131],a[48:51],v[32:35]
tr a[150:151],v234 offset:28672
mm v[32:35],a[132:135],a[56:59],v[32:35]
tr a[152:153],v235 offset:16384
s_waitcnt vmcnt(19)
mm v[36:39],a[128:131],a[52:55],v[36:39]
tr a[154:155],v235 offset:20480
s_barrier
mm v[36:39],a[132:135],a[60:63],v[36:39]
bl a[124:127],v213,s[8:11],s48 offen offset:1024 sc1
s_waitcnt lgkmcnt(6)
mm v[40:43],a[136:139],a[48:51],v[40:43]
tr a[156:157],v235 offset:24576
tr a[158:159],v235 offset:28672
mm v[40:43],a[140:143],a[56:59],v[40:43]
s_add_u32 s48,s48,2048
s_add_u32 m0,s50,16384
mm v[44:47],a[136:139],a[52:55],v[44:47]
tr a[128:129],v228 offset:32768
tr a[130:131],v228 offset:36864
mm v[44:47],a[140:143],a[60:63],v[44:47]
bl v216,s[28:31],s55 offen offset:0 lds
s_waitcnt lgkmcnt(6)
mm v[48:51],a[144:147],a[48:51],v[48:51]
tr a[132:133],v228 offset:40960
tr a[134:135],v228 offset:45056
mm v[48:51],a[148:151],a[56:59],v[48:51]
tr a[136:137],v229 offset:32768
mm v[52:55],a[144:147],a[52:55],v[52:55]
tr a[138:139],v229 offset:36864
bl v217,s[28:31],s55 offen offset:1024 lds
mm v[52:55],a[148:151],a[60:63],v[52:55]
tr a[140:141],v229 offset:40960
s_waitcnt lgkmcnt(7)
mm v[56:59],a[152:155],a[48:51],v[56:59]
tr a[142:143],v229 offset:45056
mm v[56:59],a[156:159],a[56:59],v[56:59]
tr a[144:145],v230 offset:32768
mm v[60:63],a[152:155],a[52:55],v[60:63]
tr a[146:147],v230 offset:36864
bl v218,s[28:31],s55 offen offset:2048 lds
mm v[60:63],a[156:159],a[60:63],v[60:63]
tr a[148:149],v230 offset:40960
s_waitcnt lgkmcnt(7)
mm v[0:3],a[128:131],a[64:67],v[0:3]
tr a[150:151],v230 offset:45056
mm v[0:3],a[132:135],a[72:75],v[0:3]
tr a[152:153],v231 offset:32768
mm v[4:7],a[128:131],a[68:71],v[4:7]
tr a[154:155],v231 offset:36864
bl v219,s[28:31],s55 offen offset:3072 lds
mm v[4:7],a[132:135],a[76:79],v[4:7]
tr a[156:157],v231 offset:40960
s_waitcnt lgkmcnt(7)
mm v[8:11],a[136:139],a[64:67],v[8:11]
tr a[158:159],v231 offset:45056
s_add_u32 s55,s55,131072
mm v[8:11],a[140:143],a[72:75],v[8:11]
tr a[128:129],v232 offset:32768
mm v[12:15],a[136:139],a[68:71],v[12:15]
tr a[130:131],v232 offset:36864
mm v[12:15],a[140:143],a[76:79],v[12:15]
tr a[132:133],v232 offset:40960
s_waitcnt lgkmcnt(7)
mm v[16:19],a[144:147],a[64:67],v[16:19]
tr a[134:135],v232 offset:45056
bl a[0:3],v212,s[8:11],s48 offen offset:0 sc1
mm v[16:19],a[148:151],a[72:75],v[16:19]
tr a[136:137],v233 offset:32768
mm v[20:23],a[144:147],a[68:71],v[20:23]
tr a[138:139],v233 offset:36864
mm v[20:23],a[148:151],a[76:79],v[20:23]
tr a[140:141],v233 offset:40960
s_waitcnt lgkmcnt(7)
mm v[24:27],a[152:155],a[64:67],v[24:27]
tr a[142:143],v233 offset:45056
bl a[4:7],v213,s[8:11],s48 offen offset:0 sc1
mm v[24:27],a[156:159],a[72:75],v[24:27]
tr a[144:145],v234 offset:32768
mm v[28:31],a[152:155],a[68:71],v[28:31]
tr a[146:147],v234 offset:36864
mm v[28:31],a[156:159],a[76:79],v[28:31]
tr a[148:149],v234 offset:40960
s_waitcnt lgkmcnt(7)
mm v[32:35],a[128:131],a[64:67],v[32:35]
tr a[150:151],v234 offset:45056
bl a[8:11],v212,s[8:11],s48 offen offset:1024 sc1
mm v[32:35],a[132:135],a[72:75],v[32:35]
tr a[152:153],v235 offset:32768
s_waitcnt vmcnt(19)
mm v[36:39],a[128:131],a[68:71],v[36:39]
tr a[154:155],v235 offset:36864
s_barrier
mm v[36:39],a[132:135],a[76:79],v[36:39]
tr a[156:157],v235 offset:40960
s_waitcnt lgkmcnt(7)
mm v[40:43],a[136:139],a[64:67],v[40:43]
tr a[158:159],v235 offset:45056
bl a[12:15],v213,s[8:11],s48 offen offset:1024 sc1
mm v[40:43],a[140:143],a[72:75],v[40:43]
tr a[128:129],v228 offset:49152
s_add_u32 s48,s48,2048
mm v[44:47],a[136:139],a[68:71],v[44:47]
tr a[130:131],v228 offset:53248
s_add_u32 m0,s50,32768
mm v[44:47],a[140:143],a[76:79],v[44:47]
tr a[132:133],v228 offset:57344
s_waitcnt lgkmcnt(7)
mm v[48:51],a[144:147],a[64:67],v[48:51]
tr a[134:135],v228 offset:61440
bl v216,s[28:31],s55 offen offset:0 lds
mm v[48:51],a[148:151],a[72:75],v[48:51]
tr a[136:137],v229 offset:49152
mm v[52:55],a[144:147],a[68:71],v[52:55]
tr a[138:139],v229 offset:53248
mm v[52:55],a[148:151],a[76:79],v[52:55]
tr a[140:141],v229 offset:57344
s_waitcnt lgkmcnt(7)
mm v[56:59],a[152:155],a[64:67],v[56:59]
tr a[142:143],v229 offset:61440
bl v217,s[28:31],s55 offen offset:1024 lds
mm v[56:59],a[156:159],a[72:75],v[56:59]
tr a[144:145],v230 offset:49152
mm v[60:63],a[152:155],a[68:71],v[60:63]
tr a[146:147],v230 offset:53248
mm v[60:63],a[156:159],a[76:79],v[60:63]
tr a[148:149],v230 offset:57344
s_waitcnt lgkmcnt(7)
mm v[0:3],a[128:131],a[80:83],v[0:3]
tr a[150:151],v230 offset:61440
mm v[0:3],a[132:135],a[88:91],v[0:3]
tr a[152:153],v231 offset:49152
bl v218,s[28:31],s55 offen offset:2048 lds
mm v[4:7],a[128:131],a[84:87],v[4:7]
tr a[154:155],v231 offset:53248
mm v[4:7],a[132:135],a[92:95],v[4:7]
tr a[156:157],v231 offset:57344
s_waitcnt lgkmcnt(7)
mm v[8:11],a[136:139],a[80:83],v[8:11]
tr a[158:159],v231 offset:61440
mm v[8:11],a[140:143],a[88:91],v[8:11]
tr a[128:129],v232 offset:49152
bl v219,s[28:31],s55 offen offset:3072 lds
mm v[12:15],a[136:139],a[84:87],v[12:15]
tr a[130:131],v232 offset:53248
s_add_u32 s55,s55,131072
mm v[12:15],a[140:143],a[92:95],v[12:15]
tr a[132:133],v232 offset:57344
s_waitcnt lgkmcnt(7)
mm v[16:19],a[144:147],a[80:83],v[16:19]
tr a[134:135],v232 offset:61440
mm v[16:19],a[148:151],a[88:91],v[16:19]
tr a[136:137],v233 offset:49152
bl a[16:19],v212,s[8:11],s48 offen offset:0 sc1
mm v[20:23],a[144:147],a[84:87],v[20:23]
tr a[138:139],v233 offset:53248
mm v[20:23],a[148:151],a[92:95],v[20:23]
tr a[140:141],v233 offset:57344
s_waitcnt lgkmcnt(7)
mm v[24:27],a[152:155],a[80:83],v[24:27]
tr a[142:143],v233 offset:61440
mm v[24:27],a[156:159],a[88:91],v[24:27]
tr a[144:145],v234 offset:49152
mm v[28:31],a[152:155],a[84:87],v[28:31]
tr a[146:147],v234 offset:53248
bl a[20:23],v213,s[8:11],s48 offen offset:0 sc1
mm v[28:31],a[156:159],a[92:95],v[28:31]
tr a[148:149],v234 offset:57344
s_waitcnt lgkmcnt(7)
mm v[32:35],a[128:131],a[80:83],v[32:35]
tr a[150:151],v234 offset:61440
mm v[32:35],a[132:135],a[88:91],v[32:35]
tr a[152:153],v235 offset:49152
s_waitcnt vmcnt(18)
mm v[36:39],a[128:131],a[84:87],v[36:39]
tr a[154:155],v235 offset:53248
s_barrier
mm v[36:39],a[132:135],a[92:95],v[36:39]
bl a[24:27],v212,s[8:11],s48 offen offset:1024 sc1
s_waitcnt lgkmcnt(6)
mm v[40:43],a[136:139],a[80:83],v[40:43]
tr a[156:157],v235 offset:57344
tr a[158:159],v235 offset:61440
mm v[40:43],a[140:143],a[88:91],v[40:43]
tr a[128:129],v220 offset:0
mm v[44:47],a[136:139],a[84:87],v[44:47]
tr a[130:131],v220 offset:4096
bl a[28:31],v213,s[8:11],s48 offen offset:1024 sc1
mm v[44:47],a[140:143],a[92:95],v[44:47]
tr a[132:133],v220 offset:8192
s_waitcnt lgkmcnt(7)
mm v[48:51],a[144:147],a[80:83],v[48:51]
tr a[134:135],v220 offset:12288
s_add_u32 s48,s48,2048
mm v[48:51],a[148:151],a[88:91],v[48:51]
tr a[136:137],v221 offset:0
s_add_u32 m0,s50,49152
mm v[52:55],a[144:147],a[84:87],v[52:55]
tr a[138:139],v221 offset:4096
mm v[52:55],a[148:151],a[92:95],v[52:55]
tr a[140:141],v221 offset:8192
s_waitcnt lgkmcnt(7)
mm v[56:59],a[152:155],a[80:83],v[56:59]
tr a[142:143],v221 offset:12288
bl v216,s[28:31],s55 offen offset:0 lds
mm v[56:59],a[156:159],a[88:91],v[56:59]
tr a[144:145],v222 offset:0
mm v[60:63],a[152:155],a[84:87],v[60:63]
tr a[146:147],v222 offset:4096
mm v[60:63],a[156:159],a[92:95],v[60:63]
tr a[148:149],v222 offset:8192
s_waitcnt lgkmcnt(7)
mm v[0:3],a[128:131],a[96:99],v[0:3]
tr a[150:151],v222 offset:12288
bl v217,s[28:31],s55 offen offset:1024 lds
mm v[0:3],a[132:135],a[104:107],v[0:3]
tr a[152:153],v223 offset:0
mm v[4:7],a[128:131],a[100:103],v[4:7]
tr a[154:155],v223 offset:4096
mm v[4:7],a[132:135],a[108:111],v[4:7]
tr a[156:157],v223 offset:8192
s_waitcnt lgkmcnt(7)
mm v[8:11],a[136:139],a[96:99],v[8:11]
tr a[158:159],v223 offset:12288
bl v218,s[28:31],s55 offen offset:2048 lds
mm v[8:11],a[140:143],a[104:107],v[8:11]
tr a[128:129],v224 offset:0
mm v[12:15],a[136:139],a[100:103],v[12:15]
tr a[130:131],v224 offset:4096
mm v[12:15],a[140:143],a[108:111],v[12:15]
tr a[132:133],v224 offset:8192
s_waitcnt lgkmcnt(7)
mm v[16:19],a[144:147],a[96:99],v[16:19]
tr a[134:135],v224 offset:12288
bl v219,s[28:31],s55 offen offset:3072 lds
mm v[16:19],a[148:151],a[104:107],v[16:19]
tr a[136:137],v225 offset:0
s_add_u32 s55,s55,131072
mm v[20:23],a[144:147],a[100:103],v[20:23]
tr a[138:139],v225 offset:4096
mm v[20:23],a[148:151],a[108:111],v[20:23]
tr a[140:141],v225 offset:8192
s_waitcnt lgkmcnt(7)
mm v[24:27],a[152:155],a[96:99],v[24:27]
tr a[142:143],v225 offset:12288
bl a[32:35],v212,s[8:11],s48 offen offset:0 sc1
mm v[24:27],a[156:159],a[104:107],v[24:27]
tr a[144:145],v226 offset:0
mm v[28:31],a[152:155],a[100:103],v[28:31]
tr a[146:147],v226 offset:4096
mm v[28:31],a[156:159],a[108:111],v[28:31]
tr a[148:149],v226 offset:8192
s_waitcnt lgkmcnt(7)
mm v[32:35],a[128:131],a[96:99],v[32:35]
tr a[150:151],v226 offset:12288
bl a[36:39],v213,s[8:11],s48 offen offset:0 sc1
mm v[32:35],a[132:135],a[104:107],v[32:35]
tr a[152:153],v227 offset:0
s_waitcnt vmcnt(18)
mm v[36:39],a[128:131],a[100:103],v[36:39]
tr a[154:155],v227 offset:4096
s_barrier
mm v[36:39],a[132:135],a[108:111],v[36:39]
tr a[156:157],v227 offset:8192
s_waitcnt lgkmcnt(7)
mm v[40:43],a[136:139],a[96:99],v[40:43]
tr a[158:159],v227 offset:12288
mm v[40:43],a[140:143],a[104:107],v[40:43]
tr a[128:129],v220 offset:16384
bl a[40:43],v212,s[8:11],s48 offen offset:1024 sc1
mm v[44:47],a[136:139],a[100:103],v[44:47]
tr a[130:131],v220 offset:20480
mm v[44:47],a[140:143],a[108:111],v[44:47]
tr a[132:133],v220 offset:24576
s_waitcnt lgkmcnt(7)
mm v[48:51],a[144:147],a[96:99],v[48:51]
tr a[134:135],v220 offset:28672
mm v[48:51],a[148:151],a[104:107],v[48:51]
tr a[136:137],v221 offset:16384
bl a[44:47],v213,s[8:11],s48 offen offset:1024 sc1
mm v[52:55],a[144:147],a[100:103],v[52:55]
tr a[138:139],v221 offset:20480
s_add_u32 s48,s48,2048
mm v[52:55],a[148:151],a[108:111],v[52:55]
tr a[140:141],v221 offset:24576
s_waitcnt lgkmcnt(7)
mm v[56:59],a[152:155],a[96:99],v[56:59]
tr a[142:143],v221 offset:28672
s_add_u32 m0,s50,65536
mm v[56:59],a[156:159],a[104:107],v[56:59]
tr a[144:145],v222 offset:16384
bl v216,s[28:31],s55 offen offset:0 lds
mm v[60:63],a[152:155],a[100:103],v[60:63]
tr a[146:147],v222 offset:20480
mm v[60:63],a[156:159],a[108:111],v[60:63]
tr a[148:149],v222 offset:24576
s_waitcnt lgkmcnt(7)
mm v[0:3],a[128:131],a[112:115],v[0:3]
tr a[150:151],v222 offset:28672
mm v[0:3],a[132:135],a[120:123],v[0:3]
tr a[152:153],v223 offset:16384
mm v[4:7],a[128:131],a[116:119],v[4:7]
tr a[154:155],v223 offset:20480
bl v217,s[28:31],s55 offen offset:1024 lds
mm v[4:7],a[132:135],a[124:127],v[4:7]
tr a[156:157],v223 offset:24576
s_waitcnt lgkmcnt(7)
mm v[8:11],a[136:139],a[112:115],v[8:11]
tr a[158:159],v223 offset:28672
mm v[8:11],a[140:143],a[120:123],v[8:11]
tr a[128:129],v224 offset:16384
mm v[12:15],a[136:139],a[116:119],v[12:15]
tr a[130:131],v224 offset:20480
bl v218,s[28:31],s55 offen offset:2048 lds
mm v[12:15],a[140:143],a[124:127],v[12:15]
tr a[132:133],v224 offset:24576
s_waitcnt lgkmcnt(7)
mm v[16:19],a[144:147],a[112:115],v[16:19]
tr a[134:135],v224 offset:28672
mm v[16:19],a[148:151],a[120:123],v[16:19]
tr a[136:137],v225 offset:16384
mm v[20:23],a[144:147],a[116:119],v[20:23]
tr a[138:139],v225 offset:20480
bl v219,s[28:31],s55 offen offset:3072 lds
mm v[20:23],a[148:151],a[124:127],v[20:23]
tr a[140:141],v225 offset:24576
s_waitcnt lgkmcnt(7)
mm v[24:27],a[152:155],a[112:115],v[24:27]
tr a[142:143],v225 offset:28672
s_add_u32 s55,s55,131072
mm v[24:27],a[156:159],a[120:123],v[24:27]
tr a[144:145],v226 offset:16384
mm v[28:31],a[152:155],a[116:119],v[28:31]
tr a[146:147],v226 offset:20480
mm v[28:31],a[156:159],a[124:127],v[28:31]
tr a[148:149],v226 offset:24576
s_waitcnt lgkmcnt(7)
mm v[32:35],a[128:131],a[112:115],v[32:35]
tr a[150:151],v226 offset:28672
bl a[48:51],v212,s[8:11],s48 offen offset:0 sc1
mm v[32:35],a[132:135],a[120:123],v[32:35]
tr a[152:153],v227 offset:16384
s_waitcnt vmcnt(17)
mm v[36:39],a[128:131],a[116:119],v[36:39]
tr a[154:155],v227 offset:20480
s_barrier
mm v[36:39],a[132:135],a[124:127],v[36:39]
tr a[156:157],v227 offset:24576
s_waitcnt lgkmcnt(7)
mm v[40:43],a[136:139],a[112:115],v[40:43]
tr a[158:159],v227 offset:28672
bl a[52:55],v213,s[8:11],s48 offen offset:0 sc1
mm v[40:43],a[140:143],a[120:123],v[40:43]
tr a[128:129],v220 offset:32768
mm v[44:47],a[136:139],a[116:119],v[44:47]
tr a[130:131],v220 offset:36864
mm v[44:47],a[140:143],a[124:127],v[44:47]
tr a[132:133],v220 offset:40960
s_waitcnt lgkmcnt(7)
mm v[48:51],a[144:147],a[112:115],v[48:51]
tr a[134:135],v220 offset:45056
bl a[56:59],v212,s[8:11],s48 offen offset:1024 sc1
mm v[48:51],a[148:151],a[120:123],v[48:51]
tr a[136:137],v221 offset:32768
mm v[52:55],a[144:147],a[116:119],v[52:55]
tr a[138:139],v221 offset:36864
mm v[52:55],a[148:151],a[124:127],v[52:55]
tr a[140:141],v221 offset:40960
s_waitcnt lgkmcnt(7)
mm v[56:59],a[152:155],a[112:115],v[56:59]
tr a[142:143],v221 offset:45056
bl a[60:63],v213,s[8:11],s48 offen offset:1024 sc1
mm v[56:59],a[156:159],a[120:123],v[56:59]
tr a[144:145],v222 offset:32768
s_add_u32 s48,s48,2048
mm v[60:63],a[152:155],a[116:119],v[60:63]
tr a[146:147],v222 offset:36864
s_add_u32 m0,s50,81920
mm v[60:63],a[156:159],a[124:127],v[60:63]
tr a[148:149],v222 offset:40960
s_waitcnt lgkmcnt(7)
mm v[0:3],a[128:131],a[0:3],v[0:3]
tr a[150:151],v222 offset:45056
bl v216,s[28:31],s55 offen offset:0 lds
mm v[0:3],a[132:135],a[8:11],v[0:3]
tr a[152:153],v223 offset:32768
mm v[4:7],a[128:131],a[4:7],v[4:7]
tr a[154:155],v223 offset:36864
mm v[4:7],a[132:135],a[12:15],v[4:7]
tr a[156:157],v223 offset:40960
s_waitcnt lgkmcnt(7)
mm v[8:11],a[136:139],a[0:3],v[8:11]
tr a[158:159],v223 offset:45056
bl v217,s[28:31],s55 offen offset:1024 lds
mm v[8:11],a[140:143],a[8:11],v[8:11]
tr a[128:129],v224 offset:32768
mm v[12:15],a[136:139],a[4:7],v[12:15]
tr a[130:131],v224 offset:36864
mm v[12:15],a[140:143],a[12:15],v[12:15]
tr a[132:133],v224 offset:40960
s_waitcnt lgkmcnt(7)
mm v[16:19],a[144:147],a[0:3],v[16:19]
tr a[134:135],v224 offset:45056
mm v[16:19],a[148:151],a[8:11],v[16:19]
tr a[136:137],v225 offset:32768
bl v218,s[28:31],s55 offen offset:2048 lds
mm v[20:23],a[144:147],a[4:7],v[20:23]
tr a[138:139],v225 offset:36864
mm v[20:23],a[148:151],a[12:15],v[20:23]
tr a[140:141],v225 offset:40960
s_waitcnt lgkmcnt(7)
mm v[24:27],a[152:155],a[0:3],v[24:27]
tr a[142:143],v225 offset:45056
mm v[24:27],a[156:159],a[8:11],v[24:27]
tr a[144:145],v226 offset:32768
bl v219,s[28:31],s55 offen offset:3072 lds
mm v[28:31],a[152:155],a[4:7],v[28:31]
tr a[146:147],v226 offset:36864
s_add_u32 s55,s55,131072
mm v[28:31],a[156:159],a[12:15],v[28:31]
tr a[148:149],v226 offset:40960
s_waitcnt lgkmcnt(7)
mm v[32:35],a[128:131],a[0:3],v[32:35]
tr a[150:151],v226 offset:45056
mm v[32:35],a[132:135],a[8:11],v[32:35]
tr a[152:153],v227 offset:32768
s_waitcnt vmcnt(16)
mm v[36:39],a[128:131],a[4:7],v[36:39]
tr a[154:155],v227 offset:36864
s_barrier
mm v[36:39],a[132:135],a[12:15],v[36:39]
bl v[80:83],v112,s[8:11],s27 offen offset:0 sc1
s_waitcnt lgkmcnt(6)
mm v[40:43],a[136:139],a[0:3],v[40:43]
tr a[156:157],v227 offset:40960
tr a[158:159],v227 offset:45056
mm v[40:43],a[140:143],a[8:11],v[40:43]
tr a[128:129],v220 offset:49152
mm v[44:47],a[136:139],a[4:7],v[44:47]
tr a[130:131],v220 offset:53248
buffer_load_dwordx2 v[96:97],v113,s[40:43],0 offen offset:0
mm v[44:47],a[140:143],a[12:15],v[44:47]
tr a[132:133],v220 offset:57344
s_waitcnt lgkmcnt(7)
mm v[48:51],a[144:147],a[0:3],v[48:51]
tr a[134:135],v220 offset:61440
mm v[48:51],a[148:151],a[8:11],v[48:51]
tr a[136:137],v221 offset:49152
mm v[52:55],a[144:147],a[4:7],v[52:55]
tr a[138:139],v221 offset:53248
bl v[84:87],v112,s[8:11],s27 offen offset:64 sc1
mm v[52:55],a[148:151],a[12:15],v[52:55]
tr a[140:141],v221 offset:57344
s_waitcnt lgkmcnt(7)
mm v[56:59],a[152:155],a[0:3],v[56:59]
tr a[142:143],v221 offset:61440
mm v[56:59],a[156:159],a[8:11],v[56:59]
tr a[144:145],v222 offset:49152
mm v[60:63],a[152:155],a[4:7],v[60:63]
tr a[146:147],v222 offset:53248
mm v[60:63],a[156:159],a[12:15],v[60:63]
tr a[148:149],v222 offset:57344
s_waitcnt lgkmcnt(7)
mm v[0:3],a[128:131],a[16:19],v[0:3]
tr a[150:151],v222 offset:61440
buffer_load_dwordx2 v[98:99],v113,s[40:43],0 offen offset:32
mm v[0:3],a[132:135],a[24:27],v[0:3]
tr a[152:153],v223 offset:49152
mm v[4:7],a[128:131],a[20:23],v[4:7]
tr a[154:155],v223 offset:53248
mm v[4:7],a[132:135],a[28:31],v[4:7]
tr a[156:157],v223 offset:57344
s_waitcnt lgkmcnt(7)
mm v[8:11],a[136:139],a[16:19],v[8:11]
tr a[158:159],v223 offset:61440
bl v[88:91],v112,s[8:11],s27 offen offset:128 sc1
mm v[8:11],a[140:143],a[24:27],v[8:11]
tr a[128:129],v224 offset:49152
mm v[12:15],a[136:139],a[20:23],v[12:15]
tr a[130:131],v224 offset:53248
mm v[12:15],a[140:143],a[28:31],v[12:15]
tr a[132:133],v224 offset:57344
s_waitcnt lgkmcnt(7)
mm v[16:19],a[144:147],a[16:19],v[16:19]
tr a[134:135],v224 offset:61440
buffer_load_dwordx2 v[100:101],v113,s[40:43],0 offen offset:64
mm v[16:19],a[148:151],a[24:27],v[16:19]
tr a[136:137],v225 offset:49152
mm v[20:23],a[144:147],a[20:23],v[20:23]
tr a[138:139],v225 offset:53248
mm v[20:23],a[148:151],a[28:31],v[20:23]
tr a[140:141],v225 offset:57344
s_waitcnt lgkmcnt(7)
mm v[24:27],a[152:155],a[16:19],v[24:27]
tr a[142:143],v225 offset:61440
bl v[92:95],v112,s[8:11],s27 offen offset:192 sc1
mm v[24:27],a[156:159],a[24:27],v[24:27]
tr a[144:145],v226 offset:49152
mm v[28:31],a[152:155],a[20:23],v[28:31]
tr a[146:147],v226 offset:53248
mm v[28:31],a[156:159],a[28:31],v[28:31]
tr a[148:149],v226 offset:57344
s_waitcnt lgkmcnt(7)
mm v[32:35],a[128:131],a[16:19],v[32:35]
tr a[150:151],v226 offset:61440
buffer_load_dwordx2 v[102:103],v113,s[40:43],0 offen offset:96
mm v[32:35],a[132:135],a[24:27],v[32:35]
tr a[152:153],v227 offset:49152
s_waitcnt vmcnt(16)
mm v[36:39],a[128:131],a[20:23],v[36:39]
tr a[154:155],v227 offset:53248
s_barrier
mm v[36:39],a[132:135],a[28:31],v[36:39]
tr a[156:157],v227 offset:57344
s_waitcnt lgkmcnt(7)
mm v[40:43],a[136:139],a[16:19],v[40:43]
tr a[158:159],v227 offset:61440
bl v[64:67],v254,s[8:11],s52 offen offset:0 sc1
mm v[40:43],a[140:143],a[24:27],v[40:43]
tr a[128:129],v228 offset:0
mm v[44:47],a[136:139],a[20:23],v[44:47]
tr a[130:131],v228 offset:4096
mm v[44:47],a[140:143],a[28:31],v[44:47]
tr a[132:133],v228 offset:8192
s_waitcnt lgkmcnt(7)
mm v[48:51],a[144:147],a[16:19],v[48:51]
tr a[134:135],v228 offset:12288
mm v[48:51],a[148:151],a[24:27],v[48:51]
tr a[136:137],v229 offset:0
bl v[68:71],v254,s[8:11],s52 offen offset:1024 sc1
mm v[52:55],a[144:147],a[20:23],v[52:55]
tr a[138:139],v229 offset:4096
mm v[52:55],a[148:151],a[28:31],v[52:55]
tr a[140:141],v229 offset:8192
s_waitcnt lgkmcnt(7)
mm v[56:59],a[152:155],a[16:19],v[56:59]
tr a[142:143],v229 offset:12288
mm v[56:59],a[156:159],a[24:27],v[56:59]
tr a[144:145],v230 offset:0
bl v[72:75],v254,s[8:11],s53 offen offset:0 sc1
mm v[60:63],a[152:155],a[20:23],v[60:63]
tr a[146:147],v230 offset:4096
mm v[60:63],a[156:159],a[28:31],v[60:63]
tr a[148:149],v230 offset:8192
s_waitcnt lgkmcnt(7)
mm v[0:3],a[128:131],a[32:35],v[0:3]
tr a[150:151],v230 offset:12288
mm v[0:3],a[132:135],a[40:43],v[0:3]
tr a[152:153],v231 offset:0
bl v[76:79],v254,s[8:11],s53 offen offset:1024 sc1
mm v[4:7],a[128:131],a[36:39],v[4:7]
tr a[154:155],v231 offset:4096
mm v[4:7],a[132:135],a[44:47],v[4:7]
tr a[156:157],v231 offset:8192
s_waitcnt lgkmcnt(7)
mm v[8:11],a[136:139],a[32:35],v[8:11]
tr a[158:159],v231 offset:12288
mm v[8:11],a[140:143],a[40:43],v[8:11]
tr a[128:129],v232 offset:0
mm v[12:15],a[136:139],a[36:39],v[12:15]
tr a[130:131],v232 offset:4096
mm v[12:15],a[140:143],a[44:47],v[12:15]
tr a[132:133],v232 offset:8192
s_waitcnt lgkmcnt(7)
mm v[16:19],a[144:147],a[32:35],v[16:19]
tr a[134:135],v232 offset:12288
mm v[16:19],a[148:151],a[40:43],v[16:19]
tr a[136:137],v233 offset:0
mm v[20:23],a[144:147],a[36:39],v[20:23]
tr a[138:139],v233 offset:4096
mm v[20:23],a[148:151],a[44:47],v[20:23]
tr a[140:141],v233 offset:8192
s_waitcnt lgkmcnt(7)
mm v[24:27],a[152:155],a[32:35],v[24:27]
tr a[142:143],v233 offset:12288
mm v[24:27],a[156:159],a[40:43],v[24:27]
tr a[144:145],v234 offset:0
mm v[28:31],a[152:155],a[36:39],v[28:31]
tr a[146:147],v234 offset:4096
mm v[28:31],a[156:159],a[44:47],v[28:31]
tr a[148:149],v234 offset:8192
s_waitcnt lgkmcnt(7)
mm v[32:35],a[128:131],a[32:35],v[32:35]
tr a[150:151],v234 offset:12288
mm v[32:35],a[132:135],a[40:43],v[32:35]
tr a[152:153],v235 offset:0
s_waitcnt vmcnt(12)
mm v[36:39],a[128:131],a[36:39],v[36:39]
tr a[154:155],v235 offset:4096
s_barrier
mm v[36:39],a[132:135],a[44:47],v[36:39]
tr a[156:157],v235 offset:8192
s_waitcnt lgkmcnt(7)
mm v[40:43],a[136:139],a[32:35],v[40:43]
tr a[158:159],v235 offset:12288
mm v[40:43],a[140:143],a[40:43],v[40:43]
tr a[128:129],v228 offset:16384
mm v[44:47],a[136:139],a[36:39],v[44:47]
tr a[130:131],v228 offset:20480
mm v[44:47],a[140:143],a[44:47],v[44:47]
tr a[132:133],v228 offset:24576
s_waitcnt lgkmcnt(7)
mm v[48:51],a[144:147],a[32:35],v[48:51]
tr a[134:135],v228 offset:28672
mm v[48:51],a[148:151],a[40:43],v[48:51]
tr a[136:137],v229 offset:16384
mm v[52:55],a[144:147],a[36:39],v[52:55]
tr a[138:139],v229 offset:20480
mm v[52:55],a[148:151],a[44:47],v[52:55]
tr a[140:141],v229 offset:24576
s_waitcnt lgkmcnt(7)
mm v[56:59],a[152:155],a[32:35],v[56:59]
tr a[142:143],v229 offset:28672
mm v[56:59],a[156:159],a[40:43],v[56:59]
tr a[144:145],v230 offset:16384
mm v[60:63],a[152:155],a[36:39],v[60:63]
tr a[146:147],v230 offset:20480
mm v[60:63],a[156:159],a[44:47],v[60:63]
tr a[148:149],v230 offset:24576
s_waitcnt lgkmcnt(7)
mm v[0:3],a[128:131],a[48:51],v[0:3]
tr a[150:151],v230 offset:28672
mm v[0:3],a[132:135],a[56:59],v[0:3]
tr a[152:153],v231 offset:16384
mm v[4:7],a[128:131],a[52:55],v[4:7]
tr a[154:155],v231 offset:20480
mm v[4:7],a[132:135],a[60:63],v[4:7]
tr a[156:157],v231 offset:24576
s_waitcnt lgkmcnt(7)
mm v[8:11],a[136:139],a[48:51],v[8:11]
tr a[158:159],v231 offset:28672
mm v[8:11],a[140:143],a[56:59],v[8:11]
tr a[128:129],v232 offset:16384
mm v[12:15],a[136:139],a[52:55],v[12:15]
tr a[130:131],v232 offset:20480
mm v[12:15],a[140:143],a[60:63],v[12:15]
tr a[132:133],v232 offset:24576
s_waitcnt lgkmcnt(7)
mm v[16:19],a[144:147],a[48:51],v[16:19]
tr a[134:135],v232 offset:28672
mm v[16:19],a[148:151],a[56:59],v[16:19]
tr a[136:137],v233 offset:16384
mm v[20:23],a[144:147],a[52:55],v[20:23]
tr a[138:139],v233 offset:20480
mm v[20:23],a[148:151],a[60:63],v[20:23]
tr a[140:141],v233 offset:24576
s_waitcnt lgkmcnt(7)
mm v[24:27],a[152:155],a[48:51],v[24:27]
tr a[142:143],v233 offset:28672
mm v[24:27],a[156:159],a[56:59],v[24:27]
tr a[144:145],v234 offset:16384
mm v[28:31],a[152:155],a[52:55],v[28:31]
tr a[146:147],v234 offset:20480
mm v[28:31],a[156:159],a[60:63],v[28:31]
tr a[148:149],v234 offset:24576
s_waitcnt lgkmcnt(7)
mm v[32:35],a[128:131],a[48:51],v[32:35]
tr a[150:151],v234 offset:28672
mm v[32:35],a[132:135],a[56:59],v[32:35]
tr a[152:153],v235 offset:16384
mm v[36:39],a[128:131],a[52:55],v[36:39]
tr a[154:155],v235 offset:20480
mm v[36:39],a[132:135],a[60:63],v[36:39]
tr a[156:157],v235 offset:24576
s_waitcnt lgkmcnt(7)
mm v[40:43],a[136:139],a[48:51],v[40:43]
tr a[158:159],v235 offset:28672
mm v[40:43],a[140:143],a[56:59],v[40:43]
mm v[44:47],a[136:139],a[52:55],v[44:47]
mm v[44:47],a[140:143],a[60:63],v[44:47]
s_waitcnt lgkmcnt(4)
mm v[48:51],a[144:147],a[48:51],v[48:51]
mm v[48:51],a[148:151],a[56:59],v[48:51]
mm v[52:55],a[144:147],a[52:55],v[52:55]
mm v[52:55],a[148:151],a[60:63],v[52:55]
s_waitcnt lgkmcnt(0)
mm v[56:59],a[152:155],a[48:51],v[56:59]
mm v[56:59],a[156:159],a[56:59],v[56:59]
mm v[60:63],a[152:155],a[52:55],v[60:63]
mm v[60:63],a[156:159],a[60:63],v[60:63]
tail_Depi:
cv v32,v32,v33
cv v33,v34,v35
cv v34,v40,v41
cv v35,v42,v43
buffer_store_dwordx4 v[32:35],v254,s[8:11],s56 offen offset:0 sc1
cv v48,v48,v49
cv v49,v50,v51
cv v50,v56,v57
cv v51,v58,v59
buffer_store_dwordx4 v[48:51],v254,s[8:11],s56 offen offset:1024 sc1
cv v36,v36,v37
cv v37,v38,v39
cv v38,v44,v45
cv v39,v46,v47
buffer_store_dwordx4 v[36:39],v254,s[8:11],s56 offen offset:2048 sc1
cv v52,v52,v53
cv v53,v54,v55
cv v54,v60,v61
cv v55,v62,v63
buffer_store_dwordx4 v[52:55],v254,s[8:11],s56 offen offset:3072 sc1
s_waitcnt vmcnt(14)
v_and_b32 v169,0xffff0000,v96
v_lshlrev_b32 v168,16,v96
v_and_b32 v171,0xffff0000,v97
v_lshlrev_b32 v170,16,v97
s_waitcnt vmcnt(12)
v_and_b32 v173,0xffff0000,v98
v_lshlrev_b32 v172,16,v98
v_and_b32 v175,0xffff0000,v99
v_lshlrev_b32 v174,16,v99
s_waitcnt vmcnt(10)
v_and_b32 v177,0xffff0000,v100
v_lshlrev_b32 v176,16,v100
v_and_b32 v179,0xffff0000,v101
v_lshlrev_b32 v178,16,v101
s_waitcnt vmcnt(8)
v_and_b32 v181,0xffff0000,v102
v_lshlrev_b32 v180,16,v102
v_and_b32 v183,0xffff0000,v103
v_lshlrev_b32 v182,16,v103
s_waitcnt vmcnt(7)
v_and_b32 v121,0xffff0000,v64
v_lshlrev_b32 v120,16,v64
v_and_b32 v123,0xffff0000,v65
v_lshlrev_b32 v122,16,v65
v_pk_add_f32 v[0:1],v[0:1],v[168:169]
v_pk_add_f32 v[2:3],v[2:3],v[170:171]
v_pk_fma_f32 v[120:121],v[0:1],v[80:81],v[120:121]
v_pk_fma_f32 v[122:123],v[2:3],v[82:83],v[122:123]
v_and_b32 v129,0xffff0000,v66
v_lshlrev_b32 v128,16,v66
v_and_b32 v131,0xffff0000,v67
v_lshlrev_b32 v130,16,v67
v_pk_add_f32 v[8:9],v[8:9],v[172:173]
v_pk_add_f32 v[10:11],v[10:11],v[174:175]
v_pk_fma_f32 v[128:129],v[8:9],v[84:85],v[128:129]
v_pk_fma_f32 v[130:131],v[10:11],v[86:87],v[130:131]
s_waitcnt vmcnt(6)
v_and_b32 v137,0xffff0000,v68
v_lshlrev_b32 v136,16,v68
v_and_b32 v139,0xffff0000,v69
v_lshlrev_b32 v138,16,v69
v_pk_add_f32 v[16:17],v[16:17],v[176:177]
v_pk_add_f32 v[18:19],v[18:19],v[178:179]
v_pk_fma_f32 v[136:137],v[16:17],v[88:89],v[136:137]
v_pk_fma_f32 v[138:139],v[18:19],v[90:91],v[138:139]
v_and_b32 v145,0xffff0000,v70
v_lshlrev_b32 v144,16,v70
v_and_b32 v147,0xffff0000,v71
v_lshlrev_b32 v146,16,v71
v_pk_add_f32 v[24:25],v[24:25],v[180:181]
v_pk_add_f32 v[26:27],v[26:27],v[182:183]
v_pk_fma_f32 v[144:145],v[24:25],v[92:93],v[144:145]
v_pk_fma_f32 v[146:147],v[26:27],v[94:95],v[146:147]
s_waitcnt vmcnt(5)
v_and_b32 v125,0xffff0000,v72
v_lshlrev_b32 v124,16,v72
v_and_b32 v127,0xffff0000,v73
v_lshlrev_b32 v126,16,v73
v_pk_add_f32 v[4:5],v[4:5],v[168:169]
v_pk_add_f32 v[6:7],v[6:7],v[170:171]
v_pk_fma_f32 v[124:125],v[4:5],v[80:81],v[124:125]
v_pk_fma_f32 v[126:127],v[6:7],v[82:83],v[126:127]
v_and_b32 v133,0xffff0000,v74
v_lshlrev_b32 v132,16,v74
v_and_b32 v135,0xffff0000,v75
v_lshlrev_b32 v134,16,v75
v_pk_add_f32 v[12:13],v[12:13],v[172:173]
v_pk_add_f32 v[14:15],v[14:15],v[174:175]
v_pk_fma_f32 v[132:133],v[12:13],v[84:85],v[132:133]
v_pk_fma_f32 v[134:135],v[14:15],v[86:87],v[134:135]
s_waitcnt vmcnt(4)
v_and_b32 v141,0xffff0000,v76
v_lshlrev_b32 v140,16,v76
v_and_b32 v143,0xffff0000,v77
v_lshlrev_b32 v142,16,v77
v_pk_add_f32 v[20:21],v[20:21],v[176:177]
v_pk_add_f32 v[22:23],v[22:23],v[178:179]
v_pk_fma_f32 v[140:141],v[20:21],v[88:89],v[140:141]
v_pk_fma_f32 v[142:143],v[22:23],v[90:91],v[142:143]
v_and_b32 v149,0xffff0000,v78
v_lshlrev_b32 v148,16,v78
v_and_b32 v151,0xffff0000,v79
v_lshlrev_b32 v150,16,v79
v_pk_add_f32 v[28:29],v[28:29],v[180:181]
v_pk_add_f32 v[30:31],v[30:31],v[182:183]
v_pk_fma_f32 v[148:149],v[28:29],v[92:93],v[148:149]
v_pk_fma_f32 v[150:151],v[30:31],v[94:95],v[150:151]
s_waitcnt vmcnt(0)
v_mov_b32 v204,0
v_mov_b32 v205,1
s_barrier
s_cmp_lg_u32 s20,0
s_cbranch_scc1 tail_gb4_a
s_mov_b64 exec,1
buffer_atomic_add v205,v204,s[8:11],s62 offen offset:0 sc1
s_mov_b64 exec,-1
tail_gb4_a:
s_cmp_lg_u32 s20,0
s_cbranch_scc1 tail_gb4_w
s_mov_b64 exec,1
s_mov_b32 s59,0x40000
tail_gb4_p:
buffer_load_dword v206,v204,s[8:11],s63 offen offset:0 sc1
s_waitcnt vmcnt(0)
v_readfirstlane_b32 s60,v206
s_sub_u32 s59,s59,1
s_cmp_eq_u32 s59,0
s_cbranch_scc1 tail_gb4_g
s_cmp_lt_u32 s60,1
s_cbranch_scc1 tail_gb4_p
tail_gb4_g:
s_mov_b64 exec,-1
tail_gb4_w:
s_barrier
bl v[184:187],v254,s[8:11],s61 offen offset:0 sc1
bl v[188:191],v254,s[8:11],s61 offen offset:1024 sc1
bl v[192:195],v254,s[8:11],s61 offen offset:2048 sc1
bl v[196:199],v254,s[8:11],s61 offen offset:3072 sc1
s_mov_b32 s24,32768
s_waitcnt vmcnt(3)
v_and_b32 v1,0xffff0000,v184
v_lshlrev_b32 v0,16,v184
v_and_b32 v3,0xffff0000,v185
v_lshlrev_b32 v2,16,v185
v_and_b32 v5,0xffff0000,v186
v_lshlrev_b32 v4,16,v186
v_and_b32 v7,0xffff0000,v187
v_lshlrev_b32 v6,16,v187
v_pk_fma_f32 v[0:1],v[0:1],v[80:81],v[120:121]
v_pk_fma_f32 v[2:3],v[2:3],v[82:83],v[122:123]
v_pk_fma_f32 v[4:5],v[4:5],v[84:85],v[128:129]
v_pk_fma_f32 v[6:7],v[6:7],v[86:87],v[130:131]
cv v32,v0,v1
cv v33,v2,v3
cv v34,v4,v5
cv v35,v6,v7
s_nop 0
v_permlane16_swap_b32 v32,v34
v_permlane16_swap_b32 v33,v35
buffer_store_dwordx4 v[32:35],v114,s[44:47],0 offen offset:0 sc1
s_waitcnt vmcnt(3)
v_and_b32 v9,0xffff0000,v188
v_lshlrev_b32 v8,16,v188
v_and_b32 v11,0xffff0000,v189
v_lshlrev_b32 v10,16,v189
v_and_b32 v13,0xffff0000,v190
v_lshlrev_b32 v12,16,v190
v_and_b32 v15,0xffff0000,v191
v_lshlrev_b32 v14,16,v191
v_pk_fma_f32 v[8:9],v[8:9],v[88:89],v[136:137]
v_pk_fma_f32 v[10:11],v[10:11],v[90:91],v[138:139]
v_pk_fma_f32 v[12:13],v[12:13],v[92:93],v[144:145]
v_pk_fma_f32 v[14:15],v[14:15],v[94:95],v[146:147]
cv v36,v8,v9
cv v37,v10,v11
cv v38,v12,v13
cv v39,v14,v15
s_nop 0
v_permlane16_swap_b32 v36,v38
v_permlane16_swap_b32 v37,v39
buffer_store_dwordx4 v[36:39],v114,s[44:47],0 offen offset:64 sc1
s_waitcnt vmcnt(3)
v_and_b32 v17,0xffff0000,v192
v_lshlrev_b32 v16,16,v192
v_and_b32 v19,0xffff0000,v193
v_lshlrev_b32 v18,16,v193
v_and_b32 v21,0xffff0000,v194
v_lshlrev_b32 v20,16,v194
v_and_b32 v23,0xffff0000,v195
v_lshlrev_b32 v22,16,v195
v_pk_fma_f32 v[16:17],v[16:17],v[80:81],v[124:125]
v_pk_fma_f32 v[18:19],v[18:19],v[82:83],v[126:127]
v_pk_fma_f32 v[20:21],v[20:21],v[84:85],v[132:133]
v_pk_fma_f32 v[22:23],v[22:23],v[86:87],v[134:135]
cv v40,v16,v17
cv v41,v18,v19
cv v42,v20,v21
cv v43,v22,v23
s_nop 0
v_permlane16_swap_b32 v40,v42
v_permlane16_swap_b32 v41,v43
buffer_store_dwordx4 v[40:43],v114,s[44:47],s24 offen offset:0 sc1
s_waitcnt vmcnt(3)
v_and_b32 v25,0xffff0000,v196
v_lshlrev_b32 v24,16,v196
v_and_b32 v27,0xffff0000,v197
v_lshlrev_b32 v26,16,v197
v_and_b32 v29,0xffff0000,v198
v_lshlrev_b32 v28,16,v198
v_and_b32 v31,0xffff0000,v199
v_lshlrev_b32 v30,16,v199
v_pk_fma_f32 v[24:25],v[24:25],v[88:89],v[140:141]
v_pk_fma_f32 v[26:27],v[26:27],v[90:91],v[142:143]
v_pk_fma_f32 v[28:29],v[28:29],v[92:93],v[148:149]
v_pk_fma_f32 v[30:31],v[30:31],v[94:95],v[150:151]
cv v44,v24,v25
cv v45,v26,v27
cv v46,v28,v29
cv v47,v30,v31
s_nop 0
v_permlane16_swap_b32 v44,v46
v_permlane16_swap_b32 v45,v47
buffer_store_dwordx4 v[44:47],v114,s[44:47],s24 offen offset:64 sc1
tail_end:
s_endpgm
tail_allspin:
s_mov_b32 s59,0x40000
tail_allspin_l:
buffer_load_dword v210,v209,s[8:11],s61 offen sc1
s_waitcnt vmcnt(0)
s_sub_u32 s59,s59,1
s_cmp_eq_u32 s59,0
s_cbranch_scc1 tail_allok
v_cmp_gt_u32 vcc,16,v210
s_nop 0
s_cbranch_vccnz tail_allspin_l
s_branch tail_allok
tail_xspin:
s_mov_b32 s59,0x40000
tail_xspin_l:
buffer_load_dword v210,v204,s[8:11],s57 offen offset:1536 sc1
s_waitcnt vmcnt(0)
s_sub_u32 s59,s59,1
s_cmp_eq_u32 s59,0
s_cbranch_scc1 tail_xok
v_cmp_gt_u32 vcc,16,v210
s_nop 0
s_cbranch_vccnz tail_xspin_l
s_branch tail_xok
.section .rodata,"a"
.p2align 6
.amdhsa_kernel adaLN_cond__mha_block_cached__mixer_channel_mlp__prompt_kernel
  .amdhsa_next_free_vgpr 512
  .amdhsa_next_free_sgpr 102
  .amdhsa_accum_offset 256
  .amdhsa_group_segment_fixed_size 0
  .amdhsa_kernarg_size 120
  .amdhsa_user_sgpr_count 2
  .amdhsa_user_sgpr_kernarg_segment_ptr 1
  .amdhsa_system_sgpr_workgroup_id_x 1
  .amdhsa_float_denorm_mode_32 3
  .amdhsa_float_denorm_mode_16_64 3
.end_amdhsa_kernel
```
